```python
import torch

def _softmax(x, axis=-1):
    return torch.softmax(x, dim=axis)

def _gelu(x):
    return torch.nn.functional.gelu(x, approximate='tanh')

def _silu(x):
    return torch.nn.functional.silu(x)

def _sigmoid(x):
    return torch.sigmoid(x)

def _layernorm(x, axis=-1, eps=1e-05):
    m = x.mean(dim=axis, keepdim=True)
    v = x.var(dim=axis, keepdim=True, unbiased=False)
    return (x - m) / torch.sqrt(v + eps)

def _scatter_add(tgt, idx, src, axis=0):
    return tgt.clone().index_add_(axis, idx, src)

def _segment_sum(src, seg, n):
    out = torch.zeros((n,) + src.shape[1:], dtype=src.dtype)
    return out.index_add_(0, seg, src)

def _pad(x, pw):
    flat = tuple((v for pair in reversed(pw) for v in pair))
    return torch.nn.functional.pad(x, flat)
kernel_name = 'sequential_preLN__memory_aug_recurrent_mem_tr__mixer_s_mlp__prompt'

def setup_inputs():

    _w = lambda a: (lambda t: t.to(torch.bfloat16) if t.is_floating_point() else t)(torch.as_tensor(a))

    def _A_setup():
        B, S, Dm = (1, 2048, 576)
        H, Dh = (32, 128)
        M, seg = (8, 32)
        seg = min(seg, S)
        S = S // seg * seg
        return {'x': _w((lambda *s: torch.randn(*s, dtype=torch.bfloat16) * 0.05)(B, S, Dm)), 'mem0': _w((lambda *s: torch.randn(*s, dtype=torch.bfloat16) * 0.2)(B, M, Dm)), 'Wq': _w((lambda *s: torch.randn(*s, dtype=torch.bfloat16) * 1.6)(Dm, H, Dh) * Dm ** (-0.5)), 'Wk': _w((lambda *s: torch.randn(*s, dtype=torch.bfloat16) * 1.6)(Dm, H, Dh) * Dm ** (-0.5)), 'Wv': _w((lambda *s: torch.randn(*s, dtype=torch.bfloat16) * 0.2)(Dm, H, Dh) * Dm ** (-0.5)), 'Wo': _w((lambda *s: torch.randn(*s, dtype=torch.bfloat16) * 0.2)(H, Dh, Dm) * (H * Dh) ** (-0.5)), 'seg_len': seg}
    _A_in = _A_setup()

    def _B_setup():
        B, S, D, F = (1, 2048, 576, 4608)
        return {'x': _w((lambda *s: torch.randn(*s, dtype=torch.bfloat16) * 0.05)(B, S, D)), 'w1': _w((lambda *s: torch.randn(*s, dtype=torch.bfloat16) * 0.8)(D, D) * D ** (-0.5)), 'w2': _w((lambda *s: torch.randn(*s, dtype=torch.bfloat16) * 0.8)(D, D) * D ** (-0.5)), 'w3': _w((lambda *s: torch.randn(*s, dtype=torch.bfloat16) * 0.8)(D, F) * D ** (-0.5)), 'w4': _w((lambda *s: torch.randn(*s, dtype=torch.bfloat16) * 0.8)(F, D) * F ** (-0.5))}
    _B_in = _B_setup()
    return {'A_x': _A_in['x'], 'A_mem0': _A_in['mem0'], 'A_Wq': _A_in['Wq'], 'A_Wk': _A_in['Wk'], 'A_Wv': _A_in['Wv'], 'A_Wo': _A_in['Wo'], 'A_seg_len': _A_in['seg_len'], 'B_x': _B_in['x'], 'B_w1': _B_in['w1'], 'B_w2': _B_in['w2'], 'B_w3': _B_in['w3'], 'B_w4': _B_in['w4']}

def reference(A_x, A_mem0, A_Wq, A_Wk, A_Wv, A_Wo, A_seg_len, B_x, B_w1, B_w2, B_w3, B_w4):

    def _A_ref(x, mem0, Wq, Wk, Wv, Wo, seg_len):
        B, S, Dm = x.shape
        H, Dh = (Wq.shape[1], Wq.shape[2])
        M = mem0.shape[1]
        scale = Dh ** (-0.5)
        n_seg = S // seg_len
        L = M + seg_len
        idx = torch.arange(L)
        mask = (idx[:, None] < M) | (idx[:, None] >= idx[None, :])
        mem = mem0
        outs = []
        for s in range(n_seg):
            xs = x[:, s * seg_len:(s + 1) * seg_len, :].clone()
            h = torch.concatenate([mem, xs], axis=1)
            q = torch.einsum('btd,dhe->bhte', h, Wq)
            k = torch.einsum('btd,dhe->bhte', h, Wk)
            v = torch.einsum('btd,dhe->bhte', h, Wv)
            scores = torch.einsum('bhqe,bhke->bhqk', q, k) * scale
            scores = torch.where(mask[None, None], scores, -1000000000.0)
            p = _softmax(scores, axis=-1)
            o = torch.einsum('bhqk,bhke->bhqe', p, v)
            o = torch.einsum('bhte,hed->btd', o, Wo)
            mem = o[:, :M, :].clone()
            outs.append(o[:, M:, :])
        return torch.concatenate(outs, axis=1)

    def _B_ref(x, w1, w2, w3, w4):
        B, S, D = x.shape
        h = _gelu(_layernorm(x, axis=-1) @ w1)
        c = D // 4
        g0 = _pad(h[:, :, 0 * c:1 * c], ((0, 0), (1, 0), (0, 0)))[:, :S, :]
        g1 = _pad(h[:, :, 1 * c:2 * c], ((0, 0), (0, 1), (0, 0)))[:, 1:, :]
        g2 = _pad(h[:, :, 2 * c:3 * c], ((0, 0), (2, 0), (0, 0)))[:, :S, :]
        g3 = _pad(h[:, :, 3 * c:], ((0, 0), (0, 2), (0, 0)))[:, 2:, :]
        hs = torch.concatenate([g0, g1, g2, g3], axis=-1) @ w2
        x1 = x + hs
        h2 = _gelu(_layernorm(x1, axis=-1) @ w3) @ w4
        return x1 + h2
    x = A_x
    h = x + _A_ref(_layernorm(x, axis=-1), A_mem0, A_Wq, A_Wk, A_Wv, A_Wo, A_seg_len)
    h2 = h + _B_ref(_layernorm(h, axis=-1), B_w1, B_w2, B_w3, B_w4)
    return h2
```

```asm
; @launch grid=(256,1,1) block=(256,1,1) lds=163840
.amdgcn_target "amdgcn-amd-amdhsa--gfx950"
.text
.globl sequential_preLN__memory_aug_recurrent_mem_tr__mixer_s_mlp__prompt_kernel
.p2align 8
.type sequential_preLN__memory_aug_recurrent_mem_tr__mixer_s_mlp__prompt_kernel,@function
sequential_preLN__memory_aug_recurrent_mem_tr__mixer_s_mlp__prompt_kernel:
  s_cmp_ge_u32 s2, 256
  s_cbranch_scc1 L_end
  s_load_dwordx2 s[12:13], s[0:1], 104
  s_mov_b32 s14, 0x100
  s_mov_b32 s15, 0x00020000
  s_waitcnt lgkmcnt(0)
  s_and_b32 s13, s13, 0xffff
  s_load_dwordx2 s[4:5], s[0:1], 112
  s_mov_b32 s6, 0x10000000
  s_mov_b32 s7, 0x00020000
  s_waitcnt lgkmcnt(0)
  s_and_b32 s5, s5, 0xffff
  v_lshrrev_b32 v1, 6, v0
  s_nop 0
  v_readfirstlane_b32 s17, v1
  s_nop 1
  s_cmp_eq_u32 s17, 0
  s_cbranch_scc0 L_el2_w0_2
  s_getreg_b32 s24, hwreg(HW_REG_XCC_ID, 0, 4)
  s_min_u32 s25, s24, 8
  s_lshl_b32 s26, s25, 4
  s_cmp_ge_u32 s24, 8
  s_cselect_b32 s26, 124, s26
  v_mov_b32 v1, s26
  v_mov_b32 v2, 1
  s_mov_b64 exec, 1
  buffer_atomic_add v2, v1, s[12:15], 0 offen sc0
  s_waitcnt vmcnt(0)
  v_readfirstlane_b32 s27, v2
  s_mov_b64 exec, -1
  s_cmp_ge_u32 s24, 8
  s_cbranch_scc1 L_el2_ovf_3
  s_cmp_lt_u32 s27, 32
  s_cbranch_scc1 L_el2_ok_1
L_el2_ovf_3:
  v_mov_b32 v1, 144
  v_mov_b32 v2, 1
  s_mov_b64 exec, 1
  buffer_atomic_add v2, v1, s[12:15], 0 offen sc0
  s_waitcnt vmcnt(0)
  v_readfirstlane_b32 s28, v2
  s_mov_b64 exec, -1
  v_mbcnt_lo_u32_b32 v3, -1, 0
  v_mbcnt_hi_u32_b32 v3, -1, v3
  v_min_u32 v4, 8, v3
  v_lshlrev_b32 v4, 4, v4
  v_mov_b32 v5, 124
  v_cmp_lt_u32 vcc, 7, v3
  s_nop 1
  v_cndmask_b32 v4, v4, v5, vcc
  s_mov_b32 s29, 262144
L_el2_lp_4:
  buffer_load_dword v6, v4, s[12:15], 0 offen sc1
  s_waitcnt vmcnt(0)
  s_mov_b32 s30, 0
  v_readlane_b32 s31, v6, 0
  s_nop 0
  s_add_u32 s30, s30, s31
  v_readlane_b32 s31, v6, 1
  s_nop 0
  s_add_u32 s30, s30, s31
  v_readlane_b32 s31, v6, 2
  s_nop 0
  s_add_u32 s30, s30, s31
  v_readlane_b32 s31, v6, 3
  s_nop 0
  s_add_u32 s30, s30, s31
  v_readlane_b32 s31, v6, 4
  s_nop 0
  s_add_u32 s30, s30, s31
  v_readlane_b32 s31, v6, 5
  s_nop 0
  s_add_u32 s30, s30, s31
  v_readlane_b32 s31, v6, 6
  s_nop 0
  s_add_u32 s30, s30, s31
  v_readlane_b32 s31, v6, 7
  s_nop 0
  s_add_u32 s30, s30, s31
  v_readlane_b32 s31, v6, 8
  s_nop 0
  s_add_u32 s30, s30, s31
  s_cmp_ge_u32 s30, 256
  s_cbranch_scc1 L_el2_got_5
  s_sleep 8
  s_sub_u32 s29, s29, 1
  s_cmp_lg_u32 s29, 0
  s_cbranch_scc1 L_el2_lp_4
  s_branch L_fail
L_el2_got_5:
  v_readlane_b32 s31, v6, 0
  s_nop 0
  s_min_u32 s31, s31, 32
  s_sub_u32 s32, 32, s31
  s_cmp_lt_u32 s28, s32
  s_cbranch_scc0 L_el2_nx_6
  s_mov_b32 s24, 0
  s_add_u32 s27, s31, s28
  s_branch L_el2_ok_1
L_el2_nx_6:
  s_sub_u32 s28, s28, s32
  v_readlane_b32 s31, v6, 1
  s_nop 0
  s_min_u32 s31, s31, 32
  s_sub_u32 s32, 32, s31
  s_cmp_lt_u32 s28, s32
  s_cbranch_scc0 L_el2_nx_7
  s_mov_b32 s24, 1
  s_add_u32 s27, s31, s28
  s_branch L_el2_ok_1
L_el2_nx_7:
  s_sub_u32 s28, s28, s32
  v_readlane_b32 s31, v6, 2
  s_nop 0
  s_min_u32 s31, s31, 32
  s_sub_u32 s32, 32, s31
  s_cmp_lt_u32 s28, s32
  s_cbranch_scc0 L_el2_nx_8
  s_mov_b32 s24, 2
  s_add_u32 s27, s31, s28
  s_branch L_el2_ok_1
L_el2_nx_8:
  s_sub_u32 s28, s28, s32
  v_readlane_b32 s31, v6, 3
  s_nop 0
  s_min_u32 s31, s31, 32
  s_sub_u32 s32, 32, s31
  s_cmp_lt_u32 s28, s32
  s_cbranch_scc0 L_el2_nx_9
  s_mov_b32 s24, 3
  s_add_u32 s27, s31, s28
  s_branch L_el2_ok_1
L_el2_nx_9:
  s_sub_u32 s28, s28, s32
  v_readlane_b32 s31, v6, 4
  s_nop 0
  s_min_u32 s31, s31, 32
  s_sub_u32 s32, 32, s31
  s_cmp_lt_u32 s28, s32
  s_cbranch_scc0 L_el2_nx_10
  s_mov_b32 s24, 4
  s_add_u32 s27, s31, s28
  s_branch L_el2_ok_1
L_el2_nx_10:
  s_sub_u32 s28, s28, s32
  v_readlane_b32 s31, v6, 5
  s_nop 0
  s_min_u32 s31, s31, 32
  s_sub_u32 s32, 32, s31
  s_cmp_lt_u32 s28, s32
  s_cbranch_scc0 L_el2_nx_11
  s_mov_b32 s24, 5
  s_add_u32 s27, s31, s28
  s_branch L_el2_ok_1
L_el2_nx_11:
  s_sub_u32 s28, s28, s32
  v_readlane_b32 s31, v6, 6
  s_nop 0
  s_min_u32 s31, s31, 32
  s_sub_u32 s32, 32, s31
  s_cmp_lt_u32 s28, s32
  s_cbranch_scc0 L_el2_nx_12
  s_mov_b32 s24, 6
  s_add_u32 s27, s31, s28
  s_branch L_el2_ok_1
L_el2_nx_12:
  s_sub_u32 s28, s28, s32
  v_readlane_b32 s31, v6, 7
  s_nop 0
  s_min_u32 s31, s31, 32
  s_sub_u32 s32, 32, s31
  s_cmp_lt_u32 s28, s32
  s_cbranch_scc0 L_el2_nx_13
  s_mov_b32 s24, 7
  s_add_u32 s27, s31, s28
  s_branch L_el2_ok_1
L_el2_nx_13:
  s_sub_u32 s28, s28, s32
  s_branch L_fail
L_el2_ok_1:
  v_mov_b32 v1, 0
  v_mov_b32 v2, s24
  v_mov_b32 v3, s27
  s_mov_b64 exec, 1
  ds_write_b64 v1, v[2:3]
  s_mov_b64 exec, -1
  s_waitcnt lgkmcnt(0)
L_el2_w0_2:
  s_barrier
  v_mov_b32 v1, 0
  ds_read_b64 v[2:3], v1
  s_waitcnt lgkmcnt(0)
  v_readfirstlane_b32 s20, v2
  v_readfirstlane_b32 s21, v3
  s_barrier
  s_cmp_eq_u32 s20, 0
  s_cbranch_scc0 L_worker
  s_mov_b32 s16, s21
  v_mov_b32 v2, -1
  v_mov_b32 v3, -1
  v_mov_b32 v4, -1
  v_mov_b32 v5, -1
  v_lshlrev_b32 v1, 4, v0
  s_mul_i32 s24, s16, 9344
  s_add_u32 s24, s24, 0x3c00000
  s_add_u32 s25, s24, 0
  buffer_store_dwordx4 v[2:5], v1, s[4:7], s25 offen sc1
  s_add_u32 s25, s24, 4096
  buffer_store_dwordx4 v[2:5], v1, s[4:7], s25 offen sc1
  s_add_u32 s25, s24, 8192
  v_cmp_gt_u32 vcc, 1024, v1
  v_mov_b32 v6, 0x40000000
  s_nop 0
  v_cndmask_b32 v7, v6, v1, vcc
  buffer_store_dwordx4 v[2:5], v7, s[4:7], s25 offen sc1
  s_add_u32 s25, s24, 299008
  buffer_store_dwordx4 v[2:5], v1, s[4:7], s25 offen sc1
  s_add_u32 s25, s24, 303104
  buffer_store_dwordx4 v[2:5], v1, s[4:7], s25 offen sc1
  s_add_u32 s25, s24, 307200
  v_cmp_gt_u32 vcc, 1024, v1
  v_mov_b32 v6, 0x40000000
  s_nop 0
  v_cndmask_b32 v7, v6, v1, vcc
  buffer_store_dwordx4 v[2:5], v7, s[4:7], s25 offen sc1
  s_mul_i32 s24, s16, 576
  s_add_u32 s24, s24, 0x3d00000
  v_cmp_gt_u32 vcc, 576, v1
  v_mov_b32 v6, 0x40000000
  s_nop 0
  v_cndmask_b32 v7, v6, v1, vcc
  buffer_store_dwordx4 v[2:5], v7, s[4:7], s24 offen sc1
  s_waitcnt vmcnt(0)
  s_barrier
  s_cmp_eq_u32 s17, 0
  s_cbranch_scc0 L_arr_14
  v_mov_b32 v8, 128
  v_mov_b32 v9, 1
  s_mov_b64 exec, 1
  buffer_atomic_add v9, v8, s[12:15], 0 offen
  s_mov_b64 exec, -1
L_arr_14:
  v_and_b32 v16, 63, v0
  v_lshrrev_b32 v18, 4, v16
  v_and_b32 v19, 15, v16
  v_lshlrev_b32 v30, 1, v18
  v_xor_b32 v30, v19, v30
  v_lshlrev_b32 v30, 4, v30
  v_and_b32 v31, 1, v18
  v_lshlrev_b32 v31, 4, v31
  v_lshrrev_b32 v20, 1, v18
  v_add_u32 v20, v20, v31
  s_lshl_b32 s24, s17, 1
  v_add_u32 v20, s24, v20
  v_lshlrev_b32 v20, 13, v20
  v_add_u32 v20, v20, v30
  v_xor_b32 v21, 128, v20
  s_mul_i32 s24, s17, 144
  v_lshrrev_b32 v22, 1, v18
  v_lshlrev_b32 v22, 3, v22
  v_and_b32 v23, 1, v18
  v_add3_u32 v22, v22, v23, s24
  v_lshlrev_b32 v22, 13, v22
  v_add_u32 v22, v22, v30
  v_xor_b32 v23, 128, v22
  s_lshr_b32 s24, s17, 1
  s_lshl_b32 s24, s24, 5
  s_and_b32 s25, s17, 1
  s_lshl_b32 s25, s25, 3
  s_add_u32 s26, s24, s25
  v_lshrrev_b32 v24, 1, v18
  v_lshlrev_b32 v24, 2, v24
  v_and_b32 v31, 1, v18
  v_add3_u32 v24, v24, v31, s26
  s_movk_i32 s27, 1152
  v_mul_lo_u32 v24, v24, s27
  v_xor_b32 v31, 128, v30
  v_add_u32 v25, v24, v31
  v_add_u32 v24, v24, v30
  v_lshrrev_b32 v30, 3, v16
  v_bfe_u32 v31, v30, 1, 1
  v_lshlrev_b32 v26, 2, v31
  v_lshrrev_b32 v27, 2, v30
  v_lshl_add_u32 v26, v27, 1, v26
  v_and_b32 v27, 1, v30
  v_add3_u32 v26, v26, v27, s26
  v_mul_lo_u32 v26, v26, s27
  v_and_b32 v30, 1, v16
  v_lshl_add_u32 v26, v30, 4, v26
  v_bfe_u32 v30, v16, 1, 2
  v_xor_b32 v30, v30, v31
  s_movk_i32 s28, 288
  v_xor_b32 v31, 2, v30
  v_mul_lo_u32 v30, v30, s28
  v_mul_lo_u32 v31, v31, s28
  v_add_u32 v27, v26, v31
  v_add_u32 v26, v26, v30
  v_bfe_u32 v30, v16, 2, 2
  v_lshl_add_u32 v31, v18, 3, v30
  v_lshlrev_b32 v28, 8, v31
  v_lshlrev_b32 v29, 7, v31
  v_and_b32 v31, 1, v18
  v_lshl_or_b32 v19, v31, 2, v30
  v_lshl_add_u32 v28, v19, 5, v28
  v_lshrrev_b32 v30, 1, v30
  v_lshl_or_b32 v30, v31, 1, v30
  v_xor_b32 v30, s17, v30
  v_lshl_add_u32 v29, v30, 5, v29
  v_and_b32 v30, 3, v16
  v_lshl_add_u32 v28, v30, 3, v28
  v_lshl_add_u32 v29, v30, 3, v29
  v_lshlrev_b32 v0, 4, v16
  s_mul_i32 s24, s17, 18432
  s_add_u32 s24, s24, 16384
  v_add_u32 v4, s24, v0
  s_lshl_b32 s60, s17, 12
  s_lshl_b32 s61, s16, 8
  s_mul_i32 s29, s16, 147456
  s_load_dwordx2 s[80:81], s[0:1], 16
  s_mov_b32 s82, 0x480000
  s_mov_b32 s83, 0x00020000
  s_waitcnt lgkmcnt(0)
  s_and_b32 s81, s81, 0xffff
  s_load_dwordx2 s[84:85], s[0:1], 24
  s_mov_b32 s86, 0x480000
  s_mov_b32 s87, 0x00020000
  s_waitcnt lgkmcnt(0)
  s_and_b32 s85, s85, 0xffff
  s_load_dwordx2 s[88:89], s[0:1], 32
  s_mov_b32 s90, 0x480000
  s_mov_b32 s91, 0x00020000
  s_waitcnt lgkmcnt(0)
  s_and_b32 s89, s89, 0xffff
  s_load_dwordx2 s[92:93], s[0:1], 40
  s_mov_b32 s94, 0x480000
  s_mov_b32 s95, 0x00020000
  s_waitcnt lgkmcnt(0)
  s_and_b32 s93, s93, 0xffff
  s_add_u32 m0, s60, 90112
  s_add_u32 s32, s61, 0
  buffer_load_dwordx4 v20, s[84:87], s32 offen lds
  s_add_u32 m0, s60, 91136
  s_add_u32 s32, s61, 262144
  buffer_load_dwordx4 v20, s[84:87], s32 offen lds
  s_add_u32 m0, s60, 92160
  s_add_u32 s32, s61, 524288
  buffer_load_dwordx4 v21, s[84:87], s32 offen lds
  s_add_u32 m0, s60, 93184
  s_add_u32 s32, s61, 786432
  buffer_load_dwordx4 v21, s[84:87], s32 offen lds
  s_add_u32 m0, s60, 106496
  s_add_u32 s32, s61, 65536
  buffer_load_dwordx4 v20, s[84:87], s32 offen lds
  s_add_u32 m0, s60, 107520
  s_add_u32 s32, s61, 327680
  buffer_load_dwordx4 v20, s[84:87], s32 offen lds
  s_add_u32 m0, s60, 108544
  s_add_u32 s32, s61, 589824
  buffer_load_dwordx4 v21, s[84:87], s32 offen lds
  s_add_u32 m0, s60, 109568
  s_add_u32 s32, s61, 851968
  buffer_load_dwordx4 v21, s[84:87], s32 offen lds
  s_add_u32 m0, s60, 122880
  s_add_u32 s32, s61, 1179648
  buffer_load_dwordx4 v20, s[84:87], s32 offen lds
  s_add_u32 m0, s60, 123904
  s_add_u32 s32, s61, 1441792
  buffer_load_dwordx4 v20, s[84:87], s32 offen lds
  s_add_u32 m0, s60, 124928
  s_add_u32 s32, s61, 1703936
  buffer_load_dwordx4 v21, s[84:87], s32 offen lds
  s_add_u32 m0, s60, 125952
  s_add_u32 s32, s61, 1966080
  buffer_load_dwordx4 v21, s[84:87], s32 offen lds
  s_add_u32 m0, s60, 139264
  s_add_u32 s32, s61, 1245184
  buffer_load_dwordx4 v20, s[84:87], s32 offen lds
  s_add_u32 m0, s60, 140288
  s_add_u32 s32, s61, 1507328
  buffer_load_dwordx4 v20, s[84:87], s32 offen lds
  s_add_u32 m0, s60, 141312
  s_add_u32 s32, s61, 1769472
  buffer_load_dwordx4 v21, s[84:87], s32 offen lds
  s_add_u32 m0, s60, 142336
  s_add_u32 s32, s61, 2031616
  buffer_load_dwordx4 v21, s[84:87], s32 offen lds
  s_add_u32 m0, s60, 0
  s_add_u32 s32, s61, 2359296
  buffer_load_dwordx4 v20, s[84:87], s32 offen lds
  s_add_u32 m0, s60, 1024
  s_add_u32 s32, s61, 2621440
  buffer_load_dwordx4 v20, s[84:87], s32 offen lds
  s_add_u32 m0, s60, 2048
  s_add_u32 s32, s61, 2883584
  buffer_load_dwordx4 v21, s[84:87], s32 offen lds
  s_add_u32 m0, s60, 3072
  s_add_u32 s32, s61, 3145728
  buffer_load_dwordx4 v21, s[84:87], s32 offen lds
  s_waitcnt vmcnt(16)
  s_barrier
  s_lshl_b32 s33, s17, 6
  v_xor_b32 v32, s33, v28
  v_add_u32 v32, 90112, v32
  v_xor_b32 v33, 32, v32
  ds_read_b64_tr_b16 v[112:113], v32 offset:0
  ds_read_b64_tr_b16 v[114:115], v32 offset:1024
  ds_read_b64_tr_b16 v[116:117], v32 offset:8192
  ds_read_b64_tr_b16 v[118:119], v32 offset:9216
  ds_read_b64_tr_b16 v[36:37], v33 offset:0
  ds_read_b64_tr_b16 v[38:39], v33 offset:1024
  ds_read_b64_tr_b16 v[40:41], v33 offset:8192
  ds_read_b64_tr_b16 v[42:43], v33 offset:9216
  s_waitcnt lgkmcnt(0)
  ds_write_b128 v4, v[36:39] offset:0
  ds_write_b128 v4, v[40:43] offset:1024
  s_waitcnt lgkmcnt(0)
  s_barrier
  s_add_u32 m0, s60, 90112
  s_add_u32 s32, s61, 2424832
  buffer_load_dwordx4 v20, s[84:87], s32 offen lds
  s_add_u32 m0, s60, 91136
  s_add_u32 s32, s61, 2686976
  buffer_load_dwordx4 v20, s[84:87], s32 offen lds
  s_add_u32 m0, s60, 92160
  s_add_u32 s32, s61, 2949120
  buffer_load_dwordx4 v21, s[84:87], s32 offen lds
  s_add_u32 m0, s60, 93184
  s_add_u32 s32, s61, 3211264
  buffer_load_dwordx4 v21, s[84:87], s32 offen lds
  s_waitcnt vmcnt(16)
  s_barrier
  s_lshl_b32 s33, s17, 6
  v_xor_b32 v32, s33, v28
  v_add_u32 v32, 106496, v32
  v_xor_b32 v33, 32, v32
  ds_read_b64_tr_b16 v[120:121], v32 offset:0
  ds_read_b64_tr_b16 v[122:123], v32 offset:1024
  ds_read_b64_tr_b16 v[124:125], v32 offset:8192
  ds_read_b64_tr_b16 v[126:127], v32 offset:9216
  ds_read_b64_tr_b16 v[36:37], v33 offset:0
  ds_read_b64_tr_b16 v[38:39], v33 offset:1024
  ds_read_b64_tr_b16 v[40:41], v33 offset:8192
  ds_read_b64_tr_b16 v[42:43], v33 offset:9216
  s_waitcnt lgkmcnt(0)
  ds_write_b128 v4, v[36:39] offset:2048
  ds_write_b128 v4, v[40:43] offset:3072
  s_waitcnt lgkmcnt(0)
  s_barrier
  s_add_u32 m0, s60, 106496
  s_add_u32 s32, s61, 3538944
  buffer_load_dwordx4 v20, s[84:87], s32 offen lds
  s_add_u32 m0, s60, 107520
  s_add_u32 s32, s61, 3801088
  buffer_load_dwordx4 v20, s[84:87], s32 offen lds
  s_add_u32 m0, s60, 108544
  s_add_u32 s32, s61, 4063232
  buffer_load_dwordx4 v21, s[84:87], s32 offen lds
  s_add_u32 m0, s60, 109568
  s_add_u32 s32, s61, 4325376
  buffer_load_dwordx4 v21, s[84:87], s32 offen lds
  s_waitcnt vmcnt(16)
  s_barrier
  s_lshl_b32 s33, s17, 6
  v_xor_b32 v32, s33, v28
  v_add_u32 v32, 122880, v32
  v_xor_b32 v33, 32, v32
  ds_read_b64_tr_b16 v[128:129], v32 offset:0
  ds_read_b64_tr_b16 v[130:131], v32 offset:1024
  ds_read_b64_tr_b16 v[132:133], v32 offset:8192
  ds_read_b64_tr_b16 v[134:135], v32 offset:9216
  ds_read_b64_tr_b16 v[36:37], v33 offset:0
  ds_read_b64_tr_b16 v[38:39], v33 offset:1024
  ds_read_b64_tr_b16 v[40:41], v33 offset:8192
  ds_read_b64_tr_b16 v[42:43], v33 offset:9216
  s_waitcnt lgkmcnt(0)
  ds_write_b128 v4, v[36:39] offset:4096
  ds_write_b128 v4, v[40:43] offset:5120
  s_waitcnt lgkmcnt(0)
  s_barrier
  s_add_u32 m0, s60, 122880
  s_add_u32 s32, s61, 3604480
  buffer_load_dwordx4 v20, s[84:87], s32 offen lds
  s_add_u32 m0, s60, 123904
  s_add_u32 s32, s61, 3866624
  buffer_load_dwordx4 v20, s[84:87], s32 offen lds
  s_add_u32 m0, s60, 124928
  s_add_u32 s32, s61, 4128768
  buffer_load_dwordx4 v21, s[84:87], s32 offen lds
  s_add_u32 m0, s60, 125952
  s_add_u32 s32, s61, 4390912
  buffer_load_dwordx4 v21, s[84:87], s32 offen lds
  s_waitcnt vmcnt(16)
  s_barrier
  s_lshl_b32 s33, s17, 6
  v_xor_b32 v32, s33, v28
  v_add_u32 v32, 139264, v32
  v_xor_b32 v33, 32, v32
  ds_read_b64_tr_b16 v[136:137], v32 offset:0
  ds_read_b64_tr_b16 v[138:139], v32 offset:1024
  ds_read_b64_tr_b16 v[140:141], v32 offset:8192
  ds_read_b64_tr_b16 v[142:143], v32 offset:9216
  ds_read_b64_tr_b16 v[36:37], v33 offset:0
  ds_read_b64_tr_b16 v[38:39], v33 offset:1024
  ds_read_b64_tr_b16 v[40:41], v33 offset:8192
  ds_read_b64_tr_b16 v[42:43], v33 offset:9216
  s_waitcnt lgkmcnt(0)
  ds_write_b128 v4, v[36:39] offset:6144
  ds_write_b128 v4, v[40:43] offset:7168
  s_waitcnt lgkmcnt(0)
  s_barrier
  s_add_u32 m0, s60, 139264
  s_add_u32 s32, s61, 1048576
  buffer_load_dwordx4 v22, s[84:87], s32 offen lds
  s_add_u32 m0, s60, 140288
  s_add_u32 s32, s61, 1064960
  buffer_load_dwordx4 v22, s[84:87], s32 offen lds
  s_add_u32 m0, s60, 141312
  s_add_u32 s32, s61, 1081344
  buffer_load_dwordx4 v23, s[84:87], s32 offen lds
  s_add_u32 m0, s60, 142336
  s_add_u32 s32, s61, 1097728
  buffer_load_dwordx4 v23, s[84:87], s32 offen lds
  s_waitcnt vmcnt(16)
  s_barrier
  s_lshl_b32 s33, s17, 6
  v_xor_b32 v32, s33, v28
  v_mov_b32 v32, v32
  v_xor_b32 v33, 32, v32
  ds_read_b64_tr_b16 v[144:145], v32 offset:0
  ds_read_b64_tr_b16 v[146:147], v32 offset:1024
  ds_read_b64_tr_b16 v[148:149], v32 offset:8192
  ds_read_b64_tr_b16 v[150:151], v32 offset:9216
  ds_read_b64_tr_b16 v[36:37], v33 offset:0
  ds_read_b64_tr_b16 v[38:39], v33 offset:1024
  ds_read_b64_tr_b16 v[40:41], v33 offset:8192
  ds_read_b64_tr_b16 v[42:43], v33 offset:9216
  s_waitcnt lgkmcnt(0)
  ds_write_b128 v4, v[36:39] offset:8192
  ds_write_b128 v4, v[40:43] offset:9216
  s_waitcnt lgkmcnt(0)
  s_barrier
  s_add_u32 m0, s60, 0
  s_add_u32 s32, s61, 0
  buffer_load_dwordx4 v20, s[80:83], s32 offen lds
  s_add_u32 m0, s60, 1024
  s_add_u32 s32, s61, 262144
  buffer_load_dwordx4 v20, s[80:83], s32 offen lds
  s_add_u32 m0, s60, 2048
  s_add_u32 s32, s61, 524288
  buffer_load_dwordx4 v21, s[80:83], s32 offen lds
  s_add_u32 m0, s60, 3072
  s_add_u32 s32, s61, 786432
  buffer_load_dwordx4 v21, s[80:83], s32 offen lds
  s_waitcnt vmcnt(16)
  s_barrier
  s_lshl_b32 s33, s17, 6
  v_xor_b32 v32, s33, v28
  v_add_u32 v32, 90112, v32
  v_xor_b32 v33, 32, v32
  ds_read_b64_tr_b16 v[152:153], v32 offset:0
  ds_read_b64_tr_b16 v[154:155], v32 offset:1024
  ds_read_b64_tr_b16 v[156:157], v32 offset:8192
  ds_read_b64_tr_b16 v[158:159], v32 offset:9216
  ds_read_b64_tr_b16 v[36:37], v33 offset:0
  ds_read_b64_tr_b16 v[38:39], v33 offset:1024
  ds_read_b64_tr_b16 v[40:41], v33 offset:8192
  ds_read_b64_tr_b16 v[42:43], v33 offset:9216
  s_waitcnt lgkmcnt(0)
  ds_write_b128 v4, v[36:39] offset:10240
  ds_write_b128 v4, v[40:43] offset:11264
  s_waitcnt lgkmcnt(0)
  s_barrier
  s_add_u32 m0, s60, 90112
  s_add_u32 s32, s61, 65536
  buffer_load_dwordx4 v20, s[80:83], s32 offen lds
  s_add_u32 m0, s60, 91136
  s_add_u32 s32, s61, 327680
  buffer_load_dwordx4 v20, s[80:83], s32 offen lds
  s_add_u32 m0, s60, 92160
  s_add_u32 s32, s61, 589824
  buffer_load_dwordx4 v21, s[80:83], s32 offen lds
  s_add_u32 m0, s60, 93184
  s_add_u32 s32, s61, 851968
  buffer_load_dwordx4 v21, s[80:83], s32 offen lds
  s_waitcnt vmcnt(16)
  s_barrier
  s_lshl_b32 s33, s17, 6
  v_xor_b32 v32, s33, v28
  v_add_u32 v32, 106496, v32
  v_xor_b32 v33, 32, v32
  ds_read_b64_tr_b16 v[160:161], v32 offset:0
  ds_read_b64_tr_b16 v[162:163], v32 offset:1024
  ds_read_b64_tr_b16 v[164:165], v32 offset:8192
  ds_read_b64_tr_b16 v[166:167], v32 offset:9216
  ds_read_b64_tr_b16 v[36:37], v33 offset:0
  ds_read_b64_tr_b16 v[38:39], v33 offset:1024
  ds_read_b64_tr_b16 v[40:41], v33 offset:8192
  ds_read_b64_tr_b16 v[42:43], v33 offset:9216
  s_waitcnt lgkmcnt(0)
  ds_write_b128 v4, v[36:39] offset:12288
  ds_write_b128 v4, v[40:43] offset:13312
  s_waitcnt lgkmcnt(0)
  s_barrier
  s_add_u32 m0, s60, 106496
  s_add_u32 s32, s61, 1179648
  buffer_load_dwordx4 v20, s[80:83], s32 offen lds
  s_add_u32 m0, s60, 107520
  s_add_u32 s32, s61, 1441792
  buffer_load_dwordx4 v20, s[80:83], s32 offen lds
  s_add_u32 m0, s60, 108544
  s_add_u32 s32, s61, 1703936
  buffer_load_dwordx4 v21, s[80:83], s32 offen lds
  s_add_u32 m0, s60, 109568
  s_add_u32 s32, s61, 1966080
  buffer_load_dwordx4 v21, s[80:83], s32 offen lds
  s_waitcnt vmcnt(16)
  s_barrier
  s_lshl_b32 s33, s17, 6
  v_xor_b32 v32, s33, v28
  v_add_u32 v32, 122880, v32
  v_xor_b32 v33, 32, v32
  ds_read_b64_tr_b16 v[168:169], v32 offset:0
  ds_read_b64_tr_b16 v[170:171], v32 offset:1024
  ds_read_b64_tr_b16 v[172:173], v32 offset:8192
  ds_read_b64_tr_b16 v[174:175], v32 offset:9216
  ds_read_b64_tr_b16 v[36:37], v33 offset:0
  ds_read_b64_tr_b16 v[38:39], v33 offset:1024
  ds_read_b64_tr_b16 v[40:41], v33 offset:8192
  ds_read_b64_tr_b16 v[42:43], v33 offset:9216
  s_waitcnt lgkmcnt(0)
  ds_write_b128 v4, v[36:39] offset:14336
  ds_write_b128 v4, v[40:43] offset:15360
  s_waitcnt lgkmcnt(0)
  s_barrier
  s_add_u32 m0, s60, 122880
  s_add_u32 s32, s61, 1245184
  buffer_load_dwordx4 v20, s[80:83], s32 offen lds
  s_add_u32 m0, s60, 123904
  s_add_u32 s32, s61, 1507328
  buffer_load_dwordx4 v20, s[80:83], s32 offen lds
  s_add_u32 m0, s60, 124928
  s_add_u32 s32, s61, 1769472
  buffer_load_dwordx4 v21, s[80:83], s32 offen lds
  s_add_u32 m0, s60, 125952
  s_add_u32 s32, s61, 2031616
  buffer_load_dwordx4 v21, s[80:83], s32 offen lds
  s_waitcnt vmcnt(16)
  s_barrier
  s_lshl_b32 s33, s17, 6
  v_xor_b32 v32, s33, v28
  v_add_u32 v32, 139264, v32
  v_xor_b32 v33, 32, v32
  ds_read_b64_tr_b16 v[176:177], v32 offset:0
  ds_read_b64_tr_b16 v[178:179], v32 offset:1024
  ds_read_b64_tr_b16 v[180:181], v32 offset:8192
  ds_read_b64_tr_b16 v[182:183], v32 offset:9216
  ds_read_b64_tr_b16 v[36:37], v33 offset:0
  ds_read_b64_tr_b16 v[38:39], v33 offset:1024
  ds_read_b64_tr_b16 v[40:41], v33 offset:8192
  ds_read_b64_tr_b16 v[42:43], v33 offset:9216
  s_waitcnt lgkmcnt(0)
  ds_write_b128 v4, v[36:39] offset:16384
  ds_write_b128 v4, v[40:43] offset:17408
  s_waitcnt lgkmcnt(0)
  s_barrier
  s_add_u32 m0, s60, 139264
  s_add_u32 s32, s61, 2359296
  buffer_load_dwordx4 v20, s[80:83], s32 offen lds
  s_add_u32 m0, s60, 140288
  s_add_u32 s32, s61, 2621440
  buffer_load_dwordx4 v20, s[80:83], s32 offen lds
  s_add_u32 m0, s60, 141312
  s_add_u32 s32, s61, 2883584
  buffer_load_dwordx4 v21, s[80:83], s32 offen lds
  s_add_u32 m0, s60, 142336
  s_add_u32 s32, s61, 3145728
  buffer_load_dwordx4 v21, s[80:83], s32 offen lds
  s_waitcnt vmcnt(16)
  s_barrier
  s_lshl_b32 s33, s17, 6
  v_xor_b32 v32, s33, v28
  v_mov_b32 v32, v32
  v_xor_b32 v33, 32, v32
  ds_read_b64_tr_b16 a[0:1], v32 offset:0
  ds_read_b64_tr_b16 a[2:3], v32 offset:1024
  ds_read_b64_tr_b16 a[4:5], v32 offset:8192
  ds_read_b64_tr_b16 a[6:7], v32 offset:9216
  ds_read_b64_tr_b16 a[8:9], v33 offset:0
  ds_read_b64_tr_b16 a[10:11], v33 offset:1024
  ds_read_b64_tr_b16 a[12:13], v33 offset:8192
  ds_read_b64_tr_b16 a[14:15], v33 offset:9216
  s_waitcnt lgkmcnt(0)
  s_barrier
  s_add_u32 m0, s60, 0
  s_add_u32 s32, s61, 2424832
  buffer_load_dwordx4 v20, s[80:83], s32 offen lds
  s_add_u32 m0, s60, 1024
  s_add_u32 s32, s61, 2686976
  buffer_load_dwordx4 v20, s[80:83], s32 offen lds
  s_add_u32 m0, s60, 2048
  s_add_u32 s32, s61, 2949120
  buffer_load_dwordx4 v21, s[80:83], s32 offen lds
  s_add_u32 m0, s60, 3072
  s_add_u32 s32, s61, 3211264
  buffer_load_dwordx4 v21, s[80:83], s32 offen lds
  s_waitcnt vmcnt(16)
  s_barrier
  s_lshl_b32 s33, s17, 6
  v_xor_b32 v32, s33, v28
  v_add_u32 v32, 90112, v32
  v_xor_b32 v33, 32, v32
  ds_read_b64_tr_b16 a[16:17], v32 offset:0
  ds_read_b64_tr_b16 a[18:19], v32 offset:1024
  ds_read_b64_tr_b16 a[20:21], v32 offset:8192
  ds_read_b64_tr_b16 a[22:23], v32 offset:9216
  ds_read_b64_tr_b16 a[24:25], v33 offset:0
  ds_read_b64_tr_b16 a[26:27], v33 offset:1024
  ds_read_b64_tr_b16 a[28:29], v33 offset:8192
  ds_read_b64_tr_b16 a[30:31], v33 offset:9216
  s_waitcnt lgkmcnt(0)
  s_barrier
  s_add_u32 m0, s60, 90112
  s_add_u32 s32, s61, 3538944
  buffer_load_dwordx4 v20, s[80:83], s32 offen lds
  s_add_u32 m0, s60, 91136
  s_add_u32 s32, s61, 3801088
  buffer_load_dwordx4 v20, s[80:83], s32 offen lds
  s_add_u32 m0, s60, 92160
  s_add_u32 s32, s61, 4063232
  buffer_load_dwordx4 v21, s[80:83], s32 offen lds
  s_add_u32 m0, s60, 93184
  s_add_u32 s32, s61, 4325376
  buffer_load_dwordx4 v21, s[80:83], s32 offen lds
  s_waitcnt vmcnt(16)
  s_barrier
  s_lshl_b32 s33, s17, 6
  v_xor_b32 v32, s33, v28
  v_add_u32 v32, 106496, v32
  v_xor_b32 v33, 32, v32
  ds_read_b64_tr_b16 a[32:33], v32 offset:0
  ds_read_b64_tr_b16 a[34:35], v32 offset:1024
  ds_read_b64_tr_b16 a[36:37], v32 offset:8192
  ds_read_b64_tr_b16 a[38:39], v32 offset:9216
  ds_read_b64_tr_b16 a[40:41], v33 offset:0
  ds_read_b64_tr_b16 a[42:43], v33 offset:1024
  ds_read_b64_tr_b16 a[44:45], v33 offset:8192
  ds_read_b64_tr_b16 a[46:47], v33 offset:9216
  s_waitcnt lgkmcnt(0)
  s_barrier
  s_add_u32 m0, s60, 106496
  s_add_u32 s32, s61, 3604480
  buffer_load_dwordx4 v20, s[80:83], s32 offen lds
  s_add_u32 m0, s60, 107520
  s_add_u32 s32, s61, 3866624
  buffer_load_dwordx4 v20, s[80:83], s32 offen lds
  s_add_u32 m0, s60, 108544
  s_add_u32 s32, s61, 4128768
  buffer_load_dwordx4 v21, s[80:83], s32 offen lds
  s_add_u32 m0, s60, 109568
  s_add_u32 s32, s61, 4390912
  buffer_load_dwordx4 v21, s[80:83], s32 offen lds
  s_waitcnt vmcnt(16)
  s_barrier
  s_lshl_b32 s33, s17, 6
  v_xor_b32 v32, s33, v28
  v_add_u32 v32, 122880, v32
  v_xor_b32 v33, 32, v32
  ds_read_b64_tr_b16 a[48:49], v32 offset:0
  ds_read_b64_tr_b16 a[50:51], v32 offset:1024
  ds_read_b64_tr_b16 a[52:53], v32 offset:8192
  ds_read_b64_tr_b16 a[54:55], v32 offset:9216
  ds_read_b64_tr_b16 a[56:57], v33 offset:0
  ds_read_b64_tr_b16 a[58:59], v33 offset:1024
  ds_read_b64_tr_b16 a[60:61], v33 offset:8192
  ds_read_b64_tr_b16 a[62:63], v33 offset:9216
  s_waitcnt lgkmcnt(0)
  s_barrier
  s_add_u32 m0, s60, 122880
  s_add_u32 s32, s61, 1048576
  buffer_load_dwordx4 v22, s[80:83], s32 offen lds
  s_add_u32 m0, s60, 123904
  s_add_u32 s32, s61, 1064960
  buffer_load_dwordx4 v22, s[80:83], s32 offen lds
  s_add_u32 m0, s60, 124928
  s_add_u32 s32, s61, 1081344
  buffer_load_dwordx4 v23, s[80:83], s32 offen lds
  s_add_u32 m0, s60, 125952
  s_add_u32 s32, s61, 1097728
  buffer_load_dwordx4 v23, s[80:83], s32 offen lds
  s_waitcnt vmcnt(16)
  s_barrier
  s_lshl_b32 s33, s17, 6
  v_xor_b32 v32, s33, v28
  v_add_u32 v32, 139264, v32
  v_xor_b32 v33, 32, v32
  ds_read_b64_tr_b16 a[64:65], v32 offset:0
  ds_read_b64_tr_b16 a[66:67], v32 offset:1024
  ds_read_b64_tr_b16 a[68:69], v32 offset:8192
  ds_read_b64_tr_b16 a[70:71], v32 offset:9216
  ds_read_b64_tr_b16 a[72:73], v33 offset:0
  ds_read_b64_tr_b16 a[74:75], v33 offset:1024
  ds_read_b64_tr_b16 a[76:77], v33 offset:8192
  ds_read_b64_tr_b16 a[78:79], v33 offset:9216
  s_waitcnt lgkmcnt(0)
  s_barrier
  s_add_u32 m0, s60, 139264
  s_add_u32 s32, s61, 0
  buffer_load_dwordx4 v20, s[88:91], s32 offen lds
  s_add_u32 m0, s60, 140288
  s_add_u32 s32, s61, 262144
  buffer_load_dwordx4 v20, s[88:91], s32 offen lds
  s_add_u32 m0, s60, 141312
  s_add_u32 s32, s61, 524288
  buffer_load_dwordx4 v21, s[88:91], s32 offen lds
  s_add_u32 m0, s60, 142336
  s_add_u32 s32, s61, 786432
  buffer_load_dwordx4 v21, s[88:91], s32 offen lds
  s_waitcnt vmcnt(16)
  s_barrier
  s_lshl_b32 s33, s17, 6
  v_xor_b32 v32, s33, v28
  v_mov_b32 v32, v32
  v_xor_b32 v33, 32, v32
  ds_read_b64_tr_b16 a[80:81], v32 offset:0
  ds_read_b64_tr_b16 a[82:83], v32 offset:1024
  ds_read_b64_tr_b16 a[84:85], v32 offset:8192
  ds_read_b64_tr_b16 a[86:87], v32 offset:9216
  ds_read_b64_tr_b16 a[88:89], v33 offset:0
  ds_read_b64_tr_b16 a[90:91], v33 offset:1024
  ds_read_b64_tr_b16 a[92:93], v33 offset:8192
  ds_read_b64_tr_b16 a[94:95], v33 offset:9216
  s_waitcnt lgkmcnt(0)
  s_barrier
  s_add_u32 m0, s60, 0
  s_add_u32 s32, s61, 65536
  buffer_load_dwordx4 v20, s[88:91], s32 offen lds
  s_add_u32 m0, s60, 1024
  s_add_u32 s32, s61, 327680
  buffer_load_dwordx4 v20, s[88:91], s32 offen lds
  s_add_u32 m0, s60, 2048
  s_add_u32 s32, s61, 589824
  buffer_load_dwordx4 v21, s[88:91], s32 offen lds
  s_add_u32 m0, s60, 3072
  s_add_u32 s32, s61, 851968
  buffer_load_dwordx4 v21, s[88:91], s32 offen lds
  s_waitcnt vmcnt(16)
  s_barrier
  s_lshl_b32 s33, s17, 6
  v_xor_b32 v32, s33, v28
  v_add_u32 v32, 90112, v32
  v_xor_b32 v33, 32, v32
  ds_read_b64_tr_b16 a[96:97], v32 offset:0
  ds_read_b64_tr_b16 a[98:99], v32 offset:1024
  ds_read_b64_tr_b16 a[100:101], v32 offset:8192
  ds_read_b64_tr_b16 a[102:103], v32 offset:9216
  ds_read_b64_tr_b16 a[104:105], v33 offset:0
  ds_read_b64_tr_b16 a[106:107], v33 offset:1024
  ds_read_b64_tr_b16 a[108:109], v33 offset:8192
  ds_read_b64_tr_b16 a[110:111], v33 offset:9216
  s_waitcnt lgkmcnt(0)
  s_barrier
  s_add_u32 m0, s60, 90112
  s_add_u32 s32, s61, 1179648
  buffer_load_dwordx4 v20, s[88:91], s32 offen lds
  s_add_u32 m0, s60, 91136
  s_add_u32 s32, s61, 1441792
  buffer_load_dwordx4 v20, s[88:91], s32 offen lds
  s_add_u32 m0, s60, 92160
  s_add_u32 s32, s61, 1703936
  buffer_load_dwordx4 v21, s[88:91], s32 offen lds
  s_add_u32 m0, s60, 93184
  s_add_u32 s32, s61, 1966080
  buffer_load_dwordx4 v21, s[88:91], s32 offen lds
  s_waitcnt vmcnt(16)
  s_barrier
  s_lshl_b32 s33, s17, 6
  v_xor_b32 v32, s33, v28
  v_add_u32 v32, 106496, v32
  v_xor_b32 v33, 32, v32
  ds_read_b64_tr_b16 a[112:113], v32 offset:0
  ds_read_b64_tr_b16 a[114:115], v32 offset:1024
  ds_read_b64_tr_b16 a[116:117], v32 offset:8192
  ds_read_b64_tr_b16 a[118:119], v32 offset:9216
  ds_read_b64_tr_b16 a[120:121], v33 offset:0
  ds_read_b64_tr_b16 a[122:123], v33 offset:1024
  ds_read_b64_tr_b16 a[124:125], v33 offset:8192
  ds_read_b64_tr_b16 a[126:127], v33 offset:9216
  s_waitcnt lgkmcnt(0)
  s_barrier
  s_add_u32 m0, s60, 106496
  s_add_u32 s32, s61, 1245184
  buffer_load_dwordx4 v20, s[88:91], s32 offen lds
  s_add_u32 m0, s60, 107520
  s_add_u32 s32, s61, 1507328
  buffer_load_dwordx4 v20, s[88:91], s32 offen lds
  s_add_u32 m0, s60, 108544
  s_add_u32 s32, s61, 1769472
  buffer_load_dwordx4 v21, s[88:91], s32 offen lds
  s_add_u32 m0, s60, 109568
  s_add_u32 s32, s61, 2031616
  buffer_load_dwordx4 v21, s[88:91], s32 offen lds
  s_waitcnt vmcnt(16)
  s_barrier
  s_lshl_b32 s33, s17, 6
  v_xor_b32 v32, s33, v28
  v_add_u32 v32, 122880, v32
  v_xor_b32 v33, 32, v32
  ds_read_b64_tr_b16 a[128:129], v32 offset:0
  ds_read_b64_tr_b16 a[130:131], v32 offset:1024
  ds_read_b64_tr_b16 a[132:133], v32 offset:8192
  ds_read_b64_tr_b16 a[134:135], v32 offset:9216
  ds_read_b64_tr_b16 a[136:137], v33 offset:0
  ds_read_b64_tr_b16 a[138:139], v33 offset:1024
  ds_read_b64_tr_b16 a[140:141], v33 offset:8192
  ds_read_b64_tr_b16 a[142:143], v33 offset:9216
  s_waitcnt lgkmcnt(0)
  s_barrier
  s_add_u32 m0, s60, 122880
  s_add_u32 s32, s61, 2359296
  buffer_load_dwordx4 v20, s[88:91], s32 offen lds
  s_add_u32 m0, s60, 123904
  s_add_u32 s32, s61, 2621440
  buffer_load_dwordx4 v20, s[88:91], s32 offen lds
  s_add_u32 m0, s60, 124928
  s_add_u32 s32, s61, 2883584
  buffer_load_dwordx4 v21, s[88:91], s32 offen lds
  s_add_u32 m0, s60, 125952
  s_add_u32 s32, s61, 3145728
  buffer_load_dwordx4 v21, s[88:91], s32 offen lds
  s_waitcnt vmcnt(16)
  s_barrier
  s_lshl_b32 s33, s17, 6
  v_xor_b32 v32, s33, v28
  v_add_u32 v32, 139264, v32
  v_xor_b32 v33, 32, v32
  ds_read_b64_tr_b16 a[144:145], v32 offset:0
  ds_read_b64_tr_b16 a[146:147], v32 offset:1024
  ds_read_b64_tr_b16 a[148:149], v32 offset:8192
  ds_read_b64_tr_b16 a[150:151], v32 offset:9216
  ds_read_b64_tr_b16 a[152:153], v33 offset:0
  ds_read_b64_tr_b16 a[154:155], v33 offset:1024
  ds_read_b64_tr_b16 a[156:157], v33 offset:8192
  ds_read_b64_tr_b16 a[158:159], v33 offset:9216
  s_waitcnt lgkmcnt(0)
  s_barrier
  s_add_u32 m0, s60, 139264
  s_add_u32 s32, s61, 2424832
  buffer_load_dwordx4 v20, s[88:91], s32 offen lds
  s_add_u32 m0, s60, 140288
  s_add_u32 s32, s61, 2686976
  buffer_load_dwordx4 v20, s[88:91], s32 offen lds
  s_add_u32 m0, s60, 141312
  s_add_u32 s32, s61, 2949120
  buffer_load_dwordx4 v21, s[88:91], s32 offen lds
  s_add_u32 m0, s60, 142336
  s_add_u32 s32, s61, 3211264
  buffer_load_dwordx4 v21, s[88:91], s32 offen lds
  s_waitcnt vmcnt(16)
  s_barrier
  s_lshl_b32 s33, s17, 6
  v_xor_b32 v32, s33, v28
  v_mov_b32 v32, v32
  v_xor_b32 v33, 32, v32
  ds_read_b64_tr_b16 a[160:161], v32 offset:0
  ds_read_b64_tr_b16 a[162:163], v32 offset:1024
  ds_read_b64_tr_b16 a[164:165], v32 offset:8192
  ds_read_b64_tr_b16 a[166:167], v32 offset:9216
  ds_read_b64_tr_b16 a[168:169], v33 offset:0
  ds_read_b64_tr_b16 a[170:171], v33 offset:1024
  ds_read_b64_tr_b16 a[172:173], v33 offset:8192
  ds_read_b64_tr_b16 a[174:175], v33 offset:9216
  s_waitcnt lgkmcnt(0)
  s_barrier
  s_add_u32 m0, s60, 0
  s_add_u32 s32, s61, 3538944
  buffer_load_dwordx4 v20, s[88:91], s32 offen lds
  s_add_u32 m0, s60, 1024
  s_add_u32 s32, s61, 3801088
  buffer_load_dwordx4 v20, s[88:91], s32 offen lds
  s_add_u32 m0, s60, 2048
  s_add_u32 s32, s61, 4063232
  buffer_load_dwordx4 v21, s[88:91], s32 offen lds
  s_add_u32 m0, s60, 3072
  s_add_u32 s32, s61, 4325376
  buffer_load_dwordx4 v21, s[88:91], s32 offen lds
  s_waitcnt vmcnt(16)
  s_barrier
  s_lshl_b32 s33, s17, 6
  v_xor_b32 v32, s33, v28
  v_add_u32 v32, 90112, v32
  v_xor_b32 v33, 32, v32
  ds_read_b64_tr_b16 a[176:177], v32 offset:0
  ds_read_b64_tr_b16 a[178:179], v32 offset:1024
  ds_read_b64_tr_b16 a[180:181], v32 offset:8192
  ds_read_b64_tr_b16 a[182:183], v32 offset:9216
  ds_read_b64_tr_b16 a[184:185], v33 offset:0
  ds_read_b64_tr_b16 a[186:187], v33 offset:1024
  ds_read_b64_tr_b16 a[188:189], v33 offset:8192
  ds_read_b64_tr_b16 a[190:191], v33 offset:9216
  s_waitcnt lgkmcnt(0)
  s_barrier
  s_add_u32 m0, s60, 90112
  s_add_u32 s32, s61, 3604480
  buffer_load_dwordx4 v20, s[88:91], s32 offen lds
  s_add_u32 m0, s60, 91136
  s_add_u32 s32, s61, 3866624
  buffer_load_dwordx4 v20, s[88:91], s32 offen lds
  s_add_u32 m0, s60, 92160
  s_add_u32 s32, s61, 4128768
  buffer_load_dwordx4 v21, s[88:91], s32 offen lds
  s_add_u32 m0, s60, 93184
  s_add_u32 s32, s61, 4390912
  buffer_load_dwordx4 v21, s[88:91], s32 offen lds
  s_waitcnt vmcnt(16)
  s_barrier
  s_lshl_b32 s33, s17, 6
  v_xor_b32 v32, s33, v28
  v_add_u32 v32, 106496, v32
  v_xor_b32 v33, 32, v32
  ds_read_b64_tr_b16 a[192:193], v32 offset:0
  ds_read_b64_tr_b16 a[194:195], v32 offset:1024
  ds_read_b64_tr_b16 a[196:197], v32 offset:8192
  ds_read_b64_tr_b16 a[198:199], v32 offset:9216
  ds_read_b64_tr_b16 a[200:201], v33 offset:0
  ds_read_b64_tr_b16 a[202:203], v33 offset:1024
  ds_read_b64_tr_b16 a[204:205], v33 offset:8192
  ds_read_b64_tr_b16 a[206:207], v33 offset:9216
  s_waitcnt lgkmcnt(0)
  s_barrier
  s_add_u32 m0, s60, 106496
  s_add_u32 s32, s61, 1048576
  buffer_load_dwordx4 v22, s[88:91], s32 offen lds
  s_add_u32 m0, s60, 107520
  s_add_u32 s32, s61, 1064960
  buffer_load_dwordx4 v22, s[88:91], s32 offen lds
  s_add_u32 m0, s60, 108544
  s_add_u32 s32, s61, 1081344
  buffer_load_dwordx4 v23, s[88:91], s32 offen lds
  s_add_u32 m0, s60, 109568
  s_add_u32 s32, s61, 1097728
  buffer_load_dwordx4 v23, s[88:91], s32 offen lds
  s_waitcnt vmcnt(16)
  s_barrier
  s_lshl_b32 s33, s17, 6
  v_xor_b32 v32, s33, v28
  v_add_u32 v32, 122880, v32
  v_xor_b32 v33, 32, v32
  ds_read_b64_tr_b16 a[208:209], v32 offset:0
  ds_read_b64_tr_b16 a[210:211], v32 offset:1024
  ds_read_b64_tr_b16 a[212:213], v32 offset:8192
  ds_read_b64_tr_b16 a[214:215], v32 offset:9216
  ds_read_b64_tr_b16 a[216:217], v33 offset:0
  ds_read_b64_tr_b16 a[218:219], v33 offset:1024
  ds_read_b64_tr_b16 a[220:221], v33 offset:8192
  ds_read_b64_tr_b16 a[222:223], v33 offset:9216
  s_waitcnt lgkmcnt(0)
  s_barrier
  s_add_u32 m0, s60, 122880
  s_add_u32 s32, s29, 0
  buffer_load_dwordx4 v24, s[92:95], s32 offen lds
  s_add_u32 m0, s60, 123904
  s_add_u32 s32, s29, 2304
  buffer_load_dwordx4 v24, s[92:95], s32 offen lds
  s_add_u32 m0, s60, 124928
  s_add_u32 s32, s29, 18432
  buffer_load_dwordx4 v25, s[92:95], s32 offen lds
  s_add_u32 m0, s60, 125952
  s_add_u32 s32, s29, 20736
  buffer_load_dwordx4 v25, s[92:95], s32 offen lds
  s_waitcnt vmcnt(16)
  s_barrier
  s_lshl_b32 s33, s17, 6
  v_xor_b32 v32, s33, v28
  v_add_u32 v32, 139264, v32
  v_xor_b32 v33, 32, v32
  ds_read_b64_tr_b16 a[224:225], v32 offset:0
  ds_read_b64_tr_b16 a[226:227], v32 offset:1024
  ds_read_b64_tr_b16 a[228:229], v32 offset:8192
  ds_read_b64_tr_b16 a[230:231], v32 offset:9216
  ds_read_b64_tr_b16 a[232:233], v33 offset:0
  ds_read_b64_tr_b16 a[234:235], v33 offset:1024
  ds_read_b64_tr_b16 a[236:237], v33 offset:8192
  ds_read_b64_tr_b16 a[238:239], v33 offset:9216
  s_waitcnt lgkmcnt(0)
  s_barrier
  s_add_u32 m0, s60, 139264
  s_add_u32 s32, s29, 288
  buffer_load_dwordx4 v24, s[92:95], s32 offen lds
  s_add_u32 m0, s60, 140288
  s_add_u32 s32, s29, 2592
  buffer_load_dwordx4 v24, s[92:95], s32 offen lds
  s_add_u32 m0, s60, 141312
  s_add_u32 s32, s29, 18720
  buffer_load_dwordx4 v25, s[92:95], s32 offen lds
  s_add_u32 m0, s60, 142336
  s_add_u32 s32, s29, 21024
  buffer_load_dwordx4 v25, s[92:95], s32 offen lds
  s_waitcnt vmcnt(16)
  s_barrier
  s_lshl_b32 s33, s17, 6
  v_xor_b32 v32, s33, v28
  v_mov_b32 v32, v32
  v_xor_b32 v33, 32, v32
  ds_read_b64_tr_b16 a[240:241], v32 offset:0
  ds_read_b64_tr_b16 a[242:243], v32 offset:1024
  ds_read_b64_tr_b16 a[244:245], v32 offset:8192
  ds_read_b64_tr_b16 a[246:247], v32 offset:9216
  ds_read_b64_tr_b16 a[248:249], v33 offset:0
  ds_read_b64_tr_b16 a[250:251], v33 offset:1024
  ds_read_b64_tr_b16 a[252:253], v33 offset:8192
  ds_read_b64_tr_b16 a[254:255], v33 offset:9216
  s_waitcnt lgkmcnt(0)
  s_barrier
  s_add_u32 m0, s60, 0
  s_add_u32 s32, s29, 576
  buffer_load_dwordx4 v24, s[92:95], s32 offen lds
  s_add_u32 m0, s60, 1024
  s_add_u32 s32, s29, 2880
  buffer_load_dwordx4 v24, s[92:95], s32 offen lds
  s_add_u32 m0, s60, 2048
  s_add_u32 s32, s29, 19008
  buffer_load_dwordx4 v25, s[92:95], s32 offen lds
  s_add_u32 m0, s60, 3072
  s_add_u32 s32, s29, 21312
  buffer_load_dwordx4 v25, s[92:95], s32 offen lds
  s_waitcnt vmcnt(16)
  s_barrier
  s_lshl_b32 s33, s17, 6
  v_xor_b32 v32, s33, v28
  v_add_u32 v32, 90112, v32
  v_xor_b32 v33, 32, v32
  ds_read_b64_tr_b16 v[80:81], v32 offset:0
  ds_read_b64_tr_b16 v[82:83], v32 offset:1024
  ds_read_b64_tr_b16 v[84:85], v32 offset:8192
  ds_read_b64_tr_b16 v[86:87], v32 offset:9216
  ds_read_b64_tr_b16 v[88:89], v33 offset:0
  ds_read_b64_tr_b16 v[90:91], v33 offset:1024
  ds_read_b64_tr_b16 v[92:93], v33 offset:8192
  ds_read_b64_tr_b16 v[94:95], v33 offset:9216
  s_waitcnt lgkmcnt(0)
  s_barrier
  s_add_u32 m0, s60, 90112
  s_add_u32 s32, s29, 864
  buffer_load_dwordx4 v24, s[92:95], s32 offen lds
  s_add_u32 m0, s60, 91136
  s_add_u32 s32, s29, 3168
  buffer_load_dwordx4 v24, s[92:95], s32 offen lds
  s_add_u32 m0, s60, 92160
  s_add_u32 s32, s29, 19296
  buffer_load_dwordx4 v25, s[92:95], s32 offen lds
  s_add_u32 m0, s60, 93184
  s_add_u32 s32, s29, 21600
  buffer_load_dwordx4 v25, s[92:95], s32 offen lds
  s_waitcnt vmcnt(16)
  s_barrier
  s_lshl_b32 s33, s17, 6
  v_xor_b32 v32, s33, v28
  v_add_u32 v32, 106496, v32
  v_xor_b32 v33, 32, v32
  ds_read_b64_tr_b16 v[96:97], v32 offset:0
  ds_read_b64_tr_b16 v[98:99], v32 offset:1024
  ds_read_b64_tr_b16 v[100:101], v32 offset:8192
  ds_read_b64_tr_b16 v[102:103], v32 offset:9216
  ds_read_b64_tr_b16 v[104:105], v33 offset:0
  ds_read_b64_tr_b16 v[106:107], v33 offset:1024
  ds_read_b64_tr_b16 v[108:109], v33 offset:8192
  ds_read_b64_tr_b16 v[110:111], v33 offset:9216
  s_waitcnt lgkmcnt(0)
  s_barrier
  s_lshl_b32 s33, s17, 11
  s_add_u32 m0, s33, 106496
  s_add_u32 s32, s29, 256
  buffer_load_dwordx4 v26, s[92:95], s32 offen lds
  s_add_u32 m0, s33, 107520
  s_add_u32 s32, s29, 18688
  buffer_load_dwordx4 v27, s[92:95], s32 offen lds
  s_waitcnt vmcnt(14)
  s_barrier
  s_cmp_eq_u32 s17, 0
  s_cbranch_scc0 L_om_skip_15
  v_xor_b32 v32, 0, v28
  v_add_u32 v32, 122880, v32
  ds_read_b64_tr_b16 v[184:185], v32 offset:0
  ds_read_b64_tr_b16 v[186:187], v32 offset:1024
  ds_read_b64_tr_b16 v[188:189], v32 offset:8192
  ds_read_b64_tr_b16 v[190:191], v32 offset:9216
  v_xor_b32 v32, 32, v28
  v_add_u32 v32, 122880, v32
  ds_read_b64_tr_b16 v[192:193], v32 offset:0
  ds_read_b64_tr_b16 v[194:195], v32 offset:1024
  ds_read_b64_tr_b16 v[196:197], v32 offset:8192
  ds_read_b64_tr_b16 v[198:199], v32 offset:9216
  s_waitcnt lgkmcnt(0)
  v_xor_b32 v32, 64, v28
  v_add_u32 v32, 122880, v32
  ds_read_b64_tr_b16 v[200:201], v32 offset:0
  ds_read_b64_tr_b16 v[202:203], v32 offset:1024
  ds_read_b64_tr_b16 v[204:205], v32 offset:8192
  ds_read_b64_tr_b16 v[206:207], v32 offset:9216
  v_xor_b32 v32, 96, v28
  v_add_u32 v32, 122880, v32
  ds_read_b64_tr_b16 v[208:209], v32 offset:0
  ds_read_b64_tr_b16 v[210:211], v32 offset:1024
  ds_read_b64_tr_b16 v[212:213], v32 offset:8192
  ds_read_b64_tr_b16 v[214:215], v32 offset:9216
  s_waitcnt lgkmcnt(0)
  v_xor_b32 v32, 128, v28
  v_add_u32 v32, 122880, v32
  ds_read_b64_tr_b16 v[216:217], v32 offset:0
  ds_read_b64_tr_b16 v[218:219], v32 offset:1024
  ds_read_b64_tr_b16 v[220:221], v32 offset:8192
  ds_read_b64_tr_b16 v[222:223], v32 offset:9216
  v_xor_b32 v32, 160, v28
  v_add_u32 v32, 122880, v32
  ds_read_b64_tr_b16 v[224:225], v32 offset:0
  ds_read_b64_tr_b16 v[226:227], v32 offset:1024
  ds_read_b64_tr_b16 v[228:229], v32 offset:8192
  ds_read_b64_tr_b16 v[230:231], v32 offset:9216
  s_waitcnt lgkmcnt(0)
  v_xor_b32 v32, 192, v28
  v_add_u32 v32, 122880, v32
  ds_read_b64_tr_b16 v[232:233], v32 offset:0
  ds_read_b64_tr_b16 v[234:235], v32 offset:1024
  ds_read_b64_tr_b16 v[236:237], v32 offset:8192
  ds_read_b64_tr_b16 v[238:239], v32 offset:9216
  v_xor_b32 v32, 224, v28
  v_add_u32 v32, 122880, v32
  ds_read_b64_tr_b16 v[240:241], v32 offset:0
  ds_read_b64_tr_b16 v[242:243], v32 offset:1024
  ds_read_b64_tr_b16 v[244:245], v32 offset:8192
  ds_read_b64_tr_b16 v[246:247], v32 offset:9216
  s_waitcnt lgkmcnt(0)
L_om_skip_15:
  s_barrier
  s_add_u32 m0, s60, 122880
  s_add_u32 s32, s29, 74304
  buffer_load_dwordx4 v24, s[92:95], s32 offen lds
  s_add_u32 m0, s60, 123904
  s_add_u32 s32, s29, 76608
  buffer_load_dwordx4 v24, s[92:95], s32 offen lds
  s_add_u32 m0, s60, 124928
  s_add_u32 s32, s29, 92736
  buffer_load_dwordx4 v25, s[92:95], s32 offen lds
  s_add_u32 m0, s60, 125952
  s_add_u32 s32, s29, 95040
  buffer_load_dwordx4 v25, s[92:95], s32 offen lds
  s_waitcnt vmcnt(14)
  s_barrier
  s_cmp_eq_u32 s17, 1
  s_cbranch_scc0 L_om_skip_16
  v_xor_b32 v32, 0, v28
  v_add_u32 v32, 139264, v32
  ds_read_b64_tr_b16 v[184:185], v32 offset:0
  ds_read_b64_tr_b16 v[186:187], v32 offset:1024
  ds_read_b64_tr_b16 v[188:189], v32 offset:8192
  ds_read_b64_tr_b16 v[190:191], v32 offset:9216
  v_xor_b32 v32, 32, v28
  v_add_u32 v32, 139264, v32
  ds_read_b64_tr_b16 v[192:193], v32 offset:0
  ds_read_b64_tr_b16 v[194:195], v32 offset:1024
  ds_read_b64_tr_b16 v[196:197], v32 offset:8192
  ds_read_b64_tr_b16 v[198:199], v32 offset:9216
  s_waitcnt lgkmcnt(0)
  v_xor_b32 v32, 64, v28
  v_add_u32 v32, 139264, v32
  ds_read_b64_tr_b16 v[200:201], v32 offset:0
  ds_read_b64_tr_b16 v[202:203], v32 offset:1024
  ds_read_b64_tr_b16 v[204:205], v32 offset:8192
  ds_read_b64_tr_b16 v[206:207], v32 offset:9216
  v_xor_b32 v32, 96, v28
  v_add_u32 v32, 139264, v32
  ds_read_b64_tr_b16 v[208:209], v32 offset:0
  ds_read_b64_tr_b16 v[210:211], v32 offset:1024
  ds_read_b64_tr_b16 v[212:213], v32 offset:8192
  ds_read_b64_tr_b16 v[214:215], v32 offset:9216
  s_waitcnt lgkmcnt(0)
  v_xor_b32 v32, 128, v28
  v_add_u32 v32, 139264, v32
  ds_read_b64_tr_b16 v[216:217], v32 offset:0
  ds_read_b64_tr_b16 v[218:219], v32 offset:1024
  ds_read_b64_tr_b16 v[220:221], v32 offset:8192
  ds_read_b64_tr_b16 v[222:223], v32 offset:9216
  v_xor_b32 v32, 160, v28
  v_add_u32 v32, 139264, v32
  ds_read_b64_tr_b16 v[224:225], v32 offset:0
  ds_read_b64_tr_b16 v[226:227], v32 offset:1024
  ds_read_b64_tr_b16 v[228:229], v32 offset:8192
  ds_read_b64_tr_b16 v[230:231], v32 offset:9216
  s_waitcnt lgkmcnt(0)
  v_xor_b32 v32, 192, v28
  v_add_u32 v32, 139264, v32
  ds_read_b64_tr_b16 v[232:233], v32 offset:0
  ds_read_b64_tr_b16 v[234:235], v32 offset:1024
  ds_read_b64_tr_b16 v[236:237], v32 offset:8192
  ds_read_b64_tr_b16 v[238:239], v32 offset:9216
  v_xor_b32 v32, 224, v28
  v_add_u32 v32, 139264, v32
  ds_read_b64_tr_b16 v[240:241], v32 offset:0
  ds_read_b64_tr_b16 v[242:243], v32 offset:1024
  ds_read_b64_tr_b16 v[244:245], v32 offset:8192
  ds_read_b64_tr_b16 v[246:247], v32 offset:9216
  s_waitcnt lgkmcnt(0)
L_om_skip_16:
  s_barrier
  s_add_u32 m0, s60, 139264
  s_add_u32 s32, s29, 74592
  buffer_load_dwordx4 v24, s[92:95], s32 offen lds
  s_add_u32 m0, s60, 140288
  s_add_u32 s32, s29, 76896
  buffer_load_dwordx4 v24, s[92:95], s32 offen lds
  s_add_u32 m0, s60, 141312
  s_add_u32 s32, s29, 93024
  buffer_load_dwordx4 v25, s[92:95], s32 offen lds
  s_add_u32 m0, s60, 142336
  s_add_u32 s32, s29, 95328
  buffer_load_dwordx4 v25, s[92:95], s32 offen lds
  s_waitcnt vmcnt(14)
  s_barrier
  s_cmp_eq_u32 s17, 2
  s_cbranch_scc0 L_om_skip_17
  v_xor_b32 v32, 0, v28
  ds_read_b64_tr_b16 v[184:185], v32 offset:0
  ds_read_b64_tr_b16 v[186:187], v32 offset:1024
  ds_read_b64_tr_b16 v[188:189], v32 offset:8192
  ds_read_b64_tr_b16 v[190:191], v32 offset:9216
  v_xor_b32 v32, 32, v28
  ds_read_b64_tr_b16 v[192:193], v32 offset:0
  ds_read_b64_tr_b16 v[194:195], v32 offset:1024
  ds_read_b64_tr_b16 v[196:197], v32 offset:8192
  ds_read_b64_tr_b16 v[198:199], v32 offset:9216
  s_waitcnt lgkmcnt(0)
  v_xor_b32 v32, 64, v28
  ds_read_b64_tr_b16 v[200:201], v32 offset:0
  ds_read_b64_tr_b16 v[202:203], v32 offset:1024
  ds_read_b64_tr_b16 v[204:205], v32 offset:8192
  ds_read_b64_tr_b16 v[206:207], v32 offset:9216
  v_xor_b32 v32, 96, v28
  ds_read_b64_tr_b16 v[208:209], v32 offset:0
  ds_read_b64_tr_b16 v[210:211], v32 offset:1024
  ds_read_b64_tr_b16 v[212:213], v32 offset:8192
  ds_read_b64_tr_b16 v[214:215], v32 offset:9216
  s_waitcnt lgkmcnt(0)
  v_xor_b32 v32, 128, v28
  ds_read_b64_tr_b16 v[216:217], v32 offset:0
  ds_read_b64_tr_b16 v[218:219], v32 offset:1024
  ds_read_b64_tr_b16 v[220:221], v32 offset:8192
  ds_read_b64_tr_b16 v[222:223], v32 offset:9216
  v_xor_b32 v32, 160, v28
  ds_read_b64_tr_b16 v[224:225], v32 offset:0
  ds_read_b64_tr_b16 v[226:227], v32 offset:1024
  ds_read_b64_tr_b16 v[228:229], v32 offset:8192
  ds_read_b64_tr_b16 v[230:231], v32 offset:9216
  s_waitcnt lgkmcnt(0)
  v_xor_b32 v32, 192, v28
  ds_read_b64_tr_b16 v[232:233], v32 offset:0
  ds_read_b64_tr_b16 v[234:235], v32 offset:1024
  ds_read_b64_tr_b16 v[236:237], v32 offset:8192
  ds_read_b64_tr_b16 v[238:239], v32 offset:9216
  v_xor_b32 v32, 224, v28
  ds_read_b64_tr_b16 v[240:241], v32 offset:0
  ds_read_b64_tr_b16 v[242:243], v32 offset:1024
  ds_read_b64_tr_b16 v[244:245], v32 offset:8192
  ds_read_b64_tr_b16 v[246:247], v32 offset:9216
  s_waitcnt lgkmcnt(0)
L_om_skip_17:
  s_barrier
  s_lshl_b32 s33, s17, 11
  s_add_u32 m0, s33, 155648
  s_add_u32 s32, s29, 73984
  buffer_load_dwordx4 v26, s[92:95], s32 offen lds
  s_add_u32 m0, s33, 156672
  s_add_u32 s32, s29, 92416
  buffer_load_dwordx4 v27, s[92:95], s32 offen lds
  s_waitcnt vmcnt(12)
  s_barrier
  s_cmp_eq_u32 s17, 3
  s_cbranch_scc0 L_om_skip_18
  v_xor_b32 v32, 0, v28
  v_add_u32 v32, 90112, v32
  ds_read_b64_tr_b16 v[184:185], v32 offset:0
  ds_read_b64_tr_b16 v[186:187], v32 offset:1024
  ds_read_b64_tr_b16 v[188:189], v32 offset:8192
  ds_read_b64_tr_b16 v[190:191], v32 offset:9216
  v_xor_b32 v32, 32, v28
  v_add_u32 v32, 90112, v32
  ds_read_b64_tr_b16 v[192:193], v32 offset:0
  ds_read_b64_tr_b16 v[194:195], v32 offset:1024
  ds_read_b64_tr_b16 v[196:197], v32 offset:8192
  ds_read_b64_tr_b16 v[198:199], v32 offset:9216
  s_waitcnt lgkmcnt(0)
  v_xor_b32 v32, 64, v28
  v_add_u32 v32, 90112, v32
  ds_read_b64_tr_b16 v[200:201], v32 offset:0
  ds_read_b64_tr_b16 v[202:203], v32 offset:1024
  ds_read_b64_tr_b16 v[204:205], v32 offset:8192
  ds_read_b64_tr_b16 v[206:207], v32 offset:9216
  v_xor_b32 v32, 96, v28
  v_add_u32 v32, 90112, v32
  ds_read_b64_tr_b16 v[208:209], v32 offset:0
  ds_read_b64_tr_b16 v[210:211], v32 offset:1024
  ds_read_b64_tr_b16 v[212:213], v32 offset:8192
  ds_read_b64_tr_b16 v[214:215], v32 offset:9216
  s_waitcnt lgkmcnt(0)
  v_xor_b32 v32, 128, v28
  v_add_u32 v32, 90112, v32
  ds_read_b64_tr_b16 v[216:217], v32 offset:0
  ds_read_b64_tr_b16 v[218:219], v32 offset:1024
  ds_read_b64_tr_b16 v[220:221], v32 offset:8192
  ds_read_b64_tr_b16 v[222:223], v32 offset:9216
  v_xor_b32 v32, 160, v28
  v_add_u32 v32, 90112, v32
  ds_read_b64_tr_b16 v[224:225], v32 offset:0
  ds_read_b64_tr_b16 v[226:227], v32 offset:1024
  ds_read_b64_tr_b16 v[228:229], v32 offset:8192
  ds_read_b64_tr_b16 v[230:231], v32 offset:9216
  s_waitcnt lgkmcnt(0)
  v_xor_b32 v32, 192, v28
  v_add_u32 v32, 90112, v32
  ds_read_b64_tr_b16 v[232:233], v32 offset:0
  ds_read_b64_tr_b16 v[234:235], v32 offset:1024
  ds_read_b64_tr_b16 v[236:237], v32 offset:8192
  ds_read_b64_tr_b16 v[238:239], v32 offset:9216
  v_xor_b32 v32, 224, v28
  v_add_u32 v32, 90112, v32
  ds_read_b64_tr_b16 v[240:241], v32 offset:0
  ds_read_b64_tr_b16 v[242:243], v32 offset:1024
  ds_read_b64_tr_b16 v[244:245], v32 offset:8192
  ds_read_b64_tr_b16 v[246:247], v32 offset:9216
  s_waitcnt lgkmcnt(0)
L_om_skip_18:
  s_barrier
  s_add_u32 m0, s60, 90112
  s_add_u32 s32, s29, 73728
  buffer_load_dwordx4 v24, s[92:95], s32 offen lds
  s_add_u32 m0, s60, 91136
  s_add_u32 s32, s29, 76032
  buffer_load_dwordx4 v24, s[92:95], s32 offen lds
  s_add_u32 m0, s60, 92160
  s_add_u32 s32, s29, 92160
  buffer_load_dwordx4 v25, s[92:95], s32 offen lds
  s_add_u32 m0, s60, 93184
  s_add_u32 s32, s29, 94464
  buffer_load_dwordx4 v25, s[92:95], s32 offen lds
  s_waitcnt vmcnt(14)
  s_barrier
  v_add_u32 v32, 106496, v29
  ds_read_b64_tr_b16 v[248:249], v32 offset:0
  ds_read_b64_tr_b16 v[250:251], v32 offset:512
  ds_read_b64_tr_b16 v[252:253], v32 offset:4096
  ds_read_b64_tr_b16 v[254:255], v32 offset:4608
  s_waitcnt lgkmcnt(0)
  s_barrier
  s_add_u32 m0, s60, 106496
  s_add_u32 s32, s29, 74016
  buffer_load_dwordx4 v24, s[92:95], s32 offen lds
  s_add_u32 m0, s60, 107520
  s_add_u32 s32, s29, 76320
  buffer_load_dwordx4 v24, s[92:95], s32 offen lds
  s_add_u32 m0, s60, 108544
  s_add_u32 s32, s29, 92448
  buffer_load_dwordx4 v25, s[92:95], s32 offen lds
  s_add_u32 m0, s60, 109568
  s_add_u32 s32, s29, 94752
  buffer_load_dwordx4 v25, s[92:95], s32 offen lds
  s_waitcnt vmcnt(0)
  s_barrier
  s_lshl_b32 s33, s17, 14
  s_add_u32 s33, s33, 90112
  v_add_u32 v1, s33, v28
  v_add_u32 v2, 155648, v29
  v_xor_b32 v3, 0, v1
  ds_read_b64_tr_b16 v[8:9], v3 offset:0
  ds_read_b64_tr_b16 v[10:11], v3 offset:1024
  ds_read_b64_tr_b16 v[12:13], v3 offset:8192
  ds_read_b64_tr_b16 v[14:15], v3 offset:9216
  v_xor_b32 v3, 32, v1
  ds_read_b64_tr_b16 v[16:17], v3 offset:0
  ds_read_b64_tr_b16 v[18:19], v3 offset:1024
  ds_read_b64_tr_b16 v[20:21], v3 offset:8192
  ds_read_b64_tr_b16 v[22:23], v3 offset:9216
  s_waitcnt lgkmcnt(0)
  v_xor_b32 v3, 64, v1
  ds_read_b64_tr_b16 v[24:25], v3 offset:0
  ds_read_b64_tr_b16 v[26:27], v3 offset:1024
  ds_read_b64_tr_b16 v[28:29], v3 offset:8192
  ds_read_b64_tr_b16 v[30:31], v3 offset:9216
  v_xor_b32 v3, 96, v1
  ds_read_b64_tr_b16 v[32:33], v3 offset:0
  ds_read_b64_tr_b16 v[34:35], v3 offset:1024
  ds_read_b64_tr_b16 v[36:37], v3 offset:8192
  ds_read_b64_tr_b16 v[38:39], v3 offset:9216
  s_waitcnt lgkmcnt(0)
  v_xor_b32 v3, 128, v1
  ds_read_b64_tr_b16 v[40:41], v3 offset:0
  ds_read_b64_tr_b16 v[42:43], v3 offset:1024
  ds_read_b64_tr_b16 v[44:45], v3 offset:8192
  ds_read_b64_tr_b16 v[46:47], v3 offset:9216
  v_xor_b32 v3, 160, v1
  ds_read_b64_tr_b16 v[48:49], v3 offset:0
  ds_read_b64_tr_b16 v[50:51], v3 offset:1024
  ds_read_b64_tr_b16 v[52:53], v3 offset:8192
  ds_read_b64_tr_b16 v[54:55], v3 offset:9216
  s_waitcnt lgkmcnt(0)
  v_xor_b32 v3, 192, v1
  ds_read_b64_tr_b16 v[56:57], v3 offset:0
  ds_read_b64_tr_b16 v[58:59], v3 offset:1024
  ds_read_b64_tr_b16 v[60:61], v3 offset:8192
  ds_read_b64_tr_b16 v[62:63], v3 offset:9216
  v_xor_b32 v3, 224, v1
  ds_read_b64_tr_b16 v[64:65], v3 offset:0
  ds_read_b64_tr_b16 v[66:67], v3 offset:1024
  ds_read_b64_tr_b16 v[68:69], v3 offset:8192
  ds_read_b64_tr_b16 v[70:71], v3 offset:9216
  s_waitcnt lgkmcnt(0)
  ds_read_b64_tr_b16 v[72:73], v2 offset:0
  ds_read_b64_tr_b16 v[74:75], v2 offset:512
  ds_read_b64_tr_b16 v[76:77], v2 offset:4096
  ds_read_b64_tr_b16 v[78:79], v2 offset:4608
  s_waitcnt lgkmcnt(0)
  s_barrier
  v_add_u32 v1, 73728, v4
  ds_write_b128 v1, v[8:11] offset:0
  ds_write_b128 v1, v[12:15] offset:1024
  ds_write_b128 v1, v[16:19] offset:2048
  ds_write_b128 v1, v[20:23] offset:3072
  ds_write_b128 v1, v[24:27] offset:4096
  ds_write_b128 v1, v[28:31] offset:5120
  ds_write_b128 v1, v[32:35] offset:6144
  ds_write_b128 v1, v[36:39] offset:7168
  s_waitcnt lgkmcnt(0)
  ds_write_b128 v1, v[40:43] offset:8192
  ds_write_b128 v1, v[44:47] offset:9216
  ds_write_b128 v1, v[48:51] offset:10240
  ds_write_b128 v1, v[52:55] offset:11264
  ds_write_b128 v1, v[56:59] offset:12288
  ds_write_b128 v1, v[60:63] offset:13312
  ds_write_b128 v1, v[64:67] offset:14336
  ds_write_b128 v1, v[68:71] offset:15360
  s_waitcnt lgkmcnt(0)
  ds_write_b128 v1, v[72:75] offset:16384
  ds_write_b128 v1, v[76:79] offset:17408
  s_waitcnt lgkmcnt(0)
  v_lshrrev_b32 v21, 4, v0
  v_lshrrev_b32 v22, 4, v21
  v_and_b32 v23, 15, v21
  v_mov_b32 v16, 0x4444
  v_mov_b32 v17, 0xeeee
  v_and_b32 v18, 2, v23
  v_cmp_eq_u32 vcc, 0, v18
  s_nop 1
  v_cndmask_b32 v1, v17, v16, vcc
  v_lshlrev_b32 v16, 2, v22
  v_sub_u32 v16, v23, v16
  v_mov_b32 v17, 0x3f80
  v_mov_b32 v18, 0x3f800000
  v_mov_b32 v19, 0
  v_cmp_eq_u32 vcc, 2, v16
  s_nop 1
  v_cndmask_b32 v2, v19, v17, vcc
  v_cmp_eq_u32 vcc, 3, v16
  s_nop 1
  v_cndmask_b32 v2, v2, v18, vcc
  v_cmp_eq_u32 vcc, 0, v16
  s_nop 1
  v_cndmask_b32 v3, v19, v17, vcc
  v_cmp_eq_u32 vcc, 1, v16
  s_nop 1
  v_cndmask_b32 v3, v3, v18, vcc
  v_lshrrev_b32 v16, 2, v23
  v_lshlrev_b32 v16, 1, v16
  v_lshl_add_u32 v16, v22, 3, v16
  v_and_b32 v17, 1, v23
  v_add_u32 v16, v16, v17
  s_mul_i32 s24, s17, 1280
  s_add_u32 s24, s24, 9216
  v_lshl_add_u32 v5, v16, 4, s24
  v_lshl_add_u32 v6, v16, 3, s24
  v_and_b32 v17, 2, v23
  v_xor_b32 v17, 2, v17
  v_lshlrev_b32 v18, 4, v16
  v_lshlrev_b32 v19, 6, v17
  v_xor_b32 v18, v18, v19
  v_lshl_add_u32 v18, v17, 8, v18
  v_add_u32 v7, 9472, v18
  v_lshlrev_b32 v18, 1, v17
  v_lshl_add_u32 v18, v16, 3, v18
  v_add_u32 v8, 9216, v18
  v_lshrrev_b32 v16, 1, v22
  v_lshlrev_b32 v16, 4, v16
  v_lshrrev_b32 v17, 2, v23
  v_lshl_add_u32 v16, v17, 2, v16
  v_and_b32 v17, 1, v22
  v_lshl_add_u32 v16, v17, 1, v16
  v_and_b32 v17, 1, v23
  v_add_u32 v16, v16, v17
  s_and_b32 s24, s17, 1
  s_lshl_b32 s24, s24, 9
  s_lshr_b32 s25, s17, 1
  s_lshl_b32 s25, s25, 10
  s_add_u32 s24, s24, s25
  s_add_u32 s24, s24, 14336
  v_lshl_add_u32 v9, v16, 4, s24
  v_lshrrev_b32 v16, 2, v23
  v_lshl_add_u32 v16, v16, 2, v22
  s_movk_i32 s27, 9344
  v_mul_lo_u32 v16, v16, s27
  v_and_b32 v17, 3, v23
  v_lshl_add_u32 v10, v17, 4, v16
  v_mov_b32 v20, 0x40000000
  v_lshrrev_b32 v16, 2, v23
  v_lshlrev_b32 v16, 1, v16
  v_and_b32 v17, 1, v23
  v_add_u32 v16, v16, v17
  v_lshrrev_b32 v17, 1, v22
  v_lshl_add_u32 v16, v16, 1, v17
  v_lshlrev_b32 v16, 4, v16
  v_and_b32 v17, 1, v22
  v_lshl_add_u32 v16, v17, 3, v16
  v_and_b32 v17, 2, v23
  v_cmp_ne_u32 vcc, 0, v17
  s_nop 1
  v_cndmask_b32 v11, v20, v16, vcc
  s_lshl_b32 s24, s17, 2
  v_add_u32 v16, s24, v23
  v_bfe_u32 v17, v16, 1, 2
  v_lshlrev_b32 v17, 4, v17
  v_and_b32 v18, 1, v16
  v_lshl_add_u32 v17, v18, 1, v17
  s_and_b32 s25, s16, 3
  s_lshl_b32 s25, s25, 2
  v_add3_u32 v17, v17, v22, s25
  s_lshr_b32 s26, s16, 2
  s_and_b32 s26, s26, 1
  s_lshl_b32 s26, s26, 1
  v_lshlrev_b32 v17, 2, v17
  v_add_u32 v17, s26, v17
  v_and_b32 v18, 63, v17
  v_lshrrev_b32 v17, 6, v17
  v_lshl_add_u32 v17, v18, 2, v17
  v_lshlrev_b32 v17, 2, v17
  v_lshrrev_b32 v18, 3, v16
  s_lshr_b32 s26, s16, 3
  s_lshl_b32 s26, s26, 1
  v_add_u32 v18, s26, v18
  v_lshl_add_u32 v17, v18, 10, v17
  v_and_b32 v16, 1, v23
  v_lshrrev_b32 v18, 1, v23
  v_lshl_add_u32 v16, v16, 1, v18
  s_lshr_b32 s24, s16, 2
  s_lshl_b32 s24, s24, 4
  s_and_b32 s25, s16, 3
  s_lshl_b32 s25, s25, 2
  s_add_u32 s24, s24, s25
  v_add_u32 v16, s24, v16
  v_lshlrev_b32 v16, 4, v16
  v_and_b32 v18, 1, v22
  v_lshl_add_u32 v19, v18, 3, v16
  v_add_u32 v19, 8192, v19
  s_cmp_lt_u32 s16, 16
  s_cselect_b32 s27, 1, 0
  s_cmp_eq_u32 s17, 0
  s_cselect_b32 s27, s27, 0
  s_cmp_eq_u32 s27, 1
  s_cselect_b64 vcc, -1, 0
  v_cndmask_b32 v19, v20, v19, vcc
  v_add_u32 v16, 16, v17
  v_add_u32 v18, 4, v19
  v_cmp_gt_u32 vcc, 2, v22
  s_nop 1
  v_cndmask_b32 v13, v19, v17, vcc
  v_cndmask_b32 v12, v18, v16, vcc
  v_cmp_gt_u32 vcc, 4, v23
  s_nop 1
  v_cndmask_b32 v13, v20, v13, vcc
  v_cndmask_b32 v12, v20, v12, vcc
  v_lshlrev_b32 v16, 3, v0
  v_mov_b32 v17, 0xfff800
  v_cmp_lt_u32 vcc, 15, v21
  s_nop 1
  v_cndmask_b32 v17, 0, v17, vcc
  v_add_u32 v16, v16, v17
  v_cmp_lt_u32 vcc, 31, v21
  s_nop 1
  v_cndmask_b32 v14, v16, v20, vcc
  s_mov_b32 s40, 0xcccccccc
  s_mov_b32 s41, 0xcccccccc
  s_mov_b32 s80, 0x30003
  s_mov_b32 s81, 0x30003
  s_mov_b32 s82, 0xc000c
  s_mov_b32 s83, 0xc000c
  s_mov_b32 s84, 0x300030
  s_mov_b32 s85, 0x300030
  s_mov_b32 s86, 0xc000c0
  s_mov_b32 s87, 0xc000c0
  s_mov_b32 s88, 0xaaaaaaaa
  s_mov_b32 s89, 0xaaaaaaaa
  s_load_dwordx2 s[8:9], s[0:1], 8
  s_mov_b32 s10, 0x2400
  s_mov_b32 s11, 0x00020000
  s_waitcnt lgkmcnt(0)
  s_and_b32 s9, s9, 0xffff
  v_lshrrev_b32 v16, 4, v0
  v_bfe_u32 v17, v16, 2, 2
  v_lshlrev_b32 v17, 1, v17
  v_and_b32 v18, 1, v16
  v_add_u32 v17, v17, v18
  v_bfe_u32 v18, v16, 1, 1
  v_lshrrev_b32 v19, 4, v16
  v_lshl_add_u32 v18, v19, 1, v18
  v_mul_u32_u24 v17, 1152, v17
  s_lshr_b32 s24, s17, 1
  s_mul_i32 s24, s24, 144
  s_and_b32 s25, s17, 1
  s_lshl_b32 s25, s25, 3
  s_add_u32 s24, s24, s25
  v_add_u32 v20, s24, v18
  v_lshl_add_u32 v20, v20, 1, v17
  v_mul_u32_u24 v21, 288, v19
  v_bfe_u32 v22, v16, 1, 1
  v_lshl_add_u32 v21, v22, 4, v21
  v_add3_u32 v21, v21, v17, 0
  buffer_load_ushort v40, v20, s[8:11], 0 offen offset:0
  buffer_load_ushort v41, v20, s[8:11], 0 offen offset:32
  buffer_load_ushort v42, v20, s[8:11], 0 offen offset:64
  buffer_load_ushort v43, v20, s[8:11], 0 offen offset:96
  buffer_load_ushort v44, v20, s[8:11], 0 offen offset:128
  buffer_load_ushort v45, v20, s[8:11], 0 offen offset:160
  buffer_load_ushort v46, v20, s[8:11], 0 offen offset:192
  buffer_load_ushort v47, v20, s[8:11], 0 offen offset:224
  s_waitcnt vmcnt(0)
  v_lshl_or_b32 v24, v41, 16, v40
  v_lshl_or_b32 v25, v43, 16, v42
  v_lshl_or_b32 v26, v45, 16, v44
  v_lshl_or_b32 v27, v47, 16, v46
  buffer_load_ushort v40, v20, s[8:11], 0 offen offset:576
  buffer_load_ushort v41, v20, s[8:11], 0 offen offset:608
  buffer_load_ushort v42, v20, s[8:11], 0 offen offset:640
  buffer_load_ushort v43, v20, s[8:11], 0 offen offset:672
  buffer_load_ushort v44, v20, s[8:11], 0 offen offset:704
  buffer_load_ushort v45, v20, s[8:11], 0 offen offset:736
  buffer_load_ushort v46, v20, s[8:11], 0 offen offset:768
  buffer_load_ushort v47, v20, s[8:11], 0 offen offset:800
  s_waitcnt vmcnt(0)
  v_lshl_or_b32 v28, v41, 16, v40
  v_lshl_or_b32 v29, v43, 16, v42
  v_lshl_or_b32 v30, v45, 16, v44
  v_lshl_or_b32 v31, v47, 16, v46
  buffer_load_dwordx4 v[32:35], v21, s[8:11], 0 offen offset:256
  s_waitcnt vmcnt(0)
  s_lshl_b32 s24, s17, 10
  v_add_u32 v36, s24, v0
  ds_write_b128 v36, v[24:27] offset:0
  ds_write_b128 v36, v[28:31] offset:4096
  ds_write_b128 v0, v[32:35] offset:8192
  s_waitcnt lgkmcnt(0)
  s_barrier
  v_mov_b32 v16, 128
  s_mov_b32 s24, 262144
L_wc_19:
  buffer_load_dword v17, v16, s[12:15], 0 offen sc1
  s_waitcnt vmcnt(0)
  v_cmp_gt_u32 vcc, 33, v17
  s_cbranch_vccz L_wc_ok_20
  s_sleep 8
  s_sub_u32 s24, s24, 1
  s_cmp_lg_u32 s24, 0
  s_cbranch_scc1 L_wc_19
  s_branch L_fail
L_wc_ok_20:
  v_mov_b32 v16, 0
  buffer_load_dword v17, v16, s[12:15], 0 offen sc1
  s_waitcnt vmcnt(0)
  v_readfirstlane_b32 s24, v17
  s_nop 0
  s_cmp_ge_u32 s24, 32
  s_cselect_b32 s19, 1, 0
  v_mov_b32 v16, 160
  s_mov_b32 s24, 262144
L_wc_21:
  buffer_load_dword v17, v16, s[12:15], 0 offen sc1
  s_waitcnt vmcnt(0)
  v_cmp_gt_u32 vcc, 64, v17
  s_cbranch_vccz L_wc_ok_22
  s_sleep 8
  s_sub_u32 s24, s24, 1
  s_cmp_lg_u32 s24, 0
  s_cbranch_scc1 L_wc_21
  s_branch L_fail
L_wc_ok_22:
  s_cmp_eq_u32 s19, 1
  s_cbranch_scc0 L_rec_slow_23
  s_mov_b32 s18, 0
  s_lshl_b32 s24, s16, 13
  s_lshl_b32 s25, s17, 11
  s_add_u32 s42, s24, s25
  s_add_u32 s43, s42, 0x1000000
  s_lshl_b32 s24, s16, 12
  s_lshl_b32 s26, s17, 10
  s_add_u32 s44, s24, s26
  s_add_u32 s44, s44, 0x3000000
  s_lshl_b32 s24, s16, 11
  s_lshl_b32 s26, s17, 9
  s_add_u32 s45, s24, s26
  s_add_u32 s45, s45, 0x3800000
  s_lshl_b32 s28, s16, 2
  s_add_u32 s28, s28, s17
  s_lshl_b32 s28, s28, 6
  s_add_u32 s47, s28, 0x3c00000
  s_add_u32 s48, s28, 0x3c49000
  s_lshl_b32 s28, s16, 6
  s_add_u32 s55, s28, 0x3c02000
  s_add_u32 s56, s28, 0x3c4b000
  s_cmp_lt_u32 s16, 16
  s_cselect_b32 s57, 1, 0
  s_cmp_eq_u32 s17, 0
  s_cselect_b32 s57, s57, 0
  s_mul_i32 s24, s16, 9344
  s_add_u32 s26, s24, s25
  s_add_u32 s49, s26, 0x3c00000
  s_add_u32 s50, s26, 0x3c49000
  s_lshl_b32 s27, s17, 8
  s_add_u32 s58, s27, 8192
  s_add_u32 s27, s27, s24
  s_add_u32 s51, s27, 0x3c02000
  s_add_u32 s52, s27, 0x3c4b000
  s_lshl_b32 s62, s16, 5
  s_add_u32 s62, s62, s17
  s_lshl_b32 s62, s62, 2
  s_add_u32 s62, s62, 0xe902000
  s_mul_i32 s63, s17, 1280
  s_add_u32 s63, s63, 9216
  s_lshl_b32 s59, s17, 10
  s_mov_b32 s53, 0x3d02400
  s_mov_b32 s54, 0x3d00000
  v_mov_b64 v[44:45], 0
  v_mov_b64 v[46:47], 0
  v_mov_b64 v[48:49], 0
  v_mov_b64 v[50:51], 0
  v_mov_b64 v[52:53], 0
  v_mov_b64 v[54:55], 0
  v_mov_b64 v[56:57], 0
  v_mov_b64 v[58:59], 0
  buffer_load_dwordx4 v[16:19], v0, s[4:7], s42 offen
.p2align 6
L_rec_top_25:
  ds_read_b128 v[32:35], v0 offset:0
  ds_read_b128 v[64:67], v4 offset:0
  ds_read_b128 v[68:71], v4 offset:1024
  ds_read_b128 v[36:39], v0 offset:1024
  ds_read_b128 v[40:43], v0 offset:2048
  v_mov_b64 v[60:61], -1
  v_mov_b64 v[62:63], -1
  s_waitcnt lgkmcnt(4)
  v_smfmac_f32_16x16x64_bf16 v[44:47], v[32:35], a[0:7], v1
  ds_read_b128 v[72:75], v4 offset:2048
  v_smfmac_f32_16x16x64_bf16 v[48:51], v[32:35], a[8:15], v1
  ds_read_b128 v[76:79], v4 offset:3072
  v_smfmac_f32_16x16x64_bf16 v[52:55], v[32:35], v[112:119], v1
  buffer_load_dwordx4 v[20:23], v0, s[4:7], s42 offen offset:1024
  s_waitcnt lgkmcnt(4)
  v_smfmac_f32_16x16x64_bf16 v[56:59], v[32:35], v[64:71], v1
  ds_read_b128 v[32:35], v0 offset:3072
  s_waitcnt lgkmcnt(4)
  v_smfmac_f32_16x16x64_bf16 v[44:47], v[36:39], a[16:23], v1
  ds_read_b128 v[64:67], v4 offset:4096
  v_smfmac_f32_16x16x64_bf16 v[48:51], v[36:39], a[24:31], v1
  ds_read_b128 v[68:71], v4 offset:5120
  v_smfmac_f32_16x16x64_bf16 v[52:55], v[36:39], v[120:127], v1
  buffer_load_dwordx4 v[24:27], v0, s[4:7], s43 offen
  s_waitcnt lgkmcnt(3)
  v_smfmac_f32_16x16x64_bf16 v[56:59], v[36:39], v[72:79], v1
  ds_read_b128 v[36:39], v0 offset:4096
  v_smfmac_f32_16x16x64_bf16 v[44:47], v[40:43], a[32:39], v1
  ds_read_b128 v[72:75], v4 offset:6144
  v_smfmac_f32_16x16x64_bf16 v[48:51], v[40:43], a[40:47], v1
  ds_read_b128 v[76:79], v4 offset:7168
  v_smfmac_f32_16x16x64_bf16 v[52:55], v[40:43], v[128:135], v1
  buffer_load_dwordx4 v[28:31], v0, s[4:7], s43 offen offset:1024
  s_waitcnt lgkmcnt(3)
  v_smfmac_f32_16x16x64_bf16 v[56:59], v[40:43], v[64:71], v1
  ds_read_b128 v[40:43], v0 offset:5120
  v_smfmac_f32_16x16x64_bf16 v[44:47], v[32:35], a[48:55], v1
  ds_read_b128 v[64:67], v4 offset:8192
  v_smfmac_f32_16x16x64_bf16 v[48:51], v[32:35], a[56:63], v1
  ds_read_b128 v[68:71], v4 offset:9216
  v_smfmac_f32_16x16x64_bf16 v[52:55], v[32:35], v[136:143], v1
  s_add_u32 s29, s42, 0x80000
  buffer_load_dword v15, v14, s[4:7], s29 offen
  buffer_store_dwordx4 v[60:63], v0, s[4:7], s50 offen
  s_waitcnt lgkmcnt(3)
  v_smfmac_f32_16x16x64_bf16 v[56:59], v[32:35], v[72:79], v1
  ds_read_b128 v[32:35], v0 offset:6144
  v_smfmac_f32_16x16x64_bf16 v[44:47], v[36:39], a[64:71], v1
  ds_read_b128 v[72:75], v4 offset:10240
  v_smfmac_f32_16x16x64_bf16 v[48:51], v[36:39], a[72:79], v1
  ds_read_b128 v[76:79], v4 offset:11264
  v_smfmac_f32_16x16x64_bf16 v[52:55], v[36:39], v[144:151], v1
  buffer_store_dwordx4 v[60:63], v0, s[4:7], s50 offen offset:1024
  s_waitcnt lgkmcnt(3)
  v_smfmac_f32_16x16x64_bf16 v[56:59], v[36:39], v[64:71], v1
  ds_read_b128 v[36:39], v0 offset:7168
  v_smfmac_f32_16x16x64_bf16 v[44:47], v[40:43], a[80:87], v1
  ds_read_b128 v[64:67], v4 offset:12288
  v_smfmac_f32_16x16x64_bf16 v[48:51], v[40:43], a[88:95], v1
  ds_read_b128 v[68:71], v4 offset:13312
  v_smfmac_f32_16x16x64_bf16 v[52:55], v[40:43], v[152:159], v1
  buffer_store_dwordx2 v[60:61], v11, s[4:7], s52 offen
  s_waitcnt lgkmcnt(3)
  v_smfmac_f32_16x16x64_bf16 v[56:59], v[40:43], v[72:79], v1
  ds_read_b128 v[40:43], v0 offset:8192
  v_smfmac_f32_16x16x64_bf16 v[44:47], v[32:35], a[96:103], v1
  ds_read_b128 v[72:75], v4 offset:14336
  v_smfmac_f32_16x16x64_bf16 v[48:51], v[32:35], a[104:111], v1
  ds_read_b128 v[76:79], v4 offset:15360
  v_smfmac_f32_16x16x64_bf16 v[52:55], v[32:35], v[160:167], v1
  buffer_store_dword v60, v13, s[4:7], s53 offen
  s_waitcnt lgkmcnt(3)
  v_smfmac_f32_16x16x64_bf16 v[56:59], v[32:35], v[64:71], v1
  ds_read_b128 v[32:35], v0 offset:0
  v_smfmac_f32_16x16x64_bf16 v[44:47], v[36:39], a[112:119], v1
  ds_read_b128 v[64:67], v4 offset:16384
  v_smfmac_f32_16x16x64_bf16 v[48:51], v[36:39], a[120:127], v1
  ds_read_b128 v[68:71], v4 offset:17408
  v_smfmac_f32_16x16x64_bf16 v[52:55], v[36:39], v[168:175], v1
  buffer_store_dword v60, v12, s[4:7], s53 offen
  s_waitcnt lgkmcnt(3)
  v_smfmac_f32_16x16x64_bf16 v[56:59], v[36:39], v[72:79], v1
  ds_read_b128 v[36:39], v0 offset:1024
  v_smfmac_f32_16x16x64_bf16 v[44:47], v[40:43], a[128:135], v1
  v_mov_b64 v[72:73], 0
  v_smfmac_f32_16x16x64_bf16 v[48:51], v[40:43], a[136:143], v1
  v_mov_b64 v[74:75], 0
  v_smfmac_f32_16x16x64_bf16 v[52:55], v[40:43], v[176:183], v1
  v_mov_b64 v[76:77], 0
  s_waitcnt lgkmcnt(1)
  v_smfmac_f32_16x16x64_bf16 v[56:59], v[40:43], v[64:71], v1
  ds_read_b128 v[40:43], v0 offset:2048
  v_mov_b64 v[78:79], 0
  s_nop 0
  v_smfmac_f32_16x16x64_bf16 v[72:75], v[32:35], a[144:151], v1
  v_smfmac_f32_16x16x64_bf16 v[76:79], v[32:35], a[152:159], v1
  ds_read_b128 v[32:35], v0 offset:3072
  v_add_f32 v44, v44, v46
  v_add_f32 v45, v45, v47
  v_add_f32 v48, v48, v50
  v_add_f32 v49, v49, v51
  v_add_f32 v52, v52, v54
  v_add_f32 v53, v53, v55
  v_add_f32 v56, v56, v58
  v_add_f32 v57, v57, v59
  v_cvt_pk_bf16_f32 v44, v44, v45
  v_cvt_pk_bf16_f32 v48, v48, v49
  v_cvt_pk_bf16_f32 v45, v52, v53
  v_cvt_pk_bf16_f32 v49, v56, v57
  s_nop 1
  v_mfma_f32_16x16x16_bf16 v[52:55], v[44:45], v[2:3], 0
  v_mfma_f32_16x16x16_bf16 v[56:59], v[48:49], v[2:3], 0
  s_waitcnt lgkmcnt(2)
  v_smfmac_f32_16x16x64_bf16 v[72:75], v[36:39], a[160:167], v1
  v_smfmac_f32_16x16x64_bf16 v[76:79], v[36:39], a[168:175], v1
  ds_read_b128 v[36:39], v0 offset:4096
  s_nop 3
  v_cvt_pk_bf16_f32 v44, v52, v53
  v_cvt_pk_bf16_f32 v45, v54, v55
  v_cvt_pk_bf16_f32 v46, v56, v57
  v_cvt_pk_bf16_f32 v47, v58, v59
  v_xor_b32 v60, 128, v5
  s_waitcnt vmcnt(8)
  s_nop 0
  v_mfma_f32_16x16x32_bf16 v[48:51], v[44:47], v[44:47], 0
  v_mfma_f32_16x16x32_bf16 v[52:55], v[16:19], v[44:47], 0
  v_mfma_f32_16x16x32_bf16 v[56:59], v[20:23], v[44:47], 0
  s_waitcnt lgkmcnt(2)
  v_smfmac_f32_16x16x64_bf16 v[72:75], v[40:43], a[176:183], v1
  v_smfmac_f32_16x16x64_bf16 v[76:79], v[40:43], a[184:191], v1
  ds_read_b128 v[40:43], v0 offset:5120
  s_mov_b64 exec, s[40:41]
  s_nop 2
  ds_write_b64 v6, v[48:49]
  ds_write_b128 v5, v[52:55] offset:256
  ds_write_b128 v60, v[56:59] offset:768
  s_mov_b64 exec, -1
  buffer_store_dwordx4 v[44:47], v0, s[4:7], s44 offen sc1
  v_mov_b32 v61, s18
  buffer_store_dword v61, off, s[4:7], s62 sc1
  s_and_b32 s30, s18, 7
  s_cmp_eq_u32 s30, 5
  s_cbranch_scc0 L_kvq_27
  s_lshr_b32 s30, s18, 3
  s_lshl_b32 s30, s30, 2
  s_add_u32 s30, s30, 164
  buffer_load_dword v15, off, s[12:15], s30 sc1
L_kvq_27:
  s_waitcnt lgkmcnt(5)
  v_smfmac_f32_16x16x64_bf16 v[72:75], v[32:35], a[192:199], v1
  v_smfmac_f32_16x16x64_bf16 v[76:79], v[32:35], a[200:207], v1
  ds_read_b128 v[32:35], v0 offset:6144
  s_waitcnt lgkmcnt(0)
  s_barrier
  ds_read_b128 v[52:55], v7 offset:0
  ds_read_b128 v[56:59], v7 offset:1280
  ds_read_b128 v[16:19], v7 offset:2560
  ds_read_b128 v[20:23], v7 offset:3840
  ds_read_b32 v48, v8 offset:0
  ds_read_b32 v49, v8 offset:1280
  ds_read_b32 v50, v8 offset:2560
  ds_read_b32 v51, v8 offset:3840
  v_smfmac_f32_16x16x64_bf16 v[72:75], v[36:39], a[208:215], v1
  v_smfmac_f32_16x16x64_bf16 v[76:79], v[36:39], a[216:223], v1
  ds_read_b128 v[36:39], v0 offset:7168
  v_smfmac_f32_16x16x64_bf16 v[72:75], v[40:43], a[224:231], v1
  v_smfmac_f32_16x16x64_bf16 v[76:79], v[40:43], a[232:239], v1
  ds_read_b128 v[40:43], v0 offset:8192
  v_smfmac_f32_16x16x64_bf16 v[72:75], v[32:35], a[240:247], v1
  v_smfmac_f32_16x16x64_bf16 v[76:79], v[32:35], a[248:255], v1
  s_waitcnt lgkmcnt(1)
  v_smfmac_f32_16x16x64_bf16 v[72:75], v[36:39], v[80:87], v1
  v_smfmac_f32_16x16x64_bf16 v[76:79], v[36:39], v[88:95], v1
  v_add_f32 v52, v52, v56
  v_add_f32 v53, v53, v57
  v_add_f32 v54, v54, v58
  v_add_f32 v55, v55, v59
  v_add_f32 v16, v16, v20
  v_add_f32 v17, v17, v21
  v_add_f32 v18, v18, v22
  v_add_f32 v19, v19, v23
  v_add_f32 v48, v48, v49
  v_add_f32 v50, v50, v51
  v_add_f32 v52, v52, v16
  v_add_f32 v53, v53, v17
  v_add_f32 v54, v54, v18
  v_add_f32 v55, v55, v19
  v_add_f32 v48, v48, v50
  v_max3_f32 v44, v52, v53, v54
  v_max3_f32 v44, v44, v55, v48
  s_waitcnt lgkmcnt(0)
  v_smfmac_f32_16x16x64_bf16 v[72:75], v[40:43], v[96:103], v1
  s_nop 0
  v_max_f32_dpp v44, v44, v44 quad_perm:[2,3,0,1] row_mask:0xf bank_mask:0xf
  v_mov_b32 v45, v44
  v_smfmac_f32_16x16x64_bf16 v[76:79], v[40:43], v[104:111], v1
  s_nop 0
  v_permlane16_swap_b32 v44, v45
  v_max_f32 v44, v44, v45
  v_mov_b32 v45, v44
  v_lshrrev_b32 v62, 1, v0
  v_add_u32 v4, 73728, v4
  v_permlane32_swap_b32 v44, v45
  v_max_f32 v44, v44, v45
  s_mov_b32 s30, 0x3e0293ee
  v_mul_f32 v44, s30, v44
  v_add_f32 v72, v72, v74
  v_add_f32 v73, v73, v75
  v_add_f32 v76, v76, v78
  v_add_f32 v77, v77, v79
  v_cvt_pk_bf16_f32 v60, v72, v73
  v_cvt_pk_bf16_f32 v61, v76, v77
  buffer_store_dwordx2 v[60:61], v62, s[4:7], s45 offen sc1
  v_fma_f32 v52, v52, s30, -v44
  v_fma_f32 v53, v53, s30, -v44
  v_fma_f32 v54, v54, s30, -v44
  v_fma_f32 v55, v55, s30, -v44
  v_fma_f32 v48, v48, s30, -v44
  v_exp_f32 v52, v52
  v_exp_f32 v53, v53
  v_exp_f32 v54, v54
  v_exp_f32 v55, v55
  v_exp_f32 v48, v48
  v_mov_b32 v44, 0x3f803f80
  v_mov_b32 v45, 0x3f803f80
  v_mov_b32 v46, 0x3f803f80
  v_mov_b32 v47, 0x3f803f80
  v_cvt_pk_bf16_f32 v16, v52, v53
  v_cvt_pk_bf16_f32 v17, v54, v55
  v_mov_b32_dpp v49, v48 quad_perm:[2,3,0,1] row_mask:0xf bank_mask:0xf
  v_mov_b32 v21, 0
  v_mov_b32_dpp v18, v16 quad_perm:[2,3,0,1] row_mask:0xf bank_mask:0xf
  v_mov_b32_dpp v19, v17 quad_perm:[2,3,0,1] row_mask:0xf bank_mask:0xf
  v_cvt_pk_bf16_f32 v20, v48, v49
  v_cvt_pk_bf16_f32 v23, v48, v49
  v_mov_b32 v22, 0
  s_waitcnt vmcnt(9)
  s_nop 0
  v_mfma_f32_16x16x32_bf16 v[48:51], v[44:47], v[16:19], 0
  v_mfma_f32_16x16x32_bf16 v[52:55], v[24:27], v[16:19], 0
  v_mfma_f32_16x16x32_bf16 v[56:59], v[28:31], v[16:19], 0
  v_mov_b64 v[32:33], 0
  v_mov_b64 v[34:35], 0
  v_mov_b64 v[36:37], 0
  v_mov_b64 v[38:39], 0
  v_mfma_f32_16x16x16_bf16 v[48:51], v[44:45], v[20:21], v[48:51]
  v_mfma_f32_16x16x16_bf16 v[52:55], v[60:61], v[20:21], v[52:55]
  v_mfma_f32_16x16x16_bf16 v[56:59], v[60:61], v[22:23], v[56:59]
  s_cmp_eq_u32 s18, 63
  s_cbranch_scc1 L_rec_done_26
  ds_read_b128 v[64:67], v4 offset:16384
  ds_read_b128 v[68:71], v4 offset:17408
  ds_read_b128 v[72:75], v4 offset:0
  ds_read_b128 v[76:79], v4 offset:1024
  v_rcp_f32 v46, v48
  v_mov_b64 v[24:25], 0
  v_mov_b64 v[26:27], 0
  v_mul_f32 v52, v52, v46
  v_mul_f32 v53, v53, v46
  v_mul_f32 v54, v54, v46
  v_mul_f32 v55, v55, v46
  v_mul_f32 v56, v56, v46
  v_mul_f32 v57, v57, v46
  v_mul_f32 v58, v58, v46
  v_mul_f32 v59, v59, v46
  v_cvt_pk_bf16_f32 v44, v52, v53
  v_cvt_pk_bf16_f32 v45, v54, v55
  v_cvt_pk_bf16_f32 v46, v56, v57
  v_cvt_pk_bf16_f32 v47, v58, v59
  s_mov_b64 exec, s[40:41]
  ds_write_b128 v9, v[44:47]
  s_mov_b64 exec, -1
  v_mov_b64 v[28:29], 0
  v_mov_b64 v[30:31], 0
  v_mov_b64 v[40:41], 0
  v_mov_b64 v[42:43], 0
  s_waitcnt lgkmcnt(0)
  s_barrier
  ds_read_b128 v[52:55], v0 offset:14336
  ds_read_b128 v[56:59], v0 offset:15360
  v_mov_b64 v[48:49], 0
  v_mov_b64 v[50:51], 0
  v_mov_b64 v[16:17], 0
  v_mov_b64 v[18:19], 0
  v_mov_b64 v[20:21], 0
  v_mov_b64 v[22:23], 0
  v_mov_b64 v[44:45], 0
  v_mov_b64 v[46:47], 0
  v_mov_b32 v61, 0
  s_waitcnt lgkmcnt(1)
  v_smfmac_f32_16x16x64_bf16 v[48:51], v[52:55], v[248:255], v1
  s_waitcnt lgkmcnt(0)
  v_smfmac_f32_16x16x64_bf16 v[48:51], v[56:59], v[64:71], v1
  ds_read_b128 v[64:67], v4 offset:2048
  v_smfmac_f32_16x16x64_bf16 v[16:19], v[52:55], v[184:191], v1
  ds_read_b128 v[68:71], v4 offset:3072
  v_smfmac_f32_16x16x64_bf16 v[16:19], v[56:59], v[72:79], v1
  ds_read_b128 v[72:75], v4 offset:4096
  v_smfmac_f32_16x16x64_bf16 v[20:23], v[52:55], v[192:199], v1
  ds_read_b128 v[76:79], v4 offset:5120
  s_waitcnt lgkmcnt(2)
  v_smfmac_f32_16x16x64_bf16 v[20:23], v[56:59], v[64:71], v1
  ds_read_b128 v[64:67], v4 offset:6144
  v_add_f32 v48, v48, v50
  v_add_f32 v49, v49, v51
  v_cvt_pk_bf16_f32 v60, v48, v49
  s_nop 1
  v_mfma_f32_16x16x16_bf16 v[48:51], v[60:61], v[2:3], 0
  v_smfmac_f32_16x16x64_bf16 v[24:27], v[52:55], v[200:207], v1
  ds_read_b128 v[68:71], v4 offset:7168
  s_waitcnt lgkmcnt(2)
  v_smfmac_f32_16x16x64_bf16 v[24:27], v[56:59], v[72:79], v1
  ds_read_b128 v[72:75], v4 offset:8192
  v_add_f32 v16, v16, v18
  v_add_f32 v17, v17, v19
  v_smfmac_f32_16x16x64_bf16 v[28:31], v[52:55], v[208:215], v1
  ds_read_b128 v[76:79], v4 offset:9216
  s_waitcnt lgkmcnt(2)
  v_smfmac_f32_16x16x64_bf16 v[28:31], v[56:59], v[64:71], v1
  ds_read_b128 v[64:67], v4 offset:10240
  v_add_f32 v20, v20, v22
  v_add_f32 v21, v21, v23
  v_cvt_pk_bf16_f32 v16, v16, v20
  v_cvt_pk_bf16_f32 v18, v17, v21
  v_cvt_pk_bf16_f32 v60, v48, v49
  v_cvt_pk_bf16_f32 v61, v50, v51
  s_waitcnt vmcnt(3)
  buffer_store_dwordx2 v[60:61], v11, s[4:7], s51 offen
  v_smfmac_f32_16x16x64_bf16 v[32:35], v[52:55], v[216:223], v1
  ds_read_b128 v[68:71], v4 offset:11264
  s_waitcnt lgkmcnt(2)
  v_smfmac_f32_16x16x64_bf16 v[32:35], v[56:59], v[72:79], v1
  ds_read_b128 v[72:75], v4 offset:12288
  v_add_f32 v24, v24, v26
  v_add_f32 v25, v25, v27
  v_smfmac_f32_16x16x64_bf16 v[36:39], v[52:55], v[224:231], v1
  ds_read_b128 v[76:79], v4 offset:13312
  s_waitcnt lgkmcnt(2)
  v_smfmac_f32_16x16x64_bf16 v[36:39], v[56:59], v[64:71], v1
  ds_read_b128 v[64:67], v4 offset:14336
  v_add_f32 v28, v28, v30
  v_add_f32 v29, v29, v31
  v_cvt_pk_bf16_f32 v19, v25, v29
  v_cvt_pk_bf16_f32 v17, v24, v28
  buffer_store_dwordx4 v[16:19], v0, s[4:7], s49 offen
  v_smfmac_f32_16x16x64_bf16 v[40:43], v[52:55], v[232:239], v1
  ds_read_b128 v[68:71], v4 offset:15360
  s_waitcnt lgkmcnt(2)
  v_smfmac_f32_16x16x64_bf16 v[40:43], v[56:59], v[72:79], v1
  v_add_f32 v32, v32, v34
  v_add_f32 v33, v33, v35
  v_smfmac_f32_16x16x64_bf16 v[44:47], v[52:55], v[240:247], v1
  s_waitcnt lgkmcnt(0)
  v_smfmac_f32_16x16x64_bf16 v[44:47], v[56:59], v[64:71], v1
  v_add_f32 v36, v36, v38
  v_add_f32 v37, v37, v39
  v_cvt_pk_bf16_f32 v32, v32, v36
  v_cvt_pk_bf16_f32 v34, v33, v37
  v_add_u32 v4, 4294893568, v4
  s_nop 2
  v_add_f32 v40, v40, v42
  v_add_f32 v41, v41, v43
  s_nop 1
  v_add_f32 v44, v44, v46
  v_add_f32 v45, v45, v47
  v_cvt_pk_bf16_f32 v35, v41, v45
  v_cvt_pk_bf16_f32 v33, v40, v44
  buffer_store_dwordx4 v[32:35], v0, s[4:7], s49 offen offset:1024
  s_add_u32 s24, s47, 149504
  s_add_u32 s25, s55, 149504
  v_mov_b32 v46, 0x3f80
  v_mov_b32 v47, 0x3f800000
  v_lshrrev_b32 v51, 2, v0
  v_cndmask_b32 v46, v46, v47, s[88:89]
  v_cndmask_b32 v36, 0, v46, s[80:81]
  v_cndmask_b32 v37, 0, v46, s[82:83]
  v_cndmask_b32 v38, 0, v46, s[84:85]
  v_cndmask_b32 v39, 0, v46, s[86:87]
  s_nop 1
  v_mov_b32_dpp v60, v36 row_shr:8 row_mask:0xf bank_mask:0xf bound_ctrl:1
  v_mov_b32_dpp v61, v37 row_shr:8 row_mask:0xf bank_mask:0xf bound_ctrl:1
  v_mov_b32_dpp v62, v38 row_shr:8 row_mask:0xf bank_mask:0xf bound_ctrl:1
  v_mov_b32_dpp v63, v39 row_shr:8 row_mask:0xf bank_mask:0xf bound_ctrl:1
  s_nop 7
  s_nop 7
  s_nop 7
  s_nop 7
  s_nop 7
  s_nop 7
  s_nop 7
  buffer_load_dwordx4 v[24:27], v10, s[4:7], s47 offen sc1
  buffer_load_dwordx4 v[28:31], v10, s[4:7], s24 offen sc1
  s_cmp_eq_u32 s57, 0
  s_cbranch_scc1 L_nx_28
  buffer_load_dwordx4 v[52:55], v10, s[4:7], s55 offen sc1
  buffer_load_dwordx4 v[56:59], v10, s[4:7], s25 offen sc1
L_nx_28:
  s_mov_b32 s46, 262144
L_p_poll_29:
  s_waitcnt vmcnt(0)
  v_max3_u32 v40, v24, v25, v26
  v_max3_u32 v41, v27, v28, v29
  v_max3_u32 v40, v40, v30, v31
  s_cmp_eq_u32 s57, 0
  s_cbranch_scc1 L_xchk_31
  v_max3_u32 v42, v52, v53, v54
  v_max3_u32 v43, v55, v56, v57
  v_max3_u32 v41, v41, v58, v59
  v_max3_u32 v41, v41, v42, v43
L_xchk_31:
  v_max_u32 v40, v40, v41
  v_cmp_eq_u32 vcc, -1, v40
  s_cbranch_vccz L_p_ok_30
  buffer_load_dwordx4 v[24:27], v10, s[4:7], s47 offen sc1
  buffer_load_dwordx4 v[28:31], v10, s[4:7], s24 offen sc1
  s_cmp_eq_u32 s57, 0
  s_cbranch_scc1 L_nx_32
  buffer_load_dwordx4 v[52:55], v10, s[4:7], s55 offen sc1
  buffer_load_dwordx4 v[56:59], v10, s[4:7], s25 offen sc1
L_nx_32:
  s_sub_u32 s46, s46, 1
  s_cmp_lg_u32 s46, 0
  s_cbranch_scc1 L_p_poll_29
  s_branch L_fail
L_p_ok_30:
  s_and_b32 s30, s18, 7
  s_cmp_eq_u32 s30, 5
  s_cbranch_scc0 L_kvc_33
  s_cmp_ge_u32 s18, 56
  s_cbranch_scc1 L_kvc_33
  s_lshr_b32 s30, s18, 3
  s_lshl_b32 s30, s30, 2
  s_add_u32 s30, s30, 164
  s_mov_b32 s46, 262144
L_kvl_34:
  v_cmp_gt_u32 vcc, 20, v15
  s_cbranch_vccz L_kvc_33
  s_sleep 4
  buffer_load_dword v15, off, s[12:15], s30 sc1
  s_waitcnt vmcnt(0)
  s_sub_u32 s46, s46, 1
  s_cmp_lg_u32 s46, 0
  s_cbranch_scc1 L_kvl_34
  s_branch L_fail
L_kvc_33:
  v_mfma_f32_16x16x32_bf16 v[40:43], v[36:39], v[24:27], 0
  v_mfma_f32_16x16x32_bf16 v[40:43], v[36:39], v[28:31], v[40:43]
  s_cmp_eq_u32 s57, 0
  s_cbranch_scc1 L_xtra_35
  v_mfma_f32_16x16x32_bf16 v[40:43], v[60:63], v[52:55], v[40:43]
  v_mfma_f32_16x16x32_bf16 v[40:43], v[60:63], v[56:59], v[40:43]
L_xtra_35:
  s_add_u32 s24, s53, s59
  s_add_u32 s26, s24, 4096
  s_add_u32 s25, s53, s58
  s_add_u32 s18, s18, 1
  s_add_u32 s42, s42, 0x40000
  s_add_u32 s43, s43, 0x40000
  s_add_u32 s44, s44, 0x20000
  s_add_u32 s45, s45, 0x10000
  v_add_f32_dpp v44, v40, v40 row_shl:4 row_mask:0xf bank_mask:0xf
  v_add_f32_dpp v45, v41, v41 row_shl:4 row_mask:0xf bank_mask:0xf
  v_add_f32_dpp v46, v42, v42 row_shl:4 row_mask:0xf bank_mask:0xf
  v_add_f32_dpp v47, v43, v43 row_shl:4 row_mask:0xf bank_mask:0xf
  v_add_f32_dpp v44, v44, v44 row_shl:8 row_mask:0xf bank_mask:0xf
  v_add_f32_dpp v45, v45, v45 row_shl:8 row_mask:0xf bank_mask:0xf
  v_add_f32_dpp v46, v46, v46 row_shl:8 row_mask:0xf bank_mask:0xf
  v_add_f32_dpp v47, v47, v47 row_shl:8 row_mask:0xf bank_mask:0xf
  v_cvt_pk_bf16_f32 v44, v44, v45
  v_cvt_pk_bf16_f32 v45, v46, v47
  buffer_store_dword v44, v13, s[4:7], s53 offen
  buffer_store_dword v45, v12, s[4:7], s53 offen
  v_mov_b64 v[44:45], 0
  v_mov_b64 v[46:47], 0
  v_mov_b64 v[48:49], 0
  v_mov_b64 v[52:53], 0
  v_mov_b64 v[54:55], 0
  v_mov_b64 v[56:57], 0
  v_mov_b64 v[58:59], 0
  s_nop 7
  s_nop 7
  s_nop 7
  s_nop 7
  buffer_load_dwordx4 v[32:35], v0, s[4:7], s24 offen sc1
  buffer_load_dwordx4 v[36:39], v0, s[4:7], s26 offen sc1
  buffer_load_dword v40, v51, s[4:7], s25 offen sc1
  s_mov_b32 s46, 262144
L_m_poll_36:
  s_waitcnt vmcnt(0)
  v_max3_u32 v68, v32, v33, v34
  v_max3_u32 v69, v35, v36, v37
  v_max3_u32 v70, v38, v39, v40
  v_max3_u32 v68, v68, v69, v70
  v_cmp_eq_u32 vcc, -1, v68
  s_cbranch_vccz L_m_ok_37
  buffer_load_dwordx4 v[32:35], v0, s[4:7], s24 offen sc1
  buffer_load_dwordx4 v[36:39], v0, s[4:7], s26 offen sc1
  buffer_load_dword v40, v51, s[4:7], s25 offen sc1
  s_sub_u32 s46, s46, 1
  s_cmp_lg_u32 s46, 0
  s_cbranch_scc1 L_m_poll_36
  s_branch L_fail
L_m_ok_37:
  s_lshl_b32 m0, s17, 10
  s_nop 0
  ds_write_addtid_b32 v32 offset:0
  ds_write_addtid_b32 v33 offset:256
  ds_write_addtid_b32 v34 offset:512
  ds_write_addtid_b32 v35 offset:768
  ds_write_addtid_b32 v36 offset:4096
  ds_write_addtid_b32 v37 offset:4352
  ds_write_addtid_b32 v38 offset:4608
  ds_write_addtid_b32 v39 offset:4864
  s_lshl_b32 m0, s17, 8
  s_nop 0
  ds_write_addtid_b32 v40 offset:8192
  buffer_load_dwordx4 v[16:19], v0, s[4:7], s42 offen
  v_mov_b64 v[50:51], 0
  s_mov_b32 s24, s47
  s_mov_b32 s47, s48
  s_mov_b32 s48, s24
  s_mov_b32 s24, s49
  s_mov_b32 s49, s50
  s_mov_b32 s50, s24
  s_mov_b32 s24, s51
  s_mov_b32 s51, s52
  s_mov_b32 s52, s24
  s_mov_b32 s24, s53
  s_mov_b32 s53, s54
  s_mov_b32 s54, s24
  s_mov_b32 s24, s55
  s_mov_b32 s55, s56
  s_mov_b32 s56, s24
  s_waitcnt lgkmcnt(0)
  s_barrier
  s_branch L_rec_top_25
L_rec_done_26:
  s_waitcnt vmcnt(0) lgkmcnt(0)
  v_mov_b32 v48, 64
  buffer_store_dword v48, off, s[4:7], s62 sc1
  s_branch L_rec_alldone_24
L_rec_slow_23:
  s_mov_b32 s18, 0
  s_lshl_b32 s24, s16, 13
  s_lshl_b32 s25, s17, 11
  s_add_u32 s42, s24, s25
  s_add_u32 s43, s42, 0x1000000
  s_lshl_b32 s24, s16, 12
  s_lshl_b32 s26, s17, 10
  s_add_u32 s44, s24, s26
  s_add_u32 s44, s44, 0x3000000
  s_lshl_b32 s24, s16, 11
  s_lshl_b32 s26, s17, 9
  s_add_u32 s45, s24, s26
  s_add_u32 s45, s45, 0x3800000
  s_lshl_b32 s28, s16, 2
  s_add_u32 s28, s28, s17
  s_lshl_b32 s28, s28, 6
  s_add_u32 s47, s28, 0x3c00000
  s_add_u32 s48, s28, 0x3c49000
  s_lshl_b32 s28, s16, 6
  s_add_u32 s55, s28, 0x3c02000
  s_add_u32 s56, s28, 0x3c4b000
  s_cmp_lt_u32 s16, 16
  s_cselect_b32 s57, 1, 0
  s_cmp_eq_u32 s17, 0
  s_cselect_b32 s57, s57, 0
  s_mul_i32 s24, s16, 9344
  s_add_u32 s26, s24, s25
  s_add_u32 s49, s26, 0x3c00000
  s_add_u32 s50, s26, 0x3c49000
  s_lshl_b32 s27, s17, 8
  s_add_u32 s58, s27, 8192
  s_add_u32 s27, s27, s24
  s_add_u32 s51, s27, 0x3c02000
  s_add_u32 s52, s27, 0x3c4b000
  s_lshl_b32 s62, s16, 5
  s_add_u32 s62, s62, s17
  s_lshl_b32 s62, s62, 2
  s_add_u32 s62, s62, 0xe902000
  s_mul_i32 s63, s17, 1280
  s_add_u32 s63, s63, 9216
  s_lshl_b32 s59, s17, 10
  s_mov_b32 s53, 0x3d02400
  s_mov_b32 s54, 0x3d00000
  v_mov_b64 v[44:45], 0
  v_mov_b64 v[46:47], 0
  v_mov_b64 v[48:49], 0
  v_mov_b64 v[50:51], 0
  v_mov_b64 v[52:53], 0
  v_mov_b64 v[54:55], 0
  v_mov_b64 v[56:57], 0
  v_mov_b64 v[58:59], 0
  buffer_load_dwordx4 v[16:19], v0, s[4:7], s42 offen
.p2align 6
L_rec_top_38:
  ds_read_b128 v[32:35], v0 offset:0
  ds_read_b128 v[64:67], v4 offset:0
  ds_read_b128 v[68:71], v4 offset:1024
  ds_read_b128 v[36:39], v0 offset:1024
  ds_read_b128 v[40:43], v0 offset:2048
  v_mov_b64 v[60:61], -1
  v_mov_b64 v[62:63], -1
  s_waitcnt lgkmcnt(4)
  v_smfmac_f32_16x16x64_bf16 v[44:47], v[32:35], a[0:7], v1
  ds_read_b128 v[72:75], v4 offset:2048
  v_smfmac_f32_16x16x64_bf16 v[48:51], v[32:35], a[8:15], v1
  ds_read_b128 v[76:79], v4 offset:3072
  v_smfmac_f32_16x16x64_bf16 v[52:55], v[32:35], v[112:119], v1
  buffer_load_dwordx4 v[20:23], v0, s[4:7], s42 offen offset:1024
  s_waitcnt lgkmcnt(4)
  v_smfmac_f32_16x16x64_bf16 v[56:59], v[32:35], v[64:71], v1
  ds_read_b128 v[32:35], v0 offset:3072
  s_waitcnt lgkmcnt(4)
  v_smfmac_f32_16x16x64_bf16 v[44:47], v[36:39], a[16:23], v1
  ds_read_b128 v[64:67], v4 offset:4096
  v_smfmac_f32_16x16x64_bf16 v[48:51], v[36:39], a[24:31], v1
  ds_read_b128 v[68:71], v4 offset:5120
  v_smfmac_f32_16x16x64_bf16 v[52:55], v[36:39], v[120:127], v1
  buffer_load_dwordx4 v[24:27], v0, s[4:7], s43 offen
  s_waitcnt lgkmcnt(3)
  v_smfmac_f32_16x16x64_bf16 v[56:59], v[36:39], v[72:79], v1
  ds_read_b128 v[36:39], v0 offset:4096
  v_smfmac_f32_16x16x64_bf16 v[44:47], v[40:43], a[32:39], v1
  ds_read_b128 v[72:75], v4 offset:6144
  v_smfmac_f32_16x16x64_bf16 v[48:51], v[40:43], a[40:47], v1
  ds_read_b128 v[76:79], v4 offset:7168
  v_smfmac_f32_16x16x64_bf16 v[52:55], v[40:43], v[128:135], v1
  buffer_load_dwordx4 v[28:31], v0, s[4:7], s43 offen offset:1024
  s_waitcnt lgkmcnt(3)
  v_smfmac_f32_16x16x64_bf16 v[56:59], v[40:43], v[64:71], v1
  ds_read_b128 v[40:43], v0 offset:5120
  v_smfmac_f32_16x16x64_bf16 v[44:47], v[32:35], a[48:55], v1
  ds_read_b128 v[64:67], v4 offset:8192
  v_smfmac_f32_16x16x64_bf16 v[48:51], v[32:35], a[56:63], v1
  ds_read_b128 v[68:71], v4 offset:9216
  v_smfmac_f32_16x16x64_bf16 v[52:55], v[32:35], v[136:143], v1
  s_add_u32 s29, s42, 0x80000
  buffer_load_dword v15, v14, s[4:7], s29 offen
  buffer_store_dwordx4 v[60:63], v0, s[4:7], s50 offen sc1
  s_waitcnt lgkmcnt(3)
  v_smfmac_f32_16x16x64_bf16 v[56:59], v[32:35], v[72:79], v1
  ds_read_b128 v[32:35], v0 offset:6144
  v_smfmac_f32_16x16x64_bf16 v[44:47], v[36:39], a[64:71], v1
  ds_read_b128 v[72:75], v4 offset:10240
  v_smfmac_f32_16x16x64_bf16 v[48:51], v[36:39], a[72:79], v1
  ds_read_b128 v[76:79], v4 offset:11264
  v_smfmac_f32_16x16x64_bf16 v[52:55], v[36:39], v[144:151], v1
  buffer_store_dwordx4 v[60:63], v0, s[4:7], s50 offen offset:1024 sc1
  s_waitcnt lgkmcnt(3)
  v_smfmac_f32_16x16x64_bf16 v[56:59], v[36:39], v[64:71], v1
  ds_read_b128 v[36:39], v0 offset:7168
  v_smfmac_f32_16x16x64_bf16 v[44:47], v[40:43], a[80:87], v1
  ds_read_b128 v[64:67], v4 offset:12288
  v_smfmac_f32_16x16x64_bf16 v[48:51], v[40:43], a[88:95], v1
  ds_read_b128 v[68:71], v4 offset:13312
  v_smfmac_f32_16x16x64_bf16 v[52:55], v[40:43], v[152:159], v1
  buffer_store_dwordx2 v[60:61], v11, s[4:7], s52 offen sc1
  s_waitcnt lgkmcnt(3)
  v_smfmac_f32_16x16x64_bf16 v[56:59], v[40:43], v[72:79], v1
  ds_read_b128 v[40:43], v0 offset:8192
  v_smfmac_f32_16x16x64_bf16 v[44:47], v[32:35], a[96:103], v1
  ds_read_b128 v[72:75], v4 offset:14336
  v_smfmac_f32_16x16x64_bf16 v[48:51], v[32:35], a[104:111], v1
  ds_read_b128 v[76:79], v4 offset:15360
  v_smfmac_f32_16x16x64_bf16 v[52:55], v[32:35], v[160:167], v1
  buffer_store_dword v60, v13, s[4:7], s53 offen sc1
  s_waitcnt lgkmcnt(3)
  v_smfmac_f32_16x16x64_bf16 v[56:59], v[32:35], v[64:71], v1
  ds_read_b128 v[32:35], v0 offset:0
  v_smfmac_f32_16x16x64_bf16 v[44:47], v[36:39], a[112:119], v1
  ds_read_b128 v[64:67], v4 offset:16384
  v_smfmac_f32_16x16x64_bf16 v[48:51], v[36:39], a[120:127], v1
  ds_read_b128 v[68:71], v4 offset:17408
  v_smfmac_f32_16x16x64_bf16 v[52:55], v[36:39], v[168:175], v1
  buffer_store_dword v60, v12, s[4:7], s53 offen sc1
  s_waitcnt lgkmcnt(3)
  v_smfmac_f32_16x16x64_bf16 v[56:59], v[36:39], v[72:79], v1
  ds_read_b128 v[36:39], v0 offset:1024
  v_smfmac_f32_16x16x64_bf16 v[44:47], v[40:43], a[128:135], v1
  v_mov_b64 v[72:73], 0
  v_smfmac_f32_16x16x64_bf16 v[48:51], v[40:43], a[136:143], v1
  v_mov_b64 v[74:75], 0
  v_smfmac_f32_16x16x64_bf16 v[52:55], v[40:43], v[176:183], v1
  v_mov_b64 v[76:77], 0
  s_waitcnt lgkmcnt(1)
  v_smfmac_f32_16x16x64_bf16 v[56:59], v[40:43], v[64:71], v1
  ds_read_b128 v[40:43], v0 offset:2048
  v_mov_b64 v[78:79], 0
  s_nop 0
  v_smfmac_f32_16x16x64_bf16 v[72:75], v[32:35], a[144:151], v1
  v_smfmac_f32_16x16x64_bf16 v[76:79], v[32:35], a[152:159], v1
  ds_read_b128 v[32:35], v0 offset:3072
  v_add_f32 v44, v44, v46
  v_add_f32 v45, v45, v47
  v_add_f32 v48, v48, v50
  v_add_f32 v49, v49, v51
  v_add_f32 v52, v52, v54
  v_add_f32 v53, v53, v55
  v_add_f32 v56, v56, v58
  v_add_f32 v57, v57, v59
  v_cvt_pk_bf16_f32 v44, v44, v45
  v_cvt_pk_bf16_f32 v48, v48, v49
  v_cvt_pk_bf16_f32 v45, v52, v53
  v_cvt_pk_bf16_f32 v49, v56, v57
  s_nop 1
  v_mfma_f32_16x16x16_bf16 v[52:55], v[44:45], v[2:3], 0
  v_mfma_f32_16x16x16_bf16 v[56:59], v[48:49], v[2:3], 0
  s_waitcnt lgkmcnt(2)
  v_smfmac_f32_16x16x64_bf16 v[72:75], v[36:39], a[160:167], v1
  v_smfmac_f32_16x16x64_bf16 v[76:79], v[36:39], a[168:175], v1
  ds_read_b128 v[36:39], v0 offset:4096
  s_nop 3
  v_cvt_pk_bf16_f32 v44, v52, v53
  v_cvt_pk_bf16_f32 v45, v54, v55
  v_cvt_pk_bf16_f32 v46, v56, v57
  v_cvt_pk_bf16_f32 v47, v58, v59
  v_xor_b32 v60, 128, v5
  s_waitcnt vmcnt(8)
  s_nop 0
  v_mfma_f32_16x16x32_bf16 v[48:51], v[44:47], v[44:47], 0
  v_mfma_f32_16x16x32_bf16 v[52:55], v[16:19], v[44:47], 0
  v_mfma_f32_16x16x32_bf16 v[56:59], v[20:23], v[44:47], 0
  s_waitcnt lgkmcnt(2)
  v_smfmac_f32_16x16x64_bf16 v[72:75], v[40:43], a[176:183], v1
  v_smfmac_f32_16x16x64_bf16 v[76:79], v[40:43], a[184:191], v1
  ds_read_b128 v[40:43], v0 offset:5120
  s_mov_b64 exec, s[40:41]
  s_nop 2
  ds_write_b64 v6, v[48:49]
  ds_write_b128 v5, v[52:55] offset:256
  ds_write_b128 v60, v[56:59] offset:768
  s_mov_b64 exec, -1
  buffer_store_dwordx4 v[44:47], v0, s[4:7], s44 offen sc1
  v_mov_b32 v61, s18
  buffer_store_dword v61, off, s[4:7], s62 sc1
  s_and_b32 s30, s18, 7
  s_cmp_eq_u32 s30, 5
  s_cbranch_scc0 L_kvq_40
  s_lshr_b32 s30, s18, 3
  s_lshl_b32 s30, s30, 2
  s_add_u32 s30, s30, 164
  buffer_load_dword v15, off, s[12:15], s30 sc1
L_kvq_40:
  s_waitcnt lgkmcnt(5)
  v_smfmac_f32_16x16x64_bf16 v[72:75], v[32:35], a[192:199], v1
  v_smfmac_f32_16x16x64_bf16 v[76:79], v[32:35], a[200:207], v1
  ds_read_b128 v[32:35], v0 offset:6144
  s_waitcnt lgkmcnt(0)
  s_barrier
  ds_read_b128 v[52:55], v7 offset:0
  ds_read_b128 v[56:59], v7 offset:1280
  ds_read_b128 v[16:19], v7 offset:2560
  ds_read_b128 v[20:23], v7 offset:3840
  ds_read_b32 v48, v8 offset:0
  ds_read_b32 v49, v8 offset:1280
  ds_read_b32 v50, v8 offset:2560
  ds_read_b32 v51, v8 offset:3840
  v_smfmac_f32_16x16x64_bf16 v[72:75], v[36:39], a[208:215], v1
  v_smfmac_f32_16x16x64_bf16 v[76:79], v[36:39], a[216:223], v1
  ds_read_b128 v[36:39], v0 offset:7168
  v_smfmac_f32_16x16x64_bf16 v[72:75], v[40:43], a[224:231], v1
  v_smfmac_f32_16x16x64_bf16 v[76:79], v[40:43], a[232:239], v1
  ds_read_b128 v[40:43], v0 offset:8192
  v_smfmac_f32_16x16x64_bf16 v[72:75], v[32:35], a[240:247], v1
  v_smfmac_f32_16x16x64_bf16 v[76:79], v[32:35], a[248:255], v1
  s_waitcnt lgkmcnt(1)
  v_smfmac_f32_16x16x64_bf16 v[72:75], v[36:39], v[80:87], v1
  v_smfmac_f32_16x16x64_bf16 v[76:79], v[36:39], v[88:95], v1
  v_add_f32 v52, v52, v56
  v_add_f32 v53, v53, v57
  v_add_f32 v54, v54, v58
  v_add_f32 v55, v55, v59
  v_add_f32 v16, v16, v20
  v_add_f32 v17, v17, v21
  v_add_f32 v18, v18, v22
  v_add_f32 v19, v19, v23
  v_add_f32 v48, v48, v49
  v_add_f32 v50, v50, v51
  v_add_f32 v52, v52, v16
  v_add_f32 v53, v53, v17
  v_add_f32 v54, v54, v18
  v_add_f32 v55, v55, v19
  v_add_f32 v48, v48, v50
  v_max3_f32 v44, v52, v53, v54
  v_max3_f32 v44, v44, v55, v48
  s_waitcnt lgkmcnt(0)
  v_smfmac_f32_16x16x64_bf16 v[72:75], v[40:43], v[96:103], v1
  s_nop 0
  v_max_f32_dpp v44, v44, v44 quad_perm:[2,3,0,1] row_mask:0xf bank_mask:0xf
  v_mov_b32 v45, v44
  v_smfmac_f32_16x16x64_bf16 v[76:79], v[40:43], v[104:111], v1
  s_nop 0
  v_permlane16_swap_b32 v44, v45
  v_max_f32 v44, v44, v45
  v_mov_b32 v45, v44
  v_lshrrev_b32 v62, 1, v0
  v_add_u32 v4, 73728, v4
  v_permlane32_swap_b32 v44, v45
  v_max_f32 v44, v44, v45
  s_mov_b32 s30, 0x3e0293ee
  v_mul_f32 v44, s30, v44
  v_add_f32 v72, v72, v74
  v_add_f32 v73, v73, v75
  v_add_f32 v76, v76, v78
  v_add_f32 v77, v77, v79
  v_cvt_pk_bf16_f32 v60, v72, v73
  v_cvt_pk_bf16_f32 v61, v76, v77
  buffer_store_dwordx2 v[60:61], v62, s[4:7], s45 offen sc1
  v_fma_f32 v52, v52, s30, -v44
  v_fma_f32 v53, v53, s30, -v44
  v_fma_f32 v54, v54, s30, -v44
  v_fma_f32 v55, v55, s30, -v44
  v_fma_f32 v48, v48, s30, -v44
  v_exp_f32 v52, v52
  v_exp_f32 v53, v53
  v_exp_f32 v54, v54
  v_exp_f32 v55, v55
  v_exp_f32 v48, v48
  v_mov_b32 v44, 0x3f803f80
  v_mov_b32 v45, 0x3f803f80
  v_mov_b32 v46, 0x3f803f80
  v_mov_b32 v47, 0x3f803f80
  v_cvt_pk_bf16_f32 v16, v52, v53
  v_cvt_pk_bf16_f32 v17, v54, v55
  v_mov_b32_dpp v49, v48 quad_perm:[2,3,0,1] row_mask:0xf bank_mask:0xf
  v_mov_b32 v21, 0
  v_mov_b32_dpp v18, v16 quad_perm:[2,3,0,1] row_mask:0xf bank_mask:0xf
  v_mov_b32_dpp v19, v17 quad_perm:[2,3,0,1] row_mask:0xf bank_mask:0xf
  v_cvt_pk_bf16_f32 v20, v48, v49
  v_cvt_pk_bf16_f32 v23, v48, v49
  v_mov_b32 v22, 0
  s_waitcnt vmcnt(9)
  s_nop 0
  v_mfma_f32_16x16x32_bf16 v[48:51], v[44:47], v[16:19], 0
  v_mfma_f32_16x16x32_bf16 v[52:55], v[24:27], v[16:19], 0
  v_mfma_f32_16x16x32_bf16 v[56:59], v[28:31], v[16:19], 0
  v_mov_b64 v[32:33], 0
  v_mov_b64 v[34:35], 0
  v_mov_b64 v[36:37], 0
  v_mov_b64 v[38:39], 0
  v_mfma_f32_16x16x16_bf16 v[48:51], v[44:45], v[20:21], v[48:51]
  v_mfma_f32_16x16x16_bf16 v[52:55], v[60:61], v[20:21], v[52:55]
  v_mfma_f32_16x16x16_bf16 v[56:59], v[60:61], v[22:23], v[56:59]
  s_cmp_eq_u32 s18, 63
  s_cbranch_scc1 L_rec_done_39
  ds_read_b128 v[64:67], v4 offset:16384
  ds_read_b128 v[68:71], v4 offset:17408
  ds_read_b128 v[72:75], v4 offset:0
  ds_read_b128 v[76:79], v4 offset:1024
  v_rcp_f32 v46, v48
  v_mov_b64 v[24:25], 0
  v_mov_b64 v[26:27], 0
  v_mul_f32 v52, v52, v46
  v_mul_f32 v53, v53, v46
  v_mul_f32 v54, v54, v46
  v_mul_f32 v55, v55, v46
  v_mul_f32 v56, v56, v46
  v_mul_f32 v57, v57, v46
  v_mul_f32 v58, v58, v46
  v_mul_f32 v59, v59, v46
  v_cvt_pk_bf16_f32 v44, v52, v53
  v_cvt_pk_bf16_f32 v45, v54, v55
  v_cvt_pk_bf16_f32 v46, v56, v57
  v_cvt_pk_bf16_f32 v47, v58, v59
  s_mov_b64 exec, s[40:41]
  ds_write_b128 v9, v[44:47]
  s_mov_b64 exec, -1
  v_mov_b64 v[28:29], 0
  v_mov_b64 v[30:31], 0
  v_mov_b64 v[40:41], 0
  v_mov_b64 v[42:43], 0
  s_waitcnt lgkmcnt(0)
  s_barrier
  ds_read_b128 v[52:55], v0 offset:14336
  ds_read_b128 v[56:59], v0 offset:15360
  v_mov_b64 v[48:49], 0
  v_mov_b64 v[50:51], 0
  v_mov_b64 v[16:17], 0
  v_mov_b64 v[18:19], 0
  v_mov_b64 v[20:21], 0
  v_mov_b64 v[22:23], 0
  v_mov_b64 v[44:45], 0
  v_mov_b64 v[46:47], 0
  v_mov_b32 v61, 0
  s_waitcnt lgkmcnt(1)
  v_smfmac_f32_16x16x64_bf16 v[48:51], v[52:55], v[248:255], v1
  s_waitcnt lgkmcnt(0)
  v_smfmac_f32_16x16x64_bf16 v[48:51], v[56:59], v[64:71], v1
  ds_read_b128 v[64:67], v4 offset:2048
  v_smfmac_f32_16x16x64_bf16 v[16:19], v[52:55], v[184:191], v1
  ds_read_b128 v[68:71], v4 offset:3072
  v_smfmac_f32_16x16x64_bf16 v[16:19], v[56:59], v[72:79], v1
  ds_read_b128 v[72:75], v4 offset:4096
  v_smfmac_f32_16x16x64_bf16 v[20:23], v[52:55], v[192:199], v1
  ds_read_b128 v[76:79], v4 offset:5120
  s_waitcnt lgkmcnt(2)
  v_smfmac_f32_16x16x64_bf16 v[20:23], v[56:59], v[64:71], v1
  ds_read_b128 v[64:67], v4 offset:6144
  v_add_f32 v48, v48, v50
  v_add_f32 v49, v49, v51
  v_cvt_pk_bf16_f32 v60, v48, v49
  s_nop 1
  v_mfma_f32_16x16x16_bf16 v[48:51], v[60:61], v[2:3], 0
  v_smfmac_f32_16x16x64_bf16 v[24:27], v[52:55], v[200:207], v1
  ds_read_b128 v[68:71], v4 offset:7168
  s_waitcnt lgkmcnt(2)
  v_smfmac_f32_16x16x64_bf16 v[24:27], v[56:59], v[72:79], v1
  ds_read_b128 v[72:75], v4 offset:8192
  v_add_f32 v16, v16, v18
  v_add_f32 v17, v17, v19
  v_smfmac_f32_16x16x64_bf16 v[28:31], v[52:55], v[208:215], v1
  ds_read_b128 v[76:79], v4 offset:9216
  s_waitcnt lgkmcnt(2)
  v_smfmac_f32_16x16x64_bf16 v[28:31], v[56:59], v[64:71], v1
  ds_read_b128 v[64:67], v4 offset:10240
  v_add_f32 v20, v20, v22
  v_add_f32 v21, v21, v23
  v_cvt_pk_bf16_f32 v16, v16, v20
  v_cvt_pk_bf16_f32 v18, v17, v21
  v_cvt_pk_bf16_f32 v60, v48, v49
  v_cvt_pk_bf16_f32 v61, v50, v51
  s_waitcnt vmcnt(3)
  buffer_store_dwordx2 v[60:61], v11, s[4:7], s51 offen sc1
  v_smfmac_f32_16x16x64_bf16 v[32:35], v[52:55], v[216:223], v1
  ds_read_b128 v[68:71], v4 offset:11264
  s_waitcnt lgkmcnt(2)
  v_smfmac_f32_16x16x64_bf16 v[32:35], v[56:59], v[72:79], v1
  ds_read_b128 v[72:75], v4 offset:12288
  v_add_f32 v24, v24, v26
  v_add_f32 v25, v25, v27
  v_smfmac_f32_16x16x64_bf16 v[36:39], v[52:55], v[224:231], v1
  ds_read_b128 v[76:79], v4 offset:13312
  s_waitcnt lgkmcnt(2)
  v_smfmac_f32_16x16x64_bf16 v[36:39], v[56:59], v[64:71], v1
  ds_read_b128 v[64:67], v4 offset:14336
  v_add_f32 v28, v28, v30
  v_add_f32 v29, v29, v31
  v_cvt_pk_bf16_f32 v19, v25, v29
  v_cvt_pk_bf16_f32 v17, v24, v28
  buffer_store_dwordx4 v[16:19], v0, s[4:7], s49 offen sc1
  v_smfmac_f32_16x16x64_bf16 v[40:43], v[52:55], v[232:239], v1
  ds_read_b128 v[68:71], v4 offset:15360
  s_waitcnt lgkmcnt(2)
  v_smfmac_f32_16x16x64_bf16 v[40:43], v[56:59], v[72:79], v1
  v_add_f32 v32, v32, v34
  v_add_f32 v33, v33, v35
  v_smfmac_f32_16x16x64_bf16 v[44:47], v[52:55], v[240:247], v1
  s_waitcnt lgkmcnt(0)
  v_smfmac_f32_16x16x64_bf16 v[44:47], v[56:59], v[64:71], v1
  v_add_f32 v36, v36, v38
  v_add_f32 v37, v37, v39
  v_cvt_pk_bf16_f32 v32, v32, v36
  v_cvt_pk_bf16_f32 v34, v33, v37
  v_add_u32 v4, 4294893568, v4
  s_nop 2
  v_add_f32 v40, v40, v42
  v_add_f32 v41, v41, v43
  s_nop 1
  v_add_f32 v44, v44, v46
  v_add_f32 v45, v45, v47
  v_cvt_pk_bf16_f32 v35, v41, v45
  v_cvt_pk_bf16_f32 v33, v40, v44
  buffer_store_dwordx4 v[32:35], v0, s[4:7], s49 offen offset:1024 sc1
  s_add_u32 s24, s47, 149504
  s_add_u32 s25, s55, 149504
  v_mov_b32 v46, 0x3f80
  v_mov_b32 v47, 0x3f800000
  v_lshrrev_b32 v51, 2, v0
  v_cndmask_b32 v46, v46, v47, s[88:89]
  v_cndmask_b32 v36, 0, v46, s[80:81]
  v_cndmask_b32 v37, 0, v46, s[82:83]
  v_cndmask_b32 v38, 0, v46, s[84:85]
  v_cndmask_b32 v39, 0, v46, s[86:87]
  s_nop 1
  v_mov_b32_dpp v60, v36 row_shr:8 row_mask:0xf bank_mask:0xf bound_ctrl:1
  v_mov_b32_dpp v61, v37 row_shr:8 row_mask:0xf bank_mask:0xf bound_ctrl:1
  v_mov_b32_dpp v62, v38 row_shr:8 row_mask:0xf bank_mask:0xf bound_ctrl:1
  v_mov_b32_dpp v63, v39 row_shr:8 row_mask:0xf bank_mask:0xf bound_ctrl:1
  s_nop 7
  s_nop 7
  s_nop 7
  s_nop 7
  s_nop 7
  s_nop 7
  s_nop 7
  buffer_load_dwordx4 v[24:27], v10, s[4:7], s47 offen sc1
  buffer_load_dwordx4 v[28:31], v10, s[4:7], s24 offen sc1
  s_cmp_eq_u32 s57, 0
  s_cbranch_scc1 L_nx_41
  buffer_load_dwordx4 v[52:55], v10, s[4:7], s55 offen sc1
  buffer_load_dwordx4 v[56:59], v10, s[4:7], s25 offen sc1
L_nx_41:
  s_mov_b32 s46, 262144
L_p_poll_42:
  s_waitcnt vmcnt(0)
  v_max3_u32 v40, v24, v25, v26
  v_max3_u32 v41, v27, v28, v29
  v_max3_u32 v40, v40, v30, v31
  s_cmp_eq_u32 s57, 0
  s_cbranch_scc1 L_xchk_44
  v_max3_u32 v42, v52, v53, v54
  v_max3_u32 v43, v55, v56, v57
  v_max3_u32 v41, v41, v58, v59
  v_max3_u32 v41, v41, v42, v43
L_xchk_44:
  v_max_u32 v40, v40, v41
  v_cmp_eq_u32 vcc, -1, v40
  s_cbranch_vccz L_p_ok_43
  buffer_load_dwordx4 v[24:27], v10, s[4:7], s47 offen sc1
  buffer_load_dwordx4 v[28:31], v10, s[4:7], s24 offen sc1
  s_cmp_eq_u32 s57, 0
  s_cbranch_scc1 L_nx_45
  buffer_load_dwordx4 v[52:55], v10, s[4:7], s55 offen sc1
  buffer_load_dwordx4 v[56:59], v10, s[4:7], s25 offen sc1
L_nx_45:
  s_sub_u32 s46, s46, 1
  s_cmp_lg_u32 s46, 0
  s_cbranch_scc1 L_p_poll_42
  s_branch L_fail
L_p_ok_43:
  s_and_b32 s30, s18, 7
  s_cmp_eq_u32 s30, 5
  s_cbranch_scc0 L_kvc_46
  s_cmp_ge_u32 s18, 56
  s_cbranch_scc1 L_kvc_46
  s_lshr_b32 s30, s18, 3
  s_lshl_b32 s30, s30, 2
  s_add_u32 s30, s30, 164
  s_mov_b32 s46, 262144
L_kvl_47:
  v_cmp_gt_u32 vcc, 20, v15
  s_cbranch_vccz L_kvc_46
  s_sleep 4
  buffer_load_dword v15, off, s[12:15], s30 sc1
  s_waitcnt vmcnt(0)
  s_sub_u32 s46, s46, 1
  s_cmp_lg_u32 s46, 0
  s_cbranch_scc1 L_kvl_47
  s_branch L_fail
L_kvc_46:
  v_mfma_f32_16x16x32_bf16 v[40:43], v[36:39], v[24:27], 0
  v_mfma_f32_16x16x32_bf16 v[40:43], v[36:39], v[28:31], v[40:43]
  s_cmp_eq_u32 s57, 0
  s_cbranch_scc1 L_xtra_48
  v_mfma_f32_16x16x32_bf16 v[40:43], v[60:63], v[52:55], v[40:43]
  v_mfma_f32_16x16x32_bf16 v[40:43], v[60:63], v[56:59], v[40:43]
L_xtra_48:
  s_add_u32 s24, s53, s59
  s_add_u32 s26, s24, 4096
  s_add_u32 s25, s53, s58
  s_add_u32 s18, s18, 1
  s_add_u32 s42, s42, 0x40000
  s_add_u32 s43, s43, 0x40000
  s_add_u32 s44, s44, 0x20000
  s_add_u32 s45, s45, 0x10000
  v_add_f32_dpp v44, v40, v40 row_shl:4 row_mask:0xf bank_mask:0xf
  v_add_f32_dpp v45, v41, v41 row_shl:4 row_mask:0xf bank_mask:0xf
  v_add_f32_dpp v46, v42, v42 row_shl:4 row_mask:0xf bank_mask:0xf
  v_add_f32_dpp v47, v43, v43 row_shl:4 row_mask:0xf bank_mask:0xf
  v_add_f32_dpp v44, v44, v44 row_shl:8 row_mask:0xf bank_mask:0xf
  v_add_f32_dpp v45, v45, v45 row_shl:8 row_mask:0xf bank_mask:0xf
  v_add_f32_dpp v46, v46, v46 row_shl:8 row_mask:0xf bank_mask:0xf
  v_add_f32_dpp v47, v47, v47 row_shl:8 row_mask:0xf bank_mask:0xf
  v_cvt_pk_bf16_f32 v44, v44, v45
  v_cvt_pk_bf16_f32 v45, v46, v47
  buffer_store_dword v44, v13, s[4:7], s53 offen sc1
  buffer_store_dword v45, v12, s[4:7], s53 offen sc1
  v_mov_b64 v[44:45], 0
  v_mov_b64 v[46:47], 0
  v_mov_b64 v[48:49], 0
  v_mov_b64 v[52:53], 0
  v_mov_b64 v[54:55], 0
  v_mov_b64 v[56:57], 0
  v_mov_b64 v[58:59], 0
  s_nop 7
  s_nop 7
  s_nop 7
  s_nop 7
  buffer_load_dwordx4 v[32:35], v0, s[4:7], s24 offen sc1
  buffer_load_dwordx4 v[36:39], v0, s[4:7], s26 offen sc1
  buffer_load_dword v40, v51, s[4:7], s25 offen sc1
  s_mov_b32 s46, 262144
L_m_poll_49:
  s_waitcnt vmcnt(0)
  v_max3_u32 v68, v32, v33, v34
  v_max3_u32 v69, v35, v36, v37
  v_max3_u32 v70, v38, v39, v40
  v_max3_u32 v68, v68, v69, v70
  v_cmp_eq_u32 vcc, -1, v68
  s_cbranch_vccz L_m_ok_50
  buffer_load_dwordx4 v[32:35], v0, s[4:7], s24 offen sc1
  buffer_load_dwordx4 v[36:39], v0, s[4:7], s26 offen sc1
  buffer_load_dword v40, v51, s[4:7], s25 offen sc1
  s_sub_u32 s46, s46, 1
  s_cmp_lg_u32 s46, 0
  s_cbranch_scc1 L_m_poll_49
  s_branch L_fail
L_m_ok_50:
  s_lshl_b32 m0, s17, 10
  s_nop 0
  ds_write_addtid_b32 v32 offset:0
  ds_write_addtid_b32 v33 offset:256
  ds_write_addtid_b32 v34 offset:512
  ds_write_addtid_b32 v35 offset:768
  ds_write_addtid_b32 v36 offset:4096
  ds_write_addtid_b32 v37 offset:4352
  ds_write_addtid_b32 v38 offset:4608
  ds_write_addtid_b32 v39 offset:4864
  s_lshl_b32 m0, s17, 8
  s_nop 0
  ds_write_addtid_b32 v40 offset:8192
  buffer_load_dwordx4 v[16:19], v0, s[4:7], s42 offen
  v_mov_b64 v[50:51], 0
  s_mov_b32 s24, s47
  s_mov_b32 s47, s48
  s_mov_b32 s48, s24
  s_mov_b32 s24, s49
  s_mov_b32 s49, s50
  s_mov_b32 s50, s24
  s_mov_b32 s24, s51
  s_mov_b32 s51, s52
  s_mov_b32 s52, s24
  s_mov_b32 s24, s53
  s_mov_b32 s53, s54
  s_mov_b32 s54, s24
  s_mov_b32 s24, s55
  s_mov_b32 s55, s56
  s_mov_b32 s56, s24
  s_waitcnt lgkmcnt(0)
  s_barrier
  s_branch L_rec_top_38
L_rec_done_39:
  s_waitcnt vmcnt(0) lgkmcnt(0)
  v_mov_b32 v48, 64
  buffer_store_dword v48, off, s[4:7], s62 sc1
L_rec_alldone_24:
  s_endpgm
L_worker:
  s_sub_u32 s23, s20, 1
  s_lshl_b32 s23, s23, 5
  s_add_u32 s23, s23, s21
  s_cmp_eq_u32 s23, 0
  s_cbranch_scc0 L_noclr_51
  v_lshlrev_b32 v1, 4, v0
  v_mov_b64 v[2:3], 0
  v_mov_b64 v[4:5], 0
  s_mov_b32 s24, 0xe900000
  buffer_store_dwordx4 v[2:5], v1, s[4:7], s24 offen sc1
  s_add_u32 s24, s24, 4096
  buffer_store_dwordx4 v[2:5], v1, s[4:7], s24 offen sc1
  s_add_u32 s24, s24, 4096
  buffer_store_dwordx4 v[2:5], v1, s[4:7], s24 offen sc1
  s_waitcnt vmcnt(0)
  s_barrier
  s_cmp_eq_u32 s17, 0
  s_cbranch_scc0 L_arr_52
  v_mov_b32 v8, 128
  v_mov_b32 v9, 1
  s_mov_b64 exec, 1
  buffer_atomic_add v9, v8, s[12:15], 0 offen
  s_mov_b64 exec, -1
L_arr_52:
L_noclr_51:
  s_cmp_lt_u32 s20, 3
  s_cbranch_scc1 L_g_lo_53
  s_cmp_ge_u32 s21, 28
  s_cbranch_scc1 L_nog
  s_mul_i32 s24, s21, 37
  s_lshr_b32 s24, s24, 8
  s_mul_i32 s25, s24, 7
  s_sub_u32 s25, s21, s25
  s_add_u32 s16, s25, 1
  s_sub_u32 s18, s20, 3
  s_lshl_b32 s18, s18, 2
  s_add_u32 s18, s18, s24
  s_mov_b32 s45, 20
  s_mov_b32 s46, 6
  s_branch L_g_set_54
L_g_lo_53:
  s_mov_b32 s16, 0
  s_mov_b32 s18, s23
  s_mov_b32 s45, 64
  s_mov_b32 s46, 1
L_g_set_54:
  s_lshl_b32 s47, s16, 2
  s_add_u32 s48, s47, 192
  s_add_u32 s47, s47, 160
  s_load_dwordx2 s[64:65], s[0:1], 24
  s_mov_b32 s66, 0x480000
  s_mov_b32 s67, 0x00020000
  s_waitcnt lgkmcnt(0)
  s_and_b32 s65, s65, 0xffff
  s_load_dwordx2 s[68:69], s[0:1], 32
  s_mov_b32 s70, 0x480000
  s_mov_b32 s71, 0x00020000
  s_waitcnt lgkmcnt(0)
  s_and_b32 s69, s69, 0xffff
  s_load_dwordx2 s[72:73], s[0:1], 16
  s_mov_b32 s74, 0x480000
  s_mov_b32 s75, 0x00020000
  s_waitcnt lgkmcnt(0)
  s_and_b32 s73, s73, 0xffff
  v_and_b32 v6, 63, v0
  v_lshrrev_b32 v7, 3, v6
  v_and_b32 v8, 7, v6
  v_bfe_u32 v9, v7, 1, 1
  v_lshlrev_b32 v9, 1, v9
  v_xor_b32 v8, v8, v9
  v_lshlrev_b32 v8, 4, v8
  v_lshlrev_b32 v7, 13, v7
  v_add_u32 v3, v7, v8
  v_xor_b32 v4, 64, v3
  v_lshrrev_b32 v7, 4, v6
  v_bfe_u32 v8, v6, 2, 2
  v_lshl_add_u32 v9, v7, 3, v8
  v_lshlrev_b32 v9, 7, v9
  v_lshrrev_b32 v10, 1, v8
  v_and_b32 v11, 1, v7
  v_lshl_or_b32 v10, v11, 1, v10
  v_lshl_add_u32 v9, v10, 5, v9
  v_and_b32 v10, 3, v6
  v_lshl_add_u32 v5, v10, 3, v9
  s_lshl_b32 s34, s17, 10
  s_and_b32 s28, s17, 1
  s_cmp_eq_u32 s28, 1
  s_cselect_b64 vcc, -1, 0
  v_cndmask_b32 v12, v3, v4, vcc
  s_mov_b32 s40, 0
  s_mov_b32 s41, s18
  s_lshr_b32 s28, s41, 6
  s_cmp_eq_u32 s28, 1
  s_cselect_b32 s76, s68, s64
  s_cmp_eq_u32 s28, 2
  s_cselect_b32 s76, s72, s76
  s_cmp_eq_u32 s28, 1
  s_cselect_b32 s77, s69, s65
  s_cmp_eq_u32 s28, 2
  s_cselect_b32 s77, s73, s77
  s_cmp_eq_u32 s28, 1
  s_cselect_b32 s78, s70, s66
  s_cmp_eq_u32 s28, 2
  s_cselect_b32 s78, s74, s78
  s_cmp_eq_u32 s28, 1
  s_cselect_b32 s79, s71, s67
  s_cmp_eq_u32 s28, 2
  s_cselect_b32 s79, s75, s79
  s_mov_b32 s79, 0x00020000
  s_and_b32 s29, s41, 63
  s_lshl_b32 s29, s29, 7
  s_load_dwordx2 s[8:9], s[0:1], 0
  s_mov_b32 s10, 0x240000
  s_mov_b32 s11, 0x00020000
  s_waitcnt lgkmcnt(0)
  s_and_b32 s9, s9, 0xffff
  v_and_b32 v6, 63, v0
  v_lshlrev_b32 v1, 4, v6
  v_add_u32 v7, 0, v6
  v_mul_u32_u24 v8, 58255, v7
  v_lshrrev_b32 v8, 22, v8
  v_mul_u32_u24 v9, 72, v8
  v_sub_u32 v9, v7, v9
  v_bfe_u32 v10, v8, 1, 3
  v_xor_b32 v9, v9, v10
  v_lshlrev_b32 v9, 4, v9
  v_mul_u32_u24 v8, 1152, v8
  v_add_u32 v136, v8, v9
  v_add_u32 v7, 64, v6
  v_mul_u32_u24 v8, 58255, v7
  v_lshrrev_b32 v8, 22, v8
  v_mul_u32_u24 v9, 72, v8
  v_sub_u32 v9, v7, v9
  v_bfe_u32 v10, v8, 1, 3
  v_xor_b32 v9, v9, v10
  v_lshlrev_b32 v9, 4, v9
  v_mul_u32_u24 v8, 1152, v8
  v_add_u32 v137, v8, v9
  v_add_u32 v7, 128, v6
  v_mul_u32_u24 v8, 58255, v7
  v_lshrrev_b32 v8, 22, v8
  v_mul_u32_u24 v9, 72, v8
  v_sub_u32 v9, v7, v9
  v_bfe_u32 v10, v8, 1, 3
  v_xor_b32 v9, v9, v10
  v_lshlrev_b32 v9, 4, v9
  v_mul_u32_u24 v8, 1152, v8
  v_add_u32 v138, v8, v9
  v_add_u32 v7, 192, v6
  v_mul_u32_u24 v8, 58255, v7
  v_lshrrev_b32 v8, 22, v8
  v_mul_u32_u24 v9, 72, v8
  v_sub_u32 v9, v7, v9
  v_bfe_u32 v10, v8, 1, 3
  v_xor_b32 v9, v9, v10
  v_lshlrev_b32 v9, 4, v9
  v_mul_u32_u24 v8, 1152, v8
  v_add_u32 v139, v8, v9
  v_add_u32 v7, 256, v6
  v_mul_u32_u24 v8, 58255, v7
  v_lshrrev_b32 v8, 22, v8
  v_mul_u32_u24 v9, 72, v8
  v_sub_u32 v9, v7, v9
  v_bfe_u32 v10, v8, 1, 3
  v_xor_b32 v9, v9, v10
  v_lshlrev_b32 v9, 4, v9
  v_mul_u32_u24 v8, 1152, v8
  v_add_u32 v140, v8, v9
  v_add_u32 v7, 320, v6
  v_mul_u32_u24 v8, 58255, v7
  v_lshrrev_b32 v8, 22, v8
  v_mul_u32_u24 v9, 72, v8
  v_sub_u32 v9, v7, v9
  v_bfe_u32 v10, v8, 1, 3
  v_xor_b32 v9, v9, v10
  v_lshlrev_b32 v9, 4, v9
  v_mul_u32_u24 v8, 1152, v8
  v_add_u32 v141, v8, v9
  v_add_u32 v7, 384, v6
  v_mul_u32_u24 v8, 58255, v7
  v_lshrrev_b32 v8, 22, v8
  v_mul_u32_u24 v9, 72, v8
  v_sub_u32 v9, v7, v9
  v_bfe_u32 v10, v8, 1, 3
  v_xor_b32 v9, v9, v10
  v_lshlrev_b32 v9, 4, v9
  v_mul_u32_u24 v8, 1152, v8
  v_add_u32 v142, v8, v9
  v_add_u32 v7, 448, v6
  v_mul_u32_u24 v8, 58255, v7
  v_lshrrev_b32 v8, 22, v8
  v_mul_u32_u24 v9, 72, v8
  v_sub_u32 v9, v7, v9
  v_bfe_u32 v10, v8, 1, 3
  v_xor_b32 v9, v9, v10
  v_lshlrev_b32 v9, 4, v9
  v_mul_u32_u24 v8, 1152, v8
  v_add_u32 v143, v8, v9
  v_add_u32 v7, 512, v6
  v_mul_u32_u24 v8, 58255, v7
  v_lshrrev_b32 v8, 22, v8
  v_mul_u32_u24 v9, 72, v8
  v_sub_u32 v9, v7, v9
  v_bfe_u32 v10, v8, 1, 3
  v_xor_b32 v9, v9, v10
  v_lshlrev_b32 v9, 4, v9
  v_mul_u32_u24 v8, 1152, v8
  v_add_u32 v144, v8, v9
  v_add_u32 v7, 576, v6
  v_mul_u32_u24 v8, 58255, v7
  v_lshrrev_b32 v8, 22, v8
  v_mul_u32_u24 v9, 72, v8
  v_sub_u32 v9, v7, v9
  v_bfe_u32 v10, v8, 1, 3
  v_xor_b32 v9, v9, v10
  v_lshlrev_b32 v9, 4, v9
  v_mul_u32_u24 v8, 1152, v8
  v_add_u32 v145, v8, v9
  v_add_u32 v7, 640, v6
  v_mul_u32_u24 v8, 58255, v7
  v_lshrrev_b32 v8, 22, v8
  v_mul_u32_u24 v9, 72, v8
  v_sub_u32 v9, v7, v9
  v_bfe_u32 v10, v8, 1, 3
  v_xor_b32 v9, v9, v10
  v_lshlrev_b32 v9, 4, v9
  v_mul_u32_u24 v8, 1152, v8
  v_add_u32 v146, v8, v9
  v_add_u32 v7, 704, v6
  v_mul_u32_u24 v8, 58255, v7
  v_lshrrev_b32 v8, 22, v8
  v_mul_u32_u24 v9, 72, v8
  v_sub_u32 v9, v7, v9
  v_bfe_u32 v10, v8, 1, 3
  v_xor_b32 v9, v9, v10
  v_lshlrev_b32 v9, 4, v9
  v_mul_u32_u24 v8, 1152, v8
  v_add_u32 v147, v8, v9
  v_add_u32 v7, 768, v6
  v_mul_u32_u24 v8, 58255, v7
  v_lshrrev_b32 v8, 22, v8
  v_mul_u32_u24 v9, 72, v8
  v_sub_u32 v9, v7, v9
  v_bfe_u32 v10, v8, 1, 3
  v_xor_b32 v9, v9, v10
  v_lshlrev_b32 v9, 4, v9
  v_mul_u32_u24 v8, 1152, v8
  v_add_u32 v148, v8, v9
  v_add_u32 v7, 832, v6
  v_mul_u32_u24 v8, 58255, v7
  v_lshrrev_b32 v8, 22, v8
  v_mul_u32_u24 v9, 72, v8
  v_sub_u32 v9, v7, v9
  v_bfe_u32 v10, v8, 1, 3
  v_xor_b32 v9, v9, v10
  v_lshlrev_b32 v9, 4, v9
  v_mul_u32_u24 v8, 1152, v8
  v_add_u32 v149, v8, v9
  v_add_u32 v7, 896, v6
  v_mul_u32_u24 v8, 58255, v7
  v_lshrrev_b32 v8, 22, v8
  v_mul_u32_u24 v9, 72, v8
  v_sub_u32 v9, v7, v9
  v_bfe_u32 v10, v8, 1, 3
  v_xor_b32 v9, v9, v10
  v_lshlrev_b32 v9, 4, v9
  v_mul_u32_u24 v8, 1152, v8
  v_add_u32 v150, v8, v9
  v_add_u32 v7, 960, v6
  v_mul_u32_u24 v8, 58255, v7
  v_lshrrev_b32 v8, 22, v8
  v_mul_u32_u24 v9, 72, v8
  v_sub_u32 v9, v7, v9
  v_bfe_u32 v10, v8, 1, 3
  v_xor_b32 v9, v9, v10
  v_lshlrev_b32 v9, 4, v9
  v_mul_u32_u24 v8, 1152, v8
  v_add_u32 v151, v8, v9
  v_add_u32 v7, 1024, v6
  v_mul_u32_u24 v8, 58255, v7
  v_lshrrev_b32 v8, 22, v8
  v_mul_u32_u24 v9, 72, v8
  v_sub_u32 v9, v7, v9
  v_bfe_u32 v10, v8, 1, 3
  v_xor_b32 v9, v9, v10
  v_lshlrev_b32 v9, 4, v9
  v_mul_u32_u24 v8, 1152, v8
  v_add_u32 v152, v8, v9
  v_add_u32 v7, 1088, v6
  v_mul_u32_u24 v8, 58255, v7
  v_lshrrev_b32 v8, 22, v8
  v_mul_u32_u24 v9, 72, v8
  v_sub_u32 v9, v7, v9
  v_bfe_u32 v10, v8, 1, 3
  v_xor_b32 v9, v9, v10
  v_lshlrev_b32 v9, 4, v9
  v_mul_u32_u24 v8, 1152, v8
  v_add_u32 v153, v8, v9
  v_and_b32 v9, 15, v6
  v_lshrrev_b32 v8, 4, v6
  v_bfe_u32 v7, v9, 1, 3
  v_xor_b32 v7, v7, v8
  v_lshlrev_b32 v7, 4, v7
  v_mul_u32_u24 v10, 1152, v9
  v_add_u32 v154, v10, v7
  s_mul_i32 s27, s17, 18432
  s_add_u32 s27, s27, 73728
  v_add_u32 v154, s27, v154
  v_xor_b32 v155, 64, v154
  s_lshl_b32 s24, s16, 8
  s_lshl_b32 s25, s17, 6
  s_add_u32 s24, s24, s25
  s_mul_i32 s24, s24, 1152
  s_add_u32 m0, s27, 0
  s_nop 0
  buffer_load_dwordx4 v136, s[8:11], s24 offen lds
  s_add_u32 m0, s27, 1024
  s_nop 0
  buffer_load_dwordx4 v137, s[8:11], s24 offen lds
  s_add_u32 m0, s27, 2048
  s_nop 0
  buffer_load_dwordx4 v138, s[8:11], s24 offen lds
  s_add_u32 m0, s27, 3072
  s_nop 0
  buffer_load_dwordx4 v139, s[8:11], s24 offen lds
  s_add_u32 m0, s27, 4096
  s_nop 0
  buffer_load_dwordx4 v140, s[8:11], s24 offen lds
  s_add_u32 m0, s27, 5120
  s_nop 0
  buffer_load_dwordx4 v141, s[8:11], s24 offen lds
  s_add_u32 m0, s27, 6144
  s_nop 0
  buffer_load_dwordx4 v142, s[8:11], s24 offen lds
  s_add_u32 m0, s27, 7168
  s_nop 0
  buffer_load_dwordx4 v143, s[8:11], s24 offen lds
  s_add_u32 m0, s27, 8192
  s_nop 0
  buffer_load_dwordx4 v144, s[8:11], s24 offen lds
  s_add_u32 m0, s27, 9216
  s_nop 0
  buffer_load_dwordx4 v145, s[8:11], s24 offen lds
  s_add_u32 m0, s27, 10240
  s_nop 0
  buffer_load_dwordx4 v146, s[8:11], s24 offen lds
  s_add_u32 m0, s27, 11264
  s_nop 0
  buffer_load_dwordx4 v147, s[8:11], s24 offen lds
  s_add_u32 m0, s27, 12288
  s_nop 0
  buffer_load_dwordx4 v148, s[8:11], s24 offen lds
  s_add_u32 m0, s27, 13312
  s_nop 0
  buffer_load_dwordx4 v149, s[8:11], s24 offen lds
  s_add_u32 m0, s27, 14336
  s_nop 0
  buffer_load_dwordx4 v150, s[8:11], s24 offen lds
  s_add_u32 m0, s27, 15360
  s_nop 0
  buffer_load_dwordx4 v151, s[8:11], s24 offen lds
  s_add_u32 m0, s27, 16384
  s_nop 0
  buffer_load_dwordx4 v152, s[8:11], s24 offen lds
  s_add_u32 m0, s27, 17408
  s_nop 0
  buffer_load_dwordx4 v153, s[8:11], s24 offen lds
  s_add_u32 s24, s24, 18432
  s_add_u32 m0, s34, 0
  s_lshl_b32 s30, s17, 16
  s_add_u32 s30, s30, 0
  s_add_u32 s30, s30, s29
  buffer_load_dwordx4 v12, s[76:79], s30 offen lds
  s_add_u32 m0, s34, 4096
  s_lshl_b32 s30, s17, 16
  s_add_u32 s30, s30, 262144
  s_add_u32 s30, s30, s29
  buffer_load_dwordx4 v12, s[76:79], s30 offen lds
  s_add_u32 m0, s34, 8192
  s_lshl_b32 s30, s17, 16
  s_add_u32 s30, s30, 524288
  s_add_u32 s30, s30, s29
  buffer_load_dwordx4 v12, s[76:79], s30 offen lds
  s_add_u32 m0, s34, 12288
  s_lshl_b32 s30, s17, 16
  s_add_u32 s30, s30, 786432
  s_add_u32 s30, s30, s29
  buffer_load_dwordx4 v12, s[76:79], s30 offen lds
  s_add_u32 m0, s34, 16384
  s_lshl_b32 s30, s17, 16
  s_add_u32 s30, s30, 1048576
  s_add_u32 s30, s30, s29
  buffer_load_dwordx4 v12, s[76:79], s30 offen lds
  s_add_u32 m0, s34, 20480
  s_lshl_b32 s30, s17, 16
  s_add_u32 s30, s30, 1310720
  s_add_u32 s30, s30, s29
  buffer_load_dwordx4 v12, s[76:79], s30 offen lds
  s_add_u32 m0, s34, 24576
  s_lshl_b32 s30, s17, 16
  s_add_u32 s30, s30, 1572864
  s_add_u32 s30, s30, s29
  buffer_load_dwordx4 v12, s[76:79], s30 offen lds
  s_add_u32 m0, s34, 28672
  s_lshl_b32 s30, s17, 16
  s_add_u32 s30, s30, 1835008
  s_add_u32 s30, s30, s29
  buffer_load_dwordx4 v12, s[76:79], s30 offen lds
  s_add_u32 m0, s34, 32768
  s_lshl_b32 s30, s17, 16
  s_add_u32 s30, s30, 2097152
  s_add_u32 s30, s30, s29
  buffer_load_dwordx4 v12, s[76:79], s30 offen lds
  s_add_u32 m0, s34, 36864
  s_lshl_b32 s30, s17, 16
  s_add_u32 s30, s30, 2359296
  s_add_u32 s30, s30, s29
  buffer_load_dwordx4 v12, s[76:79], s30 offen lds
  s_add_u32 m0, s34, 40960
  s_lshl_b32 s30, s17, 16
  s_add_u32 s30, s30, 2621440
  s_add_u32 s30, s30, s29
  buffer_load_dwordx4 v12, s[76:79], s30 offen lds
  s_add_u32 m0, s34, 45056
  s_lshl_b32 s30, s17, 16
  s_add_u32 s30, s30, 2883584
  s_add_u32 s30, s30, s29
  buffer_load_dwordx4 v12, s[76:79], s30 offen lds
  s_add_u32 m0, s34, 49152
  s_lshl_b32 s30, s17, 16
  s_add_u32 s30, s30, 3145728
  s_add_u32 s30, s30, s29
  buffer_load_dwordx4 v12, s[76:79], s30 offen lds
  s_add_u32 m0, s34, 53248
  s_lshl_b32 s30, s17, 16
  s_add_u32 s30, s30, 3407872
  s_add_u32 s30, s30, s29
  buffer_load_dwordx4 v12, s[76:79], s30 offen lds
  s_add_u32 m0, s34, 57344
  s_lshl_b32 s30, s17, 16
  s_add_u32 s30, s30, 3670016
  s_add_u32 s30, s30, s29
  buffer_load_dwordx4 v12, s[76:79], s30 offen lds
  s_add_u32 m0, s34, 61440
  s_lshl_b32 s30, s17, 16
  s_add_u32 s30, s30, 3932160
  s_add_u32 s30, s30, s29
  buffer_load_dwordx4 v12, s[76:79], s30 offen lds
  s_add_u32 m0, s34, 65536
  s_lshl_b32 s30, s17, 16
  s_add_u32 s30, s30, 4194304
  s_add_u32 s30, s30, s29
  buffer_load_dwordx4 v12, s[76:79], s30 offen lds
  s_add_u32 m0, s34, 69632
  s_lshl_b32 s30, s17, 16
  s_add_u32 s30, s30, 4456448
  s_add_u32 s30, s30, s29
  buffer_load_dwordx4 v12, s[76:79], s30 offen lds
  v_mov_b32 v16, 0x3f803f80
  v_mov_b32 v17, 0x3f803f80
  v_mov_b32 v18, 0x3f803f80
  v_mov_b32 v19, 0x3f803f80
  v_lshrrev_b32 v10, 2, v9
  v_and_b32 v11, 3, v9
  s_mov_b32 s26, 0
  s_waitcnt vmcnt(18)
L_ln_top_55:
  ds_read_b128 v[64:67], v154 offset:0
  ds_read_b128 v[68:71], v155 offset:0
  ds_read_b128 v[72:75], v154 offset:128
  ds_read_b128 v[76:79], v155 offset:128
  ds_read_b128 v[80:83], v154 offset:256
  ds_read_b128 v[84:87], v155 offset:256
  ds_read_b128 v[88:91], v154 offset:384
  ds_read_b128 v[92:95], v155 offset:384
  ds_read_b128 v[96:99], v154 offset:512
  ds_read_b128 v[100:103], v155 offset:512
  ds_read_b128 v[104:107], v154 offset:640
  ds_read_b128 v[108:111], v155 offset:640
  s_waitcnt lgkmcnt(0)
  ds_read_b128 v[112:115], v154 offset:768
  ds_read_b128 v[116:119], v155 offset:768
  ds_read_b128 v[120:123], v154 offset:896
  ds_read_b128 v[124:127], v155 offset:896
  ds_read_b128 v[128:131], v154 offset:1024
  ds_read_b128 v[132:135], v155 offset:1024
  s_waitcnt lgkmcnt(0)
  s_cmp_lt_u32 s26, 3
  s_cbranch_scc0 L_ln_nodma_56
  s_add_u32 m0, s27, 0
  s_nop 0
  buffer_load_dwordx4 v136, s[8:11], s24 offen lds
  s_add_u32 m0, s27, 1024
  s_nop 0
  buffer_load_dwordx4 v137, s[8:11], s24 offen lds
  s_add_u32 m0, s27, 2048
  s_nop 0
  buffer_load_dwordx4 v138, s[8:11], s24 offen lds
  s_add_u32 m0, s27, 3072
  s_nop 0
  buffer_load_dwordx4 v139, s[8:11], s24 offen lds
  s_add_u32 m0, s27, 4096
  s_nop 0
  buffer_load_dwordx4 v140, s[8:11], s24 offen lds
  s_add_u32 m0, s27, 5120
  s_nop 0
  buffer_load_dwordx4 v141, s[8:11], s24 offen lds
  s_add_u32 m0, s27, 6144
  s_nop 0
  buffer_load_dwordx4 v142, s[8:11], s24 offen lds
  s_add_u32 m0, s27, 7168
  s_nop 0
  buffer_load_dwordx4 v143, s[8:11], s24 offen lds
  s_add_u32 m0, s27, 8192
  s_nop 0
  buffer_load_dwordx4 v144, s[8:11], s24 offen lds
  s_add_u32 m0, s27, 9216
  s_nop 0
  buffer_load_dwordx4 v145, s[8:11], s24 offen lds
  s_add_u32 m0, s27, 10240
  s_nop 0
  buffer_load_dwordx4 v146, s[8:11], s24 offen lds
  s_add_u32 m0, s27, 11264
  s_nop 0
  buffer_load_dwordx4 v147, s[8:11], s24 offen lds
  s_add_u32 m0, s27, 12288
  s_nop 0
  buffer_load_dwordx4 v148, s[8:11], s24 offen lds
  s_add_u32 m0, s27, 13312
  s_nop 0
  buffer_load_dwordx4 v149, s[8:11], s24 offen lds
  s_add_u32 m0, s27, 14336
  s_nop 0
  buffer_load_dwordx4 v150, s[8:11], s24 offen lds
  s_add_u32 m0, s27, 15360
  s_nop 0
  buffer_load_dwordx4 v151, s[8:11], s24 offen lds
  s_add_u32 m0, s27, 16384
  s_nop 0
  buffer_load_dwordx4 v152, s[8:11], s24 offen lds
  s_add_u32 m0, s27, 17408
  s_nop 0
  buffer_load_dwordx4 v153, s[8:11], s24 offen lds
  s_add_u32 s24, s24, 18432
L_ln_nodma_56:
  v_mfma_f32_16x16x32_bf16 v[20:23], v[16:19], v[64:67], 0
  v_mfma_f32_16x16x32_bf16 v[24:27], v[64:67], v[64:67], 0
  v_mfma_f32_16x16x32_bf16 v[20:23], v[16:19], v[68:71], v[20:23]
  v_mfma_f32_16x16x32_bf16 v[24:27], v[68:71], v[68:71], v[24:27]
  v_mfma_f32_16x16x32_bf16 v[20:23], v[16:19], v[72:75], v[20:23]
  v_mfma_f32_16x16x32_bf16 v[24:27], v[72:75], v[72:75], v[24:27]
  v_mfma_f32_16x16x32_bf16 v[20:23], v[16:19], v[76:79], v[20:23]
  v_mfma_f32_16x16x32_bf16 v[24:27], v[76:79], v[76:79], v[24:27]
  v_mfma_f32_16x16x32_bf16 v[20:23], v[16:19], v[80:83], v[20:23]
  v_mfma_f32_16x16x32_bf16 v[24:27], v[80:83], v[80:83], v[24:27]
  v_mfma_f32_16x16x32_bf16 v[20:23], v[16:19], v[84:87], v[20:23]
  v_mfma_f32_16x16x32_bf16 v[24:27], v[84:87], v[84:87], v[24:27]
  v_mfma_f32_16x16x32_bf16 v[20:23], v[16:19], v[88:91], v[20:23]
  v_mfma_f32_16x16x32_bf16 v[24:27], v[88:91], v[88:91], v[24:27]
  v_mfma_f32_16x16x32_bf16 v[20:23], v[16:19], v[92:95], v[20:23]
  v_mfma_f32_16x16x32_bf16 v[24:27], v[92:95], v[92:95], v[24:27]
  v_mfma_f32_16x16x32_bf16 v[20:23], v[16:19], v[96:99], v[20:23]
  v_mfma_f32_16x16x32_bf16 v[24:27], v[96:99], v[96:99], v[24:27]
  v_mfma_f32_16x16x32_bf16 v[20:23], v[16:19], v[100:103], v[20:23]
  v_mfma_f32_16x16x32_bf16 v[24:27], v[100:103], v[100:103], v[24:27]
  v_mfma_f32_16x16x32_bf16 v[20:23], v[16:19], v[104:107], v[20:23]
  v_mfma_f32_16x16x32_bf16 v[24:27], v[104:107], v[104:107], v[24:27]
  v_mfma_f32_16x16x32_bf16 v[20:23], v[16:19], v[108:111], v[20:23]
  v_mfma_f32_16x16x32_bf16 v[24:27], v[108:111], v[108:111], v[24:27]
  v_mfma_f32_16x16x32_bf16 v[20:23], v[16:19], v[112:115], v[20:23]
  v_mfma_f32_16x16x32_bf16 v[24:27], v[112:115], v[112:115], v[24:27]
  v_mfma_f32_16x16x32_bf16 v[20:23], v[16:19], v[116:119], v[20:23]
  v_mfma_f32_16x16x32_bf16 v[24:27], v[116:119], v[116:119], v[24:27]
  v_mfma_f32_16x16x32_bf16 v[20:23], v[16:19], v[120:123], v[20:23]
  v_mfma_f32_16x16x32_bf16 v[24:27], v[120:123], v[120:123], v[24:27]
  v_mfma_f32_16x16x32_bf16 v[20:23], v[16:19], v[124:127], v[20:23]
  v_mfma_f32_16x16x32_bf16 v[24:27], v[124:127], v[124:127], v[24:27]
  v_mfma_f32_16x16x32_bf16 v[20:23], v[16:19], v[128:131], v[20:23]
  v_mfma_f32_16x16x32_bf16 v[24:27], v[128:131], v[128:131], v[24:27]
  v_mfma_f32_16x16x32_bf16 v[20:23], v[16:19], v[132:135], v[20:23]
  v_mfma_f32_16x16x32_bf16 v[24:27], v[132:135], v[132:135], v[24:27]
  s_nop 7
  v_cmp_eq_u32 vcc, 1, v11
  s_nop 1
  v_cndmask_b32 v28, v24, v25, vcc
  v_cmp_eq_u32 vcc, 2, v11
  s_nop 1
  v_cndmask_b32 v28, v28, v26, vcc
  v_cmp_eq_u32 vcc, 3, v11
  s_nop 1
  v_cndmask_b32 v28, v28, v27, vcc
  v_cmp_eq_u32 vcc, v8, v10
  s_nop 1
  v_cndmask_b32 v28, 0, v28, vcc
  v_mov_b32 v29, v28
  s_nop 1
  v_permlane16_swap_b32 v28, v29
  v_add_f32 v28, v28, v29
  v_mov_b32 v29, v28
  s_nop 1
  v_permlane32_swap_b32 v28, v29
  v_add_f32 v28, v28, v29
  v_mul_f32 v20, 0x3ae38e39, v20
  v_mul_f32 v28, 0x3ae38e39, v28
  v_fma_f32 v28, -v20, v20, v28
  v_max_f32 v28, 0, v28
  v_cvt_pk_bf16_f32 v20, v20, v20
  v_lshlrev_b32 v20, 16, v20
  v_cvt_pk_bf16_f32 v28, v28, v28
  v_lshlrev_b32 v28, 16, v28
  v_add_f32 v28, 0x3727c5ac, v28
  v_cvt_pk_bf16_f32 v28, v28, v28
  v_lshlrev_b32 v28, 16, v28
  v_sqrt_f32 v28, v28
  s_nop 0
  v_cvt_pk_bf16_f32 v28, v28, v28
  v_lshlrev_b32 v28, 16, v28
  v_rcp_f32 v30, v28
  s_nop 0
  v_mul_f32 v32, v20, v30
  v_sub_f32 v32, 0, v32
  v_mov_b32 v31, v30
  v_mov_b32 v33, v32
  v_lshlrev_b32 v40, 16, v64
  v_and_b32 v41, 0xffff0000, v64
  v_lshlrev_b32 v42, 16, v65
  v_and_b32 v43, 0xffff0000, v65
  v_lshlrev_b32 v44, 16, v66
  v_and_b32 v45, 0xffff0000, v66
  v_lshlrev_b32 v46, 16, v67
  v_and_b32 v47, 0xffff0000, v67
  v_pk_fma_f32 v[40:41], v[40:41], v[30:31], v[32:33]
  v_pk_fma_f32 v[42:43], v[42:43], v[30:31], v[32:33]
  v_pk_fma_f32 v[44:45], v[44:45], v[30:31], v[32:33]
  v_pk_fma_f32 v[46:47], v[46:47], v[30:31], v[32:33]
  v_cvt_pk_bf16_f32 v64, v40, v41
  v_cvt_pk_bf16_f32 v65, v42, v43
  v_cvt_pk_bf16_f32 v66, v44, v45
  v_cvt_pk_bf16_f32 v67, v46, v47
  v_lshlrev_b32 v40, 16, v68
  v_and_b32 v41, 0xffff0000, v68
  v_lshlrev_b32 v42, 16, v69
  v_and_b32 v43, 0xffff0000, v69
  v_lshlrev_b32 v44, 16, v70
  v_and_b32 v45, 0xffff0000, v70
  v_lshlrev_b32 v46, 16, v71
  v_and_b32 v47, 0xffff0000, v71
  v_pk_fma_f32 v[40:41], v[40:41], v[30:31], v[32:33]
  v_pk_fma_f32 v[42:43], v[42:43], v[30:31], v[32:33]
  v_pk_fma_f32 v[44:45], v[44:45], v[30:31], v[32:33]
  v_pk_fma_f32 v[46:47], v[46:47], v[30:31], v[32:33]
  v_cvt_pk_bf16_f32 v68, v40, v41
  v_cvt_pk_bf16_f32 v69, v42, v43
  v_cvt_pk_bf16_f32 v70, v44, v45
  v_cvt_pk_bf16_f32 v71, v46, v47
  v_lshlrev_b32 v40, 16, v72
  v_and_b32 v41, 0xffff0000, v72
  v_lshlrev_b32 v42, 16, v73
  v_and_b32 v43, 0xffff0000, v73
  v_lshlrev_b32 v44, 16, v74
  v_and_b32 v45, 0xffff0000, v74
  v_lshlrev_b32 v46, 16, v75
  v_and_b32 v47, 0xffff0000, v75
  v_pk_fma_f32 v[40:41], v[40:41], v[30:31], v[32:33]
  v_pk_fma_f32 v[42:43], v[42:43], v[30:31], v[32:33]
  v_pk_fma_f32 v[44:45], v[44:45], v[30:31], v[32:33]
  v_pk_fma_f32 v[46:47], v[46:47], v[30:31], v[32:33]
  v_cvt_pk_bf16_f32 v72, v40, v41
  v_cvt_pk_bf16_f32 v73, v42, v43
  v_cvt_pk_bf16_f32 v74, v44, v45
  v_cvt_pk_bf16_f32 v75, v46, v47
  v_lshlrev_b32 v40, 16, v76
  v_and_b32 v41, 0xffff0000, v76
  v_lshlrev_b32 v42, 16, v77
  v_and_b32 v43, 0xffff0000, v77
  v_lshlrev_b32 v44, 16, v78
  v_and_b32 v45, 0xffff0000, v78
  v_lshlrev_b32 v46, 16, v79
  v_and_b32 v47, 0xffff0000, v79
  v_pk_fma_f32 v[40:41], v[40:41], v[30:31], v[32:33]
  v_pk_fma_f32 v[42:43], v[42:43], v[30:31], v[32:33]
  v_pk_fma_f32 v[44:45], v[44:45], v[30:31], v[32:33]
  v_pk_fma_f32 v[46:47], v[46:47], v[30:31], v[32:33]
  v_cvt_pk_bf16_f32 v76, v40, v41
  v_cvt_pk_bf16_f32 v77, v42, v43
  v_cvt_pk_bf16_f32 v78, v44, v45
  v_cvt_pk_bf16_f32 v79, v46, v47
  v_lshlrev_b32 v40, 16, v80
  v_and_b32 v41, 0xffff0000, v80
  v_lshlrev_b32 v42, 16, v81
  v_and_b32 v43, 0xffff0000, v81
  v_lshlrev_b32 v44, 16, v82
  v_and_b32 v45, 0xffff0000, v82
  v_lshlrev_b32 v46, 16, v83
  v_and_b32 v47, 0xffff0000, v83
  v_pk_fma_f32 v[40:41], v[40:41], v[30:31], v[32:33]
  v_pk_fma_f32 v[42:43], v[42:43], v[30:31], v[32:33]
  v_pk_fma_f32 v[44:45], v[44:45], v[30:31], v[32:33]
  v_pk_fma_f32 v[46:47], v[46:47], v[30:31], v[32:33]
  v_cvt_pk_bf16_f32 v80, v40, v41
  v_cvt_pk_bf16_f32 v81, v42, v43
  v_cvt_pk_bf16_f32 v82, v44, v45
  v_cvt_pk_bf16_f32 v83, v46, v47
  v_lshlrev_b32 v40, 16, v84
  v_and_b32 v41, 0xffff0000, v84
  v_lshlrev_b32 v42, 16, v85
  v_and_b32 v43, 0xffff0000, v85
  v_lshlrev_b32 v44, 16, v86
  v_and_b32 v45, 0xffff0000, v86
  v_lshlrev_b32 v46, 16, v87
  v_and_b32 v47, 0xffff0000, v87
  v_pk_fma_f32 v[40:41], v[40:41], v[30:31], v[32:33]
  v_pk_fma_f32 v[42:43], v[42:43], v[30:31], v[32:33]
  v_pk_fma_f32 v[44:45], v[44:45], v[30:31], v[32:33]
  v_pk_fma_f32 v[46:47], v[46:47], v[30:31], v[32:33]
  v_cvt_pk_bf16_f32 v84, v40, v41
  v_cvt_pk_bf16_f32 v85, v42, v43
  v_cvt_pk_bf16_f32 v86, v44, v45
  v_cvt_pk_bf16_f32 v87, v46, v47
  v_lshlrev_b32 v40, 16, v88
  v_and_b32 v41, 0xffff0000, v88
  v_lshlrev_b32 v42, 16, v89
  v_and_b32 v43, 0xffff0000, v89
  v_lshlrev_b32 v44, 16, v90
  v_and_b32 v45, 0xffff0000, v90
  v_lshlrev_b32 v46, 16, v91
  v_and_b32 v47, 0xffff0000, v91
  v_pk_fma_f32 v[40:41], v[40:41], v[30:31], v[32:33]
  v_pk_fma_f32 v[42:43], v[42:43], v[30:31], v[32:33]
  v_pk_fma_f32 v[44:45], v[44:45], v[30:31], v[32:33]
  v_pk_fma_f32 v[46:47], v[46:47], v[30:31], v[32:33]
  v_cvt_pk_bf16_f32 v88, v40, v41
  v_cvt_pk_bf16_f32 v89, v42, v43
  v_cvt_pk_bf16_f32 v90, v44, v45
  v_cvt_pk_bf16_f32 v91, v46, v47
  v_lshlrev_b32 v40, 16, v92
  v_and_b32 v41, 0xffff0000, v92
  v_lshlrev_b32 v42, 16, v93
  v_and_b32 v43, 0xffff0000, v93
  v_lshlrev_b32 v44, 16, v94
  v_and_b32 v45, 0xffff0000, v94
  v_lshlrev_b32 v46, 16, v95
  v_and_b32 v47, 0xffff0000, v95
  v_pk_fma_f32 v[40:41], v[40:41], v[30:31], v[32:33]
  v_pk_fma_f32 v[42:43], v[42:43], v[30:31], v[32:33]
  v_pk_fma_f32 v[44:45], v[44:45], v[30:31], v[32:33]
  v_pk_fma_f32 v[46:47], v[46:47], v[30:31], v[32:33]
  v_cvt_pk_bf16_f32 v92, v40, v41
  v_cvt_pk_bf16_f32 v93, v42, v43
  v_cvt_pk_bf16_f32 v94, v44, v45
  v_cvt_pk_bf16_f32 v95, v46, v47
  v_lshlrev_b32 v40, 16, v96
  v_and_b32 v41, 0xffff0000, v96
  v_lshlrev_b32 v42, 16, v97
  v_and_b32 v43, 0xffff0000, v97
  v_lshlrev_b32 v44, 16, v98
  v_and_b32 v45, 0xffff0000, v98
  v_lshlrev_b32 v46, 16, v99
  v_and_b32 v47, 0xffff0000, v99
  v_pk_fma_f32 v[40:41], v[40:41], v[30:31], v[32:33]
  v_pk_fma_f32 v[42:43], v[42:43], v[30:31], v[32:33]
  v_pk_fma_f32 v[44:45], v[44:45], v[30:31], v[32:33]
  v_pk_fma_f32 v[46:47], v[46:47], v[30:31], v[32:33]
  v_cvt_pk_bf16_f32 v96, v40, v41
  v_cvt_pk_bf16_f32 v97, v42, v43
  v_cvt_pk_bf16_f32 v98, v44, v45
  v_cvt_pk_bf16_f32 v99, v46, v47
  v_lshlrev_b32 v40, 16, v100
  v_and_b32 v41, 0xffff0000, v100
  v_lshlrev_b32 v42, 16, v101
  v_and_b32 v43, 0xffff0000, v101
  v_lshlrev_b32 v44, 16, v102
  v_and_b32 v45, 0xffff0000, v102
  v_lshlrev_b32 v46, 16, v103
  v_and_b32 v47, 0xffff0000, v103
  v_pk_fma_f32 v[40:41], v[40:41], v[30:31], v[32:33]
  v_pk_fma_f32 v[42:43], v[42:43], v[30:31], v[32:33]
  v_pk_fma_f32 v[44:45], v[44:45], v[30:31], v[32:33]
  v_pk_fma_f32 v[46:47], v[46:47], v[30:31], v[32:33]
  v_cvt_pk_bf16_f32 v100, v40, v41
  v_cvt_pk_bf16_f32 v101, v42, v43
  v_cvt_pk_bf16_f32 v102, v44, v45
  v_cvt_pk_bf16_f32 v103, v46, v47
  v_lshlrev_b32 v40, 16, v104
  v_and_b32 v41, 0xffff0000, v104
  v_lshlrev_b32 v42, 16, v105
  v_and_b32 v43, 0xffff0000, v105
  v_lshlrev_b32 v44, 16, v106
  v_and_b32 v45, 0xffff0000, v106
  v_lshlrev_b32 v46, 16, v107
  v_and_b32 v47, 0xffff0000, v107
  v_pk_fma_f32 v[40:41], v[40:41], v[30:31], v[32:33]
  v_pk_fma_f32 v[42:43], v[42:43], v[30:31], v[32:33]
  v_pk_fma_f32 v[44:45], v[44:45], v[30:31], v[32:33]
  v_pk_fma_f32 v[46:47], v[46:47], v[30:31], v[32:33]
  v_cvt_pk_bf16_f32 v104, v40, v41
  v_cvt_pk_bf16_f32 v105, v42, v43
  v_cvt_pk_bf16_f32 v106, v44, v45
  v_cvt_pk_bf16_f32 v107, v46, v47
  v_lshlrev_b32 v40, 16, v108
  v_and_b32 v41, 0xffff0000, v108
  v_lshlrev_b32 v42, 16, v109
  v_and_b32 v43, 0xffff0000, v109
  v_lshlrev_b32 v44, 16, v110
  v_and_b32 v45, 0xffff0000, v110
  v_lshlrev_b32 v46, 16, v111
  v_and_b32 v47, 0xffff0000, v111
  v_pk_fma_f32 v[40:41], v[40:41], v[30:31], v[32:33]
  v_pk_fma_f32 v[42:43], v[42:43], v[30:31], v[32:33]
  v_pk_fma_f32 v[44:45], v[44:45], v[30:31], v[32:33]
  v_pk_fma_f32 v[46:47], v[46:47], v[30:31], v[32:33]
  v_cvt_pk_bf16_f32 v108, v40, v41
  v_cvt_pk_bf16_f32 v109, v42, v43
  v_cvt_pk_bf16_f32 v110, v44, v45
  v_cvt_pk_bf16_f32 v111, v46, v47
  v_lshlrev_b32 v40, 16, v112
  v_and_b32 v41, 0xffff0000, v112
  v_lshlrev_b32 v42, 16, v113
  v_and_b32 v43, 0xffff0000, v113
  v_lshlrev_b32 v44, 16, v114
  v_and_b32 v45, 0xffff0000, v114
  v_lshlrev_b32 v46, 16, v115
  v_and_b32 v47, 0xffff0000, v115
  v_pk_fma_f32 v[40:41], v[40:41], v[30:31], v[32:33]
  v_pk_fma_f32 v[42:43], v[42:43], v[30:31], v[32:33]
  v_pk_fma_f32 v[44:45], v[44:45], v[30:31], v[32:33]
  v_pk_fma_f32 v[46:47], v[46:47], v[30:31], v[32:33]
  v_cvt_pk_bf16_f32 v112, v40, v41
  v_cvt_pk_bf16_f32 v113, v42, v43
  v_cvt_pk_bf16_f32 v114, v44, v45
  v_cvt_pk_bf16_f32 v115, v46, v47
  v_lshlrev_b32 v40, 16, v116
  v_and_b32 v41, 0xffff0000, v116
  v_lshlrev_b32 v42, 16, v117
  v_and_b32 v43, 0xffff0000, v117
  v_lshlrev_b32 v44, 16, v118
  v_and_b32 v45, 0xffff0000, v118
  v_lshlrev_b32 v46, 16, v119
  v_and_b32 v47, 0xffff0000, v119
  v_pk_fma_f32 v[40:41], v[40:41], v[30:31], v[32:33]
  v_pk_fma_f32 v[42:43], v[42:43], v[30:31], v[32:33]
  v_pk_fma_f32 v[44:45], v[44:45], v[30:31], v[32:33]
  v_pk_fma_f32 v[46:47], v[46:47], v[30:31], v[32:33]
  v_cvt_pk_bf16_f32 v116, v40, v41
  v_cvt_pk_bf16_f32 v117, v42, v43
  v_cvt_pk_bf16_f32 v118, v44, v45
  v_cvt_pk_bf16_f32 v119, v46, v47
  v_lshlrev_b32 v40, 16, v120
  v_and_b32 v41, 0xffff0000, v120
  v_lshlrev_b32 v42, 16, v121
  v_and_b32 v43, 0xffff0000, v121
  v_lshlrev_b32 v44, 16, v122
  v_and_b32 v45, 0xffff0000, v122
  v_lshlrev_b32 v46, 16, v123
  v_and_b32 v47, 0xffff0000, v123
  v_pk_fma_f32 v[40:41], v[40:41], v[30:31], v[32:33]
  v_pk_fma_f32 v[42:43], v[42:43], v[30:31], v[32:33]
  v_pk_fma_f32 v[44:45], v[44:45], v[30:31], v[32:33]
  v_pk_fma_f32 v[46:47], v[46:47], v[30:31], v[32:33]
  v_cvt_pk_bf16_f32 v120, v40, v41
  v_cvt_pk_bf16_f32 v121, v42, v43
  v_cvt_pk_bf16_f32 v122, v44, v45
  v_cvt_pk_bf16_f32 v123, v46, v47
  v_lshlrev_b32 v40, 16, v124
  v_and_b32 v41, 0xffff0000, v124
  v_lshlrev_b32 v42, 16, v125
  v_and_b32 v43, 0xffff0000, v125
  v_lshlrev_b32 v44, 16, v126
  v_and_b32 v45, 0xffff0000, v126
  v_lshlrev_b32 v46, 16, v127
  v_and_b32 v47, 0xffff0000, v127
  v_pk_fma_f32 v[40:41], v[40:41], v[30:31], v[32:33]
  v_pk_fma_f32 v[42:43], v[42:43], v[30:31], v[32:33]
  v_pk_fma_f32 v[44:45], v[44:45], v[30:31], v[32:33]
  v_pk_fma_f32 v[46:47], v[46:47], v[30:31], v[32:33]
  v_cvt_pk_bf16_f32 v124, v40, v41
  v_cvt_pk_bf16_f32 v125, v42, v43
  v_cvt_pk_bf16_f32 v126, v44, v45
  v_cvt_pk_bf16_f32 v127, v46, v47
  v_lshlrev_b32 v40, 16, v128
  v_and_b32 v41, 0xffff0000, v128
  v_lshlrev_b32 v42, 16, v129
  v_and_b32 v43, 0xffff0000, v129
  v_lshlrev_b32 v44, 16, v130
  v_and_b32 v45, 0xffff0000, v130
  v_lshlrev_b32 v46, 16, v131
  v_and_b32 v47, 0xffff0000, v131
  v_pk_fma_f32 v[40:41], v[40:41], v[30:31], v[32:33]
  v_pk_fma_f32 v[42:43], v[42:43], v[30:31], v[32:33]
  v_pk_fma_f32 v[44:45], v[44:45], v[30:31], v[32:33]
  v_pk_fma_f32 v[46:47], v[46:47], v[30:31], v[32:33]
  v_cvt_pk_bf16_f32 v128, v40, v41
  v_cvt_pk_bf16_f32 v129, v42, v43
  v_cvt_pk_bf16_f32 v130, v44, v45
  v_cvt_pk_bf16_f32 v131, v46, v47
  v_lshlrev_b32 v40, 16, v132
  v_and_b32 v41, 0xffff0000, v132
  v_lshlrev_b32 v42, 16, v133
  v_and_b32 v43, 0xffff0000, v133
  v_lshlrev_b32 v44, 16, v134
  v_and_b32 v45, 0xffff0000, v134
  v_lshlrev_b32 v46, 16, v135
  v_and_b32 v47, 0xffff0000, v135
  v_pk_fma_f32 v[40:41], v[40:41], v[30:31], v[32:33]
  v_pk_fma_f32 v[42:43], v[42:43], v[30:31], v[32:33]
  v_pk_fma_f32 v[44:45], v[44:45], v[30:31], v[32:33]
  v_pk_fma_f32 v[46:47], v[46:47], v[30:31], v[32:33]
  v_cvt_pk_bf16_f32 v132, v40, v41
  v_cvt_pk_bf16_f32 v133, v42, v43
  v_cvt_pk_bf16_f32 v134, v44, v45
  v_cvt_pk_bf16_f32 v135, v46, v47
  s_cmp_eq_u32 s26, 0
  s_cbranch_scc0 L_ln_wb_58
  v_accvgpr_write_b32 a0, v64
  v_accvgpr_write_b32 a1, v65
  v_accvgpr_write_b32 a2, v66
  v_accvgpr_write_b32 a3, v67
  v_accvgpr_write_b32 a4, v68
  v_accvgpr_write_b32 a5, v69
  v_accvgpr_write_b32 a6, v70
  v_accvgpr_write_b32 a7, v71
  v_accvgpr_write_b32 a8, v72
  v_accvgpr_write_b32 a9, v73
  v_accvgpr_write_b32 a10, v74
  v_accvgpr_write_b32 a11, v75
  v_accvgpr_write_b32 a12, v76
  v_accvgpr_write_b32 a13, v77
  v_accvgpr_write_b32 a14, v78
  v_accvgpr_write_b32 a15, v79
  v_accvgpr_write_b32 a16, v80
  v_accvgpr_write_b32 a17, v81
  v_accvgpr_write_b32 a18, v82
  v_accvgpr_write_b32 a19, v83
  v_accvgpr_write_b32 a20, v84
  v_accvgpr_write_b32 a21, v85
  v_accvgpr_write_b32 a22, v86
  v_accvgpr_write_b32 a23, v87
  v_accvgpr_write_b32 a24, v88
  v_accvgpr_write_b32 a25, v89
  v_accvgpr_write_b32 a26, v90
  v_accvgpr_write_b32 a27, v91
  v_accvgpr_write_b32 a28, v92
  v_accvgpr_write_b32 a29, v93
  v_accvgpr_write_b32 a30, v94
  v_accvgpr_write_b32 a31, v95
  v_accvgpr_write_b32 a32, v96
  v_accvgpr_write_b32 a33, v97
  v_accvgpr_write_b32 a34, v98
  v_accvgpr_write_b32 a35, v99
  v_accvgpr_write_b32 a36, v100
  v_accvgpr_write_b32 a37, v101
  v_accvgpr_write_b32 a38, v102
  v_accvgpr_write_b32 a39, v103
  v_accvgpr_write_b32 a40, v104
  v_accvgpr_write_b32 a41, v105
  v_accvgpr_write_b32 a42, v106
  v_accvgpr_write_b32 a43, v107
  v_accvgpr_write_b32 a44, v108
  v_accvgpr_write_b32 a45, v109
  v_accvgpr_write_b32 a46, v110
  v_accvgpr_write_b32 a47, v111
  v_accvgpr_write_b32 a48, v112
  v_accvgpr_write_b32 a49, v113
  v_accvgpr_write_b32 a50, v114
  v_accvgpr_write_b32 a51, v115
  v_accvgpr_write_b32 a52, v116
  v_accvgpr_write_b32 a53, v117
  v_accvgpr_write_b32 a54, v118
  v_accvgpr_write_b32 a55, v119
  v_accvgpr_write_b32 a56, v120
  v_accvgpr_write_b32 a57, v121
  v_accvgpr_write_b32 a58, v122
  v_accvgpr_write_b32 a59, v123
  v_accvgpr_write_b32 a60, v124
  v_accvgpr_write_b32 a61, v125
  v_accvgpr_write_b32 a62, v126
  v_accvgpr_write_b32 a63, v127
  v_accvgpr_write_b32 a64, v128
  v_accvgpr_write_b32 a65, v129
  v_accvgpr_write_b32 a66, v130
  v_accvgpr_write_b32 a67, v131
  v_accvgpr_write_b32 a68, v132
  v_accvgpr_write_b32 a69, v133
  v_accvgpr_write_b32 a70, v134
  v_accvgpr_write_b32 a71, v135
  s_branch L_ln_next_57
L_ln_wb_58:
  s_cmp_eq_u32 s26, 1
  s_cbranch_scc0 L_ln_wb_59
  v_accvgpr_write_b32 a72, v64
  v_accvgpr_write_b32 a73, v65
  v_accvgpr_write_b32 a74, v66
  v_accvgpr_write_b32 a75, v67
  v_accvgpr_write_b32 a76, v68
  v_accvgpr_write_b32 a77, v69
  v_accvgpr_write_b32 a78, v70
  v_accvgpr_write_b32 a79, v71
  v_accvgpr_write_b32 a80, v72
  v_accvgpr_write_b32 a81, v73
  v_accvgpr_write_b32 a82, v74
  v_accvgpr_write_b32 a83, v75
  v_accvgpr_write_b32 a84, v76
  v_accvgpr_write_b32 a85, v77
  v_accvgpr_write_b32 a86, v78
  v_accvgpr_write_b32 a87, v79
  v_accvgpr_write_b32 a88, v80
  v_accvgpr_write_b32 a89, v81
  v_accvgpr_write_b32 a90, v82
  v_accvgpr_write_b32 a91, v83
  v_accvgpr_write_b32 a92, v84
  v_accvgpr_write_b32 a93, v85
  v_accvgpr_write_b32 a94, v86
  v_accvgpr_write_b32 a95, v87
  v_accvgpr_write_b32 a96, v88
  v_accvgpr_write_b32 a97, v89
  v_accvgpr_write_b32 a98, v90
  v_accvgpr_write_b32 a99, v91
  v_accvgpr_write_b32 a100, v92
  v_accvgpr_write_b32 a101, v93
  v_accvgpr_write_b32 a102, v94
  v_accvgpr_write_b32 a103, v95
  v_accvgpr_write_b32 a104, v96
  v_accvgpr_write_b32 a105, v97
  v_accvgpr_write_b32 a106, v98
  v_accvgpr_write_b32 a107, v99
  v_accvgpr_write_b32 a108, v100
  v_accvgpr_write_b32 a109, v101
  v_accvgpr_write_b32 a110, v102
  v_accvgpr_write_b32 a111, v103
  v_accvgpr_write_b32 a112, v104
  v_accvgpr_write_b32 a113, v105
  v_accvgpr_write_b32 a114, v106
  v_accvgpr_write_b32 a115, v107
  v_accvgpr_write_b32 a116, v108
  v_accvgpr_write_b32 a117, v109
  v_accvgpr_write_b32 a118, v110
  v_accvgpr_write_b32 a119, v111
  v_accvgpr_write_b32 a120, v112
  v_accvgpr_write_b32 a121, v113
  v_accvgpr_write_b32 a122, v114
  v_accvgpr_write_b32 a123, v115
  v_accvgpr_write_b32 a124, v116
  v_accvgpr_write_b32 a125, v117
  v_accvgpr_write_b32 a126, v118
  v_accvgpr_write_b32 a127, v119
  v_accvgpr_write_b32 a128, v120
  v_accvgpr_write_b32 a129, v121
  v_accvgpr_write_b32 a130, v122
  v_accvgpr_write_b32 a131, v123
  v_accvgpr_write_b32 a132, v124
  v_accvgpr_write_b32 a133, v125
  v_accvgpr_write_b32 a134, v126
  v_accvgpr_write_b32 a135, v127
  v_accvgpr_write_b32 a136, v128
  v_accvgpr_write_b32 a137, v129
  v_accvgpr_write_b32 a138, v130
  v_accvgpr_write_b32 a139, v131
  v_accvgpr_write_b32 a140, v132
  v_accvgpr_write_b32 a141, v133
  v_accvgpr_write_b32 a142, v134
  v_accvgpr_write_b32 a143, v135
  s_branch L_ln_next_57
L_ln_wb_59:
  s_cmp_eq_u32 s26, 2
  s_cbranch_scc0 L_ln_wb_60
  v_accvgpr_write_b32 a144, v64
  v_accvgpr_write_b32 a145, v65
  v_accvgpr_write_b32 a146, v66
  v_accvgpr_write_b32 a147, v67
  v_accvgpr_write_b32 a148, v68
  v_accvgpr_write_b32 a149, v69
  v_accvgpr_write_b32 a150, v70
  v_accvgpr_write_b32 a151, v71
  v_accvgpr_write_b32 a152, v72
  v_accvgpr_write_b32 a153, v73
  v_accvgpr_write_b32 a154, v74
  v_accvgpr_write_b32 a155, v75
  v_accvgpr_write_b32 a156, v76
  v_accvgpr_write_b32 a157, v77
  v_accvgpr_write_b32 a158, v78
  v_accvgpr_write_b32 a159, v79
  v_accvgpr_write_b32 a160, v80
  v_accvgpr_write_b32 a161, v81
  v_accvgpr_write_b32 a162, v82
  v_accvgpr_write_b32 a163, v83
  v_accvgpr_write_b32 a164, v84
  v_accvgpr_write_b32 a165, v85
  v_accvgpr_write_b32 a166, v86
  v_accvgpr_write_b32 a167, v87
  v_accvgpr_write_b32 a168, v88
  v_accvgpr_write_b32 a169, v89
  v_accvgpr_write_b32 a170, v90
  v_accvgpr_write_b32 a171, v91
  v_accvgpr_write_b32 a172, v92
  v_accvgpr_write_b32 a173, v93
  v_accvgpr_write_b32 a174, v94
  v_accvgpr_write_b32 a175, v95
  v_accvgpr_write_b32 a176, v96
  v_accvgpr_write_b32 a177, v97
  v_accvgpr_write_b32 a178, v98
  v_accvgpr_write_b32 a179, v99
  v_accvgpr_write_b32 a180, v100
  v_accvgpr_write_b32 a181, v101
  v_accvgpr_write_b32 a182, v102
  v_accvgpr_write_b32 a183, v103
  v_accvgpr_write_b32 a184, v104
  v_accvgpr_write_b32 a185, v105
  v_accvgpr_write_b32 a186, v106
  v_accvgpr_write_b32 a187, v107
  v_accvgpr_write_b32 a188, v108
  v_accvgpr_write_b32 a189, v109
  v_accvgpr_write_b32 a190, v110
  v_accvgpr_write_b32 a191, v111
  v_accvgpr_write_b32 a192, v112
  v_accvgpr_write_b32 a193, v113
  v_accvgpr_write_b32 a194, v114
  v_accvgpr_write_b32 a195, v115
  v_accvgpr_write_b32 a196, v116
  v_accvgpr_write_b32 a197, v117
  v_accvgpr_write_b32 a198, v118
  v_accvgpr_write_b32 a199, v119
  v_accvgpr_write_b32 a200, v120
  v_accvgpr_write_b32 a201, v121
  v_accvgpr_write_b32 a202, v122
  v_accvgpr_write_b32 a203, v123
  v_accvgpr_write_b32 a204, v124
  v_accvgpr_write_b32 a205, v125
  v_accvgpr_write_b32 a206, v126
  v_accvgpr_write_b32 a207, v127
  v_accvgpr_write_b32 a208, v128
  v_accvgpr_write_b32 a209, v129
  v_accvgpr_write_b32 a210, v130
  v_accvgpr_write_b32 a211, v131
  v_accvgpr_write_b32 a212, v132
  v_accvgpr_write_b32 a213, v133
  v_accvgpr_write_b32 a214, v134
  v_accvgpr_write_b32 a215, v135
  s_branch L_ln_next_57
L_ln_wb_60:
  s_cmp_eq_u32 s26, 3
  s_cbranch_scc0 L_ln_wb_61
  v_accvgpr_write_b32 a216, v64
  v_accvgpr_write_b32 a217, v65
  v_accvgpr_write_b32 a218, v66
  v_accvgpr_write_b32 a219, v67
  v_accvgpr_write_b32 a220, v68
  v_accvgpr_write_b32 a221, v69
  v_accvgpr_write_b32 a222, v70
  v_accvgpr_write_b32 a223, v71
  v_accvgpr_write_b32 a224, v72
  v_accvgpr_write_b32 a225, v73
  v_accvgpr_write_b32 a226, v74
  v_accvgpr_write_b32 a227, v75
  v_accvgpr_write_b32 a228, v76
  v_accvgpr_write_b32 a229, v77
  v_accvgpr_write_b32 a230, v78
  v_accvgpr_write_b32 a231, v79
  v_accvgpr_write_b32 a232, v80
  v_accvgpr_write_b32 a233, v81
  v_accvgpr_write_b32 a234, v82
  v_accvgpr_write_b32 a235, v83
  v_accvgpr_write_b32 a236, v84
  v_accvgpr_write_b32 a237, v85
  v_accvgpr_write_b32 a238, v86
  v_accvgpr_write_b32 a239, v87
  v_accvgpr_write_b32 a240, v88
  v_accvgpr_write_b32 a241, v89
  v_accvgpr_write_b32 a242, v90
  v_accvgpr_write_b32 a243, v91
  v_accvgpr_write_b32 a244, v92
  v_accvgpr_write_b32 a245, v93
  v_accvgpr_write_b32 a246, v94
  v_accvgpr_write_b32 a247, v95
  v_accvgpr_write_b32 a248, v96
  v_accvgpr_write_b32 a249, v97
  v_accvgpr_write_b32 a250, v98
  v_accvgpr_write_b32 a251, v99
  v_accvgpr_write_b32 a252, v100
  v_accvgpr_write_b32 a253, v101
  v_accvgpr_write_b32 a254, v102
  v_accvgpr_write_b32 a255, v103
  v_mov_b32 v224, v104
  v_mov_b32 v225, v105
  v_mov_b32 v226, v106
  v_mov_b32 v227, v107
  v_mov_b32 v228, v108
  v_mov_b32 v229, v109
  v_mov_b32 v230, v110
  v_mov_b32 v231, v111
  v_mov_b32 v232, v112
  v_mov_b32 v233, v113
  v_mov_b32 v234, v114
  v_mov_b32 v235, v115
  v_mov_b32 v236, v116
  v_mov_b32 v237, v117
  v_mov_b32 v238, v118
  v_mov_b32 v239, v119
  v_mov_b32 v240, v120
  v_mov_b32 v241, v121
  v_mov_b32 v242, v122
  v_mov_b32 v243, v123
  v_mov_b32 v244, v124
  v_mov_b32 v245, v125
  v_mov_b32 v246, v126
  v_mov_b32 v247, v127
  v_mov_b32 v248, v128
  v_mov_b32 v249, v129
  v_mov_b32 v250, v130
  v_mov_b32 v251, v131
  v_mov_b32 v252, v132
  v_mov_b32 v253, v133
  v_mov_b32 v254, v134
  v_mov_b32 v255, v135
  s_branch L_ln_next_57
L_ln_wb_61:
L_ln_next_57:
  s_add_u32 s26, s26, 1
  s_waitcnt vmcnt(0)
  s_cmp_lt_u32 s26, 4
  s_cbranch_scc1 L_ln_top_55
  s_barrier
  s_waitcnt vmcnt(0)
L_g_top_62:
  s_waitcnt vmcnt(8)
  s_barrier
  s_add_u32 s31, s41, s45
  s_cmp_lt_u32 s31, 192
  s_cselect_b32 s32, 1, 0
  s_cselect_b32 s33, s31, s41
  s_lshr_b32 s28, s33, 6
  s_cmp_eq_u32 s28, 1
  s_cselect_b32 s76, s68, s64
  s_cmp_eq_u32 s28, 2
  s_cselect_b32 s76, s72, s76
  s_cmp_eq_u32 s28, 1
  s_cselect_b32 s77, s69, s65
  s_cmp_eq_u32 s28, 2
  s_cselect_b32 s77, s73, s77
  s_cmp_eq_u32 s28, 1
  s_cselect_b32 s78, s70, s66
  s_cmp_eq_u32 s28, 2
  s_cselect_b32 s78, s74, s78
  s_cmp_eq_u32 s28, 1
  s_cselect_b32 s79, s71, s67
  s_cmp_eq_u32 s28, 2
  s_cselect_b32 s79, s75, s79
  s_mov_b32 s79, 0x00020000
  s_and_b32 s29, s33, 63
  s_lshl_b32 s29, s29, 7
  s_lshr_b32 s42, s41, 6
  s_and_b32 s28, s41, 63
  s_lshl_b32 s43, s28, 12
  s_lshl_b32 s28, s16, 3
  s_lshl_b32 s30, s17, 1
  s_add_u32 s28, s28, s30
  s_lshl_b32 s28, s28, 18
  s_add_u32 s43, s43, s28
  s_lshl_b32 s28, s42, 24
  s_add_u32 s43, s43, s28
  v_xor_b32 v13, 0, v5
  v_xor_b32 v14, 32, v5
  v_xor_b32 v15, 64, v5
  v_xor_b32 v6, 96, v5
  s_cmp_eq_u32 s42, 1
  s_cbranch_scc1 L_g_isv_65
  ds_read_b64_tr_b16 v[160:161], v13 offset:0
  ds_read_b64_tr_b16 v[162:163], v13 offset:512
  ds_read_b64_tr_b16 v[164:165], v14 offset:0
  ds_read_b64_tr_b16 v[166:167], v14 offset:512
  ds_read_b64_tr_b16 v[168:169], v15 offset:0
  ds_read_b64_tr_b16 v[170:171], v15 offset:512
  ds_read_b64_tr_b16 v[172:173], v6 offset:0
  ds_read_b64_tr_b16 v[174:175], v6 offset:512
  s_waitcnt lgkmcnt(0)
  v_mfma_f32_16x16x32_bf16 v[96:99], v[160:163], a[0:3], 0
  ds_read_b64_tr_b16 v[176:177], v13 offset:4096
  v_mfma_f32_16x16x32_bf16 v[100:103], v[164:167], a[0:3], 0
  ds_read_b64_tr_b16 v[178:179], v13 offset:4608
  v_mfma_f32_16x16x32_bf16 v[104:107], v[168:171], a[0:3], 0
  ds_read_b64_tr_b16 v[180:181], v14 offset:4096
  v_mfma_f32_16x16x32_bf16 v[108:111], v[172:175], a[0:3], 0
  ds_read_b64_tr_b16 v[182:183], v14 offset:4608
  v_mfma_f32_16x16x32_bf16 v[112:115], v[160:163], a[72:75], 0
  ds_read_b64_tr_b16 v[184:185], v15 offset:4096
  v_mfma_f32_16x16x32_bf16 v[116:119], v[164:167], a[72:75], 0
  ds_read_b64_tr_b16 v[186:187], v15 offset:4608
  v_mfma_f32_16x16x32_bf16 v[120:123], v[168:171], a[72:75], 0
  ds_read_b64_tr_b16 v[188:189], v6 offset:4096
  v_mfma_f32_16x16x32_bf16 v[124:127], v[172:175], a[72:75], 0
  ds_read_b64_tr_b16 v[190:191], v6 offset:4608
  v_mfma_f32_16x16x32_bf16 v[128:131], v[160:163], a[144:147], 0
  v_mfma_f32_16x16x32_bf16 v[132:135], v[164:167], a[144:147], 0
  v_mfma_f32_16x16x32_bf16 v[136:139], v[168:171], a[144:147], 0
  s_add_u32 m0, s34, 73728
  s_lshl_b32 s30, s17, 16
  s_add_u32 s30, s30, 0
  s_add_u32 s30, s30, s29
  buffer_load_dwordx4 v12, s[76:79], s30 offen lds
  v_mfma_f32_16x16x32_bf16 v[140:143], v[172:175], a[144:147], 0
  v_mfma_f32_16x16x32_bf16 v[144:147], v[160:163], a[216:219], 0
  v_mfma_f32_16x16x32_bf16 v[148:151], v[164:167], a[216:219], 0
  v_mfma_f32_16x16x32_bf16 v[152:155], v[168:171], a[216:219], 0
  v_mfma_f32_16x16x32_bf16 v[156:159], v[172:175], a[216:219], 0
  s_waitcnt lgkmcnt(0)
  v_mfma_f32_16x16x32_bf16 v[96:99], v[176:179], a[4:7], v[96:99]
  ds_read_b64_tr_b16 v[160:161], v13 offset:8192
  v_mfma_f32_16x16x32_bf16 v[100:103], v[180:183], a[4:7], v[100:103]
  ds_read_b64_tr_b16 v[162:163], v13 offset:8704
  v_mfma_f32_16x16x32_bf16 v[104:107], v[184:187], a[4:7], v[104:107]
  ds_read_b64_tr_b16 v[164:165], v14 offset:8192
  v_mfma_f32_16x16x32_bf16 v[108:111], v[188:191], a[4:7], v[108:111]
  ds_read_b64_tr_b16 v[166:167], v14 offset:8704
  v_mfma_f32_16x16x32_bf16 v[112:115], v[176:179], a[76:79], v[112:115]
  ds_read_b64_tr_b16 v[168:169], v15 offset:8192
  v_mfma_f32_16x16x32_bf16 v[116:119], v[180:183], a[76:79], v[116:119]
  ds_read_b64_tr_b16 v[170:171], v15 offset:8704
  v_mfma_f32_16x16x32_bf16 v[120:123], v[184:187], a[76:79], v[120:123]
  ds_read_b64_tr_b16 v[172:173], v6 offset:8192
  v_mfma_f32_16x16x32_bf16 v[124:127], v[188:191], a[76:79], v[124:127]
  ds_read_b64_tr_b16 v[174:175], v6 offset:8704
  v_mfma_f32_16x16x32_bf16 v[128:131], v[176:179], a[148:151], v[128:131]
  v_mfma_f32_16x16x32_bf16 v[132:135], v[180:183], a[148:151], v[132:135]
  v_mfma_f32_16x16x32_bf16 v[136:139], v[184:187], a[148:151], v[136:139]
  s_add_u32 m0, s34, 77824
  s_lshl_b32 s30, s17, 16
  s_add_u32 s30, s30, 262144
  s_add_u32 s30, s30, s29
  buffer_load_dwordx4 v12, s[76:79], s30 offen lds
  v_mfma_f32_16x16x32_bf16 v[140:143], v[188:191], a[148:151], v[140:143]
  v_mfma_f32_16x16x32_bf16 v[144:147], v[176:179], a[220:223], v[144:147]
  v_mfma_f32_16x16x32_bf16 v[148:151], v[180:183], a[220:223], v[148:151]
  v_mfma_f32_16x16x32_bf16 v[152:155], v[184:187], a[220:223], v[152:155]
  v_mfma_f32_16x16x32_bf16 v[156:159], v[188:191], a[220:223], v[156:159]
  s_waitcnt lgkmcnt(0)
  v_mfma_f32_16x16x32_bf16 v[96:99], v[160:163], a[8:11], v[96:99]
  ds_read_b64_tr_b16 v[176:177], v13 offset:12288
  v_mfma_f32_16x16x32_bf16 v[100:103], v[164:167], a[8:11], v[100:103]
  ds_read_b64_tr_b16 v[178:179], v13 offset:12800
  v_mfma_f32_16x16x32_bf16 v[104:107], v[168:171], a[8:11], v[104:107]
  ds_read_b64_tr_b16 v[180:181], v14 offset:12288
  v_mfma_f32_16x16x32_bf16 v[108:111], v[172:175], a[8:11], v[108:111]
  ds_read_b64_tr_b16 v[182:183], v14 offset:12800
  v_mfma_f32_16x16x32_bf16 v[112:115], v[160:163], a[80:83], v[112:115]
  ds_read_b64_tr_b16 v[184:185], v15 offset:12288
  v_mfma_f32_16x16x32_bf16 v[116:119], v[164:167], a[80:83], v[116:119]
  ds_read_b64_tr_b16 v[186:187], v15 offset:12800
  v_mfma_f32_16x16x32_bf16 v[120:123], v[168:171], a[80:83], v[120:123]
  ds_read_b64_tr_b16 v[188:189], v6 offset:12288
  v_mfma_f32_16x16x32_bf16 v[124:127], v[172:175], a[80:83], v[124:127]
  ds_read_b64_tr_b16 v[190:191], v6 offset:12800
  v_mfma_f32_16x16x32_bf16 v[128:131], v[160:163], a[152:155], v[128:131]
  v_mfma_f32_16x16x32_bf16 v[132:135], v[164:167], a[152:155], v[132:135]
  v_mfma_f32_16x16x32_bf16 v[136:139], v[168:171], a[152:155], v[136:139]
  s_add_u32 m0, s34, 81920
  s_lshl_b32 s30, s17, 16
  s_add_u32 s30, s30, 524288
  s_add_u32 s30, s30, s29
  buffer_load_dwordx4 v12, s[76:79], s30 offen lds
  v_mfma_f32_16x16x32_bf16 v[140:143], v[172:175], a[152:155], v[140:143]
  v_mfma_f32_16x16x32_bf16 v[144:147], v[160:163], a[224:227], v[144:147]
  v_mfma_f32_16x16x32_bf16 v[148:151], v[164:167], a[224:227], v[148:151]
  v_mfma_f32_16x16x32_bf16 v[152:155], v[168:171], a[224:227], v[152:155]
  v_mfma_f32_16x16x32_bf16 v[156:159], v[172:175], a[224:227], v[156:159]
  s_waitcnt lgkmcnt(0)
  v_mfma_f32_16x16x32_bf16 v[96:99], v[176:179], a[12:15], v[96:99]
  ds_read_b64_tr_b16 v[160:161], v13 offset:16384
  v_mfma_f32_16x16x32_bf16 v[100:103], v[180:183], a[12:15], v[100:103]
  ds_read_b64_tr_b16 v[162:163], v13 offset:16896
  v_mfma_f32_16x16x32_bf16 v[104:107], v[184:187], a[12:15], v[104:107]
  ds_read_b64_tr_b16 v[164:165], v14 offset:16384
  v_mfma_f32_16x16x32_bf16 v[108:111], v[188:191], a[12:15], v[108:111]
  ds_read_b64_tr_b16 v[166:167], v14 offset:16896
  v_mfma_f32_16x16x32_bf16 v[112:115], v[176:179], a[84:87], v[112:115]
  ds_read_b64_tr_b16 v[168:169], v15 offset:16384
  v_mfma_f32_16x16x32_bf16 v[116:119], v[180:183], a[84:87], v[116:119]
  ds_read_b64_tr_b16 v[170:171], v15 offset:16896
  v_mfma_f32_16x16x32_bf16 v[120:123], v[184:187], a[84:87], v[120:123]
  ds_read_b64_tr_b16 v[172:173], v6 offset:16384
  v_mfma_f32_16x16x32_bf16 v[124:127], v[188:191], a[84:87], v[124:127]
  ds_read_b64_tr_b16 v[174:175], v6 offset:16896
  v_mfma_f32_16x16x32_bf16 v[128:131], v[176:179], a[156:159], v[128:131]
  v_mfma_f32_16x16x32_bf16 v[132:135], v[180:183], a[156:159], v[132:135]
  v_mfma_f32_16x16x32_bf16 v[136:139], v[184:187], a[156:159], v[136:139]
  s_add_u32 m0, s34, 86016
  s_lshl_b32 s30, s17, 16
  s_add_u32 s30, s30, 786432
  s_add_u32 s30, s30, s29
  buffer_load_dwordx4 v12, s[76:79], s30 offen lds
  v_mfma_f32_16x16x32_bf16 v[140:143], v[188:191], a[156:159], v[140:143]
  v_mfma_f32_16x16x32_bf16 v[144:147], v[176:179], a[228:231], v[144:147]
  v_mfma_f32_16x16x32_bf16 v[148:151], v[180:183], a[228:231], v[148:151]
  v_mfma_f32_16x16x32_bf16 v[152:155], v[184:187], a[228:231], v[152:155]
  v_mfma_f32_16x16x32_bf16 v[156:159], v[188:191], a[228:231], v[156:159]
  s_waitcnt lgkmcnt(0)
  v_mfma_f32_16x16x32_bf16 v[96:99], v[160:163], a[16:19], v[96:99]
  ds_read_b64_tr_b16 v[176:177], v13 offset:20480
  v_mfma_f32_16x16x32_bf16 v[100:103], v[164:167], a[16:19], v[100:103]
  ds_read_b64_tr_b16 v[178:179], v13 offset:20992
  v_mfma_f32_16x16x32_bf16 v[104:107], v[168:171], a[16:19], v[104:107]
  ds_read_b64_tr_b16 v[180:181], v14 offset:20480
  v_mfma_f32_16x16x32_bf16 v[108:111], v[172:175], a[16:19], v[108:111]
  ds_read_b64_tr_b16 v[182:183], v14 offset:20992
  v_mfma_f32_16x16x32_bf16 v[112:115], v[160:163], a[88:91], v[112:115]
  ds_read_b64_tr_b16 v[184:185], v15 offset:20480
  v_mfma_f32_16x16x32_bf16 v[116:119], v[164:167], a[88:91], v[116:119]
  ds_read_b64_tr_b16 v[186:187], v15 offset:20992
  v_mfma_f32_16x16x32_bf16 v[120:123], v[168:171], a[88:91], v[120:123]
  ds_read_b64_tr_b16 v[188:189], v6 offset:20480
  v_mfma_f32_16x16x32_bf16 v[124:127], v[172:175], a[88:91], v[124:127]
  ds_read_b64_tr_b16 v[190:191], v6 offset:20992
  v_mfma_f32_16x16x32_bf16 v[128:131], v[160:163], a[160:163], v[128:131]
  v_mfma_f32_16x16x32_bf16 v[132:135], v[164:167], a[160:163], v[132:135]
  v_mfma_f32_16x16x32_bf16 v[136:139], v[168:171], a[160:163], v[136:139]
  s_add_u32 m0, s34, 90112
  s_lshl_b32 s30, s17, 16
  s_add_u32 s30, s30, 1048576
  s_add_u32 s30, s30, s29
  buffer_load_dwordx4 v12, s[76:79], s30 offen lds
  v_mfma_f32_16x16x32_bf16 v[140:143], v[172:175], a[160:163], v[140:143]
  v_mfma_f32_16x16x32_bf16 v[144:147], v[160:163], a[232:235], v[144:147]
  v_mfma_f32_16x16x32_bf16 v[148:151], v[164:167], a[232:235], v[148:151]
  v_mfma_f32_16x16x32_bf16 v[152:155], v[168:171], a[232:235], v[152:155]
  v_mfma_f32_16x16x32_bf16 v[156:159], v[172:175], a[232:235], v[156:159]
  s_waitcnt lgkmcnt(0)
  v_mfma_f32_16x16x32_bf16 v[96:99], v[176:179], a[20:23], v[96:99]
  ds_read_b64_tr_b16 v[160:161], v13 offset:24576
  v_mfma_f32_16x16x32_bf16 v[100:103], v[180:183], a[20:23], v[100:103]
  ds_read_b64_tr_b16 v[162:163], v13 offset:25088
  v_mfma_f32_16x16x32_bf16 v[104:107], v[184:187], a[20:23], v[104:107]
  ds_read_b64_tr_b16 v[164:165], v14 offset:24576
  v_mfma_f32_16x16x32_bf16 v[108:111], v[188:191], a[20:23], v[108:111]
  ds_read_b64_tr_b16 v[166:167], v14 offset:25088
  v_mfma_f32_16x16x32_bf16 v[112:115], v[176:179], a[92:95], v[112:115]
  ds_read_b64_tr_b16 v[168:169], v15 offset:24576
  v_mfma_f32_16x16x32_bf16 v[116:119], v[180:183], a[92:95], v[116:119]
  ds_read_b64_tr_b16 v[170:171], v15 offset:25088
  v_mfma_f32_16x16x32_bf16 v[120:123], v[184:187], a[92:95], v[120:123]
  ds_read_b64_tr_b16 v[172:173], v6 offset:24576
  v_mfma_f32_16x16x32_bf16 v[124:127], v[188:191], a[92:95], v[124:127]
  ds_read_b64_tr_b16 v[174:175], v6 offset:25088
  v_mfma_f32_16x16x32_bf16 v[128:131], v[176:179], a[164:167], v[128:131]
  v_mfma_f32_16x16x32_bf16 v[132:135], v[180:183], a[164:167], v[132:135]
  v_mfma_f32_16x16x32_bf16 v[136:139], v[184:187], a[164:167], v[136:139]
  s_add_u32 m0, s34, 94208
  s_lshl_b32 s30, s17, 16
  s_add_u32 s30, s30, 1310720
  s_add_u32 s30, s30, s29
  buffer_load_dwordx4 v12, s[76:79], s30 offen lds
  v_mfma_f32_16x16x32_bf16 v[140:143], v[188:191], a[164:167], v[140:143]
  v_mfma_f32_16x16x32_bf16 v[144:147], v[176:179], a[236:239], v[144:147]
  v_mfma_f32_16x16x32_bf16 v[148:151], v[180:183], a[236:239], v[148:151]
  v_mfma_f32_16x16x32_bf16 v[152:155], v[184:187], a[236:239], v[152:155]
  v_mfma_f32_16x16x32_bf16 v[156:159], v[188:191], a[236:239], v[156:159]
  s_waitcnt lgkmcnt(0)
  v_mfma_f32_16x16x32_bf16 v[96:99], v[160:163], a[24:27], v[96:99]
  ds_read_b64_tr_b16 v[176:177], v13 offset:28672
  v_mfma_f32_16x16x32_bf16 v[100:103], v[164:167], a[24:27], v[100:103]
  ds_read_b64_tr_b16 v[178:179], v13 offset:29184
  v_mfma_f32_16x16x32_bf16 v[104:107], v[168:171], a[24:27], v[104:107]
  ds_read_b64_tr_b16 v[180:181], v14 offset:28672
  v_mfma_f32_16x16x32_bf16 v[108:111], v[172:175], a[24:27], v[108:111]
  ds_read_b64_tr_b16 v[182:183], v14 offset:29184
  v_mfma_f32_16x16x32_bf16 v[112:115], v[160:163], a[96:99], v[112:115]
  ds_read_b64_tr_b16 v[184:185], v15 offset:28672
  v_mfma_f32_16x16x32_bf16 v[116:119], v[164:167], a[96:99], v[116:119]
  ds_read_b64_tr_b16 v[186:187], v15 offset:29184
  v_mfma_f32_16x16x32_bf16 v[120:123], v[168:171], a[96:99], v[120:123]
  ds_read_b64_tr_b16 v[188:189], v6 offset:28672
  v_mfma_f32_16x16x32_bf16 v[124:127], v[172:175], a[96:99], v[124:127]
  ds_read_b64_tr_b16 v[190:191], v6 offset:29184
  v_mfma_f32_16x16x32_bf16 v[128:131], v[160:163], a[168:171], v[128:131]
  v_mfma_f32_16x16x32_bf16 v[132:135], v[164:167], a[168:171], v[132:135]
  v_mfma_f32_16x16x32_bf16 v[136:139], v[168:171], a[168:171], v[136:139]
  s_add_u32 m0, s34, 98304
  s_lshl_b32 s30, s17, 16
  s_add_u32 s30, s30, 1572864
  s_add_u32 s30, s30, s29
  buffer_load_dwordx4 v12, s[76:79], s30 offen lds
  v_mfma_f32_16x16x32_bf16 v[140:143], v[172:175], a[168:171], v[140:143]
  v_mfma_f32_16x16x32_bf16 v[144:147], v[160:163], a[240:243], v[144:147]
  v_mfma_f32_16x16x32_bf16 v[148:151], v[164:167], a[240:243], v[148:151]
  v_mfma_f32_16x16x32_bf16 v[152:155], v[168:171], a[240:243], v[152:155]
  v_mfma_f32_16x16x32_bf16 v[156:159], v[172:175], a[240:243], v[156:159]
  s_waitcnt lgkmcnt(0)
  v_mfma_f32_16x16x32_bf16 v[96:99], v[176:179], a[28:31], v[96:99]
  ds_read_b64_tr_b16 v[160:161], v13 offset:32768
  v_mfma_f32_16x16x32_bf16 v[100:103], v[180:183], a[28:31], v[100:103]
  ds_read_b64_tr_b16 v[162:163], v13 offset:33280
  v_mfma_f32_16x16x32_bf16 v[104:107], v[184:187], a[28:31], v[104:107]
  ds_read_b64_tr_b16 v[164:165], v14 offset:32768
  v_mfma_f32_16x16x32_bf16 v[108:111], v[188:191], a[28:31], v[108:111]
  ds_read_b64_tr_b16 v[166:167], v14 offset:33280
  v_mfma_f32_16x16x32_bf16 v[112:115], v[176:179], a[100:103], v[112:115]
  ds_read_b64_tr_b16 v[168:169], v15 offset:32768
  v_mfma_f32_16x16x32_bf16 v[116:119], v[180:183], a[100:103], v[116:119]
  ds_read_b64_tr_b16 v[170:171], v15 offset:33280
  v_mfma_f32_16x16x32_bf16 v[120:123], v[184:187], a[100:103], v[120:123]
  ds_read_b64_tr_b16 v[172:173], v6 offset:32768
  v_mfma_f32_16x16x32_bf16 v[124:127], v[188:191], a[100:103], v[124:127]
  ds_read_b64_tr_b16 v[174:175], v6 offset:33280
  v_mfma_f32_16x16x32_bf16 v[128:131], v[176:179], a[172:175], v[128:131]
  v_mfma_f32_16x16x32_bf16 v[132:135], v[180:183], a[172:175], v[132:135]
  v_mfma_f32_16x16x32_bf16 v[136:139], v[184:187], a[172:175], v[136:139]
  s_add_u32 m0, s34, 102400
  s_lshl_b32 s30, s17, 16
  s_add_u32 s30, s30, 1835008
  s_add_u32 s30, s30, s29
  buffer_load_dwordx4 v12, s[76:79], s30 offen lds
  v_mfma_f32_16x16x32_bf16 v[140:143], v[188:191], a[172:175], v[140:143]
  v_mfma_f32_16x16x32_bf16 v[144:147], v[176:179], a[244:247], v[144:147]
  v_mfma_f32_16x16x32_bf16 v[148:151], v[180:183], a[244:247], v[148:151]
  v_mfma_f32_16x16x32_bf16 v[152:155], v[184:187], a[244:247], v[152:155]
  v_mfma_f32_16x16x32_bf16 v[156:159], v[188:191], a[244:247], v[156:159]
  s_waitcnt lgkmcnt(0)
  v_add_u32 v13, 36864, v13
  v_add_u32 v14, 36864, v14
  v_add_u32 v15, 36864, v15
  v_add_u32 v6, 36864, v6
  v_mfma_f32_16x16x32_bf16 v[96:99], v[160:163], a[32:35], v[96:99]
  ds_read_b64_tr_b16 v[176:177], v13 offset:0
  v_mfma_f32_16x16x32_bf16 v[100:103], v[164:167], a[32:35], v[100:103]
  ds_read_b64_tr_b16 v[178:179], v13 offset:512
  v_mfma_f32_16x16x32_bf16 v[104:107], v[168:171], a[32:35], v[104:107]
  ds_read_b64_tr_b16 v[180:181], v14 offset:0
  v_mfma_f32_16x16x32_bf16 v[108:111], v[172:175], a[32:35], v[108:111]
  ds_read_b64_tr_b16 v[182:183], v14 offset:512
  v_mfma_f32_16x16x32_bf16 v[112:115], v[160:163], a[104:107], v[112:115]
  ds_read_b64_tr_b16 v[184:185], v15 offset:0
  v_mfma_f32_16x16x32_bf16 v[116:119], v[164:167], a[104:107], v[116:119]
  ds_read_b64_tr_b16 v[186:187], v15 offset:512
  v_mfma_f32_16x16x32_bf16 v[120:123], v[168:171], a[104:107], v[120:123]
  ds_read_b64_tr_b16 v[188:189], v6 offset:0
  v_mfma_f32_16x16x32_bf16 v[124:127], v[172:175], a[104:107], v[124:127]
  ds_read_b64_tr_b16 v[190:191], v6 offset:512
  v_mfma_f32_16x16x32_bf16 v[128:131], v[160:163], a[176:179], v[128:131]
  v_mfma_f32_16x16x32_bf16 v[132:135], v[164:167], a[176:179], v[132:135]
  v_mfma_f32_16x16x32_bf16 v[136:139], v[168:171], a[176:179], v[136:139]
  s_add_u32 m0, s34, 106496
  s_lshl_b32 s30, s17, 16
  s_add_u32 s30, s30, 2097152
  s_add_u32 s30, s30, s29
  buffer_load_dwordx4 v12, s[76:79], s30 offen lds
  v_mfma_f32_16x16x32_bf16 v[140:143], v[172:175], a[176:179], v[140:143]
  v_mfma_f32_16x16x32_bf16 v[144:147], v[160:163], a[248:251], v[144:147]
  v_mfma_f32_16x16x32_bf16 v[148:151], v[164:167], a[248:251], v[148:151]
  v_mfma_f32_16x16x32_bf16 v[152:155], v[168:171], a[248:251], v[152:155]
  v_mfma_f32_16x16x32_bf16 v[156:159], v[172:175], a[248:251], v[156:159]
  s_waitcnt lgkmcnt(0)
  v_mfma_f32_16x16x32_bf16 v[96:99], v[176:179], a[36:39], v[96:99]
  ds_read_b64_tr_b16 v[160:161], v13 offset:4096
  v_mfma_f32_16x16x32_bf16 v[100:103], v[180:183], a[36:39], v[100:103]
  ds_read_b64_tr_b16 v[162:163], v13 offset:4608
  v_mfma_f32_16x16x32_bf16 v[104:107], v[184:187], a[36:39], v[104:107]
  ds_read_b64_tr_b16 v[164:165], v14 offset:4096
  v_mfma_f32_16x16x32_bf16 v[108:111], v[188:191], a[36:39], v[108:111]
  ds_read_b64_tr_b16 v[166:167], v14 offset:4608
  v_mfma_f32_16x16x32_bf16 v[112:115], v[176:179], a[108:111], v[112:115]
  ds_read_b64_tr_b16 v[168:169], v15 offset:4096
  v_mfma_f32_16x16x32_bf16 v[116:119], v[180:183], a[108:111], v[116:119]
  ds_read_b64_tr_b16 v[170:171], v15 offset:4608
  v_mfma_f32_16x16x32_bf16 v[120:123], v[184:187], a[108:111], v[120:123]
  ds_read_b64_tr_b16 v[172:173], v6 offset:4096
  v_mfma_f32_16x16x32_bf16 v[124:127], v[188:191], a[108:111], v[124:127]
  ds_read_b64_tr_b16 v[174:175], v6 offset:4608
  v_mfma_f32_16x16x32_bf16 v[128:131], v[176:179], a[180:183], v[128:131]
  v_mfma_f32_16x16x32_bf16 v[132:135], v[180:183], a[180:183], v[132:135]
  v_mfma_f32_16x16x32_bf16 v[136:139], v[184:187], a[180:183], v[136:139]
  s_add_u32 m0, s34, 110592
  s_lshl_b32 s30, s17, 16
  s_add_u32 s30, s30, 2359296
  s_add_u32 s30, s30, s29
  buffer_load_dwordx4 v12, s[76:79], s30 offen lds
  v_mfma_f32_16x16x32_bf16 v[140:143], v[188:191], a[180:183], v[140:143]
  v_mfma_f32_16x16x32_bf16 v[144:147], v[176:179], a[252:255], v[144:147]
  v_mfma_f32_16x16x32_bf16 v[148:151], v[180:183], a[252:255], v[148:151]
  v_mfma_f32_16x16x32_bf16 v[152:155], v[184:187], a[252:255], v[152:155]
  v_mfma_f32_16x16x32_bf16 v[156:159], v[188:191], a[252:255], v[156:159]
  s_waitcnt lgkmcnt(0)
  v_mfma_f32_16x16x32_bf16 v[96:99], v[160:163], a[40:43], v[96:99]
  ds_read_b64_tr_b16 v[176:177], v13 offset:8192
  v_mfma_f32_16x16x32_bf16 v[100:103], v[164:167], a[40:43], v[100:103]
  ds_read_b64_tr_b16 v[178:179], v13 offset:8704
  v_mfma_f32_16x16x32_bf16 v[104:107], v[168:171], a[40:43], v[104:107]
  ds_read_b64_tr_b16 v[180:181], v14 offset:8192
  v_mfma_f32_16x16x32_bf16 v[108:111], v[172:175], a[40:43], v[108:111]
  ds_read_b64_tr_b16 v[182:183], v14 offset:8704
  v_mfma_f32_16x16x32_bf16 v[112:115], v[160:163], a[112:115], v[112:115]
  ds_read_b64_tr_b16 v[184:185], v15 offset:8192
  v_mfma_f32_16x16x32_bf16 v[116:119], v[164:167], a[112:115], v[116:119]
  ds_read_b64_tr_b16 v[186:187], v15 offset:8704
  v_mfma_f32_16x16x32_bf16 v[120:123], v[168:171], a[112:115], v[120:123]
  ds_read_b64_tr_b16 v[188:189], v6 offset:8192
  v_mfma_f32_16x16x32_bf16 v[124:127], v[172:175], a[112:115], v[124:127]
  ds_read_b64_tr_b16 v[190:191], v6 offset:8704
  v_mfma_f32_16x16x32_bf16 v[128:131], v[160:163], a[184:187], v[128:131]
  v_mfma_f32_16x16x32_bf16 v[132:135], v[164:167], a[184:187], v[132:135]
  v_mfma_f32_16x16x32_bf16 v[136:139], v[168:171], a[184:187], v[136:139]
  s_add_u32 m0, s34, 114688
  s_lshl_b32 s30, s17, 16
  s_add_u32 s30, s30, 2621440
  s_add_u32 s30, s30, s29
  buffer_load_dwordx4 v12, s[76:79], s30 offen lds
  v_mfma_f32_16x16x32_bf16 v[140:143], v[172:175], a[184:187], v[140:143]
  v_mfma_f32_16x16x32_bf16 v[144:147], v[160:163], v[224:227], v[144:147]
  v_mfma_f32_16x16x32_bf16 v[148:151], v[164:167], v[224:227], v[148:151]
  v_mfma_f32_16x16x32_bf16 v[152:155], v[168:171], v[224:227], v[152:155]
  v_mfma_f32_16x16x32_bf16 v[156:159], v[172:175], v[224:227], v[156:159]
  s_waitcnt lgkmcnt(0)
  v_mfma_f32_16x16x32_bf16 v[96:99], v[176:179], a[44:47], v[96:99]
  ds_read_b64_tr_b16 v[160:161], v13 offset:12288
  v_mfma_f32_16x16x32_bf16 v[100:103], v[180:183], a[44:47], v[100:103]
  ds_read_b64_tr_b16 v[162:163], v13 offset:12800
  v_mfma_f32_16x16x32_bf16 v[104:107], v[184:187], a[44:47], v[104:107]
  ds_read_b64_tr_b16 v[164:165], v14 offset:12288
  v_mfma_f32_16x16x32_bf16 v[108:111], v[188:191], a[44:47], v[108:111]
  ds_read_b64_tr_b16 v[166:167], v14 offset:12800
  v_mfma_f32_16x16x32_bf16 v[112:115], v[176:179], a[116:119], v[112:115]
  ds_read_b64_tr_b16 v[168:169], v15 offset:12288
  v_mfma_f32_16x16x32_bf16 v[116:119], v[180:183], a[116:119], v[116:119]
  ds_read_b64_tr_b16 v[170:171], v15 offset:12800
  v_mfma_f32_16x16x32_bf16 v[120:123], v[184:187], a[116:119], v[120:123]
  ds_read_b64_tr_b16 v[172:173], v6 offset:12288
  v_mfma_f32_16x16x32_bf16 v[124:127], v[188:191], a[116:119], v[124:127]
  ds_read_b64_tr_b16 v[174:175], v6 offset:12800
  v_mfma_f32_16x16x32_bf16 v[128:131], v[176:179], a[188:191], v[128:131]
  v_mfma_f32_16x16x32_bf16 v[132:135], v[180:183], a[188:191], v[132:135]
  v_mfma_f32_16x16x32_bf16 v[136:139], v[184:187], a[188:191], v[136:139]
  s_add_u32 m0, s34, 118784
  s_lshl_b32 s30, s17, 16
  s_add_u32 s30, s30, 2883584
  s_add_u32 s30, s30, s29
  buffer_load_dwordx4 v12, s[76:79], s30 offen lds
  v_mfma_f32_16x16x32_bf16 v[140:143], v[188:191], a[188:191], v[140:143]
  v_mfma_f32_16x16x32_bf16 v[144:147], v[176:179], v[228:231], v[144:147]
  v_mfma_f32_16x16x32_bf16 v[148:151], v[180:183], v[228:231], v[148:151]
  v_mfma_f32_16x16x32_bf16 v[152:155], v[184:187], v[228:231], v[152:155]
  v_mfma_f32_16x16x32_bf16 v[156:159], v[188:191], v[228:231], v[156:159]
  s_waitcnt lgkmcnt(0)
  v_mfma_f32_16x16x32_bf16 v[96:99], v[160:163], a[48:51], v[96:99]
  ds_read_b64_tr_b16 v[176:177], v13 offset:16384
  v_mfma_f32_16x16x32_bf16 v[100:103], v[164:167], a[48:51], v[100:103]
  ds_read_b64_tr_b16 v[178:179], v13 offset:16896
  v_mfma_f32_16x16x32_bf16 v[104:107], v[168:171], a[48:51], v[104:107]
  ds_read_b64_tr_b16 v[180:181], v14 offset:16384
  v_mfma_f32_16x16x32_bf16 v[108:111], v[172:175], a[48:51], v[108:111]
  ds_read_b64_tr_b16 v[182:183], v14 offset:16896
  v_mfma_f32_16x16x32_bf16 v[112:115], v[160:163], a[120:123], v[112:115]
  ds_read_b64_tr_b16 v[184:185], v15 offset:16384
  v_mfma_f32_16x16x32_bf16 v[116:119], v[164:167], a[120:123], v[116:119]
  ds_read_b64_tr_b16 v[186:187], v15 offset:16896
  v_mfma_f32_16x16x32_bf16 v[120:123], v[168:171], a[120:123], v[120:123]
  ds_read_b64_tr_b16 v[188:189], v6 offset:16384
  v_mfma_f32_16x16x32_bf16 v[124:127], v[172:175], a[120:123], v[124:127]
  ds_read_b64_tr_b16 v[190:191], v6 offset:16896
  v_mfma_f32_16x16x32_bf16 v[128:131], v[160:163], a[192:195], v[128:131]
  v_mfma_f32_16x16x32_bf16 v[132:135], v[164:167], a[192:195], v[132:135]
  v_mfma_f32_16x16x32_bf16 v[136:139], v[168:171], a[192:195], v[136:139]
  s_add_u32 m0, s34, 122880
  s_lshl_b32 s30, s17, 16
  s_add_u32 s30, s30, 3145728
  s_add_u32 s30, s30, s29
  buffer_load_dwordx4 v12, s[76:79], s30 offen lds
  v_mfma_f32_16x16x32_bf16 v[140:143], v[172:175], a[192:195], v[140:143]
  v_mfma_f32_16x16x32_bf16 v[144:147], v[160:163], v[232:235], v[144:147]
  v_mfma_f32_16x16x32_bf16 v[148:151], v[164:167], v[232:235], v[148:151]
  v_mfma_f32_16x16x32_bf16 v[152:155], v[168:171], v[232:235], v[152:155]
  v_mfma_f32_16x16x32_bf16 v[156:159], v[172:175], v[232:235], v[156:159]
  s_waitcnt lgkmcnt(0)
  v_mfma_f32_16x16x32_bf16 v[96:99], v[176:179], a[52:55], v[96:99]
  ds_read_b64_tr_b16 v[160:161], v13 offset:20480
  v_mfma_f32_16x16x32_bf16 v[100:103], v[180:183], a[52:55], v[100:103]
  ds_read_b64_tr_b16 v[162:163], v13 offset:20992
  v_mfma_f32_16x16x32_bf16 v[104:107], v[184:187], a[52:55], v[104:107]
  ds_read_b64_tr_b16 v[164:165], v14 offset:20480
  v_mfma_f32_16x16x32_bf16 v[108:111], v[188:191], a[52:55], v[108:111]
  ds_read_b64_tr_b16 v[166:167], v14 offset:20992
  v_mfma_f32_16x16x32_bf16 v[112:115], v[176:179], a[124:127], v[112:115]
  ds_read_b64_tr_b16 v[168:169], v15 offset:20480
  v_mfma_f32_16x16x32_bf16 v[116:119], v[180:183], a[124:127], v[116:119]
  ds_read_b64_tr_b16 v[170:171], v15 offset:20992
  v_mfma_f32_16x16x32_bf16 v[120:123], v[184:187], a[124:127], v[120:123]
  ds_read_b64_tr_b16 v[172:173], v6 offset:20480
  v_mfma_f32_16x16x32_bf16 v[124:127], v[188:191], a[124:127], v[124:127]
  ds_read_b64_tr_b16 v[174:175], v6 offset:20992
  v_mfma_f32_16x16x32_bf16 v[128:131], v[176:179], a[196:199], v[128:131]
  v_mfma_f32_16x16x32_bf16 v[132:135], v[180:183], a[196:199], v[132:135]
  v_mfma_f32_16x16x32_bf16 v[136:139], v[184:187], a[196:199], v[136:139]
  s_add_u32 m0, s34, 126976
  s_lshl_b32 s30, s17, 16
  s_add_u32 s30, s30, 3407872
  s_add_u32 s30, s30, s29
  buffer_load_dwordx4 v12, s[76:79], s30 offen lds
  v_mfma_f32_16x16x32_bf16 v[140:143], v[188:191], a[196:199], v[140:143]
  v_mfma_f32_16x16x32_bf16 v[144:147], v[176:179], v[236:239], v[144:147]
  v_mfma_f32_16x16x32_bf16 v[148:151], v[180:183], v[236:239], v[148:151]
  v_mfma_f32_16x16x32_bf16 v[152:155], v[184:187], v[236:239], v[152:155]
  v_mfma_f32_16x16x32_bf16 v[156:159], v[188:191], v[236:239], v[156:159]
  s_waitcnt lgkmcnt(0)
  v_mfma_f32_16x16x32_bf16 v[96:99], v[160:163], a[56:59], v[96:99]
  ds_read_b64_tr_b16 v[176:177], v13 offset:24576
  v_mfma_f32_16x16x32_bf16 v[100:103], v[164:167], a[56:59], v[100:103]
  ds_read_b64_tr_b16 v[178:179], v13 offset:25088
  v_mfma_f32_16x16x32_bf16 v[104:107], v[168:171], a[56:59], v[104:107]
  ds_read_b64_tr_b16 v[180:181], v14 offset:24576
  v_mfma_f32_16x16x32_bf16 v[108:111], v[172:175], a[56:59], v[108:111]
  ds_read_b64_tr_b16 v[182:183], v14 offset:25088
  v_mfma_f32_16x16x32_bf16 v[112:115], v[160:163], a[128:131], v[112:115]
  ds_read_b64_tr_b16 v[184:185], v15 offset:24576
  v_mfma_f32_16x16x32_bf16 v[116:119], v[164:167], a[128:131], v[116:119]
  ds_read_b64_tr_b16 v[186:187], v15 offset:25088
  v_mfma_f32_16x16x32_bf16 v[120:123], v[168:171], a[128:131], v[120:123]
  ds_read_b64_tr_b16 v[188:189], v6 offset:24576
  v_mfma_f32_16x16x32_bf16 v[124:127], v[172:175], a[128:131], v[124:127]
  ds_read_b64_tr_b16 v[190:191], v6 offset:25088
  v_mfma_f32_16x16x32_bf16 v[128:131], v[160:163], a[200:203], v[128:131]
  v_mfma_f32_16x16x32_bf16 v[132:135], v[164:167], a[200:203], v[132:135]
  v_mfma_f32_16x16x32_bf16 v[136:139], v[168:171], a[200:203], v[136:139]
  s_add_u32 m0, s34, 131072
  s_lshl_b32 s30, s17, 16
  s_add_u32 s30, s30, 3670016
  s_add_u32 s30, s30, s29
  buffer_load_dwordx4 v12, s[76:79], s30 offen lds
  v_mfma_f32_16x16x32_bf16 v[140:143], v[172:175], a[200:203], v[140:143]
  v_mfma_f32_16x16x32_bf16 v[144:147], v[160:163], v[240:243], v[144:147]
  v_mfma_f32_16x16x32_bf16 v[148:151], v[164:167], v[240:243], v[148:151]
  v_mfma_f32_16x16x32_bf16 v[152:155], v[168:171], v[240:243], v[152:155]
  v_mfma_f32_16x16x32_bf16 v[156:159], v[172:175], v[240:243], v[156:159]
  s_waitcnt lgkmcnt(0)
  v_mfma_f32_16x16x32_bf16 v[96:99], v[176:179], a[60:63], v[96:99]
  ds_read_b64_tr_b16 v[160:161], v13 offset:28672
  v_mfma_f32_16x16x32_bf16 v[100:103], v[180:183], a[60:63], v[100:103]
  ds_read_b64_tr_b16 v[162:163], v13 offset:29184
  v_mfma_f32_16x16x32_bf16 v[104:107], v[184:187], a[60:63], v[104:107]
  ds_read_b64_tr_b16 v[164:165], v14 offset:28672
  v_mfma_f32_16x16x32_bf16 v[108:111], v[188:191], a[60:63], v[108:111]
  ds_read_b64_tr_b16 v[166:167], v14 offset:29184
  v_mfma_f32_16x16x32_bf16 v[112:115], v[176:179], a[132:135], v[112:115]
  ds_read_b64_tr_b16 v[168:169], v15 offset:28672
  v_mfma_f32_16x16x32_bf16 v[116:119], v[180:183], a[132:135], v[116:119]
  ds_read_b64_tr_b16 v[170:171], v15 offset:29184
  v_mfma_f32_16x16x32_bf16 v[120:123], v[184:187], a[132:135], v[120:123]
  ds_read_b64_tr_b16 v[172:173], v6 offset:28672
  v_mfma_f32_16x16x32_bf16 v[124:127], v[188:191], a[132:135], v[124:127]
  ds_read_b64_tr_b16 v[174:175], v6 offset:29184
  v_mfma_f32_16x16x32_bf16 v[128:131], v[176:179], a[204:207], v[128:131]
  v_mfma_f32_16x16x32_bf16 v[132:135], v[180:183], a[204:207], v[132:135]
  v_mfma_f32_16x16x32_bf16 v[136:139], v[184:187], a[204:207], v[136:139]
  s_add_u32 m0, s34, 135168
  s_lshl_b32 s30, s17, 16
  s_add_u32 s30, s30, 3932160
  s_add_u32 s30, s30, s29
  buffer_load_dwordx4 v12, s[76:79], s30 offen lds
  v_mfma_f32_16x16x32_bf16 v[140:143], v[188:191], a[204:207], v[140:143]
  v_mfma_f32_16x16x32_bf16 v[144:147], v[176:179], v[244:247], v[144:147]
  v_mfma_f32_16x16x32_bf16 v[148:151], v[180:183], v[244:247], v[148:151]
  v_mfma_f32_16x16x32_bf16 v[152:155], v[184:187], v[244:247], v[152:155]
  v_mfma_f32_16x16x32_bf16 v[156:159], v[188:191], v[244:247], v[156:159]
  s_waitcnt lgkmcnt(0)
  v_mfma_f32_16x16x32_bf16 v[96:99], v[160:163], a[64:67], v[96:99]
  ds_read_b64_tr_b16 v[176:177], v13 offset:32768
  v_mfma_f32_16x16x32_bf16 v[100:103], v[164:167], a[64:67], v[100:103]
  ds_read_b64_tr_b16 v[178:179], v13 offset:33280
  v_mfma_f32_16x16x32_bf16 v[104:107], v[168:171], a[64:67], v[104:107]
  ds_read_b64_tr_b16 v[180:181], v14 offset:32768
  v_mfma_f32_16x16x32_bf16 v[108:111], v[172:175], a[64:67], v[108:111]
  ds_read_b64_tr_b16 v[182:183], v14 offset:33280
  v_mfma_f32_16x16x32_bf16 v[112:115], v[160:163], a[136:139], v[112:115]
  ds_read_b64_tr_b16 v[184:185], v15 offset:32768
  v_mfma_f32_16x16x32_bf16 v[116:119], v[164:167], a[136:139], v[116:119]
  ds_read_b64_tr_b16 v[186:187], v15 offset:33280
  v_mfma_f32_16x16x32_bf16 v[120:123], v[168:171], a[136:139], v[120:123]
  ds_read_b64_tr_b16 v[188:189], v6 offset:32768
  v_mfma_f32_16x16x32_bf16 v[124:127], v[172:175], a[136:139], v[124:127]
  ds_read_b64_tr_b16 v[190:191], v6 offset:33280
  v_mfma_f32_16x16x32_bf16 v[128:131], v[160:163], a[208:211], v[128:131]
  v_mfma_f32_16x16x32_bf16 v[132:135], v[164:167], a[208:211], v[132:135]
  v_mfma_f32_16x16x32_bf16 v[136:139], v[168:171], a[208:211], v[136:139]
  s_add_u32 m0, s34, 139264
  s_lshl_b32 s30, s17, 16
  s_add_u32 s30, s30, 4194304
  s_add_u32 s30, s30, s29
  buffer_load_dwordx4 v12, s[76:79], s30 offen lds
  v_mfma_f32_16x16x32_bf16 v[140:143], v[172:175], a[208:211], v[140:143]
  v_mfma_f32_16x16x32_bf16 v[144:147], v[160:163], v[248:251], v[144:147]
  v_mfma_f32_16x16x32_bf16 v[148:151], v[164:167], v[248:251], v[148:151]
  v_mfma_f32_16x16x32_bf16 v[152:155], v[168:171], v[248:251], v[152:155]
  v_mfma_f32_16x16x32_bf16 v[156:159], v[172:175], v[248:251], v[156:159]
  s_waitcnt lgkmcnt(0)
  v_mfma_f32_16x16x32_bf16 v[96:99], v[176:179], a[68:71], v[96:99]
  v_mfma_f32_16x16x32_bf16 v[100:103], v[180:183], a[68:71], v[100:103]
  v_mfma_f32_16x16x32_bf16 v[104:107], v[184:187], a[68:71], v[104:107]
  v_mfma_f32_16x16x32_bf16 v[108:111], v[188:191], a[68:71], v[108:111]
  v_mfma_f32_16x16x32_bf16 v[112:115], v[176:179], a[140:143], v[112:115]
  v_mfma_f32_16x16x32_bf16 v[116:119], v[180:183], a[140:143], v[116:119]
  v_mfma_f32_16x16x32_bf16 v[120:123], v[184:187], a[140:143], v[120:123]
  v_mfma_f32_16x16x32_bf16 v[124:127], v[188:191], a[140:143], v[124:127]
  v_mfma_f32_16x16x32_bf16 v[128:131], v[176:179], a[212:215], v[128:131]
  v_mfma_f32_16x16x32_bf16 v[132:135], v[180:183], a[212:215], v[132:135]
  v_mfma_f32_16x16x32_bf16 v[136:139], v[184:187], a[212:215], v[136:139]
  s_add_u32 m0, s34, 143360
  s_lshl_b32 s30, s17, 16
  s_add_u32 s30, s30, 4456448
  s_add_u32 s30, s30, s29
  buffer_load_dwordx4 v12, s[76:79], s30 offen lds
  v_mfma_f32_16x16x32_bf16 v[140:143], v[188:191], a[212:215], v[140:143]
  v_mfma_f32_16x16x32_bf16 v[144:147], v[176:179], v[252:255], v[144:147]
  v_mfma_f32_16x16x32_bf16 v[148:151], v[180:183], v[252:255], v[148:151]
  v_mfma_f32_16x16x32_bf16 v[152:155], v[184:187], v[252:255], v[152:155]
  v_mfma_f32_16x16x32_bf16 v[156:159], v[188:191], v[252:255], v[156:159]
  s_nop 7
  v_cvt_pk_bf16_f32 v40, v96, v97
  v_cvt_pk_bf16_f32 v41, v98, v99
  v_cvt_pk_bf16_f32 v42, v100, v101
  v_cvt_pk_bf16_f32 v43, v102, v103
  s_add_u32 s30, s43, 0
  buffer_store_dwordx4 v[40:43], v1, s[4:7], s30 offen sc1
  v_cvt_pk_bf16_f32 v44, v104, v105
  v_cvt_pk_bf16_f32 v45, v106, v107
  v_cvt_pk_bf16_f32 v46, v108, v109
  v_cvt_pk_bf16_f32 v47, v110, v111
  s_add_u32 s30, s43, 2048
  buffer_store_dwordx4 v[44:47], v1, s[4:7], s30 offen sc1
  v_cvt_pk_bf16_f32 v48, v112, v113
  v_cvt_pk_bf16_f32 v49, v114, v115
  v_cvt_pk_bf16_f32 v50, v116, v117
  v_cvt_pk_bf16_f32 v51, v118, v119
  s_add_u32 s30, s43, 1024
  buffer_store_dwordx4 v[48:51], v1, s[4:7], s30 offen sc1
  v_cvt_pk_bf16_f32 v52, v120, v121
  v_cvt_pk_bf16_f32 v53, v122, v123
  v_cvt_pk_bf16_f32 v54, v124, v125
  v_cvt_pk_bf16_f32 v55, v126, v127
  s_add_u32 s30, s43, 3072
  buffer_store_dwordx4 v[52:55], v1, s[4:7], s30 offen sc1
  v_cvt_pk_bf16_f32 v40, v128, v129
  v_cvt_pk_bf16_f32 v41, v130, v131
  v_cvt_pk_bf16_f32 v42, v132, v133
  v_cvt_pk_bf16_f32 v43, v134, v135
  s_add_u32 s30, s43, 262144
  buffer_store_dwordx4 v[40:43], v1, s[4:7], s30 offen sc1
  v_cvt_pk_bf16_f32 v44, v136, v137
  v_cvt_pk_bf16_f32 v45, v138, v139
  v_cvt_pk_bf16_f32 v46, v140, v141
  v_cvt_pk_bf16_f32 v47, v142, v143
  s_add_u32 s30, s43, 264192
  buffer_store_dwordx4 v[44:47], v1, s[4:7], s30 offen sc1
  v_cvt_pk_bf16_f32 v48, v144, v145
  v_cvt_pk_bf16_f32 v49, v146, v147
  v_cvt_pk_bf16_f32 v50, v148, v149
  v_cvt_pk_bf16_f32 v51, v150, v151
  s_add_u32 s30, s43, 263168
  buffer_store_dwordx4 v[48:51], v1, s[4:7], s30 offen sc1
  v_cvt_pk_bf16_f32 v52, v152, v153
  v_cvt_pk_bf16_f32 v53, v154, v155
  v_cvt_pk_bf16_f32 v54, v156, v157
  v_cvt_pk_bf16_f32 v55, v158, v159
  s_add_u32 s30, s43, 265216
  buffer_store_dwordx4 v[52:55], v1, s[4:7], s30 offen sc1
  s_branch L_g_join_66
L_g_isv_65:
  ds_read_b64_tr_b16 v[160:161], v13 offset:0
  ds_read_b64_tr_b16 v[162:163], v13 offset:512
  ds_read_b64_tr_b16 v[164:165], v14 offset:0
  ds_read_b64_tr_b16 v[166:167], v14 offset:512
  ds_read_b64_tr_b16 v[168:169], v15 offset:0
  ds_read_b64_tr_b16 v[170:171], v15 offset:512
  ds_read_b64_tr_b16 v[172:173], v6 offset:0
  ds_read_b64_tr_b16 v[174:175], v6 offset:512
  s_waitcnt lgkmcnt(0)
  v_mfma_f32_16x16x32_bf16 v[96:99], a[0:3], v[160:163], 0
  ds_read_b64_tr_b16 v[176:177], v13 offset:4096
  v_mfma_f32_16x16x32_bf16 v[100:103], a[0:3], v[164:167], 0
  ds_read_b64_tr_b16 v[178:179], v13 offset:4608
  v_mfma_f32_16x16x32_bf16 v[104:107], a[0:3], v[168:171], 0
  ds_read_b64_tr_b16 v[180:181], v14 offset:4096
  v_mfma_f32_16x16x32_bf16 v[108:111], a[0:3], v[172:175], 0
  ds_read_b64_tr_b16 v[182:183], v14 offset:4608
  v_mfma_f32_16x16x32_bf16 v[112:115], a[72:75], v[160:163], 0
  ds_read_b64_tr_b16 v[184:185], v15 offset:4096
  v_mfma_f32_16x16x32_bf16 v[116:119], a[72:75], v[164:167], 0
  ds_read_b64_tr_b16 v[186:187], v15 offset:4608
  v_mfma_f32_16x16x32_bf16 v[120:123], a[72:75], v[168:171], 0
  ds_read_b64_tr_b16 v[188:189], v6 offset:4096
  v_mfma_f32_16x16x32_bf16 v[124:127], a[72:75], v[172:175], 0
  ds_read_b64_tr_b16 v[190:191], v6 offset:4608
  v_mfma_f32_16x16x32_bf16 v[128:131], a[144:147], v[160:163], 0
  v_mfma_f32_16x16x32_bf16 v[132:135], a[144:147], v[164:167], 0
  v_mfma_f32_16x16x32_bf16 v[136:139], a[144:147], v[168:171], 0
  s_add_u32 m0, s34, 73728
  s_lshl_b32 s30, s17, 16
  s_add_u32 s30, s30, 0
  s_add_u32 s30, s30, s29
  buffer_load_dwordx4 v12, s[76:79], s30 offen lds
  v_mfma_f32_16x16x32_bf16 v[140:143], a[144:147], v[172:175], 0
  v_mfma_f32_16x16x32_bf16 v[144:147], a[216:219], v[160:163], 0
  v_mfma_f32_16x16x32_bf16 v[148:151], a[216:219], v[164:167], 0
  v_mfma_f32_16x16x32_bf16 v[152:155], a[216:219], v[168:171], 0
  v_mfma_f32_16x16x32_bf16 v[156:159], a[216:219], v[172:175], 0
  s_waitcnt lgkmcnt(0)
  v_mfma_f32_16x16x32_bf16 v[96:99], a[4:7], v[176:179], v[96:99]
  ds_read_b64_tr_b16 v[160:161], v13 offset:8192
  v_mfma_f32_16x16x32_bf16 v[100:103], a[4:7], v[180:183], v[100:103]
  ds_read_b64_tr_b16 v[162:163], v13 offset:8704
  v_mfma_f32_16x16x32_bf16 v[104:107], a[4:7], v[184:187], v[104:107]
  ds_read_b64_tr_b16 v[164:165], v14 offset:8192
  v_mfma_f32_16x16x32_bf16 v[108:111], a[4:7], v[188:191], v[108:111]
  ds_read_b64_tr_b16 v[166:167], v14 offset:8704
  v_mfma_f32_16x16x32_bf16 v[112:115], a[76:79], v[176:179], v[112:115]
  ds_read_b64_tr_b16 v[168:169], v15 offset:8192
  v_mfma_f32_16x16x32_bf16 v[116:119], a[76:79], v[180:183], v[116:119]
  ds_read_b64_tr_b16 v[170:171], v15 offset:8704
  v_mfma_f32_16x16x32_bf16 v[120:123], a[76:79], v[184:187], v[120:123]
  ds_read_b64_tr_b16 v[172:173], v6 offset:8192
  v_mfma_f32_16x16x32_bf16 v[124:127], a[76:79], v[188:191], v[124:127]
  ds_read_b64_tr_b16 v[174:175], v6 offset:8704
  v_mfma_f32_16x16x32_bf16 v[128:131], a[148:151], v[176:179], v[128:131]
  v_mfma_f32_16x16x32_bf16 v[132:135], a[148:151], v[180:183], v[132:135]
  v_mfma_f32_16x16x32_bf16 v[136:139], a[148:151], v[184:187], v[136:139]
  s_add_u32 m0, s34, 77824
  s_lshl_b32 s30, s17, 16
  s_add_u32 s30, s30, 262144
  s_add_u32 s30, s30, s29
  buffer_load_dwordx4 v12, s[76:79], s30 offen lds
  v_mfma_f32_16x16x32_bf16 v[140:143], a[148:151], v[188:191], v[140:143]
  v_mfma_f32_16x16x32_bf16 v[144:147], a[220:223], v[176:179], v[144:147]
  v_mfma_f32_16x16x32_bf16 v[148:151], a[220:223], v[180:183], v[148:151]
  v_mfma_f32_16x16x32_bf16 v[152:155], a[220:223], v[184:187], v[152:155]
  v_mfma_f32_16x16x32_bf16 v[156:159], a[220:223], v[188:191], v[156:159]
  s_waitcnt lgkmcnt(0)
  v_mfma_f32_16x16x32_bf16 v[96:99], a[8:11], v[160:163], v[96:99]
  ds_read_b64_tr_b16 v[176:177], v13 offset:12288
  v_mfma_f32_16x16x32_bf16 v[100:103], a[8:11], v[164:167], v[100:103]
  ds_read_b64_tr_b16 v[178:179], v13 offset:12800
  v_mfma_f32_16x16x32_bf16 v[104:107], a[8:11], v[168:171], v[104:107]
  ds_read_b64_tr_b16 v[180:181], v14 offset:12288
  v_mfma_f32_16x16x32_bf16 v[108:111], a[8:11], v[172:175], v[108:111]
  ds_read_b64_tr_b16 v[182:183], v14 offset:12800
  v_mfma_f32_16x16x32_bf16 v[112:115], a[80:83], v[160:163], v[112:115]
  ds_read_b64_tr_b16 v[184:185], v15 offset:12288
  v_mfma_f32_16x16x32_bf16 v[116:119], a[80:83], v[164:167], v[116:119]
  ds_read_b64_tr_b16 v[186:187], v15 offset:12800
  v_mfma_f32_16x16x32_bf16 v[120:123], a[80:83], v[168:171], v[120:123]
  ds_read_b64_tr_b16 v[188:189], v6 offset:12288
  v_mfma_f32_16x16x32_bf16 v[124:127], a[80:83], v[172:175], v[124:127]
  ds_read_b64_tr_b16 v[190:191], v6 offset:12800
  v_mfma_f32_16x16x32_bf16 v[128:131], a[152:155], v[160:163], v[128:131]
  v_mfma_f32_16x16x32_bf16 v[132:135], a[152:155], v[164:167], v[132:135]
  v_mfma_f32_16x16x32_bf16 v[136:139], a[152:155], v[168:171], v[136:139]
  s_add_u32 m0, s34, 81920
  s_lshl_b32 s30, s17, 16
  s_add_u32 s30, s30, 524288
  s_add_u32 s30, s30, s29
  buffer_load_dwordx4 v12, s[76:79], s30 offen lds
  v_mfma_f32_16x16x32_bf16 v[140:143], a[152:155], v[172:175], v[140:143]
  v_mfma_f32_16x16x32_bf16 v[144:147], a[224:227], v[160:163], v[144:147]
  v_mfma_f32_16x16x32_bf16 v[148:151], a[224:227], v[164:167], v[148:151]
  v_mfma_f32_16x16x32_bf16 v[152:155], a[224:227], v[168:171], v[152:155]
  v_mfma_f32_16x16x32_bf16 v[156:159], a[224:227], v[172:175], v[156:159]
  s_waitcnt lgkmcnt(0)
  v_mfma_f32_16x16x32_bf16 v[96:99], a[12:15], v[176:179], v[96:99]
  ds_read_b64_tr_b16 v[160:161], v13 offset:16384
  v_mfma_f32_16x16x32_bf16 v[100:103], a[12:15], v[180:183], v[100:103]
  ds_read_b64_tr_b16 v[162:163], v13 offset:16896
  v_mfma_f32_16x16x32_bf16 v[104:107], a[12:15], v[184:187], v[104:107]
  ds_read_b64_tr_b16 v[164:165], v14 offset:16384
  v_mfma_f32_16x16x32_bf16 v[108:111], a[12:15], v[188:191], v[108:111]
  ds_read_b64_tr_b16 v[166:167], v14 offset:16896
  v_mfma_f32_16x16x32_bf16 v[112:115], a[84:87], v[176:179], v[112:115]
  ds_read_b64_tr_b16 v[168:169], v15 offset:16384
  v_mfma_f32_16x16x32_bf16 v[116:119], a[84:87], v[180:183], v[116:119]
  ds_read_b64_tr_b16 v[170:171], v15 offset:16896
  v_mfma_f32_16x16x32_bf16 v[120:123], a[84:87], v[184:187], v[120:123]
  ds_read_b64_tr_b16 v[172:173], v6 offset:16384
  v_mfma_f32_16x16x32_bf16 v[124:127], a[84:87], v[188:191], v[124:127]
  ds_read_b64_tr_b16 v[174:175], v6 offset:16896
  v_mfma_f32_16x16x32_bf16 v[128:131], a[156:159], v[176:179], v[128:131]
  v_mfma_f32_16x16x32_bf16 v[132:135], a[156:159], v[180:183], v[132:135]
  v_mfma_f32_16x16x32_bf16 v[136:139], a[156:159], v[184:187], v[136:139]
  s_add_u32 m0, s34, 86016
  s_lshl_b32 s30, s17, 16
  s_add_u32 s30, s30, 786432
  s_add_u32 s30, s30, s29
  buffer_load_dwordx4 v12, s[76:79], s30 offen lds
  v_mfma_f32_16x16x32_bf16 v[140:143], a[156:159], v[188:191], v[140:143]
  v_mfma_f32_16x16x32_bf16 v[144:147], a[228:231], v[176:179], v[144:147]
  v_mfma_f32_16x16x32_bf16 v[148:151], a[228:231], v[180:183], v[148:151]
  v_mfma_f32_16x16x32_bf16 v[152:155], a[228:231], v[184:187], v[152:155]
  v_mfma_f32_16x16x32_bf16 v[156:159], a[228:231], v[188:191], v[156:159]
  s_waitcnt lgkmcnt(0)
  v_mfma_f32_16x16x32_bf16 v[96:99], a[16:19], v[160:163], v[96:99]
  ds_read_b64_tr_b16 v[176:177], v13 offset:20480
  v_mfma_f32_16x16x32_bf16 v[100:103], a[16:19], v[164:167], v[100:103]
  ds_read_b64_tr_b16 v[178:179], v13 offset:20992
  v_mfma_f32_16x16x32_bf16 v[104:107], a[16:19], v[168:171], v[104:107]
  ds_read_b64_tr_b16 v[180:181], v14 offset:20480
  v_mfma_f32_16x16x32_bf16 v[108:111], a[16:19], v[172:175], v[108:111]
  ds_read_b64_tr_b16 v[182:183], v14 offset:20992
  v_mfma_f32_16x16x32_bf16 v[112:115], a[88:91], v[160:163], v[112:115]
  ds_read_b64_tr_b16 v[184:185], v15 offset:20480
  v_mfma_f32_16x16x32_bf16 v[116:119], a[88:91], v[164:167], v[116:119]
  ds_read_b64_tr_b16 v[186:187], v15 offset:20992
  v_mfma_f32_16x16x32_bf16 v[120:123], a[88:91], v[168:171], v[120:123]
  ds_read_b64_tr_b16 v[188:189], v6 offset:20480
  v_mfma_f32_16x16x32_bf16 v[124:127], a[88:91], v[172:175], v[124:127]
  ds_read_b64_tr_b16 v[190:191], v6 offset:20992
  v_mfma_f32_16x16x32_bf16 v[128:131], a[160:163], v[160:163], v[128:131]
  v_mfma_f32_16x16x32_bf16 v[132:135], a[160:163], v[164:167], v[132:135]
  v_mfma_f32_16x16x32_bf16 v[136:139], a[160:163], v[168:171], v[136:139]
  s_add_u32 m0, s34, 90112
  s_lshl_b32 s30, s17, 16
  s_add_u32 s30, s30, 1048576
  s_add_u32 s30, s30, s29
  buffer_load_dwordx4 v12, s[76:79], s30 offen lds
  v_mfma_f32_16x16x32_bf16 v[140:143], a[160:163], v[172:175], v[140:143]
  v_mfma_f32_16x16x32_bf16 v[144:147], a[232:235], v[160:163], v[144:147]
  v_mfma_f32_16x16x32_bf16 v[148:151], a[232:235], v[164:167], v[148:151]
  v_mfma_f32_16x16x32_bf16 v[152:155], a[232:235], v[168:171], v[152:155]
  v_mfma_f32_16x16x32_bf16 v[156:159], a[232:235], v[172:175], v[156:159]
  s_waitcnt lgkmcnt(0)
  v_mfma_f32_16x16x32_bf16 v[96:99], a[20:23], v[176:179], v[96:99]
  ds_read_b64_tr_b16 v[160:161], v13 offset:24576
  v_mfma_f32_16x16x32_bf16 v[100:103], a[20:23], v[180:183], v[100:103]
  ds_read_b64_tr_b16 v[162:163], v13 offset:25088
  v_mfma_f32_16x16x32_bf16 v[104:107], a[20:23], v[184:187], v[104:107]
  ds_read_b64_tr_b16 v[164:165], v14 offset:24576
  v_mfma_f32_16x16x32_bf16 v[108:111], a[20:23], v[188:191], v[108:111]
  ds_read_b64_tr_b16 v[166:167], v14 offset:25088
  v_mfma_f32_16x16x32_bf16 v[112:115], a[92:95], v[176:179], v[112:115]
  ds_read_b64_tr_b16 v[168:169], v15 offset:24576
  v_mfma_f32_16x16x32_bf16 v[116:119], a[92:95], v[180:183], v[116:119]
  ds_read_b64_tr_b16 v[170:171], v15 offset:25088
  v_mfma_f32_16x16x32_bf16 v[120:123], a[92:95], v[184:187], v[120:123]
  ds_read_b64_tr_b16 v[172:173], v6 offset:24576
  v_mfma_f32_16x16x32_bf16 v[124:127], a[92:95], v[188:191], v[124:127]
  ds_read_b64_tr_b16 v[174:175], v6 offset:25088
  v_mfma_f32_16x16x32_bf16 v[128:131], a[164:167], v[176:179], v[128:131]
  v_mfma_f32_16x16x32_bf16 v[132:135], a[164:167], v[180:183], v[132:135]
  v_mfma_f32_16x16x32_bf16 v[136:139], a[164:167], v[184:187], v[136:139]
  s_add_u32 m0, s34, 94208
  s_lshl_b32 s30, s17, 16
  s_add_u32 s30, s30, 1310720
  s_add_u32 s30, s30, s29
  buffer_load_dwordx4 v12, s[76:79], s30 offen lds
  v_mfma_f32_16x16x32_bf16 v[140:143], a[164:167], v[188:191], v[140:143]
  v_mfma_f32_16x16x32_bf16 v[144:147], a[236:239], v[176:179], v[144:147]
  v_mfma_f32_16x16x32_bf16 v[148:151], a[236:239], v[180:183], v[148:151]
  v_mfma_f32_16x16x32_bf16 v[152:155], a[236:239], v[184:187], v[152:155]
  v_mfma_f32_16x16x32_bf16 v[156:159], a[236:239], v[188:191], v[156:159]
  s_waitcnt lgkmcnt(0)
  v_mfma_f32_16x16x32_bf16 v[96:99], a[24:27], v[160:163], v[96:99]
  ds_read_b64_tr_b16 v[176:177], v13 offset:28672
  v_mfma_f32_16x16x32_bf16 v[100:103], a[24:27], v[164:167], v[100:103]
  ds_read_b64_tr_b16 v[178:179], v13 offset:29184
  v_mfma_f32_16x16x32_bf16 v[104:107], a[24:27], v[168:171], v[104:107]
  ds_read_b64_tr_b16 v[180:181], v14 offset:28672
  v_mfma_f32_16x16x32_bf16 v[108:111], a[24:27], v[172:175], v[108:111]
  ds_read_b64_tr_b16 v[182:183], v14 offset:29184
  v_mfma_f32_16x16x32_bf16 v[112:115], a[96:99], v[160:163], v[112:115]
  ds_read_b64_tr_b16 v[184:185], v15 offset:28672
  v_mfma_f32_16x16x32_bf16 v[116:119], a[96:99], v[164:167], v[116:119]
  ds_read_b64_tr_b16 v[186:187], v15 offset:29184
  v_mfma_f32_16x16x32_bf16 v[120:123], a[96:99], v[168:171], v[120:123]
  ds_read_b64_tr_b16 v[188:189], v6 offset:28672
  v_mfma_f32_16x16x32_bf16 v[124:127], a[96:99], v[172:175], v[124:127]
  ds_read_b64_tr_b16 v[190:191], v6 offset:29184
  v_mfma_f32_16x16x32_bf16 v[128:131], a[168:171], v[160:163], v[128:131]
  v_mfma_f32_16x16x32_bf16 v[132:135], a[168:171], v[164:167], v[132:135]
  v_mfma_f32_16x16x32_bf16 v[136:139], a[168:171], v[168:171], v[136:139]
  s_add_u32 m0, s34, 98304
  s_lshl_b32 s30, s17, 16
  s_add_u32 s30, s30, 1572864
  s_add_u32 s30, s30, s29
  buffer_load_dwordx4 v12, s[76:79], s30 offen lds
  v_mfma_f32_16x16x32_bf16 v[140:143], a[168:171], v[172:175], v[140:143]
  v_mfma_f32_16x16x32_bf16 v[144:147], a[240:243], v[160:163], v[144:147]
  v_mfma_f32_16x16x32_bf16 v[148:151], a[240:243], v[164:167], v[148:151]
  v_mfma_f32_16x16x32_bf16 v[152:155], a[240:243], v[168:171], v[152:155]
  v_mfma_f32_16x16x32_bf16 v[156:159], a[240:243], v[172:175], v[156:159]
  s_waitcnt lgkmcnt(0)
  v_mfma_f32_16x16x32_bf16 v[96:99], a[28:31], v[176:179], v[96:99]
  ds_read_b64_tr_b16 v[160:161], v13 offset:32768
  v_mfma_f32_16x16x32_bf16 v[100:103], a[28:31], v[180:183], v[100:103]
  ds_read_b64_tr_b16 v[162:163], v13 offset:33280
  v_mfma_f32_16x16x32_bf16 v[104:107], a[28:31], v[184:187], v[104:107]
  ds_read_b64_tr_b16 v[164:165], v14 offset:32768
  v_mfma_f32_16x16x32_bf16 v[108:111], a[28:31], v[188:191], v[108:111]
  ds_read_b64_tr_b16 v[166:167], v14 offset:33280
  v_mfma_f32_16x16x32_bf16 v[112:115], a[100:103], v[176:179], v[112:115]
  ds_read_b64_tr_b16 v[168:169], v15 offset:32768
  v_mfma_f32_16x16x32_bf16 v[116:119], a[100:103], v[180:183], v[116:119]
  ds_read_b64_tr_b16 v[170:171], v15 offset:33280
  v_mfma_f32_16x16x32_bf16 v[120:123], a[100:103], v[184:187], v[120:123]
  ds_read_b64_tr_b16 v[172:173], v6 offset:32768
  v_mfma_f32_16x16x32_bf16 v[124:127], a[100:103], v[188:191], v[124:127]
  ds_read_b64_tr_b16 v[174:175], v6 offset:33280
  v_mfma_f32_16x16x32_bf16 v[128:131], a[172:175], v[176:179], v[128:131]
  v_mfma_f32_16x16x32_bf16 v[132:135], a[172:175], v[180:183], v[132:135]
  v_mfma_f32_16x16x32_bf16 v[136:139], a[172:175], v[184:187], v[136:139]
  s_add_u32 m0, s34, 102400
  s_lshl_b32 s30, s17, 16
  s_add_u32 s30, s30, 1835008
  s_add_u32 s30, s30, s29
  buffer_load_dwordx4 v12, s[76:79], s30 offen lds
  v_mfma_f32_16x16x32_bf16 v[140:143], a[172:175], v[188:191], v[140:143]
  v_mfma_f32_16x16x32_bf16 v[144:147], a[244:247], v[176:179], v[144:147]
  v_mfma_f32_16x16x32_bf16 v[148:151], a[244:247], v[180:183], v[148:151]
  v_mfma_f32_16x16x32_bf16 v[152:155], a[244:247], v[184:187], v[152:155]
  v_mfma_f32_16x16x32_bf16 v[156:159], a[244:247], v[188:191], v[156:159]
  s_waitcnt lgkmcnt(0)
  v_add_u32 v13, 36864, v13
  v_add_u32 v14, 36864, v14
  v_add_u32 v15, 36864, v15
  v_add_u32 v6, 36864, v6
  v_mfma_f32_16x16x32_bf16 v[96:99], a[32:35], v[160:163], v[96:99]
  ds_read_b64_tr_b16 v[176:177], v13 offset:0
  v_mfma_f32_16x16x32_bf16 v[100:103], a[32:35], v[164:167], v[100:103]
  ds_read_b64_tr_b16 v[178:179], v13 offset:512
  v_mfma_f32_16x16x32_bf16 v[104:107], a[32:35], v[168:171], v[104:107]
  ds_read_b64_tr_b16 v[180:181], v14 offset:0
  v_mfma_f32_16x16x32_bf16 v[108:111], a[32:35], v[172:175], v[108:111]
  ds_read_b64_tr_b16 v[182:183], v14 offset:512
  v_mfma_f32_16x16x32_bf16 v[112:115], a[104:107], v[160:163], v[112:115]
  ds_read_b64_tr_b16 v[184:185], v15 offset:0
  v_mfma_f32_16x16x32_bf16 v[116:119], a[104:107], v[164:167], v[116:119]
  ds_read_b64_tr_b16 v[186:187], v15 offset:512
  v_mfma_f32_16x16x32_bf16 v[120:123], a[104:107], v[168:171], v[120:123]
  ds_read_b64_tr_b16 v[188:189], v6 offset:0
  v_mfma_f32_16x16x32_bf16 v[124:127], a[104:107], v[172:175], v[124:127]
  ds_read_b64_tr_b16 v[190:191], v6 offset:512
  v_mfma_f32_16x16x32_bf16 v[128:131], a[176:179], v[160:163], v[128:131]
  v_mfma_f32_16x16x32_bf16 v[132:135], a[176:179], v[164:167], v[132:135]
  v_mfma_f32_16x16x32_bf16 v[136:139], a[176:179], v[168:171], v[136:139]
  s_add_u32 m0, s34, 106496
  s_lshl_b32 s30, s17, 16
  s_add_u32 s30, s30, 2097152
  s_add_u32 s30, s30, s29
  buffer_load_dwordx4 v12, s[76:79], s30 offen lds
  v_mfma_f32_16x16x32_bf16 v[140:143], a[176:179], v[172:175], v[140:143]
  v_mfma_f32_16x16x32_bf16 v[144:147], a[248:251], v[160:163], v[144:147]
  v_mfma_f32_16x16x32_bf16 v[148:151], a[248:251], v[164:167], v[148:151]
  v_mfma_f32_16x16x32_bf16 v[152:155], a[248:251], v[168:171], v[152:155]
  v_mfma_f32_16x16x32_bf16 v[156:159], a[248:251], v[172:175], v[156:159]
  s_waitcnt lgkmcnt(0)
  v_mfma_f32_16x16x32_bf16 v[96:99], a[36:39], v[176:179], v[96:99]
  ds_read_b64_tr_b16 v[160:161], v13 offset:4096
  v_mfma_f32_16x16x32_bf16 v[100:103], a[36:39], v[180:183], v[100:103]
  ds_read_b64_tr_b16 v[162:163], v13 offset:4608
  v_mfma_f32_16x16x32_bf16 v[104:107], a[36:39], v[184:187], v[104:107]
  ds_read_b64_tr_b16 v[164:165], v14 offset:4096
  v_mfma_f32_16x16x32_bf16 v[108:111], a[36:39], v[188:191], v[108:111]
  ds_read_b64_tr_b16 v[166:167], v14 offset:4608
  v_mfma_f32_16x16x32_bf16 v[112:115], a[108:111], v[176:179], v[112:115]
  ds_read_b64_tr_b16 v[168:169], v15 offset:4096
  v_mfma_f32_16x16x32_bf16 v[116:119], a[108:111], v[180:183], v[116:119]
  ds_read_b64_tr_b16 v[170:171], v15 offset:4608
  v_mfma_f32_16x16x32_bf16 v[120:123], a[108:111], v[184:187], v[120:123]
  ds_read_b64_tr_b16 v[172:173], v6 offset:4096
  v_mfma_f32_16x16x32_bf16 v[124:127], a[108:111], v[188:191], v[124:127]
  ds_read_b64_tr_b16 v[174:175], v6 offset:4608
  v_mfma_f32_16x16x32_bf16 v[128:131], a[180:183], v[176:179], v[128:131]
  v_mfma_f32_16x16x32_bf16 v[132:135], a[180:183], v[180:183], v[132:135]
  v_mfma_f32_16x16x32_bf16 v[136:139], a[180:183], v[184:187], v[136:139]
  s_add_u32 m0, s34, 110592
  s_lshl_b32 s30, s17, 16
  s_add_u32 s30, s30, 2359296
  s_add_u32 s30, s30, s29
  buffer_load_dwordx4 v12, s[76:79], s30 offen lds
  v_mfma_f32_16x16x32_bf16 v[140:143], a[180:183], v[188:191], v[140:143]
  v_mfma_f32_16x16x32_bf16 v[144:147], a[252:255], v[176:179], v[144:147]
  v_mfma_f32_16x16x32_bf16 v[148:151], a[252:255], v[180:183], v[148:151]
  v_mfma_f32_16x16x32_bf16 v[152:155], a[252:255], v[184:187], v[152:155]
  v_mfma_f32_16x16x32_bf16 v[156:159], a[252:255], v[188:191], v[156:159]
  s_waitcnt lgkmcnt(0)
  v_mfma_f32_16x16x32_bf16 v[96:99], a[40:43], v[160:163], v[96:99]
  ds_read_b64_tr_b16 v[176:177], v13 offset:8192
  v_mfma_f32_16x16x32_bf16 v[100:103], a[40:43], v[164:167], v[100:103]
  ds_read_b64_tr_b16 v[178:179], v13 offset:8704
  v_mfma_f32_16x16x32_bf16 v[104:107], a[40:43], v[168:171], v[104:107]
  ds_read_b64_tr_b16 v[180:181], v14 offset:8192
  v_mfma_f32_16x16x32_bf16 v[108:111], a[40:43], v[172:175], v[108:111]
  ds_read_b64_tr_b16 v[182:183], v14 offset:8704
  v_mfma_f32_16x16x32_bf16 v[112:115], a[112:115], v[160:163], v[112:115]
  ds_read_b64_tr_b16 v[184:185], v15 offset:8192
  v_mfma_f32_16x16x32_bf16 v[116:119], a[112:115], v[164:167], v[116:119]
  ds_read_b64_tr_b16 v[186:187], v15 offset:8704
  v_mfma_f32_16x16x32_bf16 v[120:123], a[112:115], v[168:171], v[120:123]
  ds_read_b64_tr_b16 v[188:189], v6 offset:8192
  v_mfma_f32_16x16x32_bf16 v[124:127], a[112:115], v[172:175], v[124:127]
  ds_read_b64_tr_b16 v[190:191], v6 offset:8704
  v_mfma_f32_16x16x32_bf16 v[128:131], a[184:187], v[160:163], v[128:131]
  v_mfma_f32_16x16x32_bf16 v[132:135], a[184:187], v[164:167], v[132:135]
  v_mfma_f32_16x16x32_bf16 v[136:139], a[184:187], v[168:171], v[136:139]
  s_add_u32 m0, s34, 114688
  s_lshl_b32 s30, s17, 16
  s_add_u32 s30, s30, 2621440
  s_add_u32 s30, s30, s29
  buffer_load_dwordx4 v12, s[76:79], s30 offen lds
  v_mfma_f32_16x16x32_bf16 v[140:143], a[184:187], v[172:175], v[140:143]
  v_mfma_f32_16x16x32_bf16 v[144:147], v[224:227], v[160:163], v[144:147]
  v_mfma_f32_16x16x32_bf16 v[148:151], v[224:227], v[164:167], v[148:151]
  v_mfma_f32_16x16x32_bf16 v[152:155], v[224:227], v[168:171], v[152:155]
  v_mfma_f32_16x16x32_bf16 v[156:159], v[224:227], v[172:175], v[156:159]
  s_waitcnt lgkmcnt(0)
  v_mfma_f32_16x16x32_bf16 v[96:99], a[44:47], v[176:179], v[96:99]
  ds_read_b64_tr_b16 v[160:161], v13 offset:12288
  v_mfma_f32_16x16x32_bf16 v[100:103], a[44:47], v[180:183], v[100:103]
  ds_read_b64_tr_b16 v[162:163], v13 offset:12800
  v_mfma_f32_16x16x32_bf16 v[104:107], a[44:47], v[184:187], v[104:107]
  ds_read_b64_tr_b16 v[164:165], v14 offset:12288
  v_mfma_f32_16x16x32_bf16 v[108:111], a[44:47], v[188:191], v[108:111]
  ds_read_b64_tr_b16 v[166:167], v14 offset:12800
  v_mfma_f32_16x16x32_bf16 v[112:115], a[116:119], v[176:179], v[112:115]
  ds_read_b64_tr_b16 v[168:169], v15 offset:12288
  v_mfma_f32_16x16x32_bf16 v[116:119], a[116:119], v[180:183], v[116:119]
  ds_read_b64_tr_b16 v[170:171], v15 offset:12800
  v_mfma_f32_16x16x32_bf16 v[120:123], a[116:119], v[184:187], v[120:123]
  ds_read_b64_tr_b16 v[172:173], v6 offset:12288
  v_mfma_f32_16x16x32_bf16 v[124:127], a[116:119], v[188:191], v[124:127]
  ds_read_b64_tr_b16 v[174:175], v6 offset:12800
  v_mfma_f32_16x16x32_bf16 v[128:131], a[188:191], v[176:179], v[128:131]
  v_mfma_f32_16x16x32_bf16 v[132:135], a[188:191], v[180:183], v[132:135]
  v_mfma_f32_16x16x32_bf16 v[136:139], a[188:191], v[184:187], v[136:139]
  s_add_u32 m0, s34, 118784
  s_lshl_b32 s30, s17, 16
  s_add_u32 s30, s30, 2883584
  s_add_u32 s30, s30, s29
  buffer_load_dwordx4 v12, s[76:79], s30 offen lds
  v_mfma_f32_16x16x32_bf16 v[140:143], a[188:191], v[188:191], v[140:143]
  v_mfma_f32_16x16x32_bf16 v[144:147], v[228:231], v[176:179], v[144:147]
  v_mfma_f32_16x16x32_bf16 v[148:151], v[228:231], v[180:183], v[148:151]
  v_mfma_f32_16x16x32_bf16 v[152:155], v[228:231], v[184:187], v[152:155]
  v_mfma_f32_16x16x32_bf16 v[156:159], v[228:231], v[188:191], v[156:159]
  s_waitcnt lgkmcnt(0)
  v_mfma_f32_16x16x32_bf16 v[96:99], a[48:51], v[160:163], v[96:99]
  ds_read_b64_tr_b16 v[176:177], v13 offset:16384
  v_mfma_f32_16x16x32_bf16 v[100:103], a[48:51], v[164:167], v[100:103]
  ds_read_b64_tr_b16 v[178:179], v13 offset:16896
  v_mfma_f32_16x16x32_bf16 v[104:107], a[48:51], v[168:171], v[104:107]
  ds_read_b64_tr_b16 v[180:181], v14 offset:16384
  v_mfma_f32_16x16x32_bf16 v[108:111], a[48:51], v[172:175], v[108:111]
  ds_read_b64_tr_b16 v[182:183], v14 offset:16896
  v_mfma_f32_16x16x32_bf16 v[112:115], a[120:123], v[160:163], v[112:115]
  ds_read_b64_tr_b16 v[184:185], v15 offset:16384
  v_mfma_f32_16x16x32_bf16 v[116:119], a[120:123], v[164:167], v[116:119]
  ds_read_b64_tr_b16 v[186:187], v15 offset:16896
  v_mfma_f32_16x16x32_bf16 v[120:123], a[120:123], v[168:171], v[120:123]
  ds_read_b64_tr_b16 v[188:189], v6 offset:16384
  v_mfma_f32_16x16x32_bf16 v[124:127], a[120:123], v[172:175], v[124:127]
  ds_read_b64_tr_b16 v[190:191], v6 offset:16896
  v_mfma_f32_16x16x32_bf16 v[128:131], a[192:195], v[160:163], v[128:131]
  v_mfma_f32_16x16x32_bf16 v[132:135], a[192:195], v[164:167], v[132:135]
  v_mfma_f32_16x16x32_bf16 v[136:139], a[192:195], v[168:171], v[136:139]
  s_add_u32 m0, s34, 122880
  s_lshl_b32 s30, s17, 16
  s_add_u32 s30, s30, 3145728
  s_add_u32 s30, s30, s29
  buffer_load_dwordx4 v12, s[76:79], s30 offen lds
  v_mfma_f32_16x16x32_bf16 v[140:143], a[192:195], v[172:175], v[140:143]
  v_mfma_f32_16x16x32_bf16 v[144:147], v[232:235], v[160:163], v[144:147]
  v_mfma_f32_16x16x32_bf16 v[148:151], v[232:235], v[164:167], v[148:151]
  v_mfma_f32_16x16x32_bf16 v[152:155], v[232:235], v[168:171], v[152:155]
  v_mfma_f32_16x16x32_bf16 v[156:159], v[232:235], v[172:175], v[156:159]
  s_waitcnt lgkmcnt(0)
  v_mfma_f32_16x16x32_bf16 v[96:99], a[52:55], v[176:179], v[96:99]
  ds_read_b64_tr_b16 v[160:161], v13 offset:20480
  v_mfma_f32_16x16x32_bf16 v[100:103], a[52:55], v[180:183], v[100:103]
  ds_read_b64_tr_b16 v[162:163], v13 offset:20992
  v_mfma_f32_16x16x32_bf16 v[104:107], a[52:55], v[184:187], v[104:107]
  ds_read_b64_tr_b16 v[164:165], v14 offset:20480
  v_mfma_f32_16x16x32_bf16 v[108:111], a[52:55], v[188:191], v[108:111]
  ds_read_b64_tr_b16 v[166:167], v14 offset:20992
  v_mfma_f32_16x16x32_bf16 v[112:115], a[124:127], v[176:179], v[112:115]
  ds_read_b64_tr_b16 v[168:169], v15 offset:20480
  v_mfma_f32_16x16x32_bf16 v[116:119], a[124:127], v[180:183], v[116:119]
  ds_read_b64_tr_b16 v[170:171], v15 offset:20992
  v_mfma_f32_16x16x32_bf16 v[120:123], a[124:127], v[184:187], v[120:123]
  ds_read_b64_tr_b16 v[172:173], v6 offset:20480
  v_mfma_f32_16x16x32_bf16 v[124:127], a[124:127], v[188:191], v[124:127]
  ds_read_b64_tr_b16 v[174:175], v6 offset:20992
  v_mfma_f32_16x16x32_bf16 v[128:131], a[196:199], v[176:179], v[128:131]
  v_mfma_f32_16x16x32_bf16 v[132:135], a[196:199], v[180:183], v[132:135]
  v_mfma_f32_16x16x32_bf16 v[136:139], a[196:199], v[184:187], v[136:139]
  s_add_u32 m0, s34, 126976
  s_lshl_b32 s30, s17, 16
  s_add_u32 s30, s30, 3407872
  s_add_u32 s30, s30, s29
  buffer_load_dwordx4 v12, s[76:79], s30 offen lds
  v_mfma_f32_16x16x32_bf16 v[140:143], a[196:199], v[188:191], v[140:143]
  v_mfma_f32_16x16x32_bf16 v[144:147], v[236:239], v[176:179], v[144:147]
  v_mfma_f32_16x16x32_bf16 v[148:151], v[236:239], v[180:183], v[148:151]
  v_mfma_f32_16x16x32_bf16 v[152:155], v[236:239], v[184:187], v[152:155]
  v_mfma_f32_16x16x32_bf16 v[156:159], v[236:239], v[188:191], v[156:159]
  s_waitcnt lgkmcnt(0)
  v_mfma_f32_16x16x32_bf16 v[96:99], a[56:59], v[160:163], v[96:99]
  ds_read_b64_tr_b16 v[176:177], v13 offset:24576
  v_mfma_f32_16x16x32_bf16 v[100:103], a[56:59], v[164:167], v[100:103]
  ds_read_b64_tr_b16 v[178:179], v13 offset:25088
  v_mfma_f32_16x16x32_bf16 v[104:107], a[56:59], v[168:171], v[104:107]
  ds_read_b64_tr_b16 v[180:181], v14 offset:24576
  v_mfma_f32_16x16x32_bf16 v[108:111], a[56:59], v[172:175], v[108:111]
  ds_read_b64_tr_b16 v[182:183], v14 offset:25088
  v_mfma_f32_16x16x32_bf16 v[112:115], a[128:131], v[160:163], v[112:115]
  ds_read_b64_tr_b16 v[184:185], v15 offset:24576
  v_mfma_f32_16x16x32_bf16 v[116:119], a[128:131], v[164:167], v[116:119]
  ds_read_b64_tr_b16 v[186:187], v15 offset:25088
  v_mfma_f32_16x16x32_bf16 v[120:123], a[128:131], v[168:171], v[120:123]
  ds_read_b64_tr_b16 v[188:189], v6 offset:24576
  v_mfma_f32_16x16x32_bf16 v[124:127], a[128:131], v[172:175], v[124:127]
  ds_read_b64_tr_b16 v[190:191], v6 offset:25088
  v_mfma_f32_16x16x32_bf16 v[128:131], a[200:203], v[160:163], v[128:131]
  v_mfma_f32_16x16x32_bf16 v[132:135], a[200:203], v[164:167], v[132:135]
  v_mfma_f32_16x16x32_bf16 v[136:139], a[200:203], v[168:171], v[136:139]
  s_add_u32 m0, s34, 131072
  s_lshl_b32 s30, s17, 16
  s_add_u32 s30, s30, 3670016
  s_add_u32 s30, s30, s29
  buffer_load_dwordx4 v12, s[76:79], s30 offen lds
  v_mfma_f32_16x16x32_bf16 v[140:143], a[200:203], v[172:175], v[140:143]
  v_mfma_f32_16x16x32_bf16 v[144:147], v[240:243], v[160:163], v[144:147]
  v_mfma_f32_16x16x32_bf16 v[148:151], v[240:243], v[164:167], v[148:151]
  v_mfma_f32_16x16x32_bf16 v[152:155], v[240:243], v[168:171], v[152:155]
  v_mfma_f32_16x16x32_bf16 v[156:159], v[240:243], v[172:175], v[156:159]
  s_waitcnt lgkmcnt(0)
  v_mfma_f32_16x16x32_bf16 v[96:99], a[60:63], v[176:179], v[96:99]
  ds_read_b64_tr_b16 v[160:161], v13 offset:28672
  v_mfma_f32_16x16x32_bf16 v[100:103], a[60:63], v[180:183], v[100:103]
  ds_read_b64_tr_b16 v[162:163], v13 offset:29184
  v_mfma_f32_16x16x32_bf16 v[104:107], a[60:63], v[184:187], v[104:107]
  ds_read_b64_tr_b16 v[164:165], v14 offset:28672
  v_mfma_f32_16x16x32_bf16 v[108:111], a[60:63], v[188:191], v[108:111]
  ds_read_b64_tr_b16 v[166:167], v14 offset:29184
  v_mfma_f32_16x16x32_bf16 v[112:115], a[132:135], v[176:179], v[112:115]
  ds_read_b64_tr_b16 v[168:169], v15 offset:28672
  v_mfma_f32_16x16x32_bf16 v[116:119], a[132:135], v[180:183], v[116:119]
  ds_read_b64_tr_b16 v[170:171], v15 offset:29184
  v_mfma_f32_16x16x32_bf16 v[120:123], a[132:135], v[184:187], v[120:123]
  ds_read_b64_tr_b16 v[172:173], v6 offset:28672
  v_mfma_f32_16x16x32_bf16 v[124:127], a[132:135], v[188:191], v[124:127]
  ds_read_b64_tr_b16 v[174:175], v6 offset:29184
  v_mfma_f32_16x16x32_bf16 v[128:131], a[204:207], v[176:179], v[128:131]
  v_mfma_f32_16x16x32_bf16 v[132:135], a[204:207], v[180:183], v[132:135]
  v_mfma_f32_16x16x32_bf16 v[136:139], a[204:207], v[184:187], v[136:139]
  s_add_u32 m0, s34, 135168
  s_lshl_b32 s30, s17, 16
  s_add_u32 s30, s30, 3932160
  s_add_u32 s30, s30, s29
  buffer_load_dwordx4 v12, s[76:79], s30 offen lds
  v_mfma_f32_16x16x32_bf16 v[140:143], a[204:207], v[188:191], v[140:143]
  v_mfma_f32_16x16x32_bf16 v[144:147], v[244:247], v[176:179], v[144:147]
  v_mfma_f32_16x16x32_bf16 v[148:151], v[244:247], v[180:183], v[148:151]
  v_mfma_f32_16x16x32_bf16 v[152:155], v[244:247], v[184:187], v[152:155]
  v_mfma_f32_16x16x32_bf16 v[156:159], v[244:247], v[188:191], v[156:159]
  s_waitcnt lgkmcnt(0)
  v_mfma_f32_16x16x32_bf16 v[96:99], a[64:67], v[160:163], v[96:99]
  ds_read_b64_tr_b16 v[176:177], v13 offset:32768
  v_mfma_f32_16x16x32_bf16 v[100:103], a[64:67], v[164:167], v[100:103]
  ds_read_b64_tr_b16 v[178:179], v13 offset:33280
  v_mfma_f32_16x16x32_bf16 v[104:107], a[64:67], v[168:171], v[104:107]
  ds_read_b64_tr_b16 v[180:181], v14 offset:32768
  v_mfma_f32_16x16x32_bf16 v[108:111], a[64:67], v[172:175], v[108:111]
  ds_read_b64_tr_b16 v[182:183], v14 offset:33280
  v_mfma_f32_16x16x32_bf16 v[112:115], a[136:139], v[160:163], v[112:115]
  ds_read_b64_tr_b16 v[184:185], v15 offset:32768
  v_mfma_f32_16x16x32_bf16 v[116:119], a[136:139], v[164:167], v[116:119]
  ds_read_b64_tr_b16 v[186:187], v15 offset:33280
  v_mfma_f32_16x16x32_bf16 v[120:123], a[136:139], v[168:171], v[120:123]
  ds_read_b64_tr_b16 v[188:189], v6 offset:32768
  v_mfma_f32_16x16x32_bf16 v[124:127], a[136:139], v[172:175], v[124:127]
  ds_read_b64_tr_b16 v[190:191], v6 offset:33280
  v_mfma_f32_16x16x32_bf16 v[128:131], a[208:211], v[160:163], v[128:131]
  v_mfma_f32_16x16x32_bf16 v[132:135], a[208:211], v[164:167], v[132:135]
  v_mfma_f32_16x16x32_bf16 v[136:139], a[208:211], v[168:171], v[136:139]
  s_add_u32 m0, s34, 139264
  s_lshl_b32 s30, s17, 16
  s_add_u32 s30, s30, 4194304
  s_add_u32 s30, s30, s29
  buffer_load_dwordx4 v12, s[76:79], s30 offen lds
  v_mfma_f32_16x16x32_bf16 v[140:143], a[208:211], v[172:175], v[140:143]
  v_mfma_f32_16x16x32_bf16 v[144:147], v[248:251], v[160:163], v[144:147]
  v_mfma_f32_16x16x32_bf16 v[148:151], v[248:251], v[164:167], v[148:151]
  v_mfma_f32_16x16x32_bf16 v[152:155], v[248:251], v[168:171], v[152:155]
  v_mfma_f32_16x16x32_bf16 v[156:159], v[248:251], v[172:175], v[156:159]
  s_waitcnt lgkmcnt(0)
  v_mfma_f32_16x16x32_bf16 v[96:99], a[68:71], v[176:179], v[96:99]
  v_mfma_f32_16x16x32_bf16 v[100:103], a[68:71], v[180:183], v[100:103]
  v_mfma_f32_16x16x32_bf16 v[104:107], a[68:71], v[184:187], v[104:107]
  v_mfma_f32_16x16x32_bf16 v[108:111], a[68:71], v[188:191], v[108:111]
  v_mfma_f32_16x16x32_bf16 v[112:115], a[140:143], v[176:179], v[112:115]
  v_mfma_f32_16x16x32_bf16 v[116:119], a[140:143], v[180:183], v[116:119]
  v_mfma_f32_16x16x32_bf16 v[120:123], a[140:143], v[184:187], v[120:123]
  v_mfma_f32_16x16x32_bf16 v[124:127], a[140:143], v[188:191], v[124:127]
  v_mfma_f32_16x16x32_bf16 v[128:131], a[212:215], v[176:179], v[128:131]
  v_mfma_f32_16x16x32_bf16 v[132:135], a[212:215], v[180:183], v[132:135]
  v_mfma_f32_16x16x32_bf16 v[136:139], a[212:215], v[184:187], v[136:139]
  s_add_u32 m0, s34, 143360
  s_lshl_b32 s30, s17, 16
  s_add_u32 s30, s30, 4456448
  s_add_u32 s30, s30, s29
  buffer_load_dwordx4 v12, s[76:79], s30 offen lds
  v_mfma_f32_16x16x32_bf16 v[140:143], a[212:215], v[188:191], v[140:143]
  v_mfma_f32_16x16x32_bf16 v[144:147], v[252:255], v[176:179], v[144:147]
  v_mfma_f32_16x16x32_bf16 v[148:151], v[252:255], v[180:183], v[148:151]
  v_mfma_f32_16x16x32_bf16 v[152:155], v[252:255], v[184:187], v[152:155]
  v_mfma_f32_16x16x32_bf16 v[156:159], v[252:255], v[188:191], v[156:159]
  s_nop 7
  v_cvt_pk_bf16_f32 v40, v96, v97
  v_cvt_pk_bf16_f32 v41, v98, v99
  v_cvt_pk_bf16_f32 v42, v112, v113
  v_cvt_pk_bf16_f32 v43, v114, v115
  s_add_u32 s30, s43, 0
  buffer_store_dwordx4 v[40:43], v1, s[4:7], s30 offen sc1
  v_cvt_pk_bf16_f32 v44, v100, v101
  v_cvt_pk_bf16_f32 v45, v102, v103
  v_cvt_pk_bf16_f32 v46, v116, v117
  v_cvt_pk_bf16_f32 v47, v118, v119
  s_add_u32 s30, s43, 1024
  buffer_store_dwordx4 v[44:47], v1, s[4:7], s30 offen sc1
  v_cvt_pk_bf16_f32 v48, v104, v105
  v_cvt_pk_bf16_f32 v49, v106, v107
  v_cvt_pk_bf16_f32 v50, v120, v121
  v_cvt_pk_bf16_f32 v51, v122, v123
  s_add_u32 s30, s43, 2048
  buffer_store_dwordx4 v[48:51], v1, s[4:7], s30 offen sc1
  v_cvt_pk_bf16_f32 v52, v108, v109
  v_cvt_pk_bf16_f32 v53, v110, v111
  v_cvt_pk_bf16_f32 v54, v124, v125
  v_cvt_pk_bf16_f32 v55, v126, v127
  s_add_u32 s30, s43, 3072
  buffer_store_dwordx4 v[52:55], v1, s[4:7], s30 offen sc1
  v_cvt_pk_bf16_f32 v40, v128, v129
  v_cvt_pk_bf16_f32 v41, v130, v131
  v_cvt_pk_bf16_f32 v42, v144, v145
  v_cvt_pk_bf16_f32 v43, v146, v147
  s_add_u32 s30, s43, 262144
  buffer_store_dwordx4 v[40:43], v1, s[4:7], s30 offen sc1
  v_cvt_pk_bf16_f32 v44, v132, v133
  v_cvt_pk_bf16_f32 v45, v134, v135
  v_cvt_pk_bf16_f32 v46, v148, v149
  v_cvt_pk_bf16_f32 v47, v150, v151
  s_add_u32 s30, s43, 263168
  buffer_store_dwordx4 v[44:47], v1, s[4:7], s30 offen sc1
  v_cvt_pk_bf16_f32 v48, v136, v137
  v_cvt_pk_bf16_f32 v49, v138, v139
  v_cvt_pk_bf16_f32 v50, v152, v153
  v_cvt_pk_bf16_f32 v51, v154, v155
  s_add_u32 s30, s43, 264192
  buffer_store_dwordx4 v[48:51], v1, s[4:7], s30 offen sc1
  v_cvt_pk_bf16_f32 v52, v140, v141
  v_cvt_pk_bf16_f32 v53, v142, v143
  v_cvt_pk_bf16_f32 v54, v156, v157
  v_cvt_pk_bf16_f32 v55, v158, v159
  s_add_u32 s30, s43, 265216
  buffer_store_dwordx4 v[52:55], v1, s[4:7], s30 offen sc1
L_g_join_66:
  s_cmp_eq_u32 s40, s46
  s_cbranch_scc0 L_g_nokv_67
  s_waitcnt vmcnt(0)
  s_barrier
  s_cmp_eq_u32 s17, 0
  s_cbranch_scc0 L_arr_68
  v_mov_b32 v8, s47
  v_mov_b32 v9, 1
  s_mov_b64 exec, 1
  buffer_atomic_add v9, v8, s[12:15], 0 offen
  s_mov_b64 exec, -1
L_arr_68:
L_g_nokv_67:
  s_add_u32 s40, s40, 1
  s_cmp_eq_u32 s32, 0
  s_cbranch_scc1 L_g_fin_63
  s_mov_b32 s41, s31
  s_waitcnt vmcnt(8)
  s_barrier
  s_add_u32 s31, s41, s45
  s_cmp_lt_u32 s31, 192
  s_cselect_b32 s32, 1, 0
  s_cselect_b32 s33, s31, s41
  s_lshr_b32 s28, s33, 6
  s_cmp_eq_u32 s28, 1
  s_cselect_b32 s76, s68, s64
  s_cmp_eq_u32 s28, 2
  s_cselect_b32 s76, s72, s76
  s_cmp_eq_u32 s28, 1
  s_cselect_b32 s77, s69, s65
  s_cmp_eq_u32 s28, 2
  s_cselect_b32 s77, s73, s77
  s_cmp_eq_u32 s28, 1
  s_cselect_b32 s78, s70, s66
  s_cmp_eq_u32 s28, 2
  s_cselect_b32 s78, s74, s78
  s_cmp_eq_u32 s28, 1
  s_cselect_b32 s79, s71, s67
  s_cmp_eq_u32 s28, 2
  s_cselect_b32 s79, s75, s79
  s_mov_b32 s79, 0x00020000
  s_and_b32 s29, s33, 63
  s_lshl_b32 s29, s29, 7
  s_lshr_b32 s42, s41, 6
  s_and_b32 s28, s41, 63
  s_lshl_b32 s43, s28, 12
  s_lshl_b32 s28, s16, 3
  s_lshl_b32 s30, s17, 1
  s_add_u32 s28, s28, s30
  s_lshl_b32 s28, s28, 18
  s_add_u32 s43, s43, s28
  s_lshl_b32 s28, s42, 24
  s_add_u32 s43, s43, s28
  v_xor_b32 v13, 0, v5
  v_add_u32 v13, 73728, v13
  v_xor_b32 v14, 32, v5
  v_add_u32 v14, 73728, v14
  v_xor_b32 v15, 64, v5
  v_add_u32 v15, 73728, v15
  v_xor_b32 v6, 96, v5
  v_add_u32 v6, 73728, v6
  s_cmp_eq_u32 s42, 1
  s_cbranch_scc1 L_g_isv_70
  ds_read_b64_tr_b16 v[160:161], v13 offset:0
  ds_read_b64_tr_b16 v[162:163], v13 offset:512
  ds_read_b64_tr_b16 v[164:165], v14 offset:0
  ds_read_b64_tr_b16 v[166:167], v14 offset:512
  ds_read_b64_tr_b16 v[168:169], v15 offset:0
  ds_read_b64_tr_b16 v[170:171], v15 offset:512
  ds_read_b64_tr_b16 v[172:173], v6 offset:0
  ds_read_b64_tr_b16 v[174:175], v6 offset:512
  s_waitcnt lgkmcnt(0)
  v_mfma_f32_16x16x32_bf16 v[96:99], v[160:163], a[0:3], 0
  ds_read_b64_tr_b16 v[176:177], v13 offset:4096
  v_mfma_f32_16x16x32_bf16 v[100:103], v[164:167], a[0:3], 0
  ds_read_b64_tr_b16 v[178:179], v13 offset:4608
  v_mfma_f32_16x16x32_bf16 v[104:107], v[168:171], a[0:3], 0
  ds_read_b64_tr_b16 v[180:181], v14 offset:4096
  v_mfma_f32_16x16x32_bf16 v[108:111], v[172:175], a[0:3], 0
  ds_read_b64_tr_b16 v[182:183], v14 offset:4608
  v_mfma_f32_16x16x32_bf16 v[112:115], v[160:163], a[72:75], 0
  ds_read_b64_tr_b16 v[184:185], v15 offset:4096
  v_mfma_f32_16x16x32_bf16 v[116:119], v[164:167], a[72:75], 0
  ds_read_b64_tr_b16 v[186:187], v15 offset:4608
  v_mfma_f32_16x16x32_bf16 v[120:123], v[168:171], a[72:75], 0
  ds_read_b64_tr_b16 v[188:189], v6 offset:4096
  v_mfma_f32_16x16x32_bf16 v[124:127], v[172:175], a[72:75], 0
  ds_read_b64_tr_b16 v[190:191], v6 offset:4608
  v_mfma_f32_16x16x32_bf16 v[128:131], v[160:163], a[144:147], 0
  v_mfma_f32_16x16x32_bf16 v[132:135], v[164:167], a[144:147], 0
  v_mfma_f32_16x16x32_bf16 v[136:139], v[168:171], a[144:147], 0
  s_add_u32 m0, s34, 0
  s_lshl_b32 s30, s17, 16
  s_add_u32 s30, s30, 0
  s_add_u32 s30, s30, s29
  buffer_load_dwordx4 v12, s[76:79], s30 offen lds
  v_mfma_f32_16x16x32_bf16 v[140:143], v[172:175], a[144:147], 0
  v_mfma_f32_16x16x32_bf16 v[144:147], v[160:163], a[216:219], 0
  v_mfma_f32_16x16x32_bf16 v[148:151], v[164:167], a[216:219], 0
  v_mfma_f32_16x16x32_bf16 v[152:155], v[168:171], a[216:219], 0
  v_mfma_f32_16x16x32_bf16 v[156:159], v[172:175], a[216:219], 0
  s_waitcnt lgkmcnt(0)
  v_mfma_f32_16x16x32_bf16 v[96:99], v[176:179], a[4:7], v[96:99]
  ds_read_b64_tr_b16 v[160:161], v13 offset:8192
  v_mfma_f32_16x16x32_bf16 v[100:103], v[180:183], a[4:7], v[100:103]
  ds_read_b64_tr_b16 v[162:163], v13 offset:8704
  v_mfma_f32_16x16x32_bf16 v[104:107], v[184:187], a[4:7], v[104:107]
  ds_read_b64_tr_b16 v[164:165], v14 offset:8192
  v_mfma_f32_16x16x32_bf16 v[108:111], v[188:191], a[4:7], v[108:111]
  ds_read_b64_tr_b16 v[166:167], v14 offset:8704
  v_mfma_f32_16x16x32_bf16 v[112:115], v[176:179], a[76:79], v[112:115]
  ds_read_b64_tr_b16 v[168:169], v15 offset:8192
  v_mfma_f32_16x16x32_bf16 v[116:119], v[180:183], a[76:79], v[116:119]
  ds_read_b64_tr_b16 v[170:171], v15 offset:8704
  v_mfma_f32_16x16x32_bf16 v[120:123], v[184:187], a[76:79], v[120:123]
  ds_read_b64_tr_b16 v[172:173], v6 offset:8192
  v_mfma_f32_16x16x32_bf16 v[124:127], v[188:191], a[76:79], v[124:127]
  ds_read_b64_tr_b16 v[174:175], v6 offset:8704
  v_mfma_f32_16x16x32_bf16 v[128:131], v[176:179], a[148:151], v[128:131]
  v_mfma_f32_16x16x32_bf16 v[132:135], v[180:183], a[148:151], v[132:135]
  v_mfma_f32_16x16x32_bf16 v[136:139], v[184:187], a[148:151], v[136:139]
  s_add_u32 m0, s34, 4096
  s_lshl_b32 s30, s17, 16
  s_add_u32 s30, s30, 262144
  s_add_u32 s30, s30, s29
  buffer_load_dwordx4 v12, s[76:79], s30 offen lds
  v_mfma_f32_16x16x32_bf16 v[140:143], v[188:191], a[148:151], v[140:143]
  v_mfma_f32_16x16x32_bf16 v[144:147], v[176:179], a[220:223], v[144:147]
  v_mfma_f32_16x16x32_bf16 v[148:151], v[180:183], a[220:223], v[148:151]
  v_mfma_f32_16x16x32_bf16 v[152:155], v[184:187], a[220:223], v[152:155]
  v_mfma_f32_16x16x32_bf16 v[156:159], v[188:191], a[220:223], v[156:159]
  s_waitcnt lgkmcnt(0)
  v_mfma_f32_16x16x32_bf16 v[96:99], v[160:163], a[8:11], v[96:99]
  ds_read_b64_tr_b16 v[176:177], v13 offset:12288
  v_mfma_f32_16x16x32_bf16 v[100:103], v[164:167], a[8:11], v[100:103]
  ds_read_b64_tr_b16 v[178:179], v13 offset:12800
  v_mfma_f32_16x16x32_bf16 v[104:107], v[168:171], a[8:11], v[104:107]
  ds_read_b64_tr_b16 v[180:181], v14 offset:12288
  v_mfma_f32_16x16x32_bf16 v[108:111], v[172:175], a[8:11], v[108:111]
  ds_read_b64_tr_b16 v[182:183], v14 offset:12800
  v_mfma_f32_16x16x32_bf16 v[112:115], v[160:163], a[80:83], v[112:115]
  ds_read_b64_tr_b16 v[184:185], v15 offset:12288
  v_mfma_f32_16x16x32_bf16 v[116:119], v[164:167], a[80:83], v[116:119]
  ds_read_b64_tr_b16 v[186:187], v15 offset:12800
  v_mfma_f32_16x16x32_bf16 v[120:123], v[168:171], a[80:83], v[120:123]
  ds_read_b64_tr_b16 v[188:189], v6 offset:12288
  v_mfma_f32_16x16x32_bf16 v[124:127], v[172:175], a[80:83], v[124:127]
  ds_read_b64_tr_b16 v[190:191], v6 offset:12800
  v_mfma_f32_16x16x32_bf16 v[128:131], v[160:163], a[152:155], v[128:131]
  v_mfma_f32_16x16x32_bf16 v[132:135], v[164:167], a[152:155], v[132:135]
  v_mfma_f32_16x16x32_bf16 v[136:139], v[168:171], a[152:155], v[136:139]
  s_add_u32 m0, s34, 8192
  s_lshl_b32 s30, s17, 16
  s_add_u32 s30, s30, 524288
  s_add_u32 s30, s30, s29
  buffer_load_dwordx4 v12, s[76:79], s30 offen lds
  v_mfma_f32_16x16x32_bf16 v[140:143], v[172:175], a[152:155], v[140:143]
  v_mfma_f32_16x16x32_bf16 v[144:147], v[160:163], a[224:227], v[144:147]
  v_mfma_f32_16x16x32_bf16 v[148:151], v[164:167], a[224:227], v[148:151]
  v_mfma_f32_16x16x32_bf16 v[152:155], v[168:171], a[224:227], v[152:155]
  v_mfma_f32_16x16x32_bf16 v[156:159], v[172:175], a[224:227], v[156:159]
  s_waitcnt lgkmcnt(0)
  v_mfma_f32_16x16x32_bf16 v[96:99], v[176:179], a[12:15], v[96:99]
  ds_read_b64_tr_b16 v[160:161], v13 offset:16384
  v_mfma_f32_16x16x32_bf16 v[100:103], v[180:183], a[12:15], v[100:103]
  ds_read_b64_tr_b16 v[162:163], v13 offset:16896
  v_mfma_f32_16x16x32_bf16 v[104:107], v[184:187], a[12:15], v[104:107]
  ds_read_b64_tr_b16 v[164:165], v14 offset:16384
  v_mfma_f32_16x16x32_bf16 v[108:111], v[188:191], a[12:15], v[108:111]
  ds_read_b64_tr_b16 v[166:167], v14 offset:16896
  v_mfma_f32_16x16x32_bf16 v[112:115], v[176:179], a[84:87], v[112:115]
  ds_read_b64_tr_b16 v[168:169], v15 offset:16384
  v_mfma_f32_16x16x32_bf16 v[116:119], v[180:183], a[84:87], v[116:119]
  ds_read_b64_tr_b16 v[170:171], v15 offset:16896
  v_mfma_f32_16x16x32_bf16 v[120:123], v[184:187], a[84:87], v[120:123]
  ds_read_b64_tr_b16 v[172:173], v6 offset:16384
  v_mfma_f32_16x16x32_bf16 v[124:127], v[188:191], a[84:87], v[124:127]
  ds_read_b64_tr_b16 v[174:175], v6 offset:16896
  v_mfma_f32_16x16x32_bf16 v[128:131], v[176:179], a[156:159], v[128:131]
  v_mfma_f32_16x16x32_bf16 v[132:135], v[180:183], a[156:159], v[132:135]
  v_mfma_f32_16x16x32_bf16 v[136:139], v[184:187], a[156:159], v[136:139]
  s_add_u32 m0, s34, 12288
  s_lshl_b32 s30, s17, 16
  s_add_u32 s30, s30, 786432
  s_add_u32 s30, s30, s29
  buffer_load_dwordx4 v12, s[76:79], s30 offen lds
  v_mfma_f32_16x16x32_bf16 v[140:143], v[188:191], a[156:159], v[140:143]
  v_mfma_f32_16x16x32_bf16 v[144:147], v[176:179], a[228:231], v[144:147]
  v_mfma_f32_16x16x32_bf16 v[148:151], v[180:183], a[228:231], v[148:151]
  v_mfma_f32_16x16x32_bf16 v[152:155], v[184:187], a[228:231], v[152:155]
  v_mfma_f32_16x16x32_bf16 v[156:159], v[188:191], a[228:231], v[156:159]
  s_waitcnt lgkmcnt(0)
  v_mfma_f32_16x16x32_bf16 v[96:99], v[160:163], a[16:19], v[96:99]
  ds_read_b64_tr_b16 v[176:177], v13 offset:20480
  v_mfma_f32_16x16x32_bf16 v[100:103], v[164:167], a[16:19], v[100:103]
  ds_read_b64_tr_b16 v[178:179], v13 offset:20992
  v_mfma_f32_16x16x32_bf16 v[104:107], v[168:171], a[16:19], v[104:107]
  ds_read_b64_tr_b16 v[180:181], v14 offset:20480
  v_mfma_f32_16x16x32_bf16 v[108:111], v[172:175], a[16:19], v[108:111]
  ds_read_b64_tr_b16 v[182:183], v14 offset:20992
  v_mfma_f32_16x16x32_bf16 v[112:115], v[160:163], a[88:91], v[112:115]
  ds_read_b64_tr_b16 v[184:185], v15 offset:20480
  v_mfma_f32_16x16x32_bf16 v[116:119], v[164:167], a[88:91], v[116:119]
  ds_read_b64_tr_b16 v[186:187], v15 offset:20992
  v_mfma_f32_16x16x32_bf16 v[120:123], v[168:171], a[88:91], v[120:123]
  ds_read_b64_tr_b16 v[188:189], v6 offset:20480
  v_mfma_f32_16x16x32_bf16 v[124:127], v[172:175], a[88:91], v[124:127]
  ds_read_b64_tr_b16 v[190:191], v6 offset:20992
  v_mfma_f32_16x16x32_bf16 v[128:131], v[160:163], a[160:163], v[128:131]
  v_mfma_f32_16x16x32_bf16 v[132:135], v[164:167], a[160:163], v[132:135]
  v_mfma_f32_16x16x32_bf16 v[136:139], v[168:171], a[160:163], v[136:139]
  s_add_u32 m0, s34, 16384
  s_lshl_b32 s30, s17, 16
  s_add_u32 s30, s30, 1048576
  s_add_u32 s30, s30, s29
  buffer_load_dwordx4 v12, s[76:79], s30 offen lds
  v_mfma_f32_16x16x32_bf16 v[140:143], v[172:175], a[160:163], v[140:143]
  v_mfma_f32_16x16x32_bf16 v[144:147], v[160:163], a[232:235], v[144:147]
  v_mfma_f32_16x16x32_bf16 v[148:151], v[164:167], a[232:235], v[148:151]
  v_mfma_f32_16x16x32_bf16 v[152:155], v[168:171], a[232:235], v[152:155]
  v_mfma_f32_16x16x32_bf16 v[156:159], v[172:175], a[232:235], v[156:159]
  s_waitcnt lgkmcnt(0)
  v_mfma_f32_16x16x32_bf16 v[96:99], v[176:179], a[20:23], v[96:99]
  ds_read_b64_tr_b16 v[160:161], v13 offset:24576
  v_mfma_f32_16x16x32_bf16 v[100:103], v[180:183], a[20:23], v[100:103]
  ds_read_b64_tr_b16 v[162:163], v13 offset:25088
  v_mfma_f32_16x16x32_bf16 v[104:107], v[184:187], a[20:23], v[104:107]
  ds_read_b64_tr_b16 v[164:165], v14 offset:24576
  v_mfma_f32_16x16x32_bf16 v[108:111], v[188:191], a[20:23], v[108:111]
  ds_read_b64_tr_b16 v[166:167], v14 offset:25088
  v_mfma_f32_16x16x32_bf16 v[112:115], v[176:179], a[92:95], v[112:115]
  ds_read_b64_tr_b16 v[168:169], v15 offset:24576
  v_mfma_f32_16x16x32_bf16 v[116:119], v[180:183], a[92:95], v[116:119]
  ds_read_b64_tr_b16 v[170:171], v15 offset:25088
  v_mfma_f32_16x16x32_bf16 v[120:123], v[184:187], a[92:95], v[120:123]
  ds_read_b64_tr_b16 v[172:173], v6 offset:24576
  v_mfma_f32_16x16x32_bf16 v[124:127], v[188:191], a[92:95], v[124:127]
  ds_read_b64_tr_b16 v[174:175], v6 offset:25088
  v_mfma_f32_16x16x32_bf16 v[128:131], v[176:179], a[164:167], v[128:131]
  v_mfma_f32_16x16x32_bf16 v[132:135], v[180:183], a[164:167], v[132:135]
  v_mfma_f32_16x16x32_bf16 v[136:139], v[184:187], a[164:167], v[136:139]
  s_add_u32 m0, s34, 20480
  s_lshl_b32 s30, s17, 16
  s_add_u32 s30, s30, 1310720
  s_add_u32 s30, s30, s29
  buffer_load_dwordx4 v12, s[76:79], s30 offen lds
  v_mfma_f32_16x16x32_bf16 v[140:143], v[188:191], a[164:167], v[140:143]
  v_mfma_f32_16x16x32_bf16 v[144:147], v[176:179], a[236:239], v[144:147]
  v_mfma_f32_16x16x32_bf16 v[148:151], v[180:183], a[236:239], v[148:151]
  v_mfma_f32_16x16x32_bf16 v[152:155], v[184:187], a[236:239], v[152:155]
  v_mfma_f32_16x16x32_bf16 v[156:159], v[188:191], a[236:239], v[156:159]
  s_waitcnt lgkmcnt(0)
  v_mfma_f32_16x16x32_bf16 v[96:99], v[160:163], a[24:27], v[96:99]
  ds_read_b64_tr_b16 v[176:177], v13 offset:28672
  v_mfma_f32_16x16x32_bf16 v[100:103], v[164:167], a[24:27], v[100:103]
  ds_read_b64_tr_b16 v[178:179], v13 offset:29184
  v_mfma_f32_16x16x32_bf16 v[104:107], v[168:171], a[24:27], v[104:107]
  ds_read_b64_tr_b16 v[180:181], v14 offset:28672
  v_mfma_f32_16x16x32_bf16 v[108:111], v[172:175], a[24:27], v[108:111]
  ds_read_b64_tr_b16 v[182:183], v14 offset:29184
  v_mfma_f32_16x16x32_bf16 v[112:115], v[160:163], a[96:99], v[112:115]
  ds_read_b64_tr_b16 v[184:185], v15 offset:28672
  v_mfma_f32_16x16x32_bf16 v[116:119], v[164:167], a[96:99], v[116:119]
  ds_read_b64_tr_b16 v[186:187], v15 offset:29184
  v_mfma_f32_16x16x32_bf16 v[120:123], v[168:171], a[96:99], v[120:123]
  ds_read_b64_tr_b16 v[188:189], v6 offset:28672
  v_mfma_f32_16x16x32_bf16 v[124:127], v[172:175], a[96:99], v[124:127]
  ds_read_b64_tr_b16 v[190:191], v6 offset:29184
  v_mfma_f32_16x16x32_bf16 v[128:131], v[160:163], a[168:171], v[128:131]
  v_mfma_f32_16x16x32_bf16 v[132:135], v[164:167], a[168:171], v[132:135]
  v_mfma_f32_16x16x32_bf16 v[136:139], v[168:171], a[168:171], v[136:139]
  s_add_u32 m0, s34, 24576
  s_lshl_b32 s30, s17, 16
  s_add_u32 s30, s30, 1572864
  s_add_u32 s30, s30, s29
  buffer_load_dwordx4 v12, s[76:79], s30 offen lds
  v_mfma_f32_16x16x32_bf16 v[140:143], v[172:175], a[168:171], v[140:143]
  v_mfma_f32_16x16x32_bf16 v[144:147], v[160:163], a[240:243], v[144:147]
  v_mfma_f32_16x16x32_bf16 v[148:151], v[164:167], a[240:243], v[148:151]
  v_mfma_f32_16x16x32_bf16 v[152:155], v[168:171], a[240:243], v[152:155]
  v_mfma_f32_16x16x32_bf16 v[156:159], v[172:175], a[240:243], v[156:159]
  s_waitcnt lgkmcnt(0)
  v_mfma_f32_16x16x32_bf16 v[96:99], v[176:179], a[28:31], v[96:99]
  ds_read_b64_tr_b16 v[160:161], v13 offset:32768
  v_mfma_f32_16x16x32_bf16 v[100:103], v[180:183], a[28:31], v[100:103]
  ds_read_b64_tr_b16 v[162:163], v13 offset:33280
  v_mfma_f32_16x16x32_bf16 v[104:107], v[184:187], a[28:31], v[104:107]
  ds_read_b64_tr_b16 v[164:165], v14 offset:32768
  v_mfma_f32_16x16x32_bf16 v[108:111], v[188:191], a[28:31], v[108:111]
  ds_read_b64_tr_b16 v[166:167], v14 offset:33280
  v_mfma_f32_16x16x32_bf16 v[112:115], v[176:179], a[100:103], v[112:115]
  ds_read_b64_tr_b16 v[168:169], v15 offset:32768
  v_mfma_f32_16x16x32_bf16 v[116:119], v[180:183], a[100:103], v[116:119]
  ds_read_b64_tr_b16 v[170:171], v15 offset:33280
  v_mfma_f32_16x16x32_bf16 v[120:123], v[184:187], a[100:103], v[120:123]
  ds_read_b64_tr_b16 v[172:173], v6 offset:32768
  v_mfma_f32_16x16x32_bf16 v[124:127], v[188:191], a[100:103], v[124:127]
  ds_read_b64_tr_b16 v[174:175], v6 offset:33280
  v_mfma_f32_16x16x32_bf16 v[128:131], v[176:179], a[172:175], v[128:131]
  v_mfma_f32_16x16x32_bf16 v[132:135], v[180:183], a[172:175], v[132:135]
  v_mfma_f32_16x16x32_bf16 v[136:139], v[184:187], a[172:175], v[136:139]
  s_add_u32 m0, s34, 28672
  s_lshl_b32 s30, s17, 16
  s_add_u32 s30, s30, 1835008
  s_add_u32 s30, s30, s29
  buffer_load_dwordx4 v12, s[76:79], s30 offen lds
  v_mfma_f32_16x16x32_bf16 v[140:143], v[188:191], a[172:175], v[140:143]
  v_mfma_f32_16x16x32_bf16 v[144:147], v[176:179], a[244:247], v[144:147]
  v_mfma_f32_16x16x32_bf16 v[148:151], v[180:183], a[244:247], v[148:151]
  v_mfma_f32_16x16x32_bf16 v[152:155], v[184:187], a[244:247], v[152:155]
  v_mfma_f32_16x16x32_bf16 v[156:159], v[188:191], a[244:247], v[156:159]
  s_waitcnt lgkmcnt(0)
  v_add_u32 v13, 36864, v13
  v_add_u32 v14, 36864, v14
  v_add_u32 v15, 36864, v15
  v_add_u32 v6, 36864, v6
  v_mfma_f32_16x16x32_bf16 v[96:99], v[160:163], a[32:35], v[96:99]
  ds_read_b64_tr_b16 v[176:177], v13 offset:0
  v_mfma_f32_16x16x32_bf16 v[100:103], v[164:167], a[32:35], v[100:103]
  ds_read_b64_tr_b16 v[178:179], v13 offset:512
  v_mfma_f32_16x16x32_bf16 v[104:107], v[168:171], a[32:35], v[104:107]
  ds_read_b64_tr_b16 v[180:181], v14 offset:0
  v_mfma_f32_16x16x32_bf16 v[108:111], v[172:175], a[32:35], v[108:111]
  ds_read_b64_tr_b16 v[182:183], v14 offset:512
  v_mfma_f32_16x16x32_bf16 v[112:115], v[160:163], a[104:107], v[112:115]
  ds_read_b64_tr_b16 v[184:185], v15 offset:0
  v_mfma_f32_16x16x32_bf16 v[116:119], v[164:167], a[104:107], v[116:119]
  ds_read_b64_tr_b16 v[186:187], v15 offset:512
  v_mfma_f32_16x16x32_bf16 v[120:123], v[168:171], a[104:107], v[120:123]
  ds_read_b64_tr_b16 v[188:189], v6 offset:0
  v_mfma_f32_16x16x32_bf16 v[124:127], v[172:175], a[104:107], v[124:127]
  ds_read_b64_tr_b16 v[190:191], v6 offset:512
  v_mfma_f32_16x16x32_bf16 v[128:131], v[160:163], a[176:179], v[128:131]
  v_mfma_f32_16x16x32_bf16 v[132:135], v[164:167], a[176:179], v[132:135]
  v_mfma_f32_16x16x32_bf16 v[136:139], v[168:171], a[176:179], v[136:139]
  s_add_u32 m0, s34, 32768
  s_lshl_b32 s30, s17, 16
  s_add_u32 s30, s30, 2097152
  s_add_u32 s30, s30, s29
  buffer_load_dwordx4 v12, s[76:79], s30 offen lds
  v_mfma_f32_16x16x32_bf16 v[140:143], v[172:175], a[176:179], v[140:143]
  v_mfma_f32_16x16x32_bf16 v[144:147], v[160:163], a[248:251], v[144:147]
  v_mfma_f32_16x16x32_bf16 v[148:151], v[164:167], a[248:251], v[148:151]
  v_mfma_f32_16x16x32_bf16 v[152:155], v[168:171], a[248:251], v[152:155]
  v_mfma_f32_16x16x32_bf16 v[156:159], v[172:175], a[248:251], v[156:159]
  s_waitcnt lgkmcnt(0)
  v_mfma_f32_16x16x32_bf16 v[96:99], v[176:179], a[36:39], v[96:99]
  ds_read_b64_tr_b16 v[160:161], v13 offset:4096
  v_mfma_f32_16x16x32_bf16 v[100:103], v[180:183], a[36:39], v[100:103]
  ds_read_b64_tr_b16 v[162:163], v13 offset:4608
  v_mfma_f32_16x16x32_bf16 v[104:107], v[184:187], a[36:39], v[104:107]
  ds_read_b64_tr_b16 v[164:165], v14 offset:4096
  v_mfma_f32_16x16x32_bf16 v[108:111], v[188:191], a[36:39], v[108:111]
  ds_read_b64_tr_b16 v[166:167], v14 offset:4608
  v_mfma_f32_16x16x32_bf16 v[112:115], v[176:179], a[108:111], v[112:115]
  ds_read_b64_tr_b16 v[168:169], v15 offset:4096
  v_mfma_f32_16x16x32_bf16 v[116:119], v[180:183], a[108:111], v[116:119]
  ds_read_b64_tr_b16 v[170:171], v15 offset:4608
  v_mfma_f32_16x16x32_bf16 v[120:123], v[184:187], a[108:111], v[120:123]
  ds_read_b64_tr_b16 v[172:173], v6 offset:4096
  v_mfma_f32_16x16x32_bf16 v[124:127], v[188:191], a[108:111], v[124:127]
  ds_read_b64_tr_b16 v[174:175], v6 offset:4608
  v_mfma_f32_16x16x32_bf16 v[128:131], v[176:179], a[180:183], v[128:131]
  v_mfma_f32_16x16x32_bf16 v[132:135], v[180:183], a[180:183], v[132:135]
  v_mfma_f32_16x16x32_bf16 v[136:139], v[184:187], a[180:183], v[136:139]
  s_add_u32 m0, s34, 36864
  s_lshl_b32 s30, s17, 16
  s_add_u32 s30, s30, 2359296
  s_add_u32 s30, s30, s29
  buffer_load_dwordx4 v12, s[76:79], s30 offen lds
  v_mfma_f32_16x16x32_bf16 v[140:143], v[188:191], a[180:183], v[140:143]
  v_mfma_f32_16x16x32_bf16 v[144:147], v[176:179], a[252:255], v[144:147]
  v_mfma_f32_16x16x32_bf16 v[148:151], v[180:183], a[252:255], v[148:151]
  v_mfma_f32_16x16x32_bf16 v[152:155], v[184:187], a[252:255], v[152:155]
  v_mfma_f32_16x16x32_bf16 v[156:159], v[188:191], a[252:255], v[156:159]
  s_waitcnt lgkmcnt(0)
  v_mfma_f32_16x16x32_bf16 v[96:99], v[160:163], a[40:43], v[96:99]
  ds_read_b64_tr_b16 v[176:177], v13 offset:8192
  v_mfma_f32_16x16x32_bf16 v[100:103], v[164:167], a[40:43], v[100:103]
  ds_read_b64_tr_b16 v[178:179], v13 offset:8704
  v_mfma_f32_16x16x32_bf16 v[104:107], v[168:171], a[40:43], v[104:107]
  ds_read_b64_tr_b16 v[180:181], v14 offset:8192
  v_mfma_f32_16x16x32_bf16 v[108:111], v[172:175], a[40:43], v[108:111]
  ds_read_b64_tr_b16 v[182:183], v14 offset:8704
  v_mfma_f32_16x16x32_bf16 v[112:115], v[160:163], a[112:115], v[112:115]
  ds_read_b64_tr_b16 v[184:185], v15 offset:8192
  v_mfma_f32_16x16x32_bf16 v[116:119], v[164:167], a[112:115], v[116:119]
  ds_read_b64_tr_b16 v[186:187], v15 offset:8704
  v_mfma_f32_16x16x32_bf16 v[120:123], v[168:171], a[112:115], v[120:123]
  ds_read_b64_tr_b16 v[188:189], v6 offset:8192
  v_mfma_f32_16x16x32_bf16 v[124:127], v[172:175], a[112:115], v[124:127]
  ds_read_b64_tr_b16 v[190:191], v6 offset:8704
  v_mfma_f32_16x16x32_bf16 v[128:131], v[160:163], a[184:187], v[128:131]
  v_mfma_f32_16x16x32_bf16 v[132:135], v[164:167], a[184:187], v[132:135]
  v_mfma_f32_16x16x32_bf16 v[136:139], v[168:171], a[184:187], v[136:139]
  s_add_u32 m0, s34, 40960
  s_lshl_b32 s30, s17, 16
  s_add_u32 s30, s30, 2621440
  s_add_u32 s30, s30, s29
  buffer_load_dwordx4 v12, s[76:79], s30 offen lds
  v_mfma_f32_16x16x32_bf16 v[140:143], v[172:175], a[184:187], v[140:143]
  v_mfma_f32_16x16x32_bf16 v[144:147], v[160:163], v[224:227], v[144:147]
  v_mfma_f32_16x16x32_bf16 v[148:151], v[164:167], v[224:227], v[148:151]
  v_mfma_f32_16x16x32_bf16 v[152:155], v[168:171], v[224:227], v[152:155]
  v_mfma_f32_16x16x32_bf16 v[156:159], v[172:175], v[224:227], v[156:159]
  s_waitcnt lgkmcnt(0)
  v_mfma_f32_16x16x32_bf16 v[96:99], v[176:179], a[44:47], v[96:99]
  ds_read_b64_tr_b16 v[160:161], v13 offset:12288
  v_mfma_f32_16x16x32_bf16 v[100:103], v[180:183], a[44:47], v[100:103]
  ds_read_b64_tr_b16 v[162:163], v13 offset:12800
  v_mfma_f32_16x16x32_bf16 v[104:107], v[184:187], a[44:47], v[104:107]
  ds_read_b64_tr_b16 v[164:165], v14 offset:12288
  v_mfma_f32_16x16x32_bf16 v[108:111], v[188:191], a[44:47], v[108:111]
  ds_read_b64_tr_b16 v[166:167], v14 offset:12800
  v_mfma_f32_16x16x32_bf16 v[112:115], v[176:179], a[116:119], v[112:115]
  ds_read_b64_tr_b16 v[168:169], v15 offset:12288
  v_mfma_f32_16x16x32_bf16 v[116:119], v[180:183], a[116:119], v[116:119]
  ds_read_b64_tr_b16 v[170:171], v15 offset:12800
  v_mfma_f32_16x16x32_bf16 v[120:123], v[184:187], a[116:119], v[120:123]
  ds_read_b64_tr_b16 v[172:173], v6 offset:12288
  v_mfma_f32_16x16x32_bf16 v[124:127], v[188:191], a[116:119], v[124:127]
  ds_read_b64_tr_b16 v[174:175], v6 offset:12800
  v_mfma_f32_16x16x32_bf16 v[128:131], v[176:179], a[188:191], v[128:131]
  v_mfma_f32_16x16x32_bf16 v[132:135], v[180:183], a[188:191], v[132:135]
  v_mfma_f32_16x16x32_bf16 v[136:139], v[184:187], a[188:191], v[136:139]
  s_add_u32 m0, s34, 45056
  s_lshl_b32 s30, s17, 16
  s_add_u32 s30, s30, 2883584
  s_add_u32 s30, s30, s29
  buffer_load_dwordx4 v12, s[76:79], s30 offen lds
  v_mfma_f32_16x16x32_bf16 v[140:143], v[188:191], a[188:191], v[140:143]
  v_mfma_f32_16x16x32_bf16 v[144:147], v[176:179], v[228:231], v[144:147]
  v_mfma_f32_16x16x32_bf16 v[148:151], v[180:183], v[228:231], v[148:151]
  v_mfma_f32_16x16x32_bf16 v[152:155], v[184:187], v[228:231], v[152:155]
  v_mfma_f32_16x16x32_bf16 v[156:159], v[188:191], v[228:231], v[156:159]
  s_waitcnt lgkmcnt(0)
  v_mfma_f32_16x16x32_bf16 v[96:99], v[160:163], a[48:51], v[96:99]
  ds_read_b64_tr_b16 v[176:177], v13 offset:16384
  v_mfma_f32_16x16x32_bf16 v[100:103], v[164:167], a[48:51], v[100:103]
  ds_read_b64_tr_b16 v[178:179], v13 offset:16896
  v_mfma_f32_16x16x32_bf16 v[104:107], v[168:171], a[48:51], v[104:107]
  ds_read_b64_tr_b16 v[180:181], v14 offset:16384
  v_mfma_f32_16x16x32_bf16 v[108:111], v[172:175], a[48:51], v[108:111]
  ds_read_b64_tr_b16 v[182:183], v14 offset:16896
  v_mfma_f32_16x16x32_bf16 v[112:115], v[160:163], a[120:123], v[112:115]
  ds_read_b64_tr_b16 v[184:185], v15 offset:16384
  v_mfma_f32_16x16x32_bf16 v[116:119], v[164:167], a[120:123], v[116:119]
  ds_read_b64_tr_b16 v[186:187], v15 offset:16896
  v_mfma_f32_16x16x32_bf16 v[120:123], v[168:171], a[120:123], v[120:123]
  ds_read_b64_tr_b16 v[188:189], v6 offset:16384
  v_mfma_f32_16x16x32_bf16 v[124:127], v[172:175], a[120:123], v[124:127]
  ds_read_b64_tr_b16 v[190:191], v6 offset:16896
  v_mfma_f32_16x16x32_bf16 v[128:131], v[160:163], a[192:195], v[128:131]
  v_mfma_f32_16x16x32_bf16 v[132:135], v[164:167], a[192:195], v[132:135]
  v_mfma_f32_16x16x32_bf16 v[136:139], v[168:171], a[192:195], v[136:139]
  s_add_u32 m0, s34, 49152
  s_lshl_b32 s30, s17, 16
  s_add_u32 s30, s30, 3145728
  s_add_u32 s30, s30, s29
  buffer_load_dwordx4 v12, s[76:79], s30 offen lds
  v_mfma_f32_16x16x32_bf16 v[140:143], v[172:175], a[192:195], v[140:143]
  v_mfma_f32_16x16x32_bf16 v[144:147], v[160:163], v[232:235], v[144:147]
  v_mfma_f32_16x16x32_bf16 v[148:151], v[164:167], v[232:235], v[148:151]
  v_mfma_f32_16x16x32_bf16 v[152:155], v[168:171], v[232:235], v[152:155]
  v_mfma_f32_16x16x32_bf16 v[156:159], v[172:175], v[232:235], v[156:159]
  s_waitcnt lgkmcnt(0)
  v_mfma_f32_16x16x32_bf16 v[96:99], v[176:179], a[52:55], v[96:99]
  ds_read_b64_tr_b16 v[160:161], v13 offset:20480
  v_mfma_f32_16x16x32_bf16 v[100:103], v[180:183], a[52:55], v[100:103]
  ds_read_b64_tr_b16 v[162:163], v13 offset:20992
  v_mfma_f32_16x16x32_bf16 v[104:107], v[184:187], a[52:55], v[104:107]
  ds_read_b64_tr_b16 v[164:165], v14 offset:20480
  v_mfma_f32_16x16x32_bf16 v[108:111], v[188:191], a[52:55], v[108:111]
  ds_read_b64_tr_b16 v[166:167], v14 offset:20992
  v_mfma_f32_16x16x32_bf16 v[112:115], v[176:179], a[124:127], v[112:115]
  ds_read_b64_tr_b16 v[168:169], v15 offset:20480
  v_mfma_f32_16x16x32_bf16 v[116:119], v[180:183], a[124:127], v[116:119]
  ds_read_b64_tr_b16 v[170:171], v15 offset:20992
  v_mfma_f32_16x16x32_bf16 v[120:123], v[184:187], a[124:127], v[120:123]
  ds_read_b64_tr_b16 v[172:173], v6 offset:20480
  v_mfma_f32_16x16x32_bf16 v[124:127], v[188:191], a[124:127], v[124:127]
  ds_read_b64_tr_b16 v[174:175], v6 offset:20992
  v_mfma_f32_16x16x32_bf16 v[128:131], v[176:179], a[196:199], v[128:131]
  v_mfma_f32_16x16x32_bf16 v[132:135], v[180:183], a[196:199], v[132:135]
  v_mfma_f32_16x16x32_bf16 v[136:139], v[184:187], a[196:199], v[136:139]
  s_add_u32 m0, s34, 53248
  s_lshl_b32 s30, s17, 16
  s_add_u32 s30, s30, 3407872
  s_add_u32 s30, s30, s29
  buffer_load_dwordx4 v12, s[76:79], s30 offen lds
  v_mfma_f32_16x16x32_bf16 v[140:143], v[188:191], a[196:199], v[140:143]
  v_mfma_f32_16x16x32_bf16 v[144:147], v[176:179], v[236:239], v[144:147]
  v_mfma_f32_16x16x32_bf16 v[148:151], v[180:183], v[236:239], v[148:151]
  v_mfma_f32_16x16x32_bf16 v[152:155], v[184:187], v[236:239], v[152:155]
  v_mfma_f32_16x16x32_bf16 v[156:159], v[188:191], v[236:239], v[156:159]
  s_waitcnt lgkmcnt(0)
  v_mfma_f32_16x16x32_bf16 v[96:99], v[160:163], a[56:59], v[96:99]
  ds_read_b64_tr_b16 v[176:177], v13 offset:24576
  v_mfma_f32_16x16x32_bf16 v[100:103], v[164:167], a[56:59], v[100:103]
  ds_read_b64_tr_b16 v[178:179], v13 offset:25088
  v_mfma_f32_16x16x32_bf16 v[104:107], v[168:171], a[56:59], v[104:107]
  ds_read_b64_tr_b16 v[180:181], v14 offset:24576
  v_mfma_f32_16x16x32_bf16 v[108:111], v[172:175], a[56:59], v[108:111]
  ds_read_b64_tr_b16 v[182:183], v14 offset:25088
  v_mfma_f32_16x16x32_bf16 v[112:115], v[160:163], a[128:131], v[112:115]
  ds_read_b64_tr_b16 v[184:185], v15 offset:24576
  v_mfma_f32_16x16x32_bf16 v[116:119], v[164:167], a[128:131], v[116:119]
  ds_read_b64_tr_b16 v[186:187], v15 offset:25088
  v_mfma_f32_16x16x32_bf16 v[120:123], v[168:171], a[128:131], v[120:123]
  ds_read_b64_tr_b16 v[188:189], v6 offset:24576
  v_mfma_f32_16x16x32_bf16 v[124:127], v[172:175], a[128:131], v[124:127]
  ds_read_b64_tr_b16 v[190:191], v6 offset:25088
  v_mfma_f32_16x16x32_bf16 v[128:131], v[160:163], a[200:203], v[128:131]
  v_mfma_f32_16x16x32_bf16 v[132:135], v[164:167], a[200:203], v[132:135]
  v_mfma_f32_16x16x32_bf16 v[136:139], v[168:171], a[200:203], v[136:139]
  s_add_u32 m0, s34, 57344
  s_lshl_b32 s30, s17, 16
  s_add_u32 s30, s30, 3670016
  s_add_u32 s30, s30, s29
  buffer_load_dwordx4 v12, s[76:79], s30 offen lds
  v_mfma_f32_16x16x32_bf16 v[140:143], v[172:175], a[200:203], v[140:143]
  v_mfma_f32_16x16x32_bf16 v[144:147], v[160:163], v[240:243], v[144:147]
  v_mfma_f32_16x16x32_bf16 v[148:151], v[164:167], v[240:243], v[148:151]
  v_mfma_f32_16x16x32_bf16 v[152:155], v[168:171], v[240:243], v[152:155]
  v_mfma_f32_16x16x32_bf16 v[156:159], v[172:175], v[240:243], v[156:159]
  s_waitcnt lgkmcnt(0)
  v_mfma_f32_16x16x32_bf16 v[96:99], v[176:179], a[60:63], v[96:99]
  ds_read_b64_tr_b16 v[160:161], v13 offset:28672
  v_mfma_f32_16x16x32_bf16 v[100:103], v[180:183], a[60:63], v[100:103]
  ds_read_b64_tr_b16 v[162:163], v13 offset:29184
  v_mfma_f32_16x16x32_bf16 v[104:107], v[184:187], a[60:63], v[104:107]
  ds_read_b64_tr_b16 v[164:165], v14 offset:28672
  v_mfma_f32_16x16x32_bf16 v[108:111], v[188:191], a[60:63], v[108:111]
  ds_read_b64_tr_b16 v[166:167], v14 offset:29184
  v_mfma_f32_16x16x32_bf16 v[112:115], v[176:179], a[132:135], v[112:115]
  ds_read_b64_tr_b16 v[168:169], v15 offset:28672
  v_mfma_f32_16x16x32_bf16 v[116:119], v[180:183], a[132:135], v[116:119]
  ds_read_b64_tr_b16 v[170:171], v15 offset:29184
  v_mfma_f32_16x16x32_bf16 v[120:123], v[184:187], a[132:135], v[120:123]
  ds_read_b64_tr_b16 v[172:173], v6 offset:28672
  v_mfma_f32_16x16x32_bf16 v[124:127], v[188:191], a[132:135], v[124:127]
  ds_read_b64_tr_b16 v[174:175], v6 offset:29184
  v_mfma_f32_16x16x32_bf16 v[128:131], v[176:179], a[204:207], v[128:131]
  v_mfma_f32_16x16x32_bf16 v[132:135], v[180:183], a[204:207], v[132:135]
  v_mfma_f32_16x16x32_bf16 v[136:139], v[184:187], a[204:207], v[136:139]
  s_add_u32 m0, s34, 61440
  s_lshl_b32 s30, s17, 16
  s_add_u32 s30, s30, 3932160
  s_add_u32 s30, s30, s29
  buffer_load_dwordx4 v12, s[76:79], s30 offen lds
  v_mfma_f32_16x16x32_bf16 v[140:143], v[188:191], a[204:207], v[140:143]
  v_mfma_f32_16x16x32_bf16 v[144:147], v[176:179], v[244:247], v[144:147]
  v_mfma_f32_16x16x32_bf16 v[148:151], v[180:183], v[244:247], v[148:151]
  v_mfma_f32_16x16x32_bf16 v[152:155], v[184:187], v[244:247], v[152:155]
  v_mfma_f32_16x16x32_bf16 v[156:159], v[188:191], v[244:247], v[156:159]
  s_waitcnt lgkmcnt(0)
  v_mfma_f32_16x16x32_bf16 v[96:99], v[160:163], a[64:67], v[96:99]
  ds_read_b64_tr_b16 v[176:177], v13 offset:32768
  v_mfma_f32_16x16x32_bf16 v[100:103], v[164:167], a[64:67], v[100:103]
  ds_read_b64_tr_b16 v[178:179], v13 offset:33280
  v_mfma_f32_16x16x32_bf16 v[104:107], v[168:171], a[64:67], v[104:107]
  ds_read_b64_tr_b16 v[180:181], v14 offset:32768
  v_mfma_f32_16x16x32_bf16 v[108:111], v[172:175], a[64:67], v[108:111]
  ds_read_b64_tr_b16 v[182:183], v14 offset:33280
  v_mfma_f32_16x16x32_bf16 v[112:115], v[160:163], a[136:139], v[112:115]
  ds_read_b64_tr_b16 v[184:185], v15 offset:32768
  v_mfma_f32_16x16x32_bf16 v[116:119], v[164:167], a[136:139], v[116:119]
  ds_read_b64_tr_b16 v[186:187], v15 offset:33280
  v_mfma_f32_16x16x32_bf16 v[120:123], v[168:171], a[136:139], v[120:123]
  ds_read_b64_tr_b16 v[188:189], v6 offset:32768
  v_mfma_f32_16x16x32_bf16 v[124:127], v[172:175], a[136:139], v[124:127]
  ds_read_b64_tr_b16 v[190:191], v6 offset:33280
  v_mfma_f32_16x16x32_bf16 v[128:131], v[160:163], a[208:211], v[128:131]
  v_mfma_f32_16x16x32_bf16 v[132:135], v[164:167], a[208:211], v[132:135]
  v_mfma_f32_16x16x32_bf16 v[136:139], v[168:171], a[208:211], v[136:139]
  s_add_u32 m0, s34, 65536
  s_lshl_b32 s30, s17, 16
  s_add_u32 s30, s30, 4194304
  s_add_u32 s30, s30, s29
  buffer_load_dwordx4 v12, s[76:79], s30 offen lds
  v_mfma_f32_16x16x32_bf16 v[140:143], v[172:175], a[208:211], v[140:143]
  v_mfma_f32_16x16x32_bf16 v[144:147], v[160:163], v[248:251], v[144:147]
  v_mfma_f32_16x16x32_bf16 v[148:151], v[164:167], v[248:251], v[148:151]
  v_mfma_f32_16x16x32_bf16 v[152:155], v[168:171], v[248:251], v[152:155]
  v_mfma_f32_16x16x32_bf16 v[156:159], v[172:175], v[248:251], v[156:159]
  s_waitcnt lgkmcnt(0)
  v_mfma_f32_16x16x32_bf16 v[96:99], v[176:179], a[68:71], v[96:99]
  v_mfma_f32_16x16x32_bf16 v[100:103], v[180:183], a[68:71], v[100:103]
  v_mfma_f32_16x16x32_bf16 v[104:107], v[184:187], a[68:71], v[104:107]
  v_mfma_f32_16x16x32_bf16 v[108:111], v[188:191], a[68:71], v[108:111]
  v_mfma_f32_16x16x32_bf16 v[112:115], v[176:179], a[140:143], v[112:115]
  v_mfma_f32_16x16x32_bf16 v[116:119], v[180:183], a[140:143], v[116:119]
  v_mfma_f32_16x16x32_bf16 v[120:123], v[184:187], a[140:143], v[120:123]
  v_mfma_f32_16x16x32_bf16 v[124:127], v[188:191], a[140:143], v[124:127]
  v_mfma_f32_16x16x32_bf16 v[128:131], v[176:179], a[212:215], v[128:131]
  v_mfma_f32_16x16x32_bf16 v[132:135], v[180:183], a[212:215], v[132:135]
  v_mfma_f32_16x16x32_bf16 v[136:139], v[184:187], a[212:215], v[136:139]
  s_add_u32 m0, s34, 69632
  s_lshl_b32 s30, s17, 16
  s_add_u32 s30, s30, 4456448
  s_add_u32 s30, s30, s29
  buffer_load_dwordx4 v12, s[76:79], s30 offen lds
  v_mfma_f32_16x16x32_bf16 v[140:143], v[188:191], a[212:215], v[140:143]
  v_mfma_f32_16x16x32_bf16 v[144:147], v[176:179], v[252:255], v[144:147]
  v_mfma_f32_16x16x32_bf16 v[148:151], v[180:183], v[252:255], v[148:151]
  v_mfma_f32_16x16x32_bf16 v[152:155], v[184:187], v[252:255], v[152:155]
  v_mfma_f32_16x16x32_bf16 v[156:159], v[188:191], v[252:255], v[156:159]
  s_nop 7
  v_cvt_pk_bf16_f32 v40, v96, v97
  v_cvt_pk_bf16_f32 v41, v98, v99
  v_cvt_pk_bf16_f32 v42, v100, v101
  v_cvt_pk_bf16_f32 v43, v102, v103
  s_add_u32 s30, s43, 0
  buffer_store_dwordx4 v[40:43], v1, s[4:7], s30 offen sc1
  v_cvt_pk_bf16_f32 v44, v104, v105
  v_cvt_pk_bf16_f32 v45, v106, v107
  v_cvt_pk_bf16_f32 v46, v108, v109
  v_cvt_pk_bf16_f32 v47, v110, v111
  s_add_u32 s30, s43, 2048
  buffer_store_dwordx4 v[44:47], v1, s[4:7], s30 offen sc1
  v_cvt_pk_bf16_f32 v48, v112, v113
  v_cvt_pk_bf16_f32 v49, v114, v115
  v_cvt_pk_bf16_f32 v50, v116, v117
  v_cvt_pk_bf16_f32 v51, v118, v119
  s_add_u32 s30, s43, 1024
  buffer_store_dwordx4 v[48:51], v1, s[4:7], s30 offen sc1
  v_cvt_pk_bf16_f32 v52, v120, v121
  v_cvt_pk_bf16_f32 v53, v122, v123
  v_cvt_pk_bf16_f32 v54, v124, v125
  v_cvt_pk_bf16_f32 v55, v126, v127
  s_add_u32 s30, s43, 3072
  buffer_store_dwordx4 v[52:55], v1, s[4:7], s30 offen sc1
  v_cvt_pk_bf16_f32 v40, v128, v129
  v_cvt_pk_bf16_f32 v41, v130, v131
  v_cvt_pk_bf16_f32 v42, v132, v133
  v_cvt_pk_bf16_f32 v43, v134, v135
  s_add_u32 s30, s43, 262144
  buffer_store_dwordx4 v[40:43], v1, s[4:7], s30 offen sc1
  v_cvt_pk_bf16_f32 v44, v136, v137
  v_cvt_pk_bf16_f32 v45, v138, v139
  v_cvt_pk_bf16_f32 v46, v140, v141
  v_cvt_pk_bf16_f32 v47, v142, v143
  s_add_u32 s30, s43, 264192
  buffer_store_dwordx4 v[44:47], v1, s[4:7], s30 offen sc1
  v_cvt_pk_bf16_f32 v48, v144, v145
  v_cvt_pk_bf16_f32 v49, v146, v147
  v_cvt_pk_bf16_f32 v50, v148, v149
  v_cvt_pk_bf16_f32 v51, v150, v151
  s_add_u32 s30, s43, 263168
  buffer_store_dwordx4 v[48:51], v1, s[4:7], s30 offen sc1
  v_cvt_pk_bf16_f32 v52, v152, v153
  v_cvt_pk_bf16_f32 v53, v154, v155
  v_cvt_pk_bf16_f32 v54, v156, v157
  v_cvt_pk_bf16_f32 v55, v158, v159
  s_add_u32 s30, s43, 265216
  buffer_store_dwordx4 v[52:55], v1, s[4:7], s30 offen sc1
  s_branch L_g_join_71
L_g_isv_70:
  ds_read_b64_tr_b16 v[160:161], v13 offset:0
  ds_read_b64_tr_b16 v[162:163], v13 offset:512
  ds_read_b64_tr_b16 v[164:165], v14 offset:0
  ds_read_b64_tr_b16 v[166:167], v14 offset:512
  ds_read_b64_tr_b16 v[168:169], v15 offset:0
  ds_read_b64_tr_b16 v[170:171], v15 offset:512
  ds_read_b64_tr_b16 v[172:173], v6 offset:0
  ds_read_b64_tr_b16 v[174:175], v6 offset:512
  s_waitcnt lgkmcnt(0)
  v_mfma_f32_16x16x32_bf16 v[96:99], a[0:3], v[160:163], 0
  ds_read_b64_tr_b16 v[176:177], v13 offset:4096
  v_mfma_f32_16x16x32_bf16 v[100:103], a[0:3], v[164:167], 0
  ds_read_b64_tr_b16 v[178:179], v13 offset:4608
  v_mfma_f32_16x16x32_bf16 v[104:107], a[0:3], v[168:171], 0
  ds_read_b64_tr_b16 v[180:181], v14 offset:4096
  v_mfma_f32_16x16x32_bf16 v[108:111], a[0:3], v[172:175], 0
  ds_read_b64_tr_b16 v[182:183], v14 offset:4608
  v_mfma_f32_16x16x32_bf16 v[112:115], a[72:75], v[160:163], 0
  ds_read_b64_tr_b16 v[184:185], v15 offset:4096
  v_mfma_f32_16x16x32_bf16 v[116:119], a[72:75], v[164:167], 0
  ds_read_b64_tr_b16 v[186:187], v15 offset:4608
  v_mfma_f32_16x16x32_bf16 v[120:123], a[72:75], v[168:171], 0
  ds_read_b64_tr_b16 v[188:189], v6 offset:4096
  v_mfma_f32_16x16x32_bf16 v[124:127], a[72:75], v[172:175], 0
  ds_read_b64_tr_b16 v[190:191], v6 offset:4608
  v_mfma_f32_16x16x32_bf16 v[128:131], a[144:147], v[160:163], 0
  v_mfma_f32_16x16x32_bf16 v[132:135], a[144:147], v[164:167], 0
  v_mfma_f32_16x16x32_bf16 v[136:139], a[144:147], v[168:171], 0
  s_add_u32 m0, s34, 0
  s_lshl_b32 s30, s17, 16
  s_add_u32 s30, s30, 0
  s_add_u32 s30, s30, s29
  buffer_load_dwordx4 v12, s[76:79], s30 offen lds
  v_mfma_f32_16x16x32_bf16 v[140:143], a[144:147], v[172:175], 0
  v_mfma_f32_16x16x32_bf16 v[144:147], a[216:219], v[160:163], 0
  v_mfma_f32_16x16x32_bf16 v[148:151], a[216:219], v[164:167], 0
  v_mfma_f32_16x16x32_bf16 v[152:155], a[216:219], v[168:171], 0
  v_mfma_f32_16x16x32_bf16 v[156:159], a[216:219], v[172:175], 0
  s_waitcnt lgkmcnt(0)
  v_mfma_f32_16x16x32_bf16 v[96:99], a[4:7], v[176:179], v[96:99]
  ds_read_b64_tr_b16 v[160:161], v13 offset:8192
  v_mfma_f32_16x16x32_bf16 v[100:103], a[4:7], v[180:183], v[100:103]
  ds_read_b64_tr_b16 v[162:163], v13 offset:8704
  v_mfma_f32_16x16x32_bf16 v[104:107], a[4:7], v[184:187], v[104:107]
  ds_read_b64_tr_b16 v[164:165], v14 offset:8192
  v_mfma_f32_16x16x32_bf16 v[108:111], a[4:7], v[188:191], v[108:111]
  ds_read_b64_tr_b16 v[166:167], v14 offset:8704
  v_mfma_f32_16x16x32_bf16 v[112:115], a[76:79], v[176:179], v[112:115]
  ds_read_b64_tr_b16 v[168:169], v15 offset:8192
  v_mfma_f32_16x16x32_bf16 v[116:119], a[76:79], v[180:183], v[116:119]
  ds_read_b64_tr_b16 v[170:171], v15 offset:8704
  v_mfma_f32_16x16x32_bf16 v[120:123], a[76:79], v[184:187], v[120:123]
  ds_read_b64_tr_b16 v[172:173], v6 offset:8192
  v_mfma_f32_16x16x32_bf16 v[124:127], a[76:79], v[188:191], v[124:127]
  ds_read_b64_tr_b16 v[174:175], v6 offset:8704
  v_mfma_f32_16x16x32_bf16 v[128:131], a[148:151], v[176:179], v[128:131]
  v_mfma_f32_16x16x32_bf16 v[132:135], a[148:151], v[180:183], v[132:135]
  v_mfma_f32_16x16x32_bf16 v[136:139], a[148:151], v[184:187], v[136:139]
  s_add_u32 m0, s34, 4096
  s_lshl_b32 s30, s17, 16
  s_add_u32 s30, s30, 262144
  s_add_u32 s30, s30, s29
  buffer_load_dwordx4 v12, s[76:79], s30 offen lds
  v_mfma_f32_16x16x32_bf16 v[140:143], a[148:151], v[188:191], v[140:143]
  v_mfma_f32_16x16x32_bf16 v[144:147], a[220:223], v[176:179], v[144:147]
  v_mfma_f32_16x16x32_bf16 v[148:151], a[220:223], v[180:183], v[148:151]
  v_mfma_f32_16x16x32_bf16 v[152:155], a[220:223], v[184:187], v[152:155]
  v_mfma_f32_16x16x32_bf16 v[156:159], a[220:223], v[188:191], v[156:159]
  s_waitcnt lgkmcnt(0)
  v_mfma_f32_16x16x32_bf16 v[96:99], a[8:11], v[160:163], v[96:99]
  ds_read_b64_tr_b16 v[176:177], v13 offset:12288
  v_mfma_f32_16x16x32_bf16 v[100:103], a[8:11], v[164:167], v[100:103]
  ds_read_b64_tr_b16 v[178:179], v13 offset:12800
  v_mfma_f32_16x16x32_bf16 v[104:107], a[8:11], v[168:171], v[104:107]
  ds_read_b64_tr_b16 v[180:181], v14 offset:12288
  v_mfma_f32_16x16x32_bf16 v[108:111], a[8:11], v[172:175], v[108:111]
  ds_read_b64_tr_b16 v[182:183], v14 offset:12800
  v_mfma_f32_16x16x32_bf16 v[112:115], a[80:83], v[160:163], v[112:115]
  ds_read_b64_tr_b16 v[184:185], v15 offset:12288
  v_mfma_f32_16x16x32_bf16 v[116:119], a[80:83], v[164:167], v[116:119]
  ds_read_b64_tr_b16 v[186:187], v15 offset:12800
  v_mfma_f32_16x16x32_bf16 v[120:123], a[80:83], v[168:171], v[120:123]
  ds_read_b64_tr_b16 v[188:189], v6 offset:12288
  v_mfma_f32_16x16x32_bf16 v[124:127], a[80:83], v[172:175], v[124:127]
  ds_read_b64_tr_b16 v[190:191], v6 offset:12800
  v_mfma_f32_16x16x32_bf16 v[128:131], a[152:155], v[160:163], v[128:131]
  v_mfma_f32_16x16x32_bf16 v[132:135], a[152:155], v[164:167], v[132:135]
  v_mfma_f32_16x16x32_bf16 v[136:139], a[152:155], v[168:171], v[136:139]
  s_add_u32 m0, s34, 8192
  s_lshl_b32 s30, s17, 16
  s_add_u32 s30, s30, 524288
  s_add_u32 s30, s30, s29
  buffer_load_dwordx4 v12, s[76:79], s30 offen lds
  v_mfma_f32_16x16x32_bf16 v[140:143], a[152:155], v[172:175], v[140:143]
  v_mfma_f32_16x16x32_bf16 v[144:147], a[224:227], v[160:163], v[144:147]
  v_mfma_f32_16x16x32_bf16 v[148:151], a[224:227], v[164:167], v[148:151]
  v_mfma_f32_16x16x32_bf16 v[152:155], a[224:227], v[168:171], v[152:155]
  v_mfma_f32_16x16x32_bf16 v[156:159], a[224:227], v[172:175], v[156:159]
  s_waitcnt lgkmcnt(0)
  v_mfma_f32_16x16x32_bf16 v[96:99], a[12:15], v[176:179], v[96:99]
  ds_read_b64_tr_b16 v[160:161], v13 offset:16384
  v_mfma_f32_16x16x32_bf16 v[100:103], a[12:15], v[180:183], v[100:103]
  ds_read_b64_tr_b16 v[162:163], v13 offset:16896
  v_mfma_f32_16x16x32_bf16 v[104:107], a[12:15], v[184:187], v[104:107]
  ds_read_b64_tr_b16 v[164:165], v14 offset:16384
  v_mfma_f32_16x16x32_bf16 v[108:111], a[12:15], v[188:191], v[108:111]
  ds_read_b64_tr_b16 v[166:167], v14 offset:16896
  v_mfma_f32_16x16x32_bf16 v[112:115], a[84:87], v[176:179], v[112:115]
  ds_read_b64_tr_b16 v[168:169], v15 offset:16384
  v_mfma_f32_16x16x32_bf16 v[116:119], a[84:87], v[180:183], v[116:119]
  ds_read_b64_tr_b16 v[170:171], v15 offset:16896
  v_mfma_f32_16x16x32_bf16 v[120:123], a[84:87], v[184:187], v[120:123]
  ds_read_b64_tr_b16 v[172:173], v6 offset:16384
  v_mfma_f32_16x16x32_bf16 v[124:127], a[84:87], v[188:191], v[124:127]
  ds_read_b64_tr_b16 v[174:175], v6 offset:16896
  v_mfma_f32_16x16x32_bf16 v[128:131], a[156:159], v[176:179], v[128:131]
  v_mfma_f32_16x16x32_bf16 v[132:135], a[156:159], v[180:183], v[132:135]
  v_mfma_f32_16x16x32_bf16 v[136:139], a[156:159], v[184:187], v[136:139]
  s_add_u32 m0, s34, 12288
  s_lshl_b32 s30, s17, 16
  s_add_u32 s30, s30, 786432
  s_add_u32 s30, s30, s29
  buffer_load_dwordx4 v12, s[76:79], s30 offen lds
  v_mfma_f32_16x16x32_bf16 v[140:143], a[156:159], v[188:191], v[140:143]
  v_mfma_f32_16x16x32_bf16 v[144:147], a[228:231], v[176:179], v[144:147]
  v_mfma_f32_16x16x32_bf16 v[148:151], a[228:231], v[180:183], v[148:151]
  v_mfma_f32_16x16x32_bf16 v[152:155], a[228:231], v[184:187], v[152:155]
  v_mfma_f32_16x16x32_bf16 v[156:159], a[228:231], v[188:191], v[156:159]
  s_waitcnt lgkmcnt(0)
  v_mfma_f32_16x16x32_bf16 v[96:99], a[16:19], v[160:163], v[96:99]
  ds_read_b64_tr_b16 v[176:177], v13 offset:20480
  v_mfma_f32_16x16x32_bf16 v[100:103], a[16:19], v[164:167], v[100:103]
  ds_read_b64_tr_b16 v[178:179], v13 offset:20992
  v_mfma_f32_16x16x32_bf16 v[104:107], a[16:19], v[168:171], v[104:107]
  ds_read_b64_tr_b16 v[180:181], v14 offset:20480
  v_mfma_f32_16x16x32_bf16 v[108:111], a[16:19], v[172:175], v[108:111]
  ds_read_b64_tr_b16 v[182:183], v14 offset:20992
  v_mfma_f32_16x16x32_bf16 v[112:115], a[88:91], v[160:163], v[112:115]
  ds_read_b64_tr_b16 v[184:185], v15 offset:20480
  v_mfma_f32_16x16x32_bf16 v[116:119], a[88:91], v[164:167], v[116:119]
  ds_read_b64_tr_b16 v[186:187], v15 offset:20992
  v_mfma_f32_16x16x32_bf16 v[120:123], a[88:91], v[168:171], v[120:123]
  ds_read_b64_tr_b16 v[188:189], v6 offset:20480
  v_mfma_f32_16x16x32_bf16 v[124:127], a[88:91], v[172:175], v[124:127]
  ds_read_b64_tr_b16 v[190:191], v6 offset:20992
  v_mfma_f32_16x16x32_bf16 v[128:131], a[160:163], v[160:163], v[128:131]
  v_mfma_f32_16x16x32_bf16 v[132:135], a[160:163], v[164:167], v[132:135]
  v_mfma_f32_16x16x32_bf16 v[136:139], a[160:163], v[168:171], v[136:139]
  s_add_u32 m0, s34, 16384
  s_lshl_b32 s30, s17, 16
  s_add_u32 s30, s30, 1048576
  s_add_u32 s30, s30, s29
  buffer_load_dwordx4 v12, s[76:79], s30 offen lds
  v_mfma_f32_16x16x32_bf16 v[140:143], a[160:163], v[172:175], v[140:143]
  v_mfma_f32_16x16x32_bf16 v[144:147], a[232:235], v[160:163], v[144:147]
  v_mfma_f32_16x16x32_bf16 v[148:151], a[232:235], v[164:167], v[148:151]
  v_mfma_f32_16x16x32_bf16 v[152:155], a[232:235], v[168:171], v[152:155]
  v_mfma_f32_16x16x32_bf16 v[156:159], a[232:235], v[172:175], v[156:159]
  s_waitcnt lgkmcnt(0)
  v_mfma_f32_16x16x32_bf16 v[96:99], a[20:23], v[176:179], v[96:99]
  ds_read_b64_tr_b16 v[160:161], v13 offset:24576
  v_mfma_f32_16x16x32_bf16 v[100:103], a[20:23], v[180:183], v[100:103]
  ds_read_b64_tr_b16 v[162:163], v13 offset:25088
  v_mfma_f32_16x16x32_bf16 v[104:107], a[20:23], v[184:187], v[104:107]
  ds_read_b64_tr_b16 v[164:165], v14 offset:24576
  v_mfma_f32_16x16x32_bf16 v[108:111], a[20:23], v[188:191], v[108:111]
  ds_read_b64_tr_b16 v[166:167], v14 offset:25088
  v_mfma_f32_16x16x32_bf16 v[112:115], a[92:95], v[176:179], v[112:115]
  ds_read_b64_tr_b16 v[168:169], v15 offset:24576
  v_mfma_f32_16x16x32_bf16 v[116:119], a[92:95], v[180:183], v[116:119]
  ds_read_b64_tr_b16 v[170:171], v15 offset:25088
  v_mfma_f32_16x16x32_bf16 v[120:123], a[92:95], v[184:187], v[120:123]
  ds_read_b64_tr_b16 v[172:173], v6 offset:24576
  v_mfma_f32_16x16x32_bf16 v[124:127], a[92:95], v[188:191], v[124:127]
  ds_read_b64_tr_b16 v[174:175], v6 offset:25088
  v_mfma_f32_16x16x32_bf16 v[128:131], a[164:167], v[176:179], v[128:131]
  v_mfma_f32_16x16x32_bf16 v[132:135], a[164:167], v[180:183], v[132:135]
  v_mfma_f32_16x16x32_bf16 v[136:139], a[164:167], v[184:187], v[136:139]
  s_add_u32 m0, s34, 20480
  s_lshl_b32 s30, s17, 16
  s_add_u32 s30, s30, 1310720
  s_add_u32 s30, s30, s29
  buffer_load_dwordx4 v12, s[76:79], s30 offen lds
  v_mfma_f32_16x16x32_bf16 v[140:143], a[164:167], v[188:191], v[140:143]
  v_mfma_f32_16x16x32_bf16 v[144:147], a[236:239], v[176:179], v[144:147]
  v_mfma_f32_16x16x32_bf16 v[148:151], a[236:239], v[180:183], v[148:151]
  v_mfma_f32_16x16x32_bf16 v[152:155], a[236:239], v[184:187], v[152:155]
  v_mfma_f32_16x16x32_bf16 v[156:159], a[236:239], v[188:191], v[156:159]
  s_waitcnt lgkmcnt(0)
  v_mfma_f32_16x16x32_bf16 v[96:99], a[24:27], v[160:163], v[96:99]
  ds_read_b64_tr_b16 v[176:177], v13 offset:28672
  v_mfma_f32_16x16x32_bf16 v[100:103], a[24:27], v[164:167], v[100:103]
  ds_read_b64_tr_b16 v[178:179], v13 offset:29184
  v_mfma_f32_16x16x32_bf16 v[104:107], a[24:27], v[168:171], v[104:107]
  ds_read_b64_tr_b16 v[180:181], v14 offset:28672
  v_mfma_f32_16x16x32_bf16 v[108:111], a[24:27], v[172:175], v[108:111]
  ds_read_b64_tr_b16 v[182:183], v14 offset:29184
  v_mfma_f32_16x16x32_bf16 v[112:115], a[96:99], v[160:163], v[112:115]
  ds_read_b64_tr_b16 v[184:185], v15 offset:28672
  v_mfma_f32_16x16x32_bf16 v[116:119], a[96:99], v[164:167], v[116:119]
  ds_read_b64_tr_b16 v[186:187], v15 offset:29184
  v_mfma_f32_16x16x32_bf16 v[120:123], a[96:99], v[168:171], v[120:123]
  ds_read_b64_tr_b16 v[188:189], v6 offset:28672
  v_mfma_f32_16x16x32_bf16 v[124:127], a[96:99], v[172:175], v[124:127]
  ds_read_b64_tr_b16 v[190:191], v6 offset:29184
  v_mfma_f32_16x16x32_bf16 v[128:131], a[168:171], v[160:163], v[128:131]
  v_mfma_f32_16x16x32_bf16 v[132:135], a[168:171], v[164:167], v[132:135]
  v_mfma_f32_16x16x32_bf16 v[136:139], a[168:171], v[168:171], v[136:139]
  s_add_u32 m0, s34, 24576
  s_lshl_b32 s30, s17, 16
  s_add_u32 s30, s30, 1572864
  s_add_u32 s30, s30, s29
  buffer_load_dwordx4 v12, s[76:79], s30 offen lds
  v_mfma_f32_16x16x32_bf16 v[140:143], a[168:171], v[172:175], v[140:143]
  v_mfma_f32_16x16x32_bf16 v[144:147], a[240:243], v[160:163], v[144:147]
  v_mfma_f32_16x16x32_bf16 v[148:151], a[240:243], v[164:167], v[148:151]
  v_mfma_f32_16x16x32_bf16 v[152:155], a[240:243], v[168:171], v[152:155]
  v_mfma_f32_16x16x32_bf16 v[156:159], a[240:243], v[172:175], v[156:159]
  s_waitcnt lgkmcnt(0)
  v_mfma_f32_16x16x32_bf16 v[96:99], a[28:31], v[176:179], v[96:99]
  ds_read_b64_tr_b16 v[160:161], v13 offset:32768
  v_mfma_f32_16x16x32_bf16 v[100:103], a[28:31], v[180:183], v[100:103]
  ds_read_b64_tr_b16 v[162:163], v13 offset:33280
  v_mfma_f32_16x16x32_bf16 v[104:107], a[28:31], v[184:187], v[104:107]
  ds_read_b64_tr_b16 v[164:165], v14 offset:32768
  v_mfma_f32_16x16x32_bf16 v[108:111], a[28:31], v[188:191], v[108:111]
  ds_read_b64_tr_b16 v[166:167], v14 offset:33280
  v_mfma_f32_16x16x32_bf16 v[112:115], a[100:103], v[176:179], v[112:115]
  ds_read_b64_tr_b16 v[168:169], v15 offset:32768
  v_mfma_f32_16x16x32_bf16 v[116:119], a[100:103], v[180:183], v[116:119]
  ds_read_b64_tr_b16 v[170:171], v15 offset:33280
  v_mfma_f32_16x16x32_bf16 v[120:123], a[100:103], v[184:187], v[120:123]
  ds_read_b64_tr_b16 v[172:173], v6 offset:32768
  v_mfma_f32_16x16x32_bf16 v[124:127], a[100:103], v[188:191], v[124:127]
  ds_read_b64_tr_b16 v[174:175], v6 offset:33280
  v_mfma_f32_16x16x32_bf16 v[128:131], a[172:175], v[176:179], v[128:131]
  v_mfma_f32_16x16x32_bf16 v[132:135], a[172:175], v[180:183], v[132:135]
  v_mfma_f32_16x16x32_bf16 v[136:139], a[172:175], v[184:187], v[136:139]
  s_add_u32 m0, s34, 28672
  s_lshl_b32 s30, s17, 16
  s_add_u32 s30, s30, 1835008
  s_add_u32 s30, s30, s29
  buffer_load_dwordx4 v12, s[76:79], s30 offen lds
  v_mfma_f32_16x16x32_bf16 v[140:143], a[172:175], v[188:191], v[140:143]
  v_mfma_f32_16x16x32_bf16 v[144:147], a[244:247], v[176:179], v[144:147]
  v_mfma_f32_16x16x32_bf16 v[148:151], a[244:247], v[180:183], v[148:151]
  v_mfma_f32_16x16x32_bf16 v[152:155], a[244:247], v[184:187], v[152:155]
  v_mfma_f32_16x16x32_bf16 v[156:159], a[244:247], v[188:191], v[156:159]
  s_waitcnt lgkmcnt(0)
  v_add_u32 v13, 36864, v13
  v_add_u32 v14, 36864, v14
  v_add_u32 v15, 36864, v15
  v_add_u32 v6, 36864, v6
  v_mfma_f32_16x16x32_bf16 v[96:99], a[32:35], v[160:163], v[96:99]
  ds_read_b64_tr_b16 v[176:177], v13 offset:0
  v_mfma_f32_16x16x32_bf16 v[100:103], a[32:35], v[164:167], v[100:103]
  ds_read_b64_tr_b16 v[178:179], v13 offset:512
  v_mfma_f32_16x16x32_bf16 v[104:107], a[32:35], v[168:171], v[104:107]
  ds_read_b64_tr_b16 v[180:181], v14 offset:0
  v_mfma_f32_16x16x32_bf16 v[108:111], a[32:35], v[172:175], v[108:111]
  ds_read_b64_tr_b16 v[182:183], v14 offset:512
  v_mfma_f32_16x16x32_bf16 v[112:115], a[104:107], v[160:163], v[112:115]
  ds_read_b64_tr_b16 v[184:185], v15 offset:0
  v_mfma_f32_16x16x32_bf16 v[116:119], a[104:107], v[164:167], v[116:119]
  ds_read_b64_tr_b16 v[186:187], v15 offset:512
  v_mfma_f32_16x16x32_bf16 v[120:123], a[104:107], v[168:171], v[120:123]
  ds_read_b64_tr_b16 v[188:189], v6 offset:0
  v_mfma_f32_16x16x32_bf16 v[124:127], a[104:107], v[172:175], v[124:127]
  ds_read_b64_tr_b16 v[190:191], v6 offset:512
  v_mfma_f32_16x16x32_bf16 v[128:131], a[176:179], v[160:163], v[128:131]
  v_mfma_f32_16x16x32_bf16 v[132:135], a[176:179], v[164:167], v[132:135]
  v_mfma_f32_16x16x32_bf16 v[136:139], a[176:179], v[168:171], v[136:139]
  s_add_u32 m0, s34, 32768
  s_lshl_b32 s30, s17, 16
  s_add_u32 s30, s30, 2097152
  s_add_u32 s30, s30, s29
  buffer_load_dwordx4 v12, s[76:79], s30 offen lds
  v_mfma_f32_16x16x32_bf16 v[140:143], a[176:179], v[172:175], v[140:143]
  v_mfma_f32_16x16x32_bf16 v[144:147], a[248:251], v[160:163], v[144:147]
  v_mfma_f32_16x16x32_bf16 v[148:151], a[248:251], v[164:167], v[148:151]
  v_mfma_f32_16x16x32_bf16 v[152:155], a[248:251], v[168:171], v[152:155]
  v_mfma_f32_16x16x32_bf16 v[156:159], a[248:251], v[172:175], v[156:159]
  s_waitcnt lgkmcnt(0)
  v_mfma_f32_16x16x32_bf16 v[96:99], a[36:39], v[176:179], v[96:99]
  ds_read_b64_tr_b16 v[160:161], v13 offset:4096
  v_mfma_f32_16x16x32_bf16 v[100:103], a[36:39], v[180:183], v[100:103]
  ds_read_b64_tr_b16 v[162:163], v13 offset:4608
  v_mfma_f32_16x16x32_bf16 v[104:107], a[36:39], v[184:187], v[104:107]
  ds_read_b64_tr_b16 v[164:165], v14 offset:4096
  v_mfma_f32_16x16x32_bf16 v[108:111], a[36:39], v[188:191], v[108:111]
  ds_read_b64_tr_b16 v[166:167], v14 offset:4608
  v_mfma_f32_16x16x32_bf16 v[112:115], a[108:111], v[176:179], v[112:115]
  ds_read_b64_tr_b16 v[168:169], v15 offset:4096
  v_mfma_f32_16x16x32_bf16 v[116:119], a[108:111], v[180:183], v[116:119]
  ds_read_b64_tr_b16 v[170:171], v15 offset:4608
  v_mfma_f32_16x16x32_bf16 v[120:123], a[108:111], v[184:187], v[120:123]
  ds_read_b64_tr_b16 v[172:173], v6 offset:4096
  v_mfma_f32_16x16x32_bf16 v[124:127], a[108:111], v[188:191], v[124:127]
  ds_read_b64_tr_b16 v[174:175], v6 offset:4608
  v_mfma_f32_16x16x32_bf16 v[128:131], a[180:183], v[176:179], v[128:131]
  v_mfma_f32_16x16x32_bf16 v[132:135], a[180:183], v[180:183], v[132:135]
  v_mfma_f32_16x16x32_bf16 v[136:139], a[180:183], v[184:187], v[136:139]
  s_add_u32 m0, s34, 36864
  s_lshl_b32 s30, s17, 16
  s_add_u32 s30, s30, 2359296
  s_add_u32 s30, s30, s29
  buffer_load_dwordx4 v12, s[76:79], s30 offen lds
  v_mfma_f32_16x16x32_bf16 v[140:143], a[180:183], v[188:191], v[140:143]
  v_mfma_f32_16x16x32_bf16 v[144:147], a[252:255], v[176:179], v[144:147]
  v_mfma_f32_16x16x32_bf16 v[148:151], a[252:255], v[180:183], v[148:151]
  v_mfma_f32_16x16x32_bf16 v[152:155], a[252:255], v[184:187], v[152:155]
  v_mfma_f32_16x16x32_bf16 v[156:159], a[252:255], v[188:191], v[156:159]
  s_waitcnt lgkmcnt(0)
  v_mfma_f32_16x16x32_bf16 v[96:99], a[40:43], v[160:163], v[96:99]
  ds_read_b64_tr_b16 v[176:177], v13 offset:8192
  v_mfma_f32_16x16x32_bf16 v[100:103], a[40:43], v[164:167], v[100:103]
  ds_read_b64_tr_b16 v[178:179], v13 offset:8704
  v_mfma_f32_16x16x32_bf16 v[104:107], a[40:43], v[168:171], v[104:107]
  ds_read_b64_tr_b16 v[180:181], v14 offset:8192
  v_mfma_f32_16x16x32_bf16 v[108:111], a[40:43], v[172:175], v[108:111]
  ds_read_b64_tr_b16 v[182:183], v14 offset:8704
  v_mfma_f32_16x16x32_bf16 v[112:115], a[112:115], v[160:163], v[112:115]
  ds_read_b64_tr_b16 v[184:185], v15 offset:8192
  v_mfma_f32_16x16x32_bf16 v[116:119], a[112:115], v[164:167], v[116:119]
  ds_read_b64_tr_b16 v[186:187], v15 offset:8704
  v_mfma_f32_16x16x32_bf16 v[120:123], a[112:115], v[168:171], v[120:123]
  ds_read_b64_tr_b16 v[188:189], v6 offset:8192
  v_mfma_f32_16x16x32_bf16 v[124:127], a[112:115], v[172:175], v[124:127]
  ds_read_b64_tr_b16 v[190:191], v6 offset:8704
  v_mfma_f32_16x16x32_bf16 v[128:131], a[184:187], v[160:163], v[128:131]
  v_mfma_f32_16x16x32_bf16 v[132:135], a[184:187], v[164:167], v[132:135]
  v_mfma_f32_16x16x32_bf16 v[136:139], a[184:187], v[168:171], v[136:139]
  s_add_u32 m0, s34, 40960
  s_lshl_b32 s30, s17, 16
  s_add_u32 s30, s30, 2621440
  s_add_u32 s30, s30, s29
  buffer_load_dwordx4 v12, s[76:79], s30 offen lds
  v_mfma_f32_16x16x32_bf16 v[140:143], a[184:187], v[172:175], v[140:143]
  v_mfma_f32_16x16x32_bf16 v[144:147], v[224:227], v[160:163], v[144:147]
  v_mfma_f32_16x16x32_bf16 v[148:151], v[224:227], v[164:167], v[148:151]
  v_mfma_f32_16x16x32_bf16 v[152:155], v[224:227], v[168:171], v[152:155]
  v_mfma_f32_16x16x32_bf16 v[156:159], v[224:227], v[172:175], v[156:159]
  s_waitcnt lgkmcnt(0)
  v_mfma_f32_16x16x32_bf16 v[96:99], a[44:47], v[176:179], v[96:99]
  ds_read_b64_tr_b16 v[160:161], v13 offset:12288
  v_mfma_f32_16x16x32_bf16 v[100:103], a[44:47], v[180:183], v[100:103]
  ds_read_b64_tr_b16 v[162:163], v13 offset:12800
  v_mfma_f32_16x16x32_bf16 v[104:107], a[44:47], v[184:187], v[104:107]
  ds_read_b64_tr_b16 v[164:165], v14 offset:12288
  v_mfma_f32_16x16x32_bf16 v[108:111], a[44:47], v[188:191], v[108:111]
  ds_read_b64_tr_b16 v[166:167], v14 offset:12800
  v_mfma_f32_16x16x32_bf16 v[112:115], a[116:119], v[176:179], v[112:115]
  ds_read_b64_tr_b16 v[168:169], v15 offset:12288
  v_mfma_f32_16x16x32_bf16 v[116:119], a[116:119], v[180:183], v[116:119]
  ds_read_b64_tr_b16 v[170:171], v15 offset:12800
  v_mfma_f32_16x16x32_bf16 v[120:123], a[116:119], v[184:187], v[120:123]
  ds_read_b64_tr_b16 v[172:173], v6 offset:12288
  v_mfma_f32_16x16x32_bf16 v[124:127], a[116:119], v[188:191], v[124:127]
  ds_read_b64_tr_b16 v[174:175], v6 offset:12800
  v_mfma_f32_16x16x32_bf16 v[128:131], a[188:191], v[176:179], v[128:131]
  v_mfma_f32_16x16x32_bf16 v[132:135], a[188:191], v[180:183], v[132:135]
  v_mfma_f32_16x16x32_bf16 v[136:139], a[188:191], v[184:187], v[136:139]
  s_add_u32 m0, s34, 45056
  s_lshl_b32 s30, s17, 16
  s_add_u32 s30, s30, 2883584
  s_add_u32 s30, s30, s29
  buffer_load_dwordx4 v12, s[76:79], s30 offen lds
  v_mfma_f32_16x16x32_bf16 v[140:143], a[188:191], v[188:191], v[140:143]
  v_mfma_f32_16x16x32_bf16 v[144:147], v[228:231], v[176:179], v[144:147]
  v_mfma_f32_16x16x32_bf16 v[148:151], v[228:231], v[180:183], v[148:151]
  v_mfma_f32_16x16x32_bf16 v[152:155], v[228:231], v[184:187], v[152:155]
  v_mfma_f32_16x16x32_bf16 v[156:159], v[228:231], v[188:191], v[156:159]
  s_waitcnt lgkmcnt(0)
  v_mfma_f32_16x16x32_bf16 v[96:99], a[48:51], v[160:163], v[96:99]
  ds_read_b64_tr_b16 v[176:177], v13 offset:16384
  v_mfma_f32_16x16x32_bf16 v[100:103], a[48:51], v[164:167], v[100:103]
  ds_read_b64_tr_b16 v[178:179], v13 offset:16896
  v_mfma_f32_16x16x32_bf16 v[104:107], a[48:51], v[168:171], v[104:107]
  ds_read_b64_tr_b16 v[180:181], v14 offset:16384
  v_mfma_f32_16x16x32_bf16 v[108:111], a[48:51], v[172:175], v[108:111]
  ds_read_b64_tr_b16 v[182:183], v14 offset:16896
  v_mfma_f32_16x16x32_bf16 v[112:115], a[120:123], v[160:163], v[112:115]
  ds_read_b64_tr_b16 v[184:185], v15 offset:16384
  v_mfma_f32_16x16x32_bf16 v[116:119], a[120:123], v[164:167], v[116:119]
  ds_read_b64_tr_b16 v[186:187], v15 offset:16896
  v_mfma_f32_16x16x32_bf16 v[120:123], a[120:123], v[168:171], v[120:123]
  ds_read_b64_tr_b16 v[188:189], v6 offset:16384
  v_mfma_f32_16x16x32_bf16 v[124:127], a[120:123], v[172:175], v[124:127]
  ds_read_b64_tr_b16 v[190:191], v6 offset:16896
  v_mfma_f32_16x16x32_bf16 v[128:131], a[192:195], v[160:163], v[128:131]
  v_mfma_f32_16x16x32_bf16 v[132:135], a[192:195], v[164:167], v[132:135]
  v_mfma_f32_16x16x32_bf16 v[136:139], a[192:195], v[168:171], v[136:139]
  s_add_u32 m0, s34, 49152
  s_lshl_b32 s30, s17, 16
  s_add_u32 s30, s30, 3145728
  s_add_u32 s30, s30, s29
  buffer_load_dwordx4 v12, s[76:79], s30 offen lds
  v_mfma_f32_16x16x32_bf16 v[140:143], a[192:195], v[172:175], v[140:143]
  v_mfma_f32_16x16x32_bf16 v[144:147], v[232:235], v[160:163], v[144:147]
  v_mfma_f32_16x16x32_bf16 v[148:151], v[232:235], v[164:167], v[148:151]
  v_mfma_f32_16x16x32_bf16 v[152:155], v[232:235], v[168:171], v[152:155]
  v_mfma_f32_16x16x32_bf16 v[156:159], v[232:235], v[172:175], v[156:159]
  s_waitcnt lgkmcnt(0)
  v_mfma_f32_16x16x32_bf16 v[96:99], a[52:55], v[176:179], v[96:99]
  ds_read_b64_tr_b16 v[160:161], v13 offset:20480
  v_mfma_f32_16x16x32_bf16 v[100:103], a[52:55], v[180:183], v[100:103]
  ds_read_b64_tr_b16 v[162:163], v13 offset:20992
  v_mfma_f32_16x16x32_bf16 v[104:107], a[52:55], v[184:187], v[104:107]
  ds_read_b64_tr_b16 v[164:165], v14 offset:20480
  v_mfma_f32_16x16x32_bf16 v[108:111], a[52:55], v[188:191], v[108:111]
  ds_read_b64_tr_b16 v[166:167], v14 offset:20992
  v_mfma_f32_16x16x32_bf16 v[112:115], a[124:127], v[176:179], v[112:115]
  ds_read_b64_tr_b16 v[168:169], v15 offset:20480
  v_mfma_f32_16x16x32_bf16 v[116:119], a[124:127], v[180:183], v[116:119]
  ds_read_b64_tr_b16 v[170:171], v15 offset:20992
  v_mfma_f32_16x16x32_bf16 v[120:123], a[124:127], v[184:187], v[120:123]
  ds_read_b64_tr_b16 v[172:173], v6 offset:20480
  v_mfma_f32_16x16x32_bf16 v[124:127], a[124:127], v[188:191], v[124:127]
  ds_read_b64_tr_b16 v[174:175], v6 offset:20992
  v_mfma_f32_16x16x32_bf16 v[128:131], a[196:199], v[176:179], v[128:131]
  v_mfma_f32_16x16x32_bf16 v[132:135], a[196:199], v[180:183], v[132:135]
  v_mfma_f32_16x16x32_bf16 v[136:139], a[196:199], v[184:187], v[136:139]
  s_add_u32 m0, s34, 53248
  s_lshl_b32 s30, s17, 16
  s_add_u32 s30, s30, 3407872
  s_add_u32 s30, s30, s29
  buffer_load_dwordx4 v12, s[76:79], s30 offen lds
  v_mfma_f32_16x16x32_bf16 v[140:143], a[196:199], v[188:191], v[140:143]
  v_mfma_f32_16x16x32_bf16 v[144:147], v[236:239], v[176:179], v[144:147]
  v_mfma_f32_16x16x32_bf16 v[148:151], v[236:239], v[180:183], v[148:151]
  v_mfma_f32_16x16x32_bf16 v[152:155], v[236:239], v[184:187], v[152:155]
  v_mfma_f32_16x16x32_bf16 v[156:159], v[236:239], v[188:191], v[156:159]
  s_waitcnt lgkmcnt(0)
  v_mfma_f32_16x16x32_bf16 v[96:99], a[56:59], v[160:163], v[96:99]
  ds_read_b64_tr_b16 v[176:177], v13 offset:24576
  v_mfma_f32_16x16x32_bf16 v[100:103], a[56:59], v[164:167], v[100:103]
  ds_read_b64_tr_b16 v[178:179], v13 offset:25088
  v_mfma_f32_16x16x32_bf16 v[104:107], a[56:59], v[168:171], v[104:107]
  ds_read_b64_tr_b16 v[180:181], v14 offset:24576
  v_mfma_f32_16x16x32_bf16 v[108:111], a[56:59], v[172:175], v[108:111]
  ds_read_b64_tr_b16 v[182:183], v14 offset:25088
  v_mfma_f32_16x16x32_bf16 v[112:115], a[128:131], v[160:163], v[112:115]
  ds_read_b64_tr_b16 v[184:185], v15 offset:24576
  v_mfma_f32_16x16x32_bf16 v[116:119], a[128:131], v[164:167], v[116:119]
  ds_read_b64_tr_b16 v[186:187], v15 offset:25088
  v_mfma_f32_16x16x32_bf16 v[120:123], a[128:131], v[168:171], v[120:123]
  ds_read_b64_tr_b16 v[188:189], v6 offset:24576
  v_mfma_f32_16x16x32_bf16 v[124:127], a[128:131], v[172:175], v[124:127]
  ds_read_b64_tr_b16 v[190:191], v6 offset:25088
  v_mfma_f32_16x16x32_bf16 v[128:131], a[200:203], v[160:163], v[128:131]
  v_mfma_f32_16x16x32_bf16 v[132:135], a[200:203], v[164:167], v[132:135]
  v_mfma_f32_16x16x32_bf16 v[136:139], a[200:203], v[168:171], v[136:139]
  s_add_u32 m0, s34, 57344
  s_lshl_b32 s30, s17, 16
  s_add_u32 s30, s30, 3670016
  s_add_u32 s30, s30, s29
  buffer_load_dwordx4 v12, s[76:79], s30 offen lds
  v_mfma_f32_16x16x32_bf16 v[140:143], a[200:203], v[172:175], v[140:143]
  v_mfma_f32_16x16x32_bf16 v[144:147], v[240:243], v[160:163], v[144:147]
  v_mfma_f32_16x16x32_bf16 v[148:151], v[240:243], v[164:167], v[148:151]
  v_mfma_f32_16x16x32_bf16 v[152:155], v[240:243], v[168:171], v[152:155]
  v_mfma_f32_16x16x32_bf16 v[156:159], v[240:243], v[172:175], v[156:159]
  s_waitcnt lgkmcnt(0)
  v_mfma_f32_16x16x32_bf16 v[96:99], a[60:63], v[176:179], v[96:99]
  ds_read_b64_tr_b16 v[160:161], v13 offset:28672
  v_mfma_f32_16x16x32_bf16 v[100:103], a[60:63], v[180:183], v[100:103]
  ds_read_b64_tr_b16 v[162:163], v13 offset:29184
  v_mfma_f32_16x16x32_bf16 v[104:107], a[60:63], v[184:187], v[104:107]
  ds_read_b64_tr_b16 v[164:165], v14 offset:28672
  v_mfma_f32_16x16x32_bf16 v[108:111], a[60:63], v[188:191], v[108:111]
  ds_read_b64_tr_b16 v[166:167], v14 offset:29184
  v_mfma_f32_16x16x32_bf16 v[112:115], a[132:135], v[176:179], v[112:115]
  ds_read_b64_tr_b16 v[168:169], v15 offset:28672
  v_mfma_f32_16x16x32_bf16 v[116:119], a[132:135], v[180:183], v[116:119]
  ds_read_b64_tr_b16 v[170:171], v15 offset:29184
  v_mfma_f32_16x16x32_bf16 v[120:123], a[132:135], v[184:187], v[120:123]
  ds_read_b64_tr_b16 v[172:173], v6 offset:28672
  v_mfma_f32_16x16x32_bf16 v[124:127], a[132:135], v[188:191], v[124:127]
  ds_read_b64_tr_b16 v[174:175], v6 offset:29184
  v_mfma_f32_16x16x32_bf16 v[128:131], a[204:207], v[176:179], v[128:131]
  v_mfma_f32_16x16x32_bf16 v[132:135], a[204:207], v[180:183], v[132:135]
  v_mfma_f32_16x16x32_bf16 v[136:139], a[204:207], v[184:187], v[136:139]
  s_add_u32 m0, s34, 61440
  s_lshl_b32 s30, s17, 16
  s_add_u32 s30, s30, 3932160
  s_add_u32 s30, s30, s29
  buffer_load_dwordx4 v12, s[76:79], s30 offen lds
  v_mfma_f32_16x16x32_bf16 v[140:143], a[204:207], v[188:191], v[140:143]
  v_mfma_f32_16x16x32_bf16 v[144:147], v[244:247], v[176:179], v[144:147]
  v_mfma_f32_16x16x32_bf16 v[148:151], v[244:247], v[180:183], v[148:151]
  v_mfma_f32_16x16x32_bf16 v[152:155], v[244:247], v[184:187], v[152:155]
  v_mfma_f32_16x16x32_bf16 v[156:159], v[244:247], v[188:191], v[156:159]
  s_waitcnt lgkmcnt(0)
  v_mfma_f32_16x16x32_bf16 v[96:99], a[64:67], v[160:163], v[96:99]
  ds_read_b64_tr_b16 v[176:177], v13 offset:32768
  v_mfma_f32_16x16x32_bf16 v[100:103], a[64:67], v[164:167], v[100:103]
  ds_read_b64_tr_b16 v[178:179], v13 offset:33280
  v_mfma_f32_16x16x32_bf16 v[104:107], a[64:67], v[168:171], v[104:107]
  ds_read_b64_tr_b16 v[180:181], v14 offset:32768
  v_mfma_f32_16x16x32_bf16 v[108:111], a[64:67], v[172:175], v[108:111]
  ds_read_b64_tr_b16 v[182:183], v14 offset:33280
  v_mfma_f32_16x16x32_bf16 v[112:115], a[136:139], v[160:163], v[112:115]
  ds_read_b64_tr_b16 v[184:185], v15 offset:32768
  v_mfma_f32_16x16x32_bf16 v[116:119], a[136:139], v[164:167], v[116:119]
  ds_read_b64_tr_b16 v[186:187], v15 offset:33280
  v_mfma_f32_16x16x32_bf16 v[120:123], a[136:139], v[168:171], v[120:123]
  ds_read_b64_tr_b16 v[188:189], v6 offset:32768
  v_mfma_f32_16x16x32_bf16 v[124:127], a[136:139], v[172:175], v[124:127]
  ds_read_b64_tr_b16 v[190:191], v6 offset:33280
  v_mfma_f32_16x16x32_bf16 v[128:131], a[208:211], v[160:163], v[128:131]
  v_mfma_f32_16x16x32_bf16 v[132:135], a[208:211], v[164:167], v[132:135]
  v_mfma_f32_16x16x32_bf16 v[136:139], a[208:211], v[168:171], v[136:139]
  s_add_u32 m0, s34, 65536
  s_lshl_b32 s30, s17, 16
  s_add_u32 s30, s30, 4194304
  s_add_u32 s30, s30, s29
  buffer_load_dwordx4 v12, s[76:79], s30 offen lds
  v_mfma_f32_16x16x32_bf16 v[140:143], a[208:211], v[172:175], v[140:143]
  v_mfma_f32_16x16x32_bf16 v[144:147], v[248:251], v[160:163], v[144:147]
  v_mfma_f32_16x16x32_bf16 v[148:151], v[248:251], v[164:167], v[148:151]
  v_mfma_f32_16x16x32_bf16 v[152:155], v[248:251], v[168:171], v[152:155]
  v_mfma_f32_16x16x32_bf16 v[156:159], v[248:251], v[172:175], v[156:159]
  s_waitcnt lgkmcnt(0)
  v_mfma_f32_16x16x32_bf16 v[96:99], a[68:71], v[176:179], v[96:99]
  v_mfma_f32_16x16x32_bf16 v[100:103], a[68:71], v[180:183], v[100:103]
  v_mfma_f32_16x16x32_bf16 v[104:107], a[68:71], v[184:187], v[104:107]
  v_mfma_f32_16x16x32_bf16 v[108:111], a[68:71], v[188:191], v[108:111]
  v_mfma_f32_16x16x32_bf16 v[112:115], a[140:143], v[176:179], v[112:115]
  v_mfma_f32_16x16x32_bf16 v[116:119], a[140:143], v[180:183], v[116:119]
  v_mfma_f32_16x16x32_bf16 v[120:123], a[140:143], v[184:187], v[120:123]
  v_mfma_f32_16x16x32_bf16 v[124:127], a[140:143], v[188:191], v[124:127]
  v_mfma_f32_16x16x32_bf16 v[128:131], a[212:215], v[176:179], v[128:131]
  v_mfma_f32_16x16x32_bf16 v[132:135], a[212:215], v[180:183], v[132:135]
  v_mfma_f32_16x16x32_bf16 v[136:139], a[212:215], v[184:187], v[136:139]
  s_add_u32 m0, s34, 69632
  s_lshl_b32 s30, s17, 16
  s_add_u32 s30, s30, 4456448
  s_add_u32 s30, s30, s29
  buffer_load_dwordx4 v12, s[76:79], s30 offen lds
  v_mfma_f32_16x16x32_bf16 v[140:143], a[212:215], v[188:191], v[140:143]
  v_mfma_f32_16x16x32_bf16 v[144:147], v[252:255], v[176:179], v[144:147]
  v_mfma_f32_16x16x32_bf16 v[148:151], v[252:255], v[180:183], v[148:151]
  v_mfma_f32_16x16x32_bf16 v[152:155], v[252:255], v[184:187], v[152:155]
  v_mfma_f32_16x16x32_bf16 v[156:159], v[252:255], v[188:191], v[156:159]
  s_nop 7
  v_cvt_pk_bf16_f32 v40, v96, v97
  v_cvt_pk_bf16_f32 v41, v98, v99
  v_cvt_pk_bf16_f32 v42, v112, v113
  v_cvt_pk_bf16_f32 v43, v114, v115
  s_add_u32 s30, s43, 0
  buffer_store_dwordx4 v[40:43], v1, s[4:7], s30 offen sc1
  v_cvt_pk_bf16_f32 v44, v100, v101
  v_cvt_pk_bf16_f32 v45, v102, v103
  v_cvt_pk_bf16_f32 v46, v116, v117
  v_cvt_pk_bf16_f32 v47, v118, v119
  s_add_u32 s30, s43, 1024
  buffer_store_dwordx4 v[44:47], v1, s[4:7], s30 offen sc1
  v_cvt_pk_bf16_f32 v48, v104, v105
  v_cvt_pk_bf16_f32 v49, v106, v107
  v_cvt_pk_bf16_f32 v50, v120, v121
  v_cvt_pk_bf16_f32 v51, v122, v123
  s_add_u32 s30, s43, 2048
  buffer_store_dwordx4 v[48:51], v1, s[4:7], s30 offen sc1
  v_cvt_pk_bf16_f32 v52, v108, v109
  v_cvt_pk_bf16_f32 v53, v110, v111
  v_cvt_pk_bf16_f32 v54, v124, v125
  v_cvt_pk_bf16_f32 v55, v126, v127
  s_add_u32 s30, s43, 3072
  buffer_store_dwordx4 v[52:55], v1, s[4:7], s30 offen sc1
  v_cvt_pk_bf16_f32 v40, v128, v129
  v_cvt_pk_bf16_f32 v41, v130, v131
  v_cvt_pk_bf16_f32 v42, v144, v145
  v_cvt_pk_bf16_f32 v43, v146, v147
  s_add_u32 s30, s43, 262144
  buffer_store_dwordx4 v[40:43], v1, s[4:7], s30 offen sc1
  v_cvt_pk_bf16_f32 v44, v132, v133
  v_cvt_pk_bf16_f32 v45, v134, v135
  v_cvt_pk_bf16_f32 v46, v148, v149
  v_cvt_pk_bf16_f32 v47, v150, v151
  s_add_u32 s30, s43, 263168
  buffer_store_dwordx4 v[44:47], v1, s[4:7], s30 offen sc1
  v_cvt_pk_bf16_f32 v48, v136, v137
  v_cvt_pk_bf16_f32 v49, v138, v139
  v_cvt_pk_bf16_f32 v50, v152, v153
  v_cvt_pk_bf16_f32 v51, v154, v155
  s_add_u32 s30, s43, 264192
  buffer_store_dwordx4 v[48:51], v1, s[4:7], s30 offen sc1
  v_cvt_pk_bf16_f32 v52, v140, v141
  v_cvt_pk_bf16_f32 v53, v142, v143
  v_cvt_pk_bf16_f32 v54, v156, v157
  v_cvt_pk_bf16_f32 v55, v158, v159
  s_add_u32 s30, s43, 265216
  buffer_store_dwordx4 v[52:55], v1, s[4:7], s30 offen sc1
L_g_join_71:
  s_cmp_eq_u32 s40, s46
  s_cbranch_scc0 L_g_nokv_72
  s_waitcnt vmcnt(0)
  s_barrier
  s_cmp_eq_u32 s17, 0
  s_cbranch_scc0 L_arr_73
  v_mov_b32 v8, s47
  v_mov_b32 v9, 1
  s_mov_b64 exec, 1
  buffer_atomic_add v9, v8, s[12:15], 0 offen
  s_mov_b64 exec, -1
L_arr_73:
L_g_nokv_72:
  s_add_u32 s40, s40, 1
  s_cmp_eq_u32 s32, 0
  s_cbranch_scc1 L_g_fin_63
  s_mov_b32 s41, s31
  s_branch L_g_top_62
L_g_fin_63:
  s_waitcnt vmcnt(0)
  s_waitcnt vmcnt(0)
  s_barrier
  s_cmp_eq_u32 s17, 0
  s_cbranch_scc0 L_arr_74
  v_mov_b32 v8, s48
  v_mov_b32 v9, 1
  s_mov_b64 exec, 1
  buffer_atomic_add v9, v8, s[12:15], 0 offen
  s_mov_b64 exec, -1
L_arr_74:
L_nog:
  s_mov_b32 s42, 0
  s_cmp_lt_u32 s23, 64
  s_cbranch_scc1 L_role_r12
  s_cmp_lt_u32 s23, 90
  s_cbranch_scc1 L_role_r3
  s_cmp_lt_u32 s23, 108
  s_cbranch_scc1 L_role_r4
  s_cmp_lt_u32 s23, 126
  s_cbranch_scc1 L_role_r5
  s_cmp_lt_u32 s23, 198
  s_cbranch_scc1 L_role_r67
  s_cmp_lt_u32 s23, 224
  s_cbranch_scc1 L_role_r8
  s_endpgm
L_role_r12:
  s_sub_u32 s16, s23, 0
  s_lshr_b32 s59, s16, 5
  s_lshl_b32 s41, s16, 2
  s_add_u32 s41, s41, 0xe900400
  s_and_b32 s16, s16, 31
  s_load_dwordx2 s[8:9], s[0:1], 40
  s_mov_b32 s10, 0x480000
  s_mov_b32 s11, 0x00020000
  s_waitcnt lgkmcnt(0)
  s_and_b32 s9, s9, 0xffff
  v_and_b32 v5, 63, v0
  v_lshlrev_b32 v1, 4, v5
  s_mul_i32 s24, s16, 147456
  s_lshl_b32 s33, s17, 10
  s_add_u32 m0, s33, 0
  s_add_u32 s32, s24, s33
  s_nop 0
  buffer_load_dwordx4 v1, s[8:11], s32 offen lds
  s_add_u32 m0, s33, 4096
  s_add_u32 s32, s24, s33
  s_add_u32 s32, s32, 4096
  buffer_load_dwordx4 v1, s[8:11], s32 offen lds
  s_add_u32 m0, s33, 8192
  s_add_u32 s32, s24, s33
  s_add_u32 s32, s32, 8192
  buffer_load_dwordx4 v1, s[8:11], s32 offen lds
  s_add_u32 m0, s33, 12288
  s_add_u32 s32, s24, s33
  s_add_u32 s32, s32, 12288
  buffer_load_dwordx4 v1, s[8:11], s32 offen lds
  s_add_u32 m0, s33, 16384
  s_add_u32 s32, s24, s33
  s_add_u32 s32, s32, 16384
  buffer_load_dwordx4 v1, s[8:11], s32 offen lds
  s_add_u32 m0, s33, 20480
  s_add_u32 s32, s24, s33
  s_add_u32 s32, s32, 20480
  buffer_load_dwordx4 v1, s[8:11], s32 offen lds
  s_add_u32 m0, s33, 24576
  s_add_u32 s32, s24, s33
  s_add_u32 s32, s32, 24576
  buffer_load_dwordx4 v1, s[8:11], s32 offen lds
  s_add_u32 m0, s33, 28672
  s_add_u32 s32, s24, s33
  s_add_u32 s32, s32, 28672
  buffer_load_dwordx4 v1, s[8:11], s32 offen lds
  s_add_u32 m0, s33, 32768
  s_add_u32 s32, s24, s33
  s_add_u32 s32, s32, 32768
  buffer_load_dwordx4 v1, s[8:11], s32 offen lds
  s_add_u32 m0, s33, 36864
  s_add_u32 s32, s24, s33
  s_add_u32 s32, s32, 36864
  buffer_load_dwordx4 v1, s[8:11], s32 offen lds
  s_add_u32 m0, s33, 40960
  s_add_u32 s32, s24, s33
  s_add_u32 s32, s32, 40960
  buffer_load_dwordx4 v1, s[8:11], s32 offen lds
  s_add_u32 m0, s33, 45056
  s_add_u32 s32, s24, s33
  s_add_u32 s32, s32, 45056
  buffer_load_dwordx4 v1, s[8:11], s32 offen lds
  s_add_u32 m0, s33, 49152
  s_add_u32 s32, s24, s33
  s_add_u32 s32, s32, 49152
  buffer_load_dwordx4 v1, s[8:11], s32 offen lds
  s_add_u32 m0, s33, 53248
  s_add_u32 s32, s24, s33
  s_add_u32 s32, s32, 53248
  buffer_load_dwordx4 v1, s[8:11], s32 offen lds
  s_add_u32 m0, s33, 57344
  s_add_u32 s32, s24, s33
  s_add_u32 s32, s32, 57344
  buffer_load_dwordx4 v1, s[8:11], s32 offen lds
  s_add_u32 m0, s33, 61440
  s_add_u32 s32, s24, s33
  s_add_u32 s32, s32, 61440
  buffer_load_dwordx4 v1, s[8:11], s32 offen lds
  s_add_u32 m0, s33, 65536
  s_add_u32 s32, s24, s33
  s_add_u32 s32, s32, 65536
  buffer_load_dwordx4 v1, s[8:11], s32 offen lds
  s_add_u32 m0, s33, 69632
  s_add_u32 s32, s24, s33
  s_add_u32 s32, s32, 69632
  buffer_load_dwordx4 v1, s[8:11], s32 offen lds
  s_add_u32 m0, s33, 73728
  s_add_u32 s32, s24, s33
  s_add_u32 s32, s32, 73728
  buffer_load_dwordx4 v1, s[8:11], s32 offen lds
  s_add_u32 m0, s33, 77824
  s_add_u32 s32, s24, s33
  s_add_u32 s32, s32, 77824
  buffer_load_dwordx4 v1, s[8:11], s32 offen lds
  s_add_u32 m0, s33, 81920
  s_add_u32 s32, s24, s33
  s_add_u32 s32, s32, 81920
  buffer_load_dwordx4 v1, s[8:11], s32 offen lds
  s_add_u32 m0, s33, 86016
  s_add_u32 s32, s24, s33
  s_add_u32 s32, s32, 86016
  buffer_load_dwordx4 v1, s[8:11], s32 offen lds
  s_add_u32 m0, s33, 90112
  s_add_u32 s32, s24, s33
  s_add_u32 s32, s32, 90112
  buffer_load_dwordx4 v1, s[8:11], s32 offen lds
  s_add_u32 m0, s33, 94208
  s_add_u32 s32, s24, s33
  s_add_u32 s32, s32, 94208
  buffer_load_dwordx4 v1, s[8:11], s32 offen lds
  s_add_u32 m0, s33, 98304
  s_add_u32 s32, s24, s33
  s_add_u32 s32, s32, 98304
  buffer_load_dwordx4 v1, s[8:11], s32 offen lds
  s_add_u32 m0, s33, 102400
  s_add_u32 s32, s24, s33
  s_add_u32 s32, s32, 102400
  buffer_load_dwordx4 v1, s[8:11], s32 offen lds
  s_add_u32 m0, s33, 106496
  s_add_u32 s32, s24, s33
  s_add_u32 s32, s32, 106496
  buffer_load_dwordx4 v1, s[8:11], s32 offen lds
  s_add_u32 m0, s33, 110592
  s_add_u32 s32, s24, s33
  s_add_u32 s32, s32, 110592
  buffer_load_dwordx4 v1, s[8:11], s32 offen lds
  s_add_u32 m0, s33, 114688
  s_add_u32 s32, s24, s33
  s_add_u32 s32, s32, 114688
  buffer_load_dwordx4 v1, s[8:11], s32 offen lds
  s_add_u32 m0, s33, 118784
  s_add_u32 s32, s24, s33
  s_add_u32 s32, s32, 118784
  buffer_load_dwordx4 v1, s[8:11], s32 offen lds
  s_add_u32 m0, s33, 122880
  s_add_u32 s32, s24, s33
  s_add_u32 s32, s32, 122880
  buffer_load_dwordx4 v1, s[8:11], s32 offen lds
  s_add_u32 m0, s33, 126976
  s_add_u32 s32, s24, s33
  s_add_u32 s32, s32, 126976
  buffer_load_dwordx4 v1, s[8:11], s32 offen lds
  s_add_u32 m0, s33, 131072
  s_add_u32 s32, s24, s33
  s_add_u32 s32, s32, 131072
  buffer_load_dwordx4 v1, s[8:11], s32 offen lds
  s_add_u32 m0, s33, 135168
  s_add_u32 s32, s24, s33
  s_add_u32 s32, s32, 135168
  buffer_load_dwordx4 v1, s[8:11], s32 offen lds
  s_add_u32 m0, s33, 139264
  s_add_u32 s32, s24, s33
  s_add_u32 s32, s32, 139264
  buffer_load_dwordx4 v1, s[8:11], s32 offen lds
  s_add_u32 m0, s33, 143360
  s_add_u32 s32, s24, s33
  s_add_u32 s32, s32, 143360
  buffer_load_dwordx4 v1, s[8:11], s32 offen lds
  s_waitcnt vmcnt(0)
  s_barrier
  s_mul_i32 s25, s17, 288
  v_and_b32 v6, 63, v0
  v_lshrrev_b32 v7, 4, v6
  v_bfe_u32 v8, v6, 2, 2
  v_lshl_add_u32 v7, v7, 2, v8
  v_mul_u32_u24 v7, 1152, v7
  v_and_b32 v8, 3, v6
  v_lshl_add_u32 v7, v8, 3, v7
  v_add_u32 v7, s25, v7
  v_add_u32 v9, 0, v7
  ds_read_b64_tr_b16 a[0:1], v9 offset:0
  ds_read_b64_tr_b16 a[16:17], v9 offset:32
  ds_read_b64_tr_b16 a[32:33], v9 offset:64
  ds_read_b64_tr_b16 a[48:49], v9 offset:96
  ds_read_b64_tr_b16 a[64:65], v9 offset:128
  ds_read_b64_tr_b16 a[80:81], v9 offset:160
  ds_read_b64_tr_b16 a[96:97], v9 offset:192
  ds_read_b64_tr_b16 a[112:113], v9 offset:224
  ds_read_b64_tr_b16 a[128:129], v9 offset:256
  v_add_u32 v9, 18432, v7
  ds_read_b64_tr_b16 a[2:3], v9 offset:0
  ds_read_b64_tr_b16 a[18:19], v9 offset:32
  ds_read_b64_tr_b16 a[34:35], v9 offset:64
  s_waitcnt lgkmcnt(0)
  ds_read_b64_tr_b16 a[50:51], v9 offset:96
  ds_read_b64_tr_b16 a[66:67], v9 offset:128
  ds_read_b64_tr_b16 a[82:83], v9 offset:160
  ds_read_b64_tr_b16 a[98:99], v9 offset:192
  ds_read_b64_tr_b16 a[114:115], v9 offset:224
  ds_read_b64_tr_b16 a[130:131], v9 offset:256
  v_add_u32 v9, 36864, v7
  ds_read_b64_tr_b16 a[4:5], v9 offset:0
  ds_read_b64_tr_b16 a[20:21], v9 offset:32
  ds_read_b64_tr_b16 a[36:37], v9 offset:64
  ds_read_b64_tr_b16 a[52:53], v9 offset:96
  ds_read_b64_tr_b16 a[68:69], v9 offset:128
  ds_read_b64_tr_b16 a[84:85], v9 offset:160
  s_waitcnt lgkmcnt(0)
  ds_read_b64_tr_b16 a[100:101], v9 offset:192
  ds_read_b64_tr_b16 a[116:117], v9 offset:224
  ds_read_b64_tr_b16 a[132:133], v9 offset:256
  v_add_u32 v9, 55296, v7
  ds_read_b64_tr_b16 a[6:7], v9 offset:0
  ds_read_b64_tr_b16 a[22:23], v9 offset:32
  ds_read_b64_tr_b16 a[38:39], v9 offset:64
  ds_read_b64_tr_b16 a[54:55], v9 offset:96
  ds_read_b64_tr_b16 a[70:71], v9 offset:128
  ds_read_b64_tr_b16 a[86:87], v9 offset:160
  ds_read_b64_tr_b16 a[102:103], v9 offset:192
  ds_read_b64_tr_b16 a[118:119], v9 offset:224
  ds_read_b64_tr_b16 a[134:135], v9 offset:256
  s_waitcnt lgkmcnt(0)
  v_add_u32 v9, 73728, v7
  ds_read_b64_tr_b16 a[8:9], v9 offset:0
  ds_read_b64_tr_b16 a[24:25], v9 offset:32
  ds_read_b64_tr_b16 a[40:41], v9 offset:64
  ds_read_b64_tr_b16 a[56:57], v9 offset:96
  ds_read_b64_tr_b16 a[72:73], v9 offset:128
  ds_read_b64_tr_b16 a[88:89], v9 offset:160
  ds_read_b64_tr_b16 a[104:105], v9 offset:192
  ds_read_b64_tr_b16 a[120:121], v9 offset:224
  ds_read_b64_tr_b16 a[136:137], v9 offset:256
  v_add_u32 v9, 92160, v7
  ds_read_b64_tr_b16 a[10:11], v9 offset:0
  ds_read_b64_tr_b16 a[26:27], v9 offset:32
  ds_read_b64_tr_b16 a[42:43], v9 offset:64
  s_waitcnt lgkmcnt(0)
  ds_read_b64_tr_b16 a[58:59], v9 offset:96
  ds_read_b64_tr_b16 a[74:75], v9 offset:128
  ds_read_b64_tr_b16 a[90:91], v9 offset:160
  ds_read_b64_tr_b16 a[106:107], v9 offset:192
  ds_read_b64_tr_b16 a[122:123], v9 offset:224
  ds_read_b64_tr_b16 a[138:139], v9 offset:256
  v_add_u32 v9, 110592, v7
  ds_read_b64_tr_b16 a[12:13], v9 offset:0
  ds_read_b64_tr_b16 a[28:29], v9 offset:32
  ds_read_b64_tr_b16 a[44:45], v9 offset:64
  ds_read_b64_tr_b16 a[60:61], v9 offset:96
  ds_read_b64_tr_b16 a[76:77], v9 offset:128
  ds_read_b64_tr_b16 a[92:93], v9 offset:160
  s_waitcnt lgkmcnt(0)
  ds_read_b64_tr_b16 a[108:109], v9 offset:192
  ds_read_b64_tr_b16 a[124:125], v9 offset:224
  ds_read_b64_tr_b16 a[140:141], v9 offset:256
  v_add_u32 v9, 129024, v7
  ds_read_b64_tr_b16 a[14:15], v9 offset:0
  ds_read_b64_tr_b16 a[30:31], v9 offset:32
  ds_read_b64_tr_b16 a[46:47], v9 offset:64
  ds_read_b64_tr_b16 a[62:63], v9 offset:96
  ds_read_b64_tr_b16 a[78:79], v9 offset:128
  ds_read_b64_tr_b16 a[94:95], v9 offset:160
  ds_read_b64_tr_b16 a[110:111], v9 offset:192
  ds_read_b64_tr_b16 a[126:127], v9 offset:224
  ds_read_b64_tr_b16 a[142:143], v9 offset:256
  s_waitcnt lgkmcnt(0)
  s_waitcnt lgkmcnt(0)
  s_barrier
  v_and_b32 v6, 15, v5
  v_lshrrev_b32 v7, 4, v5
  v_and_b32 v136, 63, v0
  v_lshrrev_b32 v137, 3, v136
  v_and_b32 v138, 7, v136
  v_and_b32 v139, 3, v138
  v_lshlrev_b32 v139, 4, v139
  v_lshrrev_b32 v140, 2, v138
  v_lshl_add_u32 v139, v140, 3, v139
  v_add_u32 v139, v139, v137
  v_lshlrev_b32 v249, 2, v139
  s_mov_b32 s32, 53248
  v_mul_lo_u32 v2, v137, s32
  v_lshl_add_u32 v2, v138, 4, v2
  v_lshrrev_b32 v137, 2, v136
  v_and_b32 v138, 3, v136
  v_lshl_add_u32 v139, v138, 4, v137
  v_lshlrev_b32 v251, 2, v139
  v_mul_lo_u32 v248, v137, s32
  v_lshl_add_u32 v248, v138, 3, v248
  v_add_u32 v248, 256, v248
  s_mov_b32 s62, 0x00ff00ff
  s_mov_b32 s63, 0x00ff00ff
  v_min_u32 v8, 35, v5
  v_subrev_u32 v9, 4, v8
  v_lshlrev_b32 v9, 2, v9
  v_add_u32 v9, 0xe901800, v9
  s_lshl_b32 s24, s16, 7
  s_add_u32 s24, s24, 0xe902000
  v_lshl_add_u32 v3, v8, 2, s24
  v_cmp_gt_u32 s[60:61], 4, v8
  s_nop 1
  v_cndmask_b32 v3, v9, v3, s[60:61]
  v_lshl_add_u32 v8, v7, 2, 0
  v_cmp_le_u32 s[44:45], v8, v6
  v_lshl_add_u32 v8, v7, 2, 1
  v_cmp_le_u32 s[46:47], v8, v6
  v_lshl_add_u32 v8, v7, 2, 2
  v_cmp_le_u32 s[48:49], v8, v6
  v_lshl_add_u32 v8, v7, 2, 3
  v_cmp_le_u32 s[50:51], v8, v6
  s_and_b32 s52, s17, 1
  s_lshr_b32 s53, s17, 1
  s_lshl_b32 s54, s16, 13
  s_lshl_b32 s56, s16, 12
  s_add_u32 s56, s56, 0x3000000
  s_lshl_b32 s57, s16, 11
  s_lshl_b32 s24, s53, 10
  s_add_u32 s57, s57, s24
  s_add_u32 s57, s57, 0x3800000
  s_lshl_b32 s58, s16, 4
  s_add_u32 s58, s58, 0xe902000
  s_mul_i32 s24, s17, 384
  s_mul_i32 s55, s16, 1664
  s_add_u32 s55, s55, s24
  s_add_u32 s55, s55, 0x4000000
  v_mov_b32 v232, 128
  s_mov_b32 s24, 262144
L_wc_75:
  buffer_load_dword v233, v232, s[12:15], 0 offen sc1
  s_waitcnt vmcnt(0)
  v_cmp_gt_u32 vcc, 33, v233
  s_cbranch_vccz L_wc_ok_76
  s_sleep 8
  s_sub_u32 s24, s24, 1
  s_cmp_lg_u32 s24, 0
  s_cbranch_scc1 L_wc_75
  s_branch L_fail
L_wc_ok_76:
  s_mov_b32 s18, s59
  s_and_b32 s24, s18, 6
  s_cmp_eq_u32 s24, 0
  s_cbranch_scc0 L_r12_gw_77
  s_cmp_lt_u32 s18, 64
  s_cbranch_scc0 L_r12_gw_77
  s_lshr_b32 s26, s18, 3
  s_cmp_eq_u32 s26, 0
  s_cselect_b32 s27, 64, 20
  s_lshl_b32 s26, s26, 2
  s_add_u32 s28, s26, 160
  s_add_u32 s29, s26, 192
  v_mov_b32 v12, s28
  s_mov_b32 s30, 262144
L_wc_78:
  buffer_load_dword v13, v12, s[12:15], 0 offen sc1
  s_waitcnt vmcnt(0)
  v_cmp_gt_u32 vcc, s27, v13
  s_cbranch_vccz L_wc_ok_79
  s_sleep 8
  s_sub_u32 s30, s30, 1
  s_cmp_lg_u32 s30, 0
  s_cbranch_scc1 L_wc_78
  s_branch L_fail
L_wc_ok_79:
  v_mov_b32 v12, s29
  s_mov_b32 s30, 262144
L_wc_80:
  buffer_load_dword v13, v12, s[12:15], 0 offen sc1
  s_waitcnt vmcnt(0)
  v_cmp_gt_u32 vcc, s27, v13
  s_cbranch_vccz L_wc_ok_81
  s_sleep 8
  s_sub_u32 s30, s30, 1
  s_cmp_lg_u32 s30, 0
  s_cbranch_scc1 L_wc_80
  s_branch L_fail
L_wc_ok_81:
L_r12_gw_77:
  s_lshl_b32 s24, s18, 18
  s_add_u32 s24, s24, s54
  s_lshl_b32 s25, s52, 10
  s_add_u32 s25, s25, s24
  s_add_u32 s25, s25, 0x2000000
  s_add_u32 s26, s25, 0
  buffer_load_dwordx4 v[16:19], v1, s[4:7], s26 offen
  s_add_u32 s26, s25, 2048
  buffer_load_dwordx4 v[20:23], v1, s[4:7], s26 offen
  s_add_u32 s26, s25, 4096
  buffer_load_dwordx4 v[24:27], v1, s[4:7], s26 offen
  s_add_u32 s26, s25, 6144
  buffer_load_dwordx4 v[28:31], v1, s[4:7], s26 offen
  s_add_u32 s26, s24, 0
  buffer_load_dwordx4 v[32:35], v1, s[4:7], s26 offen offset:0
  buffer_load_dwordx4 v[48:51], v1, s[4:7], s26 offen offset:1024
  s_add_u32 s26, s24, 2048
  buffer_load_dwordx4 v[36:39], v1, s[4:7], s26 offen offset:0
  buffer_load_dwordx4 v[52:55], v1, s[4:7], s26 offen offset:1024
  s_add_u32 s26, s24, 4096
  buffer_load_dwordx4 v[40:43], v1, s[4:7], s26 offen offset:0
  buffer_load_dwordx4 v[56:59], v1, s[4:7], s26 offen offset:1024
  s_add_u32 s26, s24, 6144
  buffer_load_dwordx4 v[44:47], v1, s[4:7], s26 offen offset:0
  buffer_load_dwordx4 v[60:63], v1, s[4:7], s26 offen offset:1024
  s_lshl_b32 s25, s53, 12
  s_add_u32 s25, s25, s24
  s_add_u32 s25, s25, 0x1000000
  s_add_u32 s26, s25, 0
  buffer_load_dwordx4 v[64:67], v1, s[4:7], s26 offen
  s_add_u32 s26, s25, 1024
  buffer_load_dwordx4 v[68:71], v1, s[4:7], s26 offen
  s_add_u32 s26, s25, 2048
  buffer_load_dwordx4 v[72:75], v1, s[4:7], s26 offen
  s_add_u32 s26, s25, 3072
  buffer_load_dwordx4 v[76:79], v1, s[4:7], s26 offen
  s_waitcnt vmcnt(0)
L_r12_top_82:
  v_mov_b32 v132, 0x3f803f80
  v_mov_b32 v133, 0x3f803f80
  v_mov_b32 v134, 0x3f803f80
  v_mov_b32 v135, 0x3f803f80
  s_waitcnt vmcnt(14)
  v_mfma_f32_16x16x32_bf16 v[104:107], v[32:35], v[16:19], 0
  v_mfma_f32_16x16x32_bf16 v[108:111], v[48:51], v[16:19], 0
  v_mfma_f32_16x16x32_bf16 v[104:107], v[36:39], v[20:23], v[104:107]
  v_mfma_f32_16x16x32_bf16 v[108:111], v[52:55], v[20:23], v[108:111]
  v_mfma_f32_16x16x32_bf16 v[104:107], v[40:43], v[24:27], v[104:107]
  v_mfma_f32_16x16x32_bf16 v[108:111], v[56:59], v[24:27], v[108:111]
  v_mfma_f32_16x16x32_bf16 v[104:107], v[44:47], v[28:31], v[104:107]
  v_mfma_f32_16x16x32_bf16 v[108:111], v[60:63], v[28:31], v[108:111]
  s_add_u32 s28, s18, 1
  s_max_u32 s29, s18, 7
  s_sub_u32 s29, s29, 7
  v_mov_b32 v4, s29
  v_mov_b32 v11, s28
  v_cndmask_b32 v4, v4, v11, s[60:61]
  s_and_b32 s29, s18, 7
  s_lshl_b32 s29, s29, 7
  v_mov_b32 v11, s29
  v_cndmask_b32 v11, v11, 0, s[60:61]
  v_add_u32 v15, v3, v11
  s_mov_b32 s40, 262144
  s_cmp_eq_u32 s17, 0
  s_cbranch_scc0 L_wf_first_86
  buffer_load_dword v8, v15, s[4:7], 0 offen sc1
L_wf_first_86:
  s_waitcnt vmcnt(0)
  s_cmp_eq_u32 s42, 0
  s_cbranch_scc1 L_pend_87
  s_barrier
  s_cmp_eq_u32 s17, 0
  s_cbranch_scc0 L_pend2_88
  v_mov_b32 v9, s42
  buffer_store_dword v9, off, s[4:7], s41 sc1
L_pend2_88:
  s_mov_b32 s42, 0
L_pend_87:
  s_cmp_eq_u32 s17, 0
  s_cbranch_scc0 L_wf_rel_85
  v_cmp_gt_u32 vcc, v4, v8
  s_cbranch_vccz L_wf_ok_84
L_wf_83:
  s_sleep 8
  buffer_load_dword v8, v15, s[4:7], 0 offen sc1
  s_waitcnt vmcnt(0)
  v_cmp_gt_u32 vcc, v4, v8
  s_cbranch_vccz L_wf_ok_84
  s_sub_u32 s40, s40, 1
  s_cmp_lg_u32 s40, 0
  s_cbranch_scc1 L_wf_83
  s_branch L_fail
L_wf_ok_84:
L_wf_rel_85:
  s_barrier
  s_lshl_b32 s24, s18, 17
  s_add_u32 s24, s24, s56
  s_add_u32 s26, s24, 0
  buffer_load_dwordx4 v[80:83], v1, s[4:7], s26 offen sc1
  s_add_u32 s26, s24, 1024
  buffer_load_dwordx4 v[84:87], v1, s[4:7], s26 offen sc1
  s_add_u32 s26, s24, 2048
  buffer_load_dwordx4 v[88:91], v1, s[4:7], s26 offen sc1
  s_add_u32 s26, s24, 3072
  buffer_load_dwordx4 v[92:95], v1, s[4:7], s26 offen sc1
  s_lshl_b32 s24, s18, 16
  s_add_u32 s24, s24, s57
  v_lshrrev_b32 v8, 1, v1
  buffer_load_dwordx2 v[96:97], v8, s[4:7], s24 offen sc1
  buffer_load_dwordx2 v[98:99], v8, s[4:7], s24 offen offset:512 sc1
  v_mov_b32 v9, 0xff800000
  s_cmp_eq_u32 s52, 1
  s_cbranch_scc1 L_r12_tt1_89
  v_cndmask_b32 v104, v9, v104, s[44:45]
  v_mov_b32 v108, v9
  v_cndmask_b32 v105, v9, v105, s[46:47]
  v_mov_b32 v109, v9
  v_cndmask_b32 v106, v9, v106, s[48:49]
  v_mov_b32 v110, v9
  v_cndmask_b32 v107, v9, v107, s[50:51]
  v_mov_b32 v111, v9
  s_branch L_r12_msk_90
L_r12_tt1_89:
  v_cndmask_b32 v108, v9, v108, s[44:45]
  v_cndmask_b32 v109, v9, v109, s[46:47]
  v_cndmask_b32 v110, v9, v110, s[48:49]
  v_cndmask_b32 v111, v9, v111, s[50:51]
L_r12_msk_90:
  s_waitcnt vmcnt(2)
  v_mfma_f32_16x16x32_bf16 v[100:103], v[80:83], v[16:19], 0
  v_mfma_f32_16x16x32_bf16 v[100:103], v[84:87], v[20:23], v[100:103]
  v_mfma_f32_16x16x32_bf16 v[100:103], v[88:91], v[24:27], v[100:103]
  v_mfma_f32_16x16x32_bf16 v[100:103], v[92:95], v[28:31], v[100:103]
  v_max3_f32 v10, v104, v105, v106
  v_max3_f32 v11, v107, v108, v109
  v_max3_f32 v10, v10, v110, v111
  v_max_f32 v10, v10, v11
  s_nop 3
  v_max3_f32 v10, v10, v100, v101
  v_mov_b32 v11, v10
  s_nop 1
  v_permlane16_swap_b32 v10, v11
  v_max_f32 v10, v10, v11
  v_mov_b32 v11, v10
  s_nop 1
  v_permlane32_swap_b32 v10, v11
  v_max_f32 v10, v10, v11
  s_mov_b32 s30, 0x3e0293ee
  v_mul_f32 v10, s30, v10
  v_fma_f32 v100, v100, s30, -v10
  v_fma_f32 v101, v101, s30, -v10
  v_fma_f32 v104, v104, s30, -v10
  v_fma_f32 v105, v105, s30, -v10
  v_fma_f32 v106, v106, s30, -v10
  v_fma_f32 v107, v107, s30, -v10
  v_fma_f32 v108, v108, s30, -v10
  v_fma_f32 v109, v109, s30, -v10
  v_fma_f32 v110, v110, s30, -v10
  v_fma_f32 v111, v111, s30, -v10
  v_exp_f32 v100, v100
  v_exp_f32 v101, v101
  v_exp_f32 v104, v104
  v_exp_f32 v105, v105
  v_exp_f32 v106, v106
  v_exp_f32 v107, v107
  v_exp_f32 v108, v108
  v_exp_f32 v109, v109
  v_exp_f32 v110, v110
  v_exp_f32 v111, v111
  s_nop 0
  v_cvt_pk_bf16_f32 v136, v104, v105
  v_cvt_pk_bf16_f32 v137, v106, v107
  v_cvt_pk_bf16_f32 v138, v108, v109
  v_cvt_pk_bf16_f32 v139, v110, v111
  v_cvt_pk_bf16_f32 v140, v100, v101
  v_mov_b32 v141, 0
  v_mov_b32 v142, 0
  v_cvt_pk_bf16_f32 v143, v100, v101
  s_waitcnt vmcnt(0)
  s_nop 0
  v_mfma_f32_16x16x32_bf16 v[128:131], v[132:135], v[136:139], 0
  v_mfma_f32_16x16x32_bf16 v[112:115], v[64:67], v[136:139], 0
  v_mfma_f32_16x16x32_bf16 v[116:119], v[68:71], v[136:139], 0
  v_mfma_f32_16x16x32_bf16 v[120:123], v[72:75], v[136:139], 0
  v_mfma_f32_16x16x32_bf16 v[124:127], v[76:79], v[136:139], 0
  s_nop 1
  v_mfma_f32_16x16x16_bf16 v[128:131], v[132:133], v[140:141], v[128:131]
  v_mfma_f32_16x16x16_bf16 v[112:115], v[96:97], v[140:141], v[112:115]
  v_mfma_f32_16x16x16_bf16 v[116:119], v[96:97], v[142:143], v[116:119]
  v_mfma_f32_16x16x16_bf16 v[120:123], v[98:99], v[140:141], v[120:123]
  v_mfma_f32_16x16x16_bf16 v[124:127], v[98:99], v[142:143], v[124:127]
  s_add_u32 s43, s18, 2
  s_and_b32 s24, s43, 6
  s_cmp_eq_u32 s24, 0
  s_cbranch_scc0 L_r12_gw_91
  s_cmp_lt_u32 s43, 64
  s_cbranch_scc0 L_r12_gw_91
  s_lshr_b32 s26, s43, 3
  s_cmp_eq_u32 s26, 0
  s_cselect_b32 s27, 64, 20
  s_lshl_b32 s26, s26, 2
  s_add_u32 s28, s26, 160
  s_add_u32 s29, s26, 192
  v_mov_b32 v12, s28
  s_mov_b32 s30, 262144
L_wc_92:
  buffer_load_dword v13, v12, s[12:15], 0 offen sc1
  s_waitcnt vmcnt(0)
  v_cmp_gt_u32 vcc, s27, v13
  s_cbranch_vccz L_wc_ok_93
  s_sleep 8
  s_sub_u32 s30, s30, 1
  s_cmp_lg_u32 s30, 0
  s_cbranch_scc1 L_wc_92
  s_branch L_fail
L_wc_ok_93:
  v_mov_b32 v12, s29
  s_mov_b32 s30, 262144
L_wc_94:
  buffer_load_dword v13, v12, s[12:15], 0 offen sc1
  s_waitcnt vmcnt(0)
  v_cmp_gt_u32 vcc, s27, v13
  s_cbranch_vccz L_wc_ok_95
  s_sleep 8
  s_sub_u32 s30, s30, 1
  s_cmp_lg_u32 s30, 0
  s_cbranch_scc1 L_wc_94
  s_branch L_fail
L_wc_ok_95:
L_r12_gw_91:
  s_lshl_b32 s24, s43, 18
  s_add_u32 s24, s24, s54
  s_lshl_b32 s25, s52, 10
  s_add_u32 s25, s25, s24
  s_add_u32 s25, s25, 0x2000000
  s_add_u32 s26, s25, 0
  buffer_load_dwordx4 v[16:19], v1, s[4:7], s26 offen
  s_add_u32 s26, s25, 2048
  buffer_load_dwordx4 v[20:23], v1, s[4:7], s26 offen
  s_add_u32 s26, s25, 4096
  buffer_load_dwordx4 v[24:27], v1, s[4:7], s26 offen
  s_add_u32 s26, s25, 6144
  buffer_load_dwordx4 v[28:31], v1, s[4:7], s26 offen
  s_add_u32 s26, s24, 0
  buffer_load_dwordx4 v[32:35], v1, s[4:7], s26 offen offset:0
  buffer_load_dwordx4 v[48:51], v1, s[4:7], s26 offen offset:1024
  s_add_u32 s26, s24, 2048
  buffer_load_dwordx4 v[36:39], v1, s[4:7], s26 offen offset:0
  buffer_load_dwordx4 v[52:55], v1, s[4:7], s26 offen offset:1024
  s_add_u32 s26, s24, 4096
  buffer_load_dwordx4 v[40:43], v1, s[4:7], s26 offen offset:0
  buffer_load_dwordx4 v[56:59], v1, s[4:7], s26 offen offset:1024
  s_add_u32 s26, s24, 6144
  buffer_load_dwordx4 v[44:47], v1, s[4:7], s26 offen offset:0
  buffer_load_dwordx4 v[60:63], v1, s[4:7], s26 offen offset:1024
  s_lshl_b32 s25, s53, 12
  s_add_u32 s25, s25, s24
  s_add_u32 s25, s25, 0x1000000
  s_add_u32 s26, s25, 0
  buffer_load_dwordx4 v[64:67], v1, s[4:7], s26 offen
  s_add_u32 s26, s25, 1024
  buffer_load_dwordx4 v[68:71], v1, s[4:7], s26 offen
  s_add_u32 s26, s25, 2048
  buffer_load_dwordx4 v[72:75], v1, s[4:7], s26 offen
  s_add_u32 s26, s25, 3072
  buffer_load_dwordx4 v[76:79], v1, s[4:7], s26 offen
  v_rcp_f32 v10, v128
  s_nop 2
  v_mul_f32 v112, v112, v10
  v_mul_f32 v113, v113, v10
  v_mul_f32 v114, v114, v10
  v_mul_f32 v115, v115, v10
  v_mul_f32 v116, v116, v10
  v_mul_f32 v117, v117, v10
  v_mul_f32 v118, v118, v10
  v_mul_f32 v119, v119, v10
  v_mul_f32 v120, v120, v10
  v_mul_f32 v121, v121, v10
  v_mul_f32 v122, v122, v10
  v_mul_f32 v123, v123, v10
  v_mul_f32 v124, v124, v10
  v_mul_f32 v125, v125, v10
  v_mul_f32 v126, v126, v10
  v_mul_f32 v127, v127, v10
  v_cvt_pk_bf16_f32 v80, v112, v113
  v_cvt_pk_bf16_f32 v81, v114, v115
  v_cvt_pk_bf16_f32 v82, v116, v117
  v_cvt_pk_bf16_f32 v83, v118, v119
  v_cvt_pk_bf16_f32 v84, v120, v121
  v_cvt_pk_bf16_f32 v85, v122, v123
  v_cvt_pk_bf16_f32 v86, v124, v125
  v_cvt_pk_bf16_f32 v87, v126, v127
  s_lshl_b32 s24, s52, 12
  s_lshl_b32 s25, s53, 11
  s_add_u32 s24, s24, s25
  v_add_u32 v8, s24, v1
  s_barrier
  ds_write_b128 v8, v[80:83] offset:0
  ds_write_b128 v8, v[84:87] offset:1024
  s_waitcnt lgkmcnt(0)
  s_barrier
  ds_read_b128 v[144:147], v1 offset:0
  ds_read_b128 v[160:163], v1 offset:4096
  ds_read_b128 v[148:151], v1 offset:1024
  ds_read_b128 v[164:167], v1 offset:5120
  ds_read_b128 v[152:155], v1 offset:2048
  ds_read_b128 v[168:171], v1 offset:6144
  ds_read_b128 v[156:159], v1 offset:3072
  ds_read_b128 v[172:175], v1 offset:7168
  s_waitcnt lgkmcnt(6)
  v_mfma_f32_16x16x32_bf16 v[176:179], a[0:3], v[144:147], 0
  v_mfma_f32_16x16x32_bf16 v[180:183], a[0:3], v[160:163], 0
  v_mfma_f32_16x16x32_bf16 v[184:187], a[16:19], v[144:147], 0
  v_mfma_f32_16x16x32_bf16 v[188:191], a[16:19], v[160:163], 0
  v_mfma_f32_16x16x32_bf16 v[192:195], a[32:35], v[144:147], 0
  v_mfma_f32_16x16x32_bf16 v[196:199], a[32:35], v[160:163], 0
  v_mfma_f32_16x16x32_bf16 v[200:203], a[48:51], v[144:147], 0
  v_mfma_f32_16x16x32_bf16 v[204:207], a[48:51], v[160:163], 0
  v_mfma_f32_16x16x32_bf16 v[208:211], a[64:67], v[144:147], 0
  v_mfma_f32_16x16x32_bf16 v[212:215], a[64:67], v[160:163], 0
  v_mfma_f32_16x16x32_bf16 v[216:219], a[80:83], v[144:147], 0
  v_mfma_f32_16x16x32_bf16 v[220:223], a[80:83], v[160:163], 0
  v_mfma_f32_16x16x32_bf16 v[224:227], a[96:99], v[144:147], 0
  v_mfma_f32_16x16x32_bf16 v[228:231], a[96:99], v[160:163], 0
  v_mfma_f32_16x16x32_bf16 v[232:235], a[112:115], v[144:147], 0
  v_mfma_f32_16x16x32_bf16 v[236:239], a[112:115], v[160:163], 0
  v_mfma_f32_16x16x32_bf16 v[240:243], a[128:131], v[144:147], 0
  v_mfma_f32_16x16x32_bf16 v[244:247], a[128:131], v[160:163], 0
  s_waitcnt lgkmcnt(4)
  v_mfma_f32_16x16x32_bf16 v[176:179], a[4:7], v[148:151], v[176:179]
  v_mfma_f32_16x16x32_bf16 v[180:183], a[4:7], v[164:167], v[180:183]
  v_mfma_f32_16x16x32_bf16 v[184:187], a[20:23], v[148:151], v[184:187]
  v_mfma_f32_16x16x32_bf16 v[188:191], a[20:23], v[164:167], v[188:191]
  v_mfma_f32_16x16x32_bf16 v[192:195], a[36:39], v[148:151], v[192:195]
  v_mfma_f32_16x16x32_bf16 v[196:199], a[36:39], v[164:167], v[196:199]
  v_mfma_f32_16x16x32_bf16 v[200:203], a[52:55], v[148:151], v[200:203]
  v_mfma_f32_16x16x32_bf16 v[204:207], a[52:55], v[164:167], v[204:207]
  v_mfma_f32_16x16x32_bf16 v[208:211], a[68:71], v[148:151], v[208:211]
  v_mfma_f32_16x16x32_bf16 v[212:215], a[68:71], v[164:167], v[212:215]
  v_mfma_f32_16x16x32_bf16 v[216:219], a[84:87], v[148:151], v[216:219]
  v_mfma_f32_16x16x32_bf16 v[220:223], a[84:87], v[164:167], v[220:223]
  v_mfma_f32_16x16x32_bf16 v[224:227], a[100:103], v[148:151], v[224:227]
  v_mfma_f32_16x16x32_bf16 v[228:231], a[100:103], v[164:167], v[228:231]
  v_mfma_f32_16x16x32_bf16 v[232:235], a[116:119], v[148:151], v[232:235]
  v_mfma_f32_16x16x32_bf16 v[236:239], a[116:119], v[164:167], v[236:239]
  v_mfma_f32_16x16x32_bf16 v[240:243], a[132:135], v[148:151], v[240:243]
  v_mfma_f32_16x16x32_bf16 v[244:247], a[132:135], v[164:167], v[244:247]
  s_waitcnt lgkmcnt(2)
  v_mfma_f32_16x16x32_bf16 v[176:179], a[8:11], v[152:155], v[176:179]
  v_mfma_f32_16x16x32_bf16 v[180:183], a[8:11], v[168:171], v[180:183]
  v_mfma_f32_16x16x32_bf16 v[184:187], a[24:27], v[152:155], v[184:187]
  v_mfma_f32_16x16x32_bf16 v[188:191], a[24:27], v[168:171], v[188:191]
  v_mfma_f32_16x16x32_bf16 v[192:195], a[40:43], v[152:155], v[192:195]
  v_mfma_f32_16x16x32_bf16 v[196:199], a[40:43], v[168:171], v[196:199]
  v_mfma_f32_16x16x32_bf16 v[200:203], a[56:59], v[152:155], v[200:203]
  v_mfma_f32_16x16x32_bf16 v[204:207], a[56:59], v[168:171], v[204:207]
  v_mfma_f32_16x16x32_bf16 v[208:211], a[72:75], v[152:155], v[208:211]
  v_mfma_f32_16x16x32_bf16 v[212:215], a[72:75], v[168:171], v[212:215]
  v_mfma_f32_16x16x32_bf16 v[216:219], a[88:91], v[152:155], v[216:219]
  v_mfma_f32_16x16x32_bf16 v[220:223], a[88:91], v[168:171], v[220:223]
  v_mfma_f32_16x16x32_bf16 v[224:227], a[104:107], v[152:155], v[224:227]
  v_mfma_f32_16x16x32_bf16 v[228:231], a[104:107], v[168:171], v[228:231]
  v_mfma_f32_16x16x32_bf16 v[232:235], a[120:123], v[152:155], v[232:235]
  v_mfma_f32_16x16x32_bf16 v[236:239], a[120:123], v[168:171], v[236:239]
  v_mfma_f32_16x16x32_bf16 v[240:243], a[136:139], v[152:155], v[240:243]
  v_mfma_f32_16x16x32_bf16 v[244:247], a[136:139], v[168:171], v[244:247]
  s_waitcnt lgkmcnt(0)
  v_mfma_f32_16x16x32_bf16 v[176:179], a[12:15], v[156:159], v[176:179]
  v_mfma_f32_16x16x32_bf16 v[180:183], a[12:15], v[172:175], v[180:183]
  v_mfma_f32_16x16x32_bf16 v[184:187], a[28:31], v[156:159], v[184:187]
  v_mfma_f32_16x16x32_bf16 v[188:191], a[28:31], v[172:175], v[188:191]
  v_mfma_f32_16x16x32_bf16 v[192:195], a[44:47], v[156:159], v[192:195]
  v_mfma_f32_16x16x32_bf16 v[196:199], a[44:47], v[172:175], v[196:199]
  v_mfma_f32_16x16x32_bf16 v[200:203], a[60:63], v[156:159], v[200:203]
  v_mfma_f32_16x16x32_bf16 v[204:207], a[60:63], v[172:175], v[204:207]
  v_mfma_f32_16x16x32_bf16 v[208:211], a[76:79], v[156:159], v[208:211]
  v_mfma_f32_16x16x32_bf16 v[212:215], a[76:79], v[172:175], v[212:215]
  v_mfma_f32_16x16x32_bf16 v[216:219], a[92:95], v[156:159], v[216:219]
  v_mfma_f32_16x16x32_bf16 v[220:223], a[92:95], v[172:175], v[220:223]
  v_mfma_f32_16x16x32_bf16 v[224:227], a[108:111], v[156:159], v[224:227]
  v_mfma_f32_16x16x32_bf16 v[228:231], a[108:111], v[172:175], v[228:231]
  v_mfma_f32_16x16x32_bf16 v[232:235], a[124:127], v[156:159], v[232:235]
  v_mfma_f32_16x16x32_bf16 v[236:239], a[124:127], v[172:175], v[236:239]
  v_mfma_f32_16x16x32_bf16 v[240:243], a[140:143], v[156:159], v[240:243]
  v_mfma_f32_16x16x32_bf16 v[244:247], a[140:143], v[172:175], v[244:247]
  s_nop 7
  s_and_b32 s24, s18, 7
  s_mul_i32 s24, s24, 1703936
  s_add_u32 s24, s24, s55
  v_cvt_pk_bf16_f32 v144, v176, v177
  v_cvt_pk_bf16_f32 v145, v178, v179
  v_cvt_pk_bf16_f32 v146, v184, v185
  v_cvt_pk_bf16_f32 v147, v186, v187
  v_cvt_pk_bf16_f32 v148, v192, v193
  v_cvt_pk_bf16_f32 v149, v194, v195
  v_cvt_pk_bf16_f32 v150, v200, v201
  v_cvt_pk_bf16_f32 v151, v202, v203
  s_mov_b64 vcc, s[62:63]
  s_nop 0
  v_cndmask_b32_dpp v152, v148, v144, vcc row_shr:8 row_mask:0xf bank_mask:0xf bound_ctrl:1
  v_cndmask_b32_dpp v153, v149, v145, vcc row_shr:8 row_mask:0xf bank_mask:0xf bound_ctrl:1
  v_cndmask_b32_dpp v154, v150, v146, vcc row_shr:8 row_mask:0xf bank_mask:0xf bound_ctrl:1
  v_cndmask_b32_dpp v155, v151, v147, vcc row_shr:8 row_mask:0xf bank_mask:0xf bound_ctrl:1
  s_not_b64 vcc, vcc
  v_cndmask_b32_dpp v156, v144, v148, vcc row_shl:8 row_mask:0xf bank_mask:0xf bound_ctrl:1
  v_cndmask_b32_dpp v157, v145, v149, vcc row_shl:8 row_mask:0xf bank_mask:0xf bound_ctrl:1
  v_cndmask_b32_dpp v158, v146, v150, vcc row_shl:8 row_mask:0xf bank_mask:0xf bound_ctrl:1
  v_cndmask_b32_dpp v159, v147, v151, vcc row_shl:8 row_mask:0xf bank_mask:0xf bound_ctrl:1
  ds_bpermute_b32 v160, v249, v152
  ds_bpermute_b32 v161, v249, v153
  ds_bpermute_b32 v162, v249, v154
  ds_bpermute_b32 v163, v249, v155
  ds_bpermute_b32 v164, v249, v156
  ds_bpermute_b32 v165, v249, v157
  ds_bpermute_b32 v166, v249, v158
  ds_bpermute_b32 v167, v249, v159
  s_add_u32 s33, s24, 0
  s_add_u32 s34, s33, 425984
  s_waitcnt lgkmcnt(4)
  buffer_store_dwordx4 v[160:163], v2, s[4:7], s33 offen sc1
  s_waitcnt lgkmcnt(0)
  buffer_store_dwordx4 v[164:167], v2, s[4:7], s34 offen sc1
  v_cvt_pk_bf16_f32 v144, v208, v209
  v_cvt_pk_bf16_f32 v145, v210, v211
  v_cvt_pk_bf16_f32 v146, v216, v217
  v_cvt_pk_bf16_f32 v147, v218, v219
  v_cvt_pk_bf16_f32 v148, v224, v225
  v_cvt_pk_bf16_f32 v149, v226, v227
  v_cvt_pk_bf16_f32 v150, v232, v233
  v_cvt_pk_bf16_f32 v151, v234, v235
  s_mov_b64 vcc, s[62:63]
  s_nop 0
  v_cndmask_b32_dpp v152, v148, v144, vcc row_shr:8 row_mask:0xf bank_mask:0xf bound_ctrl:1
  v_cndmask_b32_dpp v153, v149, v145, vcc row_shr:8 row_mask:0xf bank_mask:0xf bound_ctrl:1
  v_cndmask_b32_dpp v154, v150, v146, vcc row_shr:8 row_mask:0xf bank_mask:0xf bound_ctrl:1
  v_cndmask_b32_dpp v155, v151, v147, vcc row_shr:8 row_mask:0xf bank_mask:0xf bound_ctrl:1
  s_not_b64 vcc, vcc
  v_cndmask_b32_dpp v156, v144, v148, vcc row_shl:8 row_mask:0xf bank_mask:0xf bound_ctrl:1
  v_cndmask_b32_dpp v157, v145, v149, vcc row_shl:8 row_mask:0xf bank_mask:0xf bound_ctrl:1
  v_cndmask_b32_dpp v158, v146, v150, vcc row_shl:8 row_mask:0xf bank_mask:0xf bound_ctrl:1
  v_cndmask_b32_dpp v159, v147, v151, vcc row_shl:8 row_mask:0xf bank_mask:0xf bound_ctrl:1
  ds_bpermute_b32 v160, v249, v152
  ds_bpermute_b32 v161, v249, v153
  ds_bpermute_b32 v162, v249, v154
  ds_bpermute_b32 v163, v249, v155
  ds_bpermute_b32 v164, v249, v156
  ds_bpermute_b32 v165, v249, v157
  ds_bpermute_b32 v166, v249, v158
  ds_bpermute_b32 v167, v249, v159
  s_add_u32 s33, s24, 128
  s_add_u32 s34, s33, 425984
  s_waitcnt lgkmcnt(4)
  buffer_store_dwordx4 v[160:163], v2, s[4:7], s33 offen sc1
  s_waitcnt lgkmcnt(0)
  buffer_store_dwordx4 v[164:167], v2, s[4:7], s34 offen sc1
  v_cvt_pk_bf16_f32 v144, v240, v241
  v_cvt_pk_bf16_f32 v145, v242, v243
  ds_bpermute_b32 v148, v251, v144
  ds_bpermute_b32 v149, v251, v145
  s_add_u32 s33, s24, 0
  s_waitcnt lgkmcnt(0)
  buffer_store_dwordx2 v[148:149], v248, s[4:7], s33 offen sc1
  v_cvt_pk_bf16_f32 v144, v180, v181
  v_cvt_pk_bf16_f32 v145, v182, v183
  v_cvt_pk_bf16_f32 v146, v188, v189
  v_cvt_pk_bf16_f32 v147, v190, v191
  v_cvt_pk_bf16_f32 v148, v196, v197
  v_cvt_pk_bf16_f32 v149, v198, v199
  v_cvt_pk_bf16_f32 v150, v204, v205
  v_cvt_pk_bf16_f32 v151, v206, v207
  s_mov_b64 vcc, s[62:63]
  s_nop 0
  v_cndmask_b32_dpp v152, v148, v144, vcc row_shr:8 row_mask:0xf bank_mask:0xf bound_ctrl:1
  v_cndmask_b32_dpp v153, v149, v145, vcc row_shr:8 row_mask:0xf bank_mask:0xf bound_ctrl:1
  v_cndmask_b32_dpp v154, v150, v146, vcc row_shr:8 row_mask:0xf bank_mask:0xf bound_ctrl:1
  v_cndmask_b32_dpp v155, v151, v147, vcc row_shr:8 row_mask:0xf bank_mask:0xf bound_ctrl:1
  s_not_b64 vcc, vcc
  v_cndmask_b32_dpp v156, v144, v148, vcc row_shl:8 row_mask:0xf bank_mask:0xf bound_ctrl:1
  v_cndmask_b32_dpp v157, v145, v149, vcc row_shl:8 row_mask:0xf bank_mask:0xf bound_ctrl:1
  v_cndmask_b32_dpp v158, v146, v150, vcc row_shl:8 row_mask:0xf bank_mask:0xf bound_ctrl:1
  v_cndmask_b32_dpp v159, v147, v151, vcc row_shl:8 row_mask:0xf bank_mask:0xf bound_ctrl:1
  ds_bpermute_b32 v160, v249, v152
  ds_bpermute_b32 v161, v249, v153
  ds_bpermute_b32 v162, v249, v154
  ds_bpermute_b32 v163, v249, v155
  ds_bpermute_b32 v164, v249, v156
  ds_bpermute_b32 v165, v249, v157
  ds_bpermute_b32 v166, v249, v158
  ds_bpermute_b32 v167, v249, v159
  s_add_u32 s33, s24, 851968
  s_add_u32 s34, s33, 425984
  s_waitcnt lgkmcnt(4)
  buffer_store_dwordx4 v[160:163], v2, s[4:7], s33 offen sc1
  s_waitcnt lgkmcnt(0)
  buffer_store_dwordx4 v[164:167], v2, s[4:7], s34 offen sc1
  v_cvt_pk_bf16_f32 v144, v212, v213
  v_cvt_pk_bf16_f32 v145, v214, v215
  v_cvt_pk_bf16_f32 v146, v220, v221
  v_cvt_pk_bf16_f32 v147, v222, v223
  v_cvt_pk_bf16_f32 v148, v228, v229
  v_cvt_pk_bf16_f32 v149, v230, v231
  v_cvt_pk_bf16_f32 v150, v236, v237
  v_cvt_pk_bf16_f32 v151, v238, v239
  s_mov_b64 vcc, s[62:63]
  s_nop 0
  v_cndmask_b32_dpp v152, v148, v144, vcc row_shr:8 row_mask:0xf bank_mask:0xf bound_ctrl:1
  v_cndmask_b32_dpp v153, v149, v145, vcc row_shr:8 row_mask:0xf bank_mask:0xf bound_ctrl:1
  v_cndmask_b32_dpp v154, v150, v146, vcc row_shr:8 row_mask:0xf bank_mask:0xf bound_ctrl:1
  v_cndmask_b32_dpp v155, v151, v147, vcc row_shr:8 row_mask:0xf bank_mask:0xf bound_ctrl:1
  s_not_b64 vcc, vcc
  v_cndmask_b32_dpp v156, v144, v148, vcc row_shl:8 row_mask:0xf bank_mask:0xf bound_ctrl:1
  v_cndmask_b32_dpp v157, v145, v149, vcc row_shl:8 row_mask:0xf bank_mask:0xf bound_ctrl:1
  v_cndmask_b32_dpp v158, v146, v150, vcc row_shl:8 row_mask:0xf bank_mask:0xf bound_ctrl:1
  v_cndmask_b32_dpp v159, v147, v151, vcc row_shl:8 row_mask:0xf bank_mask:0xf bound_ctrl:1
  ds_bpermute_b32 v160, v249, v152
  ds_bpermute_b32 v161, v249, v153
  ds_bpermute_b32 v162, v249, v154
  ds_bpermute_b32 v163, v249, v155
  ds_bpermute_b32 v164, v249, v156
  ds_bpermute_b32 v165, v249, v157
  ds_bpermute_b32 v166, v249, v158
  ds_bpermute_b32 v167, v249, v159
  s_add_u32 s33, s24, 852096
  s_add_u32 s34, s33, 425984
  s_waitcnt lgkmcnt(4)
  buffer_store_dwordx4 v[160:163], v2, s[4:7], s33 offen sc1
  s_waitcnt lgkmcnt(0)
  buffer_store_dwordx4 v[164:167], v2, s[4:7], s34 offen sc1
  v_cvt_pk_bf16_f32 v144, v244, v245
  v_cvt_pk_bf16_f32 v145, v246, v247
  ds_bpermute_b32 v148, v251, v144
  ds_bpermute_b32 v149, v251, v145
  s_add_u32 s33, s24, 851968
  s_waitcnt lgkmcnt(0)
  buffer_store_dwordx2 v[148:149], v248, s[4:7], s33 offen sc1
  s_add_u32 s42, s18, 1
  s_add_u32 s18, s18, 2
  s_cmp_lt_u32 s18, 64
  s_cbranch_scc1 L_r12_top_82
  s_waitcnt vmcnt(0)
  s_barrier
  s_cmp_eq_u32 s17, 0
  s_cbranch_scc0 L_sf_96
  v_mov_b32 v8, s42
  v_mov_b32 v9, 0
  s_mov_b64 exec, 1
  buffer_store_dword v8, v9, s[4:7], s41 offen sc1
  s_mov_b64 exec, -1
L_sf_96:
  s_endpgm
L_role_r3:
  s_sub_u32 s16, s23, 64
  s_load_dwordx2 s[8:9], s[0:1], 0
  s_mov_b32 s10, 0x240000
  s_mov_b32 s11, 0x00020000
  s_waitcnt lgkmcnt(0)
  s_and_b32 s9, s9, 0xffff
  v_and_b32 v20, 15, v0
  v_mov_b32 v21, 0x3f80
  v_mov_b32 v22, 0x3f800000
  v_and_b32 v12, 1, v20
  v_cmp_eq_u32 vcc, 0, v12
  s_nop 1
  v_cndmask_b32 v21, v22, v21, vcc
  v_lshrrev_b32 v20, 1, v20
  v_cmp_eq_u32 vcc, 0, v20
  s_nop 1
  v_cndmask_b32 v12, 0, v21, vcc
  v_cmp_eq_u32 vcc, 1, v20
  s_nop 1
  v_cndmask_b32 v13, 0, v21, vcc
  v_cmp_eq_u32 vcc, 2, v20
  s_nop 1
  v_cndmask_b32 v14, 0, v21, vcc
  v_cmp_eq_u32 vcc, 3, v20
  s_nop 1
  v_cndmask_b32 v15, 0, v21, vcc
  s_nop 1
  v_mov_b32_dpp v16, v12 row_shr:8 row_mask:0xf bank_mask:0xf bound_ctrl:1
  v_mov_b32_dpp v17, v13 row_shr:8 row_mask:0xf bank_mask:0xf bound_ctrl:1
  v_mov_b32_dpp v18, v14 row_shr:8 row_mask:0xf bank_mask:0xf bound_ctrl:1
  v_mov_b32_dpp v19, v15 row_shr:8 row_mask:0xf bank_mask:0xf bound_ctrl:1
  v_and_b32 v20, 63, v0
  v_lshrrev_b32 v21, 4, v20
  v_and_b32 v22, 15, v20
  v_mul_u32_u24 v1, 1664, v21
  v_lshl_add_u32 v1, v22, 4, v1
  v_lshrrev_b32 v23, 3, v22
  v_lshl_add_u32 v2, v23, 2, v21
  v_mul_u32_u24 v2, 1664, v2
  v_bfe_u32 v24, v22, 1, 2
  v_mul_u32_u24 v24, 384, v24
  v_add_u32 v2, v2, v24
  v_and_b32 v24, 1, v22
  v_lshl_add_u32 v2, v24, 4, v2
  v_add_u32 v2, 256, v2
  v_and_b32 v24, 1, v21
  v_lshrrev_b32 v23, 1, v21
  v_add_u32 v23, 0, v23
  v_mul_u32_u24 v23, 9, v23
  v_lshrrev_b32 v25, 2, v22
  v_lshl_add_u32 v23, v25, 1, v23
  v_add_u32 v23, v23, v24
  v_and_b32 v25, 3, v22
  v_lshrrev_b32 v4, 1, v23
  v_lshlrev_b32 v4, 6, v4
  v_lshl_add_u32 v4, v25, 4, v4
  v_and_b32 v26, 1, v23
  v_lshl_add_u32 v4, v26, 3, v4
  v_lshlrev_b32 v7, 5, v23
  v_lshl_add_u32 v7, v25, 3, v7
  v_and_b32 v24, 1, v21
  v_lshrrev_b32 v23, 1, v21
  v_add_u32 v23, 2, v23
  v_mul_u32_u24 v23, 9, v23
  v_lshrrev_b32 v25, 2, v22
  v_lshl_add_u32 v23, v25, 1, v23
  v_add_u32 v23, v23, v24
  v_and_b32 v25, 3, v22
  v_lshrrev_b32 v5, 1, v23
  v_lshlrev_b32 v5, 6, v5
  v_lshl_add_u32 v5, v25, 4, v5
  v_and_b32 v26, 1, v23
  v_lshl_add_u32 v5, v26, 3, v5
  v_lshlrev_b32 v8, 5, v23
  v_lshl_add_u32 v8, v25, 3, v8
  v_and_b32 v24, 1, v21
  v_bfe_u32 v23, v22, 1, 2
  v_mul_u32_u24 v23, 9, v23
  v_add_u32 v23, 8, v23
  v_and_b32 v25, 1, v22
  v_lshl_add_u32 v25, v25, 1, v24
  v_lshrrev_b32 v6, 1, v23
  v_lshlrev_b32 v6, 6, v6
  v_lshl_add_u32 v6, v25, 4, v6
  v_and_b32 v26, 1, v23
  v_lshl_add_u32 v6, v26, 3, v6
  v_lshlrev_b32 v9, 5, v23
  v_lshl_add_u32 v9, v25, 3, v9
  v_cmp_gt_u32 vcc, 8, v22
  v_cmp_gt_u32 s[34:35], 2, v21
  s_nop 1
  s_and_b64 vcc, vcc, s[34:35]
  v_mov_b32 v26, 0x40000000
  s_nop 0
  v_cndmask_b32 v6, v26, v6, vcc
  v_cndmask_b32 v9, v26, v9, vcc
  v_and_b32 v20, 63, v0
  v_min_u32 v3, 31, v20
  v_lshlrev_b32 v3, 2, v3
  v_mov_b32 v232, 128
  s_mov_b32 s24, 262144
L_wc_97:
  buffer_load_dword v233, v232, s[12:15], 0 offen sc1
  s_waitcnt vmcnt(0)
  v_cmp_gt_u32 vcc, 33, v233
  s_cbranch_vccz L_wc_ok_98
  s_sleep 8
  s_sub_u32 s24, s24, 1
  s_cmp_lg_u32 s24, 0
  s_cbranch_scc1 L_wc_97
  s_branch L_fail
L_wc_ok_98:
  s_lshl_b32 s47, s16, 2
  s_add_u32 s47, s47, s17
  s_mov_b32 s38, 0x07060302
L_r3_top_99:
  s_lshr_b32 s18, s47, 5
  s_and_b32 s52, s47, 31
  s_mul_i32 s45, s47, 1152
  buffer_load_dwordx2 v[48:49], v7, s[8:11], s45 offen
  buffer_load_dwordx2 v[50:51], v8, s[8:11], s45 offen
  buffer_load_dwordx2 v[52:53], v9, s[8:11], s45 offen
  s_and_b32 s46, s18, 1
  s_lshl_b32 s46, s46, 7
  s_add_u32 s46, s46, 0xe900400
  s_add_u32 s28, s18, 1
  s_mov_b32 s40, 262144
  buffer_load_dword v20, v3, s[4:7], s46 offen sc1
L_wf_first_103:
  s_waitcnt vmcnt(0)
  v_cmp_gt_u32 vcc, s28, v20
  s_cbranch_vccz L_wf_ok_101
L_wf_100:
  s_sleep 8
  buffer_load_dword v20, v3, s[4:7], s46 offen sc1
  s_waitcnt vmcnt(0)
  v_cmp_gt_u32 vcc, s28, v20
  s_cbranch_vccz L_wf_ok_101
  s_sub_u32 s40, s40, 1
  s_cmp_lg_u32 s40, 0
  s_cbranch_scc1 L_wf_100
  s_branch L_fail
L_wf_ok_101:
  s_and_b32 s44, s18, 7
  s_mul_i32 s44, s44, 1703936
  s_mul_i32 s24, s52, 53248
  s_add_u32 s44, s44, s24
  s_add_u32 s44, s44, 0x4000000
  s_and_b32 s41, s18, 7
  s_lshl_b32 s41, s41, 5
  s_add_u32 s41, s41, s52
  s_lshl_b32 s41, s41, 2
  s_add_u32 s41, s41, 0xe901800
  s_add_u32 s32, s44, 0
  buffer_load_dwordx4 a[0:3], v1, s[4:7], s32 offen sc1
  s_add_u32 s32, s44, 6656
  buffer_load_dwordx4 a[4:7], v1, s[4:7], s32 offen sc1
  s_add_u32 s32, s44, 13312
  buffer_load_dwordx4 a[8:11], v1, s[4:7], s32 offen sc1
  s_add_u32 s32, s44, 19968
  buffer_load_dwordx4 a[12:15], v1, s[4:7], s32 offen sc1
  s_add_u32 s32, s44, 26624
  buffer_load_dwordx4 a[16:19], v1, s[4:7], s32 offen sc1
  s_add_u32 s32, s44, 33280
  buffer_load_dwordx4 a[20:23], v1, s[4:7], s32 offen sc1
  s_add_u32 s32, s44, 39936
  buffer_load_dwordx4 a[24:27], v1, s[4:7], s32 offen sc1
  s_add_u32 s32, s44, 46592
  buffer_load_dwordx4 a[28:31], v1, s[4:7], s32 offen sc1
  s_add_u32 s32, s44, 384
  buffer_load_dwordx4 a[32:35], v1, s[4:7], s32 offen sc1
  s_add_u32 s32, s44, 7040
  buffer_load_dwordx4 a[36:39], v1, s[4:7], s32 offen sc1
  s_add_u32 s32, s44, 13696
  buffer_load_dwordx4 a[40:43], v1, s[4:7], s32 offen sc1
  s_add_u32 s32, s44, 20352
  buffer_load_dwordx4 a[44:47], v1, s[4:7], s32 offen sc1
  s_add_u32 s32, s44, 27008
  buffer_load_dwordx4 a[48:51], v1, s[4:7], s32 offen sc1
  s_add_u32 s32, s44, 33664
  buffer_load_dwordx4 a[52:55], v1, s[4:7], s32 offen sc1
  s_add_u32 s32, s44, 40320
  buffer_load_dwordx4 a[56:59], v1, s[4:7], s32 offen sc1
  s_add_u32 s32, s44, 46976
  buffer_load_dwordx4 a[60:63], v1, s[4:7], s32 offen sc1
  s_add_u32 s32, s44, 768
  buffer_load_dwordx4 a[64:67], v1, s[4:7], s32 offen sc1
  s_add_u32 s32, s44, 7424
  buffer_load_dwordx4 a[68:71], v1, s[4:7], s32 offen sc1
  s_add_u32 s32, s44, 14080
  buffer_load_dwordx4 a[72:75], v1, s[4:7], s32 offen sc1
  s_add_u32 s32, s44, 20736
  buffer_load_dwordx4 a[76:79], v1, s[4:7], s32 offen sc1
  s_add_u32 s32, s44, 27392
  buffer_load_dwordx4 a[80:83], v1, s[4:7], s32 offen sc1
  s_add_u32 s32, s44, 34048
  buffer_load_dwordx4 a[84:87], v1, s[4:7], s32 offen sc1
  s_add_u32 s32, s44, 40704
  buffer_load_dwordx4 a[88:91], v1, s[4:7], s32 offen sc1
  s_add_u32 s32, s44, 47360
  buffer_load_dwordx4 a[92:95], v1, s[4:7], s32 offen sc1
  s_add_u32 s32, s44, 1152
  buffer_load_dwordx4 a[96:99], v1, s[4:7], s32 offen sc1
  s_add_u32 s32, s44, 7808
  buffer_load_dwordx4 a[100:103], v1, s[4:7], s32 offen sc1
  s_add_u32 s32, s44, 14464
  buffer_load_dwordx4 a[104:107], v1, s[4:7], s32 offen sc1
  s_add_u32 s32, s44, 21120
  buffer_load_dwordx4 a[108:111], v1, s[4:7], s32 offen sc1
  s_add_u32 s32, s44, 27776
  buffer_load_dwordx4 a[112:115], v1, s[4:7], s32 offen sc1
  s_add_u32 s32, s44, 34432
  buffer_load_dwordx4 a[116:119], v1, s[4:7], s32 offen sc1
  s_add_u32 s32, s44, 41088
  buffer_load_dwordx4 a[120:123], v1, s[4:7], s32 offen sc1
  s_add_u32 s32, s44, 47744
  buffer_load_dwordx4 a[124:127], v1, s[4:7], s32 offen sc1
  s_add_u32 s32, s44, 0
  buffer_load_dwordx4 a[128:131], v2, s[4:7], s32 offen sc1
  s_add_u32 s32, s44, 13312
  buffer_load_dwordx4 a[132:135], v2, s[4:7], s32 offen sc1
  s_add_u32 s32, s44, 26624
  buffer_load_dwordx4 a[136:139], v2, s[4:7], s32 offen sc1
  s_add_u32 s32, s44, 39936
  buffer_load_dwordx4 a[140:143], v2, s[4:7], s32 offen sc1
  s_waitcnt vmcnt(35)
  v_mfma_f32_16x16x32_bf16 v[36:39], v[12:15], a[0:3], 0
  s_waitcnt vmcnt(34)
  v_mfma_f32_16x16x32_bf16 v[36:39], v[12:15], a[4:7], v[36:39]
  s_waitcnt vmcnt(33)
  v_mfma_f32_16x16x32_bf16 v[36:39], v[12:15], a[8:11], v[36:39]
  s_waitcnt vmcnt(32)
  v_mfma_f32_16x16x32_bf16 v[36:39], v[12:15], a[12:15], v[36:39]
  s_waitcnt vmcnt(31)
  v_mfma_f32_16x16x32_bf16 v[36:39], v[12:15], a[16:19], v[36:39]
  s_waitcnt vmcnt(30)
  v_mfma_f32_16x16x32_bf16 v[36:39], v[12:15], a[20:23], v[36:39]
  s_waitcnt vmcnt(29)
  v_mfma_f32_16x16x32_bf16 v[36:39], v[12:15], a[24:27], v[36:39]
  s_waitcnt vmcnt(28)
  v_mfma_f32_16x16x32_bf16 v[36:39], v[12:15], a[28:31], v[36:39]
  s_waitcnt vmcnt(27)
  v_mfma_f32_16x16x32_bf16 v[36:39], v[16:19], a[32:35], v[36:39]
  s_waitcnt vmcnt(26)
  v_mfma_f32_16x16x32_bf16 v[36:39], v[16:19], a[36:39], v[36:39]
  s_waitcnt vmcnt(25)
  v_mfma_f32_16x16x32_bf16 v[36:39], v[16:19], a[40:43], v[36:39]
  s_waitcnt vmcnt(24)
  v_mfma_f32_16x16x32_bf16 v[36:39], v[16:19], a[44:47], v[36:39]
  s_waitcnt vmcnt(23)
  v_mfma_f32_16x16x32_bf16 v[36:39], v[16:19], a[48:51], v[36:39]
  s_waitcnt vmcnt(22)
  v_mfma_f32_16x16x32_bf16 v[36:39], v[16:19], a[52:55], v[36:39]
  s_waitcnt vmcnt(21)
  v_mfma_f32_16x16x32_bf16 v[36:39], v[16:19], a[56:59], v[36:39]
  s_waitcnt vmcnt(20)
  v_mfma_f32_16x16x32_bf16 v[36:39], v[16:19], a[60:63], v[36:39]
  s_waitcnt vmcnt(19)
  v_mfma_f32_16x16x32_bf16 v[40:43], v[12:15], a[64:67], 0
  s_waitcnt vmcnt(18)
  v_mfma_f32_16x16x32_bf16 v[40:43], v[12:15], a[68:71], v[40:43]
  s_waitcnt vmcnt(17)
  v_mfma_f32_16x16x32_bf16 v[40:43], v[12:15], a[72:75], v[40:43]
  s_waitcnt vmcnt(16)
  v_mfma_f32_16x16x32_bf16 v[40:43], v[12:15], a[76:79], v[40:43]
  s_waitcnt vmcnt(15)
  v_mfma_f32_16x16x32_bf16 v[40:43], v[12:15], a[80:83], v[40:43]
  s_waitcnt vmcnt(14)
  v_mfma_f32_16x16x32_bf16 v[40:43], v[12:15], a[84:87], v[40:43]
  s_waitcnt vmcnt(13)
  v_mfma_f32_16x16x32_bf16 v[40:43], v[12:15], a[88:91], v[40:43]
  s_waitcnt vmcnt(12)
  v_mfma_f32_16x16x32_bf16 v[40:43], v[12:15], a[92:95], v[40:43]
  s_waitcnt vmcnt(11)
  v_mfma_f32_16x16x32_bf16 v[40:43], v[16:19], a[96:99], v[40:43]
  s_waitcnt vmcnt(10)
  v_mfma_f32_16x16x32_bf16 v[40:43], v[16:19], a[100:103], v[40:43]
  s_waitcnt vmcnt(9)
  v_mfma_f32_16x16x32_bf16 v[40:43], v[16:19], a[104:107], v[40:43]
  s_waitcnt vmcnt(8)
  v_mfma_f32_16x16x32_bf16 v[40:43], v[16:19], a[108:111], v[40:43]
  s_waitcnt vmcnt(7)
  v_mfma_f32_16x16x32_bf16 v[40:43], v[16:19], a[112:115], v[40:43]
  s_waitcnt vmcnt(6)
  v_mfma_f32_16x16x32_bf16 v[40:43], v[16:19], a[116:119], v[40:43]
  s_waitcnt vmcnt(5)
  v_mfma_f32_16x16x32_bf16 v[40:43], v[16:19], a[120:123], v[40:43]
  s_waitcnt vmcnt(4)
  v_mfma_f32_16x16x32_bf16 v[40:43], v[16:19], a[124:127], v[40:43]
  s_waitcnt vmcnt(3)
  v_mfma_f32_16x16x32_bf16 v[44:47], v[12:15], a[128:131], 0
  s_waitcnt vmcnt(2)
  v_mfma_f32_16x16x32_bf16 v[44:47], v[12:15], a[132:135], v[44:47]
  s_waitcnt vmcnt(1)
  v_mfma_f32_16x16x32_bf16 v[44:47], v[12:15], a[136:139], v[44:47]
  s_waitcnt vmcnt(0)
  v_mfma_f32_16x16x32_bf16 v[44:47], v[12:15], a[140:143], v[44:47]
  s_nop 7
  v_add_f32_dpp v44, v44, v44 row_shl:8 row_mask:0xf bank_mask:0xf bound_ctrl:1
  v_add_f32_dpp v45, v45, v45 row_shl:8 row_mask:0xf bank_mask:0xf bound_ctrl:1
  v_add_f32_dpp v46, v46, v46 row_shl:8 row_mask:0xf bank_mask:0xf bound_ctrl:1
  v_add_f32_dpp v47, v47, v47 row_shl:8 row_mask:0xf bank_mask:0xf bound_ctrl:1
  v_cmp_gt_u32 vcc, 0x40000000, v6
  s_nop 1
  v_cndmask_b32 v44, 0, v44, vcc
  v_cndmask_b32 v45, 0, v45, vcc
  v_cndmask_b32 v46, 0, v46, vcc
  v_cndmask_b32 v47, 0, v47, vcc
  v_cvt_pk_bf16_f32 v36, v36, v36
  v_lshlrev_b32 v36, 16, v36
  v_cvt_pk_bf16_f32 v37, v37, v37
  v_lshlrev_b32 v37, 16, v37
  v_cvt_pk_bf16_f32 v38, v38, v38
  v_lshlrev_b32 v38, 16, v38
  v_cvt_pk_bf16_f32 v39, v39, v39
  v_lshlrev_b32 v39, 16, v39
  v_cvt_pk_bf16_f32 v40, v40, v40
  v_lshlrev_b32 v40, 16, v40
  v_cvt_pk_bf16_f32 v41, v41, v41
  v_lshlrev_b32 v41, 16, v41
  v_cvt_pk_bf16_f32 v42, v42, v42
  v_lshlrev_b32 v42, 16, v42
  v_cvt_pk_bf16_f32 v43, v43, v43
  v_lshlrev_b32 v43, 16, v43
  v_cvt_pk_bf16_f32 v44, v44, v44
  v_lshlrev_b32 v44, 16, v44
  v_cvt_pk_bf16_f32 v45, v45, v45
  v_lshlrev_b32 v45, 16, v45
  v_cvt_pk_bf16_f32 v46, v46, v46
  v_lshlrev_b32 v46, 16, v46
  v_cvt_pk_bf16_f32 v47, v47, v47
  v_lshlrev_b32 v47, 16, v47
  v_lshlrev_b32 v20, 16, v48
  v_and_b32 v21, 0xffff0000, v48
  v_lshlrev_b32 v22, 16, v49
  v_and_b32 v23, 0xffff0000, v49
  v_lshlrev_b32 v24, 16, v50
  v_and_b32 v25, 0xffff0000, v50
  v_lshlrev_b32 v26, 16, v51
  v_and_b32 v27, 0xffff0000, v51
  v_lshlrev_b32 v28, 16, v52
  v_and_b32 v29, 0xffff0000, v52
  v_lshlrev_b32 v30, 16, v53
  v_and_b32 v31, 0xffff0000, v53
  v_add_f32 v36, v36, v20
  v_add_f32 v37, v37, v21
  v_add_f32 v38, v38, v22
  v_add_f32 v39, v39, v23
  v_add_f32 v40, v40, v24
  v_add_f32 v41, v41, v25
  v_add_f32 v42, v42, v26
  v_add_f32 v43, v43, v27
  v_add_f32 v44, v44, v28
  v_add_f32 v45, v45, v29
  v_add_f32 v46, v46, v30
  v_add_f32 v47, v47, v31
  v_cvt_pk_bf16_f32 v36, v36, v36
  v_lshlrev_b32 v36, 16, v36
  v_cvt_pk_bf16_f32 v37, v37, v37
  v_lshlrev_b32 v37, 16, v37
  v_cvt_pk_bf16_f32 v38, v38, v38
  v_lshlrev_b32 v38, 16, v38
  v_cvt_pk_bf16_f32 v39, v39, v39
  v_lshlrev_b32 v39, 16, v39
  v_cvt_pk_bf16_f32 v40, v40, v40
  v_lshlrev_b32 v40, 16, v40
  v_cvt_pk_bf16_f32 v41, v41, v41
  v_lshlrev_b32 v41, 16, v41
  v_cvt_pk_bf16_f32 v42, v42, v42
  v_lshlrev_b32 v42, 16, v42
  v_cvt_pk_bf16_f32 v43, v43, v43
  v_lshlrev_b32 v43, 16, v43
  v_cvt_pk_bf16_f32 v44, v44, v44
  v_lshlrev_b32 v44, 16, v44
  v_cvt_pk_bf16_f32 v45, v45, v45
  v_lshlrev_b32 v45, 16, v45
  v_cvt_pk_bf16_f32 v46, v46, v46
  v_lshlrev_b32 v46, 16, v46
  v_cvt_pk_bf16_f32 v47, v47, v47
  v_lshlrev_b32 v47, 16, v47
  s_add_u32 s32, s45, 0xdf00000
  v_perm_b32 v20, v37, v36, s38
  v_perm_b32 v21, v39, v38, s38
  buffer_store_dwordx2 v[20:21], v4, s[4:7], s32 offen sc1
  v_perm_b32 v22, v41, v40, s38
  v_perm_b32 v23, v43, v42, s38
  buffer_store_dwordx2 v[22:23], v5, s[4:7], s32 offen sc1
  v_perm_b32 v24, v45, v44, s38
  v_perm_b32 v25, v47, v46, s38
  buffer_store_dwordx2 v[24:25], v6, s[4:7], s32 offen sc1
  v_add_f32 v28, v36, v37
  v_mul_f32 v29, v36, v36
  v_fma_f32 v29, v37, v37, v29
  v_add_f32 v28, v28, v38
  v_fma_f32 v29, v38, v38, v29
  v_add_f32 v28, v28, v39
  v_fma_f32 v29, v39, v39, v29
  v_add_f32 v28, v28, v40
  v_fma_f32 v29, v40, v40, v29
  v_add_f32 v28, v28, v41
  v_fma_f32 v29, v41, v41, v29
  v_add_f32 v28, v28, v42
  v_fma_f32 v29, v42, v42, v29
  v_add_f32 v28, v28, v43
  v_fma_f32 v29, v43, v43, v29
  v_add_f32 v28, v28, v44
  v_fma_f32 v29, v44, v44, v29
  v_add_f32 v28, v28, v45
  v_fma_f32 v29, v45, v45, v29
  v_add_f32 v28, v28, v46
  v_fma_f32 v29, v46, v46, v29
  v_add_f32 v28, v28, v47
  v_fma_f32 v29, v47, v47, v29
  s_nop 0
  v_add_f32_dpp v30, v28, v28 row_ror:1 row_mask:0xf bank_mask:0xf
  v_add_f32_dpp v31, v29, v29 row_ror:1 row_mask:0xf bank_mask:0xf
  v_mov_b32 v28, v30
  v_mov_b32 v29, v31
  s_nop 0
  v_add_f32_dpp v30, v28, v28 row_ror:2 row_mask:0xf bank_mask:0xf
  v_add_f32_dpp v31, v29, v29 row_ror:2 row_mask:0xf bank_mask:0xf
  v_mov_b32 v28, v30
  v_mov_b32 v29, v31
  s_nop 0
  v_add_f32_dpp v30, v28, v28 row_ror:4 row_mask:0xf bank_mask:0xf
  v_add_f32_dpp v31, v29, v29 row_ror:4 row_mask:0xf bank_mask:0xf
  v_mov_b32 v28, v30
  v_mov_b32 v29, v31
  s_nop 0
  v_add_f32_dpp v30, v28, v28 row_ror:8 row_mask:0xf bank_mask:0xf
  v_add_f32_dpp v31, v29, v29 row_ror:8 row_mask:0xf bank_mask:0xf
  v_mov_b32 v28, v30
  v_mov_b32 v29, v31
  s_nop 0
  v_mov_b32 v30, v28
  v_mov_b32 v31, v29
  s_nop 0
  v_permlane16_swap_b32 v28, v30
  v_permlane16_swap_b32 v29, v31
  v_add_f32 v28, v28, v30
  v_add_f32 v29, v29, v31
  v_mov_b32 v30, v28
  v_mov_b32 v31, v29
  s_nop 0
  v_permlane32_swap_b32 v28, v30
  v_permlane32_swap_b32 v29, v31
  v_add_f32 v28, v28, v30
  v_add_f32 v29, v29, v31
  v_mul_f32 v28, 0x3ae38e39, v28
  v_mul_f32 v29, 0x3ae38e39, v29
  v_fma_f32 v29, -v28, v28, v29
  v_max_f32 v29, 0, v29
  v_cvt_pk_bf16_f32 v28, v28, v28
  v_lshlrev_b32 v28, 16, v28
  v_cvt_pk_bf16_f32 v29, v29, v29
  v_lshlrev_b32 v29, 16, v29
  v_add_f32 v29, 0x3727c5ac, v29
  v_cvt_pk_bf16_f32 v29, v29, v29
  v_lshlrev_b32 v29, 16, v29
  v_sqrt_f32 v29, v29
  s_nop 0
  v_cvt_pk_bf16_f32 v29, v29, v29
  v_lshlrev_b32 v29, 16, v29
  v_rcp_f32 v29, v29
  v_sub_f32 v36, v36, v28
  v_sub_f32 v37, v37, v28
  v_sub_f32 v38, v38, v28
  v_sub_f32 v39, v39, v28
  v_sub_f32 v40, v40, v28
  v_sub_f32 v41, v41, v28
  v_sub_f32 v42, v42, v28
  v_sub_f32 v43, v43, v28
  v_sub_f32 v44, v44, v28
  v_sub_f32 v45, v45, v28
  v_sub_f32 v46, v46, v28
  v_sub_f32 v47, v47, v28
  v_cvt_pk_bf16_f32 v36, v36, v36
  v_lshlrev_b32 v36, 16, v36
  v_cvt_pk_bf16_f32 v37, v37, v37
  v_lshlrev_b32 v37, 16, v37
  v_cvt_pk_bf16_f32 v38, v38, v38
  v_lshlrev_b32 v38, 16, v38
  v_cvt_pk_bf16_f32 v39, v39, v39
  v_lshlrev_b32 v39, 16, v39
  v_cvt_pk_bf16_f32 v40, v40, v40
  v_lshlrev_b32 v40, 16, v40
  v_cvt_pk_bf16_f32 v41, v41, v41
  v_lshlrev_b32 v41, 16, v41
  v_cvt_pk_bf16_f32 v42, v42, v42
  v_lshlrev_b32 v42, 16, v42
  v_cvt_pk_bf16_f32 v43, v43, v43
  v_lshlrev_b32 v43, 16, v43
  v_cvt_pk_bf16_f32 v44, v44, v44
  v_lshlrev_b32 v44, 16, v44
  v_cvt_pk_bf16_f32 v45, v45, v45
  v_lshlrev_b32 v45, 16, v45
  v_cvt_pk_bf16_f32 v46, v46, v46
  v_lshlrev_b32 v46, 16, v46
  v_cvt_pk_bf16_f32 v47, v47, v47
  v_lshlrev_b32 v47, 16, v47
  v_mul_f32 v36, v36, v29
  v_mul_f32 v37, v37, v29
  v_mul_f32 v38, v38, v29
  v_mul_f32 v39, v39, v29
  v_mul_f32 v40, v40, v29
  v_mul_f32 v41, v41, v29
  v_mul_f32 v42, v42, v29
  v_mul_f32 v43, v43, v29
  v_mul_f32 v44, v44, v29
  v_mul_f32 v45, v45, v29
  v_mul_f32 v46, v46, v29
  v_mul_f32 v47, v47, v29
  v_cvt_pk_bf16_f32 v36, v36, v36
  v_lshlrev_b32 v36, 16, v36
  v_cvt_pk_bf16_f32 v37, v37, v37
  v_lshlrev_b32 v37, 16, v37
  v_cvt_pk_bf16_f32 v38, v38, v38
  v_lshlrev_b32 v38, 16, v38
  v_cvt_pk_bf16_f32 v39, v39, v39
  v_lshlrev_b32 v39, 16, v39
  v_cvt_pk_bf16_f32 v40, v40, v40
  v_lshlrev_b32 v40, 16, v40
  v_cvt_pk_bf16_f32 v41, v41, v41
  v_lshlrev_b32 v41, 16, v41
  v_cvt_pk_bf16_f32 v42, v42, v42
  v_lshlrev_b32 v42, 16, v42
  v_cvt_pk_bf16_f32 v43, v43, v43
  v_lshlrev_b32 v43, 16, v43
  v_cvt_pk_bf16_f32 v44, v44, v44
  v_lshlrev_b32 v44, 16, v44
  v_cvt_pk_bf16_f32 v45, v45, v45
  v_lshlrev_b32 v45, 16, v45
  v_cvt_pk_bf16_f32 v46, v46, v46
  v_lshlrev_b32 v46, 16, v46
  v_cvt_pk_bf16_f32 v47, v47, v47
  v_lshlrev_b32 v47, 16, v47
  v_cmp_gt_u32 vcc, 0x40000000, v6
  s_nop 1
  v_cndmask_b32 v44, 0, v44, vcc
  v_cndmask_b32 v45, 0, v45, vcc
  v_cndmask_b32 v46, 0, v46, vcc
  v_cndmask_b32 v47, 0, v47, vcc
  s_add_u32 s32, s45, 0xdc00000
  v_perm_b32 v20, v37, v36, s38
  v_perm_b32 v21, v39, v38, s38
  buffer_store_dwordx2 v[20:21], v4, s[4:7], s32 offen sc1
  v_perm_b32 v22, v41, v40, s38
  v_perm_b32 v23, v43, v42, s38
  buffer_store_dwordx2 v[22:23], v5, s[4:7], s32 offen sc1
  v_perm_b32 v24, v45, v44, s38
  v_perm_b32 v25, v47, v46, s38
  buffer_store_dwordx2 v[24:25], v6, s[4:7], s32 offen sc1
  v_add_f32 v28, v36, v37
  v_mul_f32 v29, v36, v36
  v_fma_f32 v29, v37, v37, v29
  v_add_f32 v28, v28, v38
  v_fma_f32 v29, v38, v38, v29
  v_add_f32 v28, v28, v39
  v_fma_f32 v29, v39, v39, v29
  v_add_f32 v28, v28, v40
  v_fma_f32 v29, v40, v40, v29
  v_add_f32 v28, v28, v41
  v_fma_f32 v29, v41, v41, v29
  v_add_f32 v28, v28, v42
  v_fma_f32 v29, v42, v42, v29
  v_add_f32 v28, v28, v43
  v_fma_f32 v29, v43, v43, v29
  v_add_f32 v28, v28, v44
  v_fma_f32 v29, v44, v44, v29
  v_add_f32 v28, v28, v45
  v_fma_f32 v29, v45, v45, v29
  v_add_f32 v28, v28, v46
  v_fma_f32 v29, v46, v46, v29
  v_add_f32 v28, v28, v47
  v_fma_f32 v29, v47, v47, v29
  s_nop 0
  v_add_f32_dpp v30, v28, v28 row_ror:1 row_mask:0xf bank_mask:0xf
  v_add_f32_dpp v31, v29, v29 row_ror:1 row_mask:0xf bank_mask:0xf
  v_mov_b32 v28, v30
  v_mov_b32 v29, v31
  s_nop 0
  v_add_f32_dpp v30, v28, v28 row_ror:2 row_mask:0xf bank_mask:0xf
  v_add_f32_dpp v31, v29, v29 row_ror:2 row_mask:0xf bank_mask:0xf
  v_mov_b32 v28, v30
  v_mov_b32 v29, v31
  s_nop 0
  v_add_f32_dpp v30, v28, v28 row_ror:4 row_mask:0xf bank_mask:0xf
  v_add_f32_dpp v31, v29, v29 row_ror:4 row_mask:0xf bank_mask:0xf
  v_mov_b32 v28, v30
  v_mov_b32 v29, v31
  s_nop 0
  v_add_f32_dpp v30, v28, v28 row_ror:8 row_mask:0xf bank_mask:0xf
  v_add_f32_dpp v31, v29, v29 row_ror:8 row_mask:0xf bank_mask:0xf
  v_mov_b32 v28, v30
  v_mov_b32 v29, v31
  s_nop 0
  v_mov_b32 v30, v28
  v_mov_b32 v31, v29
  s_nop 0
  v_permlane16_swap_b32 v28, v30
  v_permlane16_swap_b32 v29, v31
  v_add_f32 v28, v28, v30
  v_add_f32 v29, v29, v31
  v_mov_b32 v30, v28
  v_mov_b32 v31, v29
  s_nop 0
  v_permlane32_swap_b32 v28, v30
  v_permlane32_swap_b32 v29, v31
  v_add_f32 v28, v28, v30
  v_add_f32 v29, v29, v31
  v_mul_f32 v28, 0x3ae38e39, v28
  v_mul_f32 v29, 0x3ae38e39, v29
  v_fma_f32 v29, -v28, v28, v29
  v_max_f32 v29, 0, v29
  v_cvt_pk_bf16_f32 v28, v28, v28
  v_lshlrev_b32 v28, 16, v28
  v_cvt_pk_bf16_f32 v29, v29, v29
  v_lshlrev_b32 v29, 16, v29
  v_add_f32 v29, 0x3727c5ac, v29
  v_cvt_pk_bf16_f32 v29, v29, v29
  v_lshlrev_b32 v29, 16, v29
  v_sqrt_f32 v29, v29
  s_nop 0
  v_cvt_pk_bf16_f32 v29, v29, v29
  v_lshlrev_b32 v29, 16, v29
  v_rcp_f32 v29, v29
  v_sub_f32 v36, v36, v28
  v_sub_f32 v37, v37, v28
  v_sub_f32 v38, v38, v28
  v_sub_f32 v39, v39, v28
  v_sub_f32 v40, v40, v28
  v_sub_f32 v41, v41, v28
  v_sub_f32 v42, v42, v28
  v_sub_f32 v43, v43, v28
  v_sub_f32 v44, v44, v28
  v_sub_f32 v45, v45, v28
  v_sub_f32 v46, v46, v28
  v_sub_f32 v47, v47, v28
  v_cvt_pk_bf16_f32 v36, v36, v36
  v_lshlrev_b32 v36, 16, v36
  v_cvt_pk_bf16_f32 v37, v37, v37
  v_lshlrev_b32 v37, 16, v37
  v_cvt_pk_bf16_f32 v38, v38, v38
  v_lshlrev_b32 v38, 16, v38
  v_cvt_pk_bf16_f32 v39, v39, v39
  v_lshlrev_b32 v39, 16, v39
  v_cvt_pk_bf16_f32 v40, v40, v40
  v_lshlrev_b32 v40, 16, v40
  v_cvt_pk_bf16_f32 v41, v41, v41
  v_lshlrev_b32 v41, 16, v41
  v_cvt_pk_bf16_f32 v42, v42, v42
  v_lshlrev_b32 v42, 16, v42
  v_cvt_pk_bf16_f32 v43, v43, v43
  v_lshlrev_b32 v43, 16, v43
  v_cvt_pk_bf16_f32 v44, v44, v44
  v_lshlrev_b32 v44, 16, v44
  v_cvt_pk_bf16_f32 v45, v45, v45
  v_lshlrev_b32 v45, 16, v45
  v_cvt_pk_bf16_f32 v46, v46, v46
  v_lshlrev_b32 v46, 16, v46
  v_cvt_pk_bf16_f32 v47, v47, v47
  v_lshlrev_b32 v47, 16, v47
  v_mul_f32 v36, v36, v29
  v_mul_f32 v37, v37, v29
  v_mul_f32 v38, v38, v29
  v_mul_f32 v39, v39, v29
  v_mul_f32 v40, v40, v29
  v_mul_f32 v41, v41, v29
  v_mul_f32 v42, v42, v29
  v_mul_f32 v43, v43, v29
  v_mul_f32 v44, v44, v29
  v_mul_f32 v45, v45, v29
  v_mul_f32 v46, v46, v29
  v_mul_f32 v47, v47, v29
  v_cvt_pk_bf16_f32 v36, v36, v36
  v_lshlrev_b32 v36, 16, v36
  v_cvt_pk_bf16_f32 v37, v37, v37
  v_lshlrev_b32 v37, 16, v37
  v_cvt_pk_bf16_f32 v38, v38, v38
  v_lshlrev_b32 v38, 16, v38
  v_cvt_pk_bf16_f32 v39, v39, v39
  v_lshlrev_b32 v39, 16, v39
  v_cvt_pk_bf16_f32 v40, v40, v40
  v_lshlrev_b32 v40, 16, v40
  v_cvt_pk_bf16_f32 v41, v41, v41
  v_lshlrev_b32 v41, 16, v41
  v_cvt_pk_bf16_f32 v42, v42, v42
  v_lshlrev_b32 v42, 16, v42
  v_cvt_pk_bf16_f32 v43, v43, v43
  v_lshlrev_b32 v43, 16, v43
  v_cvt_pk_bf16_f32 v44, v44, v44
  v_lshlrev_b32 v44, 16, v44
  v_cvt_pk_bf16_f32 v45, v45, v45
  v_lshlrev_b32 v45, 16, v45
  v_cvt_pk_bf16_f32 v46, v46, v46
  v_lshlrev_b32 v46, 16, v46
  v_cvt_pk_bf16_f32 v47, v47, v47
  v_lshlrev_b32 v47, 16, v47
  v_cmp_gt_u32 vcc, 0x40000000, v6
  s_nop 1
  v_cndmask_b32 v44, 0, v44, vcc
  v_cndmask_b32 v45, 0, v45, vcc
  v_cndmask_b32 v46, 0, v46, vcc
  v_cndmask_b32 v47, 0, v47, vcc
  s_add_u32 s32, s45, 0xd900000
  v_perm_b32 v20, v37, v36, s38
  v_perm_b32 v21, v39, v38, s38
  buffer_store_dwordx2 v[20:21], v4, s[4:7], s32 offen sc1
  v_perm_b32 v22, v41, v40, s38
  v_perm_b32 v23, v43, v42, s38
  buffer_store_dwordx2 v[22:23], v5, s[4:7], s32 offen sc1
  v_perm_b32 v24, v45, v44, s38
  v_perm_b32 v25, v47, v46, s38
  buffer_store_dwordx2 v[24:25], v6, s[4:7], s32 offen sc1
  s_add_u32 s28, s18, 1
  s_waitcnt vmcnt(0)
  v_mov_b32 v20, s28
  buffer_store_dword v20, off, s[4:7], s41 sc1
  s_add_u32 s47, s47, 104
  s_cmp_lt_u32 s47, 2048
  s_cbranch_scc1 L_r3_top_99
  s_endpgm
L_role_r4:
  s_sub_u32 s16, s23, 90
  s_lshl_b32 s41, s16, 2
  s_add_u32 s41, s41, 0xe900800
  s_cmp_ge_u32 s16, 9
  s_cselect_b32 s47, 1, 0
  s_mul_i32 s24, s47, 9
  s_sub_u32 s16, s16, s24
  s_load_dwordx2 s[8:9], s[0:1], 64
  s_mov_b32 s10, 0xa2000
  s_mov_b32 s11, 0x00020000
  s_waitcnt lgkmcnt(0)
  s_and_b32 s9, s9, 0xffff
  s_lshl_b32 s24, s16, 7
  s_lshl_b32 s25, s17, 5
  v_and_b32 v16, 63, v0
  v_lshrrev_b32 v17, 3, v16
  v_and_b32 v18, 7, v16
  s_mov_b32 s32, 1152
  v_mul_lo_u32 v17, v17, s32
  v_lshl_add_u32 v17, v18, 4, v17
  s_mul_i32 s34, s17, 9216
  s_add_u32 s34, s34, s24
  s_lshl_b32 s33, s17, 10
  s_add_u32 m0, s33, 0
  s_add_u32 s32, s34, 0
  buffer_load_dwordx4 v17, s[8:11], s32 offen lds
  s_add_u32 m0, s33, 4096
  s_add_u32 s32, s34, 36864
  buffer_load_dwordx4 v17, s[8:11], s32 offen lds
  s_add_u32 m0, s33, 8192
  s_add_u32 s32, s34, 73728
  buffer_load_dwordx4 v17, s[8:11], s32 offen lds
  s_add_u32 m0, s33, 12288
  s_add_u32 s32, s34, 110592
  buffer_load_dwordx4 v17, s[8:11], s32 offen lds
  s_add_u32 m0, s33, 16384
  s_add_u32 s32, s34, 147456
  buffer_load_dwordx4 v17, s[8:11], s32 offen lds
  s_add_u32 m0, s33, 20480
  s_add_u32 s32, s34, 184320
  buffer_load_dwordx4 v17, s[8:11], s32 offen lds
  s_add_u32 m0, s33, 24576
  s_add_u32 s32, s34, 221184
  buffer_load_dwordx4 v17, s[8:11], s32 offen lds
  s_add_u32 m0, s33, 28672
  s_add_u32 s32, s34, 258048
  buffer_load_dwordx4 v17, s[8:11], s32 offen lds
  s_add_u32 m0, s33, 32768
  s_add_u32 s32, s34, 294912
  buffer_load_dwordx4 v17, s[8:11], s32 offen lds
  s_add_u32 m0, s33, 36864
  s_add_u32 s32, s34, 331776
  buffer_load_dwordx4 v17, s[8:11], s32 offen lds
  s_add_u32 m0, s33, 40960
  s_add_u32 s32, s34, 368640
  buffer_load_dwordx4 v17, s[8:11], s32 offen lds
  s_add_u32 m0, s33, 45056
  s_add_u32 s32, s34, 405504
  buffer_load_dwordx4 v17, s[8:11], s32 offen lds
  s_add_u32 m0, s33, 49152
  s_add_u32 s32, s34, 442368
  buffer_load_dwordx4 v17, s[8:11], s32 offen lds
  s_add_u32 m0, s33, 53248
  s_add_u32 s32, s34, 479232
  buffer_load_dwordx4 v17, s[8:11], s32 offen lds
  s_add_u32 m0, s33, 57344
  s_add_u32 s32, s34, 516096
  buffer_load_dwordx4 v17, s[8:11], s32 offen lds
  s_add_u32 m0, s33, 61440
  s_add_u32 s32, s34, 552960
  buffer_load_dwordx4 v17, s[8:11], s32 offen lds
  s_add_u32 m0, s33, 65536
  s_add_u32 s32, s34, 589824
  buffer_load_dwordx4 v17, s[8:11], s32 offen lds
  s_add_u32 m0, s33, 69632
  s_add_u32 s32, s34, 626688
  buffer_load_dwordx4 v17, s[8:11], s32 offen lds
  s_waitcnt vmcnt(0)
  s_barrier
  v_lshrrev_b32 v17, 4, v16
  v_bfe_u32 v18, v16, 2, 2
  v_lshl_add_u32 v17, v17, 2, v18
  v_mul_u32_u24 v17, 128, v17
  v_and_b32 v18, 3, v16
  v_lshl_add_u32 v17, v18, 3, v17
  v_add_u32 v17, s25, v17
  v_add_u32 v19, 0, v17
  ds_read_b64_tr_b16 a[0:1], v19 offset:0
  v_add_u32 v19, 2048, v17
  ds_read_b64_tr_b16 a[2:3], v19 offset:0
  v_add_u32 v19, 4096, v17
  ds_read_b64_tr_b16 a[4:5], v19 offset:0
  v_add_u32 v19, 6144, v17
  ds_read_b64_tr_b16 a[6:7], v19 offset:0
  v_add_u32 v19, 8192, v17
  ds_read_b64_tr_b16 a[8:9], v19 offset:0
  v_add_u32 v19, 10240, v17
  ds_read_b64_tr_b16 a[10:11], v19 offset:0
  v_add_u32 v19, 12288, v17
  ds_read_b64_tr_b16 a[12:13], v19 offset:0
  v_add_u32 v19, 14336, v17
  ds_read_b64_tr_b16 a[14:15], v19 offset:0
  v_add_u32 v19, 16384, v17
  ds_read_b64_tr_b16 a[16:17], v19 offset:0
  v_add_u32 v19, 18432, v17
  ds_read_b64_tr_b16 a[18:19], v19 offset:0
  v_add_u32 v19, 20480, v17
  ds_read_b64_tr_b16 a[20:21], v19 offset:0
  v_add_u32 v19, 22528, v17
  ds_read_b64_tr_b16 a[22:23], v19 offset:0
  s_waitcnt lgkmcnt(0)
  v_add_u32 v19, 24576, v17
  ds_read_b64_tr_b16 a[24:25], v19 offset:0
  v_add_u32 v19, 26624, v17
  ds_read_b64_tr_b16 a[26:27], v19 offset:0
  v_add_u32 v19, 28672, v17
  ds_read_b64_tr_b16 a[28:29], v19 offset:0
  v_add_u32 v19, 30720, v17
  ds_read_b64_tr_b16 a[30:31], v19 offset:0
  v_add_u32 v19, 32768, v17
  ds_read_b64_tr_b16 a[32:33], v19 offset:0
  v_add_u32 v19, 34816, v17
  ds_read_b64_tr_b16 a[34:35], v19 offset:0
  v_add_u32 v19, 36864, v17
  ds_read_b64_tr_b16 a[36:37], v19 offset:0
  v_add_u32 v19, 38912, v17
  ds_read_b64_tr_b16 a[38:39], v19 offset:0
  v_add_u32 v19, 40960, v17
  ds_read_b64_tr_b16 a[40:41], v19 offset:0
  v_add_u32 v19, 43008, v17
  ds_read_b64_tr_b16 a[42:43], v19 offset:0
  v_add_u32 v19, 45056, v17
  ds_read_b64_tr_b16 a[44:45], v19 offset:0
  v_add_u32 v19, 47104, v17
  ds_read_b64_tr_b16 a[46:47], v19 offset:0
  s_waitcnt lgkmcnt(0)
  v_add_u32 v19, 49152, v17
  ds_read_b64_tr_b16 a[48:49], v19 offset:0
  v_add_u32 v19, 51200, v17
  ds_read_b64_tr_b16 a[50:51], v19 offset:0
  v_add_u32 v19, 53248, v17
  ds_read_b64_tr_b16 a[52:53], v19 offset:0
  v_add_u32 v19, 55296, v17
  ds_read_b64_tr_b16 a[54:55], v19 offset:0
  v_add_u32 v19, 57344, v17
  ds_read_b64_tr_b16 a[56:57], v19 offset:0
  v_add_u32 v19, 59392, v17
  ds_read_b64_tr_b16 a[58:59], v19 offset:0
  v_add_u32 v19, 61440, v17
  ds_read_b64_tr_b16 a[60:61], v19 offset:0
  v_add_u32 v19, 63488, v17
  ds_read_b64_tr_b16 a[62:63], v19 offset:0
  v_add_u32 v19, 65536, v17
  ds_read_b64_tr_b16 a[64:65], v19 offset:0
  v_add_u32 v19, 67584, v17
  ds_read_b64_tr_b16 a[66:67], v19 offset:0
  v_add_u32 v19, 69632, v17
  ds_read_b64_tr_b16 a[68:69], v19 offset:0
  v_add_u32 v19, 71680, v17
  ds_read_b64_tr_b16 a[70:71], v19 offset:0
  s_waitcnt lgkmcnt(0)
  s_waitcnt lgkmcnt(0)
  s_barrier
  v_and_b32 v16, 63, v0
  s_lshl_b32 s32, s17, 6
  s_add_u32 s32, s32, 0
  v_add_u32 v17, s32, v16
  v_mul_u32_u24 v18, 58255, v17
  v_lshrrev_b32 v18, 22, v18
  v_mul_u32_u24 v19, 72, v18
  v_sub_u32 v19, v17, v19
  v_bfe_u32 v20, v18, 1, 3
  v_xor_b32 v19, v19, v20
  v_lshlrev_b32 v19, 4, v19
  v_mul_u32_u24 v18, 1152, v18
  v_add_u32 v6, v18, v19
  s_lshl_b32 s32, s17, 6
  s_add_u32 s32, s32, 256
  v_add_u32 v17, s32, v16
  v_mul_u32_u24 v18, 58255, v17
  v_lshrrev_b32 v18, 22, v18
  v_mul_u32_u24 v19, 72, v18
  v_sub_u32 v19, v17, v19
  v_bfe_u32 v20, v18, 1, 3
  v_xor_b32 v19, v19, v20
  v_lshlrev_b32 v19, 4, v19
  v_mul_u32_u24 v18, 1152, v18
  v_add_u32 v7, v18, v19
  s_lshl_b32 s32, s17, 6
  s_add_u32 s32, s32, 512
  v_add_u32 v17, s32, v16
  v_mul_u32_u24 v18, 58255, v17
  v_lshrrev_b32 v18, 22, v18
  v_mul_u32_u24 v19, 72, v18
  v_sub_u32 v19, v17, v19
  v_bfe_u32 v20, v18, 1, 3
  v_xor_b32 v19, v19, v20
  v_lshlrev_b32 v19, 4, v19
  v_mul_u32_u24 v18, 1152, v18
  v_add_u32 v8, v18, v19
  s_lshl_b32 s32, s17, 6
  s_add_u32 s32, s32, 768
  v_add_u32 v17, s32, v16
  v_mul_u32_u24 v18, 58255, v17
  v_lshrrev_b32 v18, 22, v18
  v_mul_u32_u24 v19, 72, v18
  v_sub_u32 v19, v17, v19
  v_bfe_u32 v20, v18, 1, 3
  v_xor_b32 v19, v19, v20
  v_lshlrev_b32 v19, 4, v19
  v_mul_u32_u24 v18, 1152, v18
  v_add_u32 v9, v18, v19
  s_lshl_b32 s32, s17, 6
  s_add_u32 s32, s32, 1024
  v_add_u32 v17, s32, v16
  v_mul_u32_u24 v18, 58255, v17
  v_lshrrev_b32 v18, 22, v18
  v_mul_u32_u24 v19, 72, v18
  v_sub_u32 v19, v17, v19
  v_bfe_u32 v20, v18, 1, 3
  v_xor_b32 v19, v19, v20
  v_lshlrev_b32 v19, 4, v19
  v_mul_u32_u24 v18, 1152, v18
  v_add_u32 v10, v18, v19
  s_lshl_b32 s32, s17, 6
  s_add_u32 s32, s32, 1280
  v_add_u32 v17, s32, v16
  v_mul_u32_u24 v18, 58255, v17
  v_lshrrev_b32 v18, 22, v18
  v_mul_u32_u24 v19, 72, v18
  v_sub_u32 v19, v17, v19
  v_bfe_u32 v20, v18, 1, 3
  v_xor_b32 v19, v19, v20
  v_lshlrev_b32 v19, 4, v19
  v_mul_u32_u24 v18, 1152, v18
  v_add_u32 v11, v18, v19
  s_lshl_b32 s32, s17, 6
  s_add_u32 s32, s32, 1536
  v_add_u32 v17, s32, v16
  v_mul_u32_u24 v18, 58255, v17
  v_lshrrev_b32 v18, 22, v18
  v_mul_u32_u24 v19, 72, v18
  v_sub_u32 v19, v17, v19
  v_bfe_u32 v20, v18, 1, 3
  v_xor_b32 v19, v19, v20
  v_lshlrev_b32 v19, 4, v19
  v_mul_u32_u24 v18, 1152, v18
  v_add_u32 v12, v18, v19
  s_lshl_b32 s32, s17, 6
  s_add_u32 s32, s32, 1792
  v_add_u32 v17, s32, v16
  v_mul_u32_u24 v18, 58255, v17
  v_lshrrev_b32 v18, 22, v18
  v_mul_u32_u24 v19, 72, v18
  v_sub_u32 v19, v17, v19
  v_bfe_u32 v20, v18, 1, 3
  v_xor_b32 v19, v19, v20
  v_lshlrev_b32 v19, 4, v19
  v_mul_u32_u24 v18, 1152, v18
  v_add_u32 v13, v18, v19
  s_lshl_b32 s32, s17, 6
  s_add_u32 s32, s32, 2048
  v_add_u32 v17, s32, v16
  v_mul_u32_u24 v18, 58255, v17
  v_lshrrev_b32 v18, 22, v18
  v_mul_u32_u24 v19, 72, v18
  v_sub_u32 v19, v17, v19
  v_bfe_u32 v20, v18, 1, 3
  v_xor_b32 v19, v19, v20
  v_lshlrev_b32 v19, 4, v19
  v_mul_u32_u24 v18, 1152, v18
  v_add_u32 v14, v18, v19
  v_and_b32 v17, 15, v16
  v_lshrrev_b32 v18, 4, v16
  v_bfe_u32 v19, v17, 1, 3
  v_xor_b32 v19, v19, v18
  v_lshlrev_b32 v19, 4, v19
  v_mul_u32_u24 v17, 1152, v17
  v_add_u32 v2, v17, v19
  v_xor_b32 v3, 64, v2
  v_and_b32 v16, 63, v0
  v_min_u32 v1, 31, v16
  v_lshlrev_b32 v1, 2, v1
  s_lshl_b32 s44, s16, 2
  s_add_u32 s44, s44, s17
  s_mov_b32 s45, 1
  s_cmp_ge_u32 s44, 9
  s_cselect_b32 s45, -1, s45
  s_cmp_ge_u32 s44, 18
  s_cselect_b32 s45, 2, s45
  s_cmp_ge_u32 s44, 27
  s_cselect_b32 s45, -2, s45
  s_lshr_b32 s46, s44, 1
  s_lshl_b32 s46, s46, 6
  s_and_b32 s24, s44, 1
  s_lshl_b32 s24, s24, 3
  s_add_u32 s46, s46, s24
  s_add_u32 s46, s46, 0xe200000
  v_and_b32 v4, 15, v16
  v_lshrrev_b32 v5, 4, v16
  v_lshlrev_b32 v5, 4, v5
  v_mov_b64 v[18:19], 0
  s_cmp_gt_i32 s45, 0
  s_cselect_b32 s24, 0, 2046
  v_add_u32 v20, s24, v4
  s_abs_i32 s25, s45
  s_cmp_eq_u32 s25, 2
  s_cselect_b32 s26, 3, 0
  s_cmp_eq_i32 s45, 1
  s_cselect_b32 s26, 1, s26
  s_cmp_eq_i32 s45, -1
  s_cselect_b32 s26, 2, s26
  v_mov_b32 v21, 1
  v_lshlrev_b32 v21, v4, v21
  v_and_b32 v21, s26, v21
  v_cmp_ne_u32 vcc, 0, v21
  v_mul_u32_u24 v20, 1152, v20
  v_add_u32 v20, v20, v5
  v_mov_b32 v22, 0x40000000
  v_cndmask_b32 v20, v22, v20, vcc
  buffer_store_dwordx2 v[18:19], v20, s[4:7], s46 offen sc1
  v_mov_b32 v232, 128
  s_mov_b32 s24, 262144
L_wc_104:
  buffer_load_dword v233, v232, s[12:15], 0 offen sc1
  s_waitcnt vmcnt(0)
  v_cmp_gt_u32 vcc, 33, v233
  s_cbranch_vccz L_wc_ok_105
  s_sleep 8
  s_sub_u32 s24, s24, 1
  s_cmp_lg_u32 s24, 0
  s_cbranch_scc1 L_wc_104
  s_branch L_fail
L_wc_ok_105:
  s_mov_b32 s18, s47
L_r4_top_106:
  s_add_u32 s28, s18, 1
  s_and_b32 s29, s18, 7
  s_lshl_b32 s29, s29, 7
  s_add_u32 s29, s29, 0xe901800
  s_mov_b32 s40, 262144
  s_cmp_eq_u32 s17, 0
  s_cbranch_scc0 L_wf_first_110
  buffer_load_dword v16, v1, s[4:7], s29 offen sc1
L_wf_first_110:
  s_waitcnt vmcnt(0)
  s_cmp_eq_u32 s42, 0
  s_cbranch_scc1 L_pend_111
  s_barrier
  s_cmp_eq_u32 s17, 0
  s_cbranch_scc0 L_pend2_112
  v_mov_b32 v17, s42
  buffer_store_dword v17, off, s[4:7], s41 sc1
L_pend2_112:
  s_mov_b32 s42, 0
L_pend_111:
  s_cmp_eq_u32 s17, 0
  s_cbranch_scc0 L_wf_rel_109
  v_cmp_gt_u32 vcc, s28, v16
  s_cbranch_vccz L_wf_ok_108
L_wf_107:
  s_sleep 8
  buffer_load_dword v16, v1, s[4:7], s29 offen sc1
  s_waitcnt vmcnt(0)
  v_cmp_gt_u32 vcc, s28, v16
  s_cbranch_vccz L_wf_ok_108
  s_sub_u32 s40, s40, 1
  s_cmp_lg_u32 s40, 0
  s_cbranch_scc1 L_wf_107
  s_branch L_fail
L_wf_ok_108:
L_wf_rel_109:
  s_barrier
  s_mul_i32 s24, s18, 36864
  s_add_u32 s24, s24, 0xd900000
  s_lshl_b32 s33, s17, 10
  s_add_u32 m0, s33, 0
  s_nop 0
  buffer_load_dwordx4 v6, s[4:7], s24 offen sc1 lds
  s_add_u32 m0, s33, 4096
  s_nop 0
  buffer_load_dwordx4 v7, s[4:7], s24 offen sc1 lds
  s_add_u32 m0, s33, 8192
  s_nop 0
  buffer_load_dwordx4 v8, s[4:7], s24 offen sc1 lds
  s_add_u32 m0, s33, 12288
  s_nop 0
  buffer_load_dwordx4 v9, s[4:7], s24 offen sc1 lds
  s_add_u32 m0, s33, 16384
  s_nop 0
  buffer_load_dwordx4 v10, s[4:7], s24 offen sc1 lds
  s_add_u32 m0, s33, 20480
  s_nop 0
  buffer_load_dwordx4 v11, s[4:7], s24 offen sc1 lds
  s_add_u32 m0, s33, 24576
  s_nop 0
  buffer_load_dwordx4 v12, s[4:7], s24 offen sc1 lds
  s_add_u32 m0, s33, 28672
  s_nop 0
  buffer_load_dwordx4 v13, s[4:7], s24 offen sc1 lds
  s_add_u32 m0, s33, 32768
  s_nop 0
  buffer_load_dwordx4 v14, s[4:7], s24 offen sc1 lds
  s_waitcnt vmcnt(0)
  s_barrier
  ds_read_b128 v[40:43], v2 offset:0
  ds_read_b128 v[44:47], v2 offset:18432
  ds_read_b128 v[48:51], v3 offset:0
  ds_read_b128 v[52:55], v3 offset:18432
  s_waitcnt lgkmcnt(2)
  v_mfma_f32_16x16x32_bf16 v[56:59], a[0:3], v[40:43], 0
  v_mfma_f32_16x16x32_bf16 v[60:63], a[0:3], v[44:47], 0
  ds_read_b128 v[40:43], v2 offset:128
  ds_read_b128 v[44:47], v2 offset:18560
  s_waitcnt lgkmcnt(2)
  v_mfma_f32_16x16x32_bf16 v[56:59], a[4:7], v[48:51], v[56:59]
  v_mfma_f32_16x16x32_bf16 v[60:63], a[4:7], v[52:55], v[60:63]
  ds_read_b128 v[48:51], v3 offset:128
  ds_read_b128 v[52:55], v3 offset:18560
  s_waitcnt lgkmcnt(2)
  v_mfma_f32_16x16x32_bf16 v[56:59], a[8:11], v[40:43], v[56:59]
  v_mfma_f32_16x16x32_bf16 v[60:63], a[8:11], v[44:47], v[60:63]
  ds_read_b128 v[40:43], v2 offset:256
  ds_read_b128 v[44:47], v2 offset:18688
  s_waitcnt lgkmcnt(2)
  v_mfma_f32_16x16x32_bf16 v[56:59], a[12:15], v[48:51], v[56:59]
  v_mfma_f32_16x16x32_bf16 v[60:63], a[12:15], v[52:55], v[60:63]
  ds_read_b128 v[48:51], v3 offset:256
  ds_read_b128 v[52:55], v3 offset:18688
  s_waitcnt lgkmcnt(2)
  v_mfma_f32_16x16x32_bf16 v[56:59], a[16:19], v[40:43], v[56:59]
  v_mfma_f32_16x16x32_bf16 v[60:63], a[16:19], v[44:47], v[60:63]
  ds_read_b128 v[40:43], v2 offset:384
  ds_read_b128 v[44:47], v2 offset:18816
  s_waitcnt lgkmcnt(2)
  v_mfma_f32_16x16x32_bf16 v[56:59], a[20:23], v[48:51], v[56:59]
  v_mfma_f32_16x16x32_bf16 v[60:63], a[20:23], v[52:55], v[60:63]
  ds_read_b128 v[48:51], v3 offset:384
  ds_read_b128 v[52:55], v3 offset:18816
  s_waitcnt lgkmcnt(2)
  v_mfma_f32_16x16x32_bf16 v[56:59], a[24:27], v[40:43], v[56:59]
  v_mfma_f32_16x16x32_bf16 v[60:63], a[24:27], v[44:47], v[60:63]
  ds_read_b128 v[40:43], v2 offset:512
  ds_read_b128 v[44:47], v2 offset:18944
  s_waitcnt lgkmcnt(2)
  v_mfma_f32_16x16x32_bf16 v[56:59], a[28:31], v[48:51], v[56:59]
  v_mfma_f32_16x16x32_bf16 v[60:63], a[28:31], v[52:55], v[60:63]
  ds_read_b128 v[48:51], v3 offset:512
  ds_read_b128 v[52:55], v3 offset:18944
  s_waitcnt lgkmcnt(2)
  v_mfma_f32_16x16x32_bf16 v[56:59], a[32:35], v[40:43], v[56:59]
  v_mfma_f32_16x16x32_bf16 v[60:63], a[32:35], v[44:47], v[60:63]
  ds_read_b128 v[40:43], v2 offset:640
  ds_read_b128 v[44:47], v2 offset:19072
  s_waitcnt lgkmcnt(2)
  v_mfma_f32_16x16x32_bf16 v[56:59], a[36:39], v[48:51], v[56:59]
  v_mfma_f32_16x16x32_bf16 v[60:63], a[36:39], v[52:55], v[60:63]
  ds_read_b128 v[48:51], v3 offset:640
  ds_read_b128 v[52:55], v3 offset:19072
  s_waitcnt lgkmcnt(2)
  v_mfma_f32_16x16x32_bf16 v[56:59], a[40:43], v[40:43], v[56:59]
  v_mfma_f32_16x16x32_bf16 v[60:63], a[40:43], v[44:47], v[60:63]
  ds_read_b128 v[40:43], v2 offset:768
  ds_read_b128 v[44:47], v2 offset:19200
  s_waitcnt lgkmcnt(2)
  v_mfma_f32_16x16x32_bf16 v[56:59], a[44:47], v[48:51], v[56:59]
  v_mfma_f32_16x16x32_bf16 v[60:63], a[44:47], v[52:55], v[60:63]
  ds_read_b128 v[48:51], v3 offset:768
  ds_read_b128 v[52:55], v3 offset:19200
  s_waitcnt lgkmcnt(2)
  v_mfma_f32_16x16x32_bf16 v[56:59], a[48:51], v[40:43], v[56:59]
  v_mfma_f32_16x16x32_bf16 v[60:63], a[48:51], v[44:47], v[60:63]
  ds_read_b128 v[40:43], v2 offset:896
  ds_read_b128 v[44:47], v2 offset:19328
  s_waitcnt lgkmcnt(2)
  v_mfma_f32_16x16x32_bf16 v[56:59], a[52:55], v[48:51], v[56:59]
  v_mfma_f32_16x16x32_bf16 v[60:63], a[52:55], v[52:55], v[60:63]
  ds_read_b128 v[48:51], v3 offset:896
  ds_read_b128 v[52:55], v3 offset:19328
  s_waitcnt lgkmcnt(2)
  v_mfma_f32_16x16x32_bf16 v[56:59], a[56:59], v[40:43], v[56:59]
  v_mfma_f32_16x16x32_bf16 v[60:63], a[56:59], v[44:47], v[60:63]
  ds_read_b128 v[40:43], v2 offset:1024
  ds_read_b128 v[44:47], v2 offset:19456
  s_waitcnt lgkmcnt(2)
  v_mfma_f32_16x16x32_bf16 v[56:59], a[60:63], v[48:51], v[56:59]
  v_mfma_f32_16x16x32_bf16 v[60:63], a[60:63], v[52:55], v[60:63]
  ds_read_b128 v[48:51], v3 offset:1024
  ds_read_b128 v[52:55], v3 offset:19456
  s_waitcnt lgkmcnt(2)
  v_mfma_f32_16x16x32_bf16 v[56:59], a[64:67], v[40:43], v[56:59]
  v_mfma_f32_16x16x32_bf16 v[60:63], a[64:67], v[44:47], v[60:63]
  s_waitcnt lgkmcnt(0)
  v_mfma_f32_16x16x32_bf16 v[56:59], a[68:71], v[48:51], v[56:59]
  v_mfma_f32_16x16x32_bf16 v[60:63], a[68:71], v[52:55], v[60:63]
  s_nop 7
  v_cvt_pk_bf16_f32 v56, v56, v56
  v_lshlrev_b32 v56, 16, v56
  v_cvt_pk_bf16_f32 v57, v57, v57
  v_lshlrev_b32 v57, 16, v57
  v_cvt_pk_bf16_f32 v58, v58, v58
  v_lshlrev_b32 v58, 16, v58
  v_cvt_pk_bf16_f32 v59, v59, v59
  v_lshlrev_b32 v59, 16, v59
  v_cvt_pk_bf16_f32 v60, v60, v60
  v_lshlrev_b32 v60, 16, v60
  v_cvt_pk_bf16_f32 v61, v61, v61
  v_lshlrev_b32 v61, 16, v61
  v_cvt_pk_bf16_f32 v62, v62, v62
  v_lshlrev_b32 v62, 16, v62
  v_cvt_pk_bf16_f32 v63, v63, v63
  v_lshlrev_b32 v63, 16, v63
  s_mov_b32 s36, 0xbdd2d3e8
  s_mov_b32 s37, 0xc0135761
  v_mul_f32 v16, v56, v56
  v_mul_f32 v17, v57, v57
  v_mul_f32 v18, v58, v58
  v_mul_f32 v19, v59, v59
  v_mul_f32 v20, v60, v60
  v_mul_f32 v21, v61, v61
  v_mul_f32 v22, v62, v62
  v_mul_f32 v23, v63, v63
  v_mov_b32 v24, s37
  v_fma_f32 v16, v16, s36, v24
  v_fma_f32 v17, v17, s36, v24
  v_fma_f32 v18, v18, s36, v24
  v_fma_f32 v19, v19, s36, v24
  v_fma_f32 v20, v20, s36, v24
  v_fma_f32 v21, v21, s36, v24
  v_fma_f32 v22, v22, s36, v24
  v_fma_f32 v23, v23, s36, v24
  v_mul_f32 v16, v16, v56
  v_mul_f32 v17, v17, v57
  v_mul_f32 v18, v18, v58
  v_mul_f32 v19, v19, v59
  v_mul_f32 v20, v20, v60
  v_mul_f32 v21, v21, v61
  v_mul_f32 v22, v22, v62
  v_mul_f32 v23, v23, v63
  v_exp_f32 v16, v16
  v_exp_f32 v17, v17
  v_exp_f32 v18, v18
  v_exp_f32 v19, v19
  v_exp_f32 v20, v20
  v_exp_f32 v21, v21
  v_exp_f32 v22, v22
  v_exp_f32 v23, v23
  v_add_f32 v16, 1.0, v16
  v_add_f32 v17, 1.0, v17
  v_add_f32 v18, 1.0, v18
  v_add_f32 v19, 1.0, v19
  v_add_f32 v20, 1.0, v20
  v_add_f32 v21, 1.0, v21
  v_add_f32 v22, 1.0, v22
  v_add_f32 v23, 1.0, v23
  v_rcp_f32 v16, v16
  v_rcp_f32 v17, v17
  v_rcp_f32 v18, v18
  v_rcp_f32 v19, v19
  v_rcp_f32 v20, v20
  v_rcp_f32 v21, v21
  v_rcp_f32 v22, v22
  v_rcp_f32 v23, v23
  s_nop 0
  v_mul_f32 v56, v56, v16
  v_mul_f32 v57, v57, v17
  v_mul_f32 v58, v58, v18
  v_mul_f32 v59, v59, v19
  v_mul_f32 v60, v60, v20
  v_mul_f32 v61, v61, v21
  v_mul_f32 v62, v62, v22
  v_mul_f32 v63, v63, v23
  v_cvt_pk_bf16_f32 v16, v56, v57
  v_cvt_pk_bf16_f32 v17, v58, v59
  s_lshl_b32 s24, s18, 5
  s_add_i32 s24, s24, s45
  s_add_i32 s24, s24, 0
  v_add_u32 v20, s24, v4
  v_cmp_gt_u32 vcc, 2048, v20
  v_mul_u32_u24 v20, 1152, v20
  v_add_u32 v20, v20, v5
  v_mov_b32 v21, 0x40000000
  v_cndmask_b32 v20, v21, v20, vcc
  buffer_store_dwordx2 v[16:17], v20, s[4:7], s46 offen sc1
  v_cvt_pk_bf16_f32 v18, v60, v61
  v_cvt_pk_bf16_f32 v19, v62, v63
  s_lshl_b32 s24, s18, 5
  s_add_i32 s24, s24, s45
  s_add_i32 s24, s24, 16
  v_add_u32 v20, s24, v4
  v_cmp_gt_u32 vcc, 2048, v20
  v_mul_u32_u24 v20, 1152, v20
  v_add_u32 v20, v20, v5
  v_mov_b32 v21, 0x40000000
  v_cndmask_b32 v20, v21, v20, vcc
  buffer_store_dwordx2 v[18:19], v20, s[4:7], s46 offen sc1
  s_add_u32 s42, s18, 1
  s_add_u32 s18, s18, 2
  s_cmp_lt_u32 s18, 64
  s_cbranch_scc1 L_r4_top_106
  s_waitcnt vmcnt(0)
  s_barrier
  s_cmp_eq_u32 s17, 0
  s_cbranch_scc0 L_sf_113
  v_mov_b32 v24, s42
  v_mov_b32 v25, 0
  s_mov_b64 exec, 1
  buffer_store_dword v24, v25, s[4:7], s41 offen sc1
  s_mov_b64 exec, -1
L_sf_113:
  s_endpgm
L_role_r5:
  s_sub_u32 s16, s23, 108
  s_lshl_b32 s41, s16, 2
  s_add_u32 s41, s41, 0xe900a00
  s_cmp_ge_u32 s16, 9
  s_cselect_b32 s47, 1, 0
  s_mul_i32 s24, s47, 9
  s_sub_u32 s16, s16, s24
  s_load_dwordx2 s[8:9], s[0:1], 72
  s_mov_b32 s10, 0xa2000
  s_mov_b32 s11, 0x00020000
  s_waitcnt lgkmcnt(0)
  s_and_b32 s9, s9, 0xffff
  s_lshl_b32 s24, s16, 7
  s_lshl_b32 s25, s17, 5
  v_and_b32 v16, 63, v0
  v_lshrrev_b32 v17, 3, v16
  v_and_b32 v18, 7, v16
  s_mov_b32 s32, 1152
  v_mul_lo_u32 v17, v17, s32
  v_lshl_add_u32 v17, v18, 4, v17
  s_mul_i32 s34, s17, 9216
  s_add_u32 s34, s34, s24
  s_lshl_b32 s33, s17, 10
  s_add_u32 m0, s33, 0
  s_add_u32 s32, s34, 0
  buffer_load_dwordx4 v17, s[8:11], s32 offen lds
  s_add_u32 m0, s33, 4096
  s_add_u32 s32, s34, 36864
  buffer_load_dwordx4 v17, s[8:11], s32 offen lds
  s_add_u32 m0, s33, 8192
  s_add_u32 s32, s34, 73728
  buffer_load_dwordx4 v17, s[8:11], s32 offen lds
  s_add_u32 m0, s33, 12288
  s_add_u32 s32, s34, 110592
  buffer_load_dwordx4 v17, s[8:11], s32 offen lds
  s_add_u32 m0, s33, 16384
  s_add_u32 s32, s34, 147456
  buffer_load_dwordx4 v17, s[8:11], s32 offen lds
  s_add_u32 m0, s33, 20480
  s_add_u32 s32, s34, 184320
  buffer_load_dwordx4 v17, s[8:11], s32 offen lds
  s_add_u32 m0, s33, 24576
  s_add_u32 s32, s34, 221184
  buffer_load_dwordx4 v17, s[8:11], s32 offen lds
  s_add_u32 m0, s33, 28672
  s_add_u32 s32, s34, 258048
  buffer_load_dwordx4 v17, s[8:11], s32 offen lds
  s_add_u32 m0, s33, 32768
  s_add_u32 s32, s34, 294912
  buffer_load_dwordx4 v17, s[8:11], s32 offen lds
  s_add_u32 m0, s33, 36864
  s_add_u32 s32, s34, 331776
  buffer_load_dwordx4 v17, s[8:11], s32 offen lds
  s_add_u32 m0, s33, 40960
  s_add_u32 s32, s34, 368640
  buffer_load_dwordx4 v17, s[8:11], s32 offen lds
  s_add_u32 m0, s33, 45056
  s_add_u32 s32, s34, 405504
  buffer_load_dwordx4 v17, s[8:11], s32 offen lds
  s_add_u32 m0, s33, 49152
  s_add_u32 s32, s34, 442368
  buffer_load_dwordx4 v17, s[8:11], s32 offen lds
  s_add_u32 m0, s33, 53248
  s_add_u32 s32, s34, 479232
  buffer_load_dwordx4 v17, s[8:11], s32 offen lds
  s_add_u32 m0, s33, 57344
  s_add_u32 s32, s34, 516096
  buffer_load_dwordx4 v17, s[8:11], s32 offen lds
  s_add_u32 m0, s33, 61440
  s_add_u32 s32, s34, 552960
  buffer_load_dwordx4 v17, s[8:11], s32 offen lds
  s_add_u32 m0, s33, 65536
  s_add_u32 s32, s34, 589824
  buffer_load_dwordx4 v17, s[8:11], s32 offen lds
  s_add_u32 m0, s33, 69632
  s_add_u32 s32, s34, 626688
  buffer_load_dwordx4 v17, s[8:11], s32 offen lds
  s_waitcnt vmcnt(0)
  s_barrier
  v_lshrrev_b32 v17, 4, v16
  v_bfe_u32 v18, v16, 2, 2
  v_lshl_add_u32 v17, v17, 2, v18
  v_mul_u32_u24 v17, 128, v17
  v_and_b32 v18, 3, v16
  v_lshl_add_u32 v17, v18, 3, v17
  v_add_u32 v17, s25, v17
  v_add_u32 v19, 0, v17
  ds_read_b64_tr_b16 a[0:1], v19 offset:0
  v_add_u32 v19, 2048, v17
  ds_read_b64_tr_b16 a[2:3], v19 offset:0
  v_add_u32 v19, 4096, v17
  ds_read_b64_tr_b16 a[4:5], v19 offset:0
  v_add_u32 v19, 6144, v17
  ds_read_b64_tr_b16 a[6:7], v19 offset:0
  v_add_u32 v19, 8192, v17
  ds_read_b64_tr_b16 a[8:9], v19 offset:0
  v_add_u32 v19, 10240, v17
  ds_read_b64_tr_b16 a[10:11], v19 offset:0
  v_add_u32 v19, 12288, v17
  ds_read_b64_tr_b16 a[12:13], v19 offset:0
  v_add_u32 v19, 14336, v17
  ds_read_b64_tr_b16 a[14:15], v19 offset:0
  v_add_u32 v19, 16384, v17
  ds_read_b64_tr_b16 a[16:17], v19 offset:0
  v_add_u32 v19, 18432, v17
  ds_read_b64_tr_b16 a[18:19], v19 offset:0
  v_add_u32 v19, 20480, v17
  ds_read_b64_tr_b16 a[20:21], v19 offset:0
  v_add_u32 v19, 22528, v17
  ds_read_b64_tr_b16 a[22:23], v19 offset:0
  s_waitcnt lgkmcnt(0)
  v_add_u32 v19, 24576, v17
  ds_read_b64_tr_b16 a[24:25], v19 offset:0
  v_add_u32 v19, 26624, v17
  ds_read_b64_tr_b16 a[26:27], v19 offset:0
  v_add_u32 v19, 28672, v17
  ds_read_b64_tr_b16 a[28:29], v19 offset:0
  v_add_u32 v19, 30720, v17
  ds_read_b64_tr_b16 a[30:31], v19 offset:0
  v_add_u32 v19, 32768, v17
  ds_read_b64_tr_b16 a[32:33], v19 offset:0
  v_add_u32 v19, 34816, v17
  ds_read_b64_tr_b16 a[34:35], v19 offset:0
  v_add_u32 v19, 36864, v17
  ds_read_b64_tr_b16 a[36:37], v19 offset:0
  v_add_u32 v19, 38912, v17
  ds_read_b64_tr_b16 a[38:39], v19 offset:0
  v_add_u32 v19, 40960, v17
  ds_read_b64_tr_b16 a[40:41], v19 offset:0
  v_add_u32 v19, 43008, v17
  ds_read_b64_tr_b16 a[42:43], v19 offset:0
  v_add_u32 v19, 45056, v17
  ds_read_b64_tr_b16 a[44:45], v19 offset:0
  v_add_u32 v19, 47104, v17
  ds_read_b64_tr_b16 a[46:47], v19 offset:0
  s_waitcnt lgkmcnt(0)
  v_add_u32 v19, 49152, v17
  ds_read_b64_tr_b16 a[48:49], v19 offset:0
  v_add_u32 v19, 51200, v17
  ds_read_b64_tr_b16 a[50:51], v19 offset:0
  v_add_u32 v19, 53248, v17
  ds_read_b64_tr_b16 a[52:53], v19 offset:0
  v_add_u32 v19, 55296, v17
  ds_read_b64_tr_b16 a[54:55], v19 offset:0
  v_add_u32 v19, 57344, v17
  ds_read_b64_tr_b16 a[56:57], v19 offset:0
  v_add_u32 v19, 59392, v17
  ds_read_b64_tr_b16 a[58:59], v19 offset:0
  v_add_u32 v19, 61440, v17
  ds_read_b64_tr_b16 a[60:61], v19 offset:0
  v_add_u32 v19, 63488, v17
  ds_read_b64_tr_b16 a[62:63], v19 offset:0
  v_add_u32 v19, 65536, v17
  ds_read_b64_tr_b16 a[64:65], v19 offset:0
  v_add_u32 v19, 67584, v17
  ds_read_b64_tr_b16 a[66:67], v19 offset:0
  v_add_u32 v19, 69632, v17
  ds_read_b64_tr_b16 a[68:69], v19 offset:0
  v_add_u32 v19, 71680, v17
  ds_read_b64_tr_b16 a[70:71], v19 offset:0
  s_waitcnt lgkmcnt(0)
  s_waitcnt lgkmcnt(0)
  s_barrier
  v_and_b32 v16, 63, v0
  s_lshl_b32 s32, s17, 6
  s_add_u32 s32, s32, 0
  v_add_u32 v17, s32, v16
  v_mul_u32_u24 v18, 58255, v17
  v_lshrrev_b32 v18, 22, v18
  v_mul_u32_u24 v19, 72, v18
  v_sub_u32 v19, v17, v19
  v_bfe_u32 v20, v18, 1, 3
  v_xor_b32 v19, v19, v20
  v_lshlrev_b32 v19, 4, v19
  v_mul_u32_u24 v18, 1152, v18
  v_add_u32 v6, v18, v19
  s_lshl_b32 s32, s17, 6
  s_add_u32 s32, s32, 256
  v_add_u32 v17, s32, v16
  v_mul_u32_u24 v18, 58255, v17
  v_lshrrev_b32 v18, 22, v18
  v_mul_u32_u24 v19, 72, v18
  v_sub_u32 v19, v17, v19
  v_bfe_u32 v20, v18, 1, 3
  v_xor_b32 v19, v19, v20
  v_lshlrev_b32 v19, 4, v19
  v_mul_u32_u24 v18, 1152, v18
  v_add_u32 v7, v18, v19
  s_lshl_b32 s32, s17, 6
  s_add_u32 s32, s32, 512
  v_add_u32 v17, s32, v16
  v_mul_u32_u24 v18, 58255, v17
  v_lshrrev_b32 v18, 22, v18
  v_mul_u32_u24 v19, 72, v18
  v_sub_u32 v19, v17, v19
  v_bfe_u32 v20, v18, 1, 3
  v_xor_b32 v19, v19, v20
  v_lshlrev_b32 v19, 4, v19
  v_mul_u32_u24 v18, 1152, v18
  v_add_u32 v8, v18, v19
  s_lshl_b32 s32, s17, 6
  s_add_u32 s32, s32, 768
  v_add_u32 v17, s32, v16
  v_mul_u32_u24 v18, 58255, v17
  v_lshrrev_b32 v18, 22, v18
  v_mul_u32_u24 v19, 72, v18
  v_sub_u32 v19, v17, v19
  v_bfe_u32 v20, v18, 1, 3
  v_xor_b32 v19, v19, v20
  v_lshlrev_b32 v19, 4, v19
  v_mul_u32_u24 v18, 1152, v18
  v_add_u32 v9, v18, v19
  s_lshl_b32 s32, s17, 6
  s_add_u32 s32, s32, 1024
  v_add_u32 v17, s32, v16
  v_mul_u32_u24 v18, 58255, v17
  v_lshrrev_b32 v18, 22, v18
  v_mul_u32_u24 v19, 72, v18
  v_sub_u32 v19, v17, v19
  v_bfe_u32 v20, v18, 1, 3
  v_xor_b32 v19, v19, v20
  v_lshlrev_b32 v19, 4, v19
  v_mul_u32_u24 v18, 1152, v18
  v_add_u32 v10, v18, v19
  s_lshl_b32 s32, s17, 6
  s_add_u32 s32, s32, 1280
  v_add_u32 v17, s32, v16
  v_mul_u32_u24 v18, 58255, v17
  v_lshrrev_b32 v18, 22, v18
  v_mul_u32_u24 v19, 72, v18
  v_sub_u32 v19, v17, v19
  v_bfe_u32 v20, v18, 1, 3
  v_xor_b32 v19, v19, v20
  v_lshlrev_b32 v19, 4, v19
  v_mul_u32_u24 v18, 1152, v18
  v_add_u32 v11, v18, v19
  s_lshl_b32 s32, s17, 6
  s_add_u32 s32, s32, 1536
  v_add_u32 v17, s32, v16
  v_mul_u32_u24 v18, 58255, v17
  v_lshrrev_b32 v18, 22, v18
  v_mul_u32_u24 v19, 72, v18
  v_sub_u32 v19, v17, v19
  v_bfe_u32 v20, v18, 1, 3
  v_xor_b32 v19, v19, v20
  v_lshlrev_b32 v19, 4, v19
  v_mul_u32_u24 v18, 1152, v18
  v_add_u32 v12, v18, v19
  s_lshl_b32 s32, s17, 6
  s_add_u32 s32, s32, 1792
  v_add_u32 v17, s32, v16
  v_mul_u32_u24 v18, 58255, v17
  v_lshrrev_b32 v18, 22, v18
  v_mul_u32_u24 v19, 72, v18
  v_sub_u32 v19, v17, v19
  v_bfe_u32 v20, v18, 1, 3
  v_xor_b32 v19, v19, v20
  v_lshlrev_b32 v19, 4, v19
  v_mul_u32_u24 v18, 1152, v18
  v_add_u32 v13, v18, v19
  s_lshl_b32 s32, s17, 6
  s_add_u32 s32, s32, 2048
  v_add_u32 v17, s32, v16
  v_mul_u32_u24 v18, 58255, v17
  v_lshrrev_b32 v18, 22, v18
  v_mul_u32_u24 v19, 72, v18
  v_sub_u32 v19, v17, v19
  v_bfe_u32 v20, v18, 1, 3
  v_xor_b32 v19, v19, v20
  v_lshlrev_b32 v19, 4, v19
  v_mul_u32_u24 v18, 1152, v18
  v_add_u32 v14, v18, v19
  v_and_b32 v17, 15, v16
  v_lshrrev_b32 v18, 4, v16
  v_bfe_u32 v19, v17, 1, 3
  v_xor_b32 v19, v19, v18
  v_lshlrev_b32 v19, 4, v19
  v_mul_u32_u24 v17, 1152, v17
  v_add_u32 v2, v17, v19
  v_xor_b32 v3, 64, v2
  v_and_b32 v16, 63, v0
  v_min_u32 v1, 17, v16
  v_cmp_le_u32 vcc, 9, v1
  s_cmp_eq_u32 s47, 1
  s_cselect_b64 s[48:49], vcc, 0
  s_not_b64 vcc, vcc
  s_cmp_eq_u32 s47, 0
  s_cselect_b64 s[48:49], vcc, s[48:49]
  v_lshlrev_b32 v1, 2, v1
  s_lshl_b32 s44, s16, 2
  s_add_u32 s44, s44, s17
  s_lshr_b32 s46, s44, 1
  s_lshl_b32 s46, s46, 6
  s_and_b32 s24, s44, 1
  s_lshl_b32 s24, s24, 3
  s_add_u32 s46, s46, s24
  v_and_b32 v4, 15, v16
  v_lshrrev_b32 v17, 4, v16
  v_mul_u32_u24 v5, 1152, v4
  v_lshl_add_u32 v5, v17, 4, v5
  v_mov_b32 v232, 128
  s_mov_b32 s24, 262144
L_wc_114:
  buffer_load_dword v233, v232, s[12:15], 0 offen sc1
  s_waitcnt vmcnt(0)
  v_cmp_gt_u32 vcc, 33, v233
  s_cbranch_vccz L_wc_ok_115
  s_sleep 8
  s_sub_u32 s24, s24, 1
  s_cmp_lg_u32 s24, 0
  s_cbranch_scc1 L_wc_114
  s_branch L_fail
L_wc_ok_115:
  s_mov_b32 s18, s47
L_r5_top_116:
  s_add_u32 s28, s18, 1
  s_add_u32 s29, s18, 2
  s_cmp_eq_u32 s18, 63
  s_cselect_b32 s29, s18, s29
  v_mov_b32 v15, s28
  v_mov_b32 v19, s29
  v_cndmask_b32 v15, v19, v15, s[48:49]
  s_mov_b32 s29, 0xe900800
  s_mov_b32 s40, 262144
  s_cmp_eq_u32 s17, 0
  s_cbranch_scc0 L_wf_first_120
  buffer_load_dword v16, v1, s[4:7], s29 offen sc1
L_wf_first_120:
  s_waitcnt vmcnt(0)
  s_cmp_eq_u32 s42, 0
  s_cbranch_scc1 L_pend_121
  s_barrier
  s_cmp_eq_u32 s17, 0
  s_cbranch_scc0 L_pend2_122
  v_mov_b32 v17, s42
  buffer_store_dword v17, off, s[4:7], s41 sc1
L_pend2_122:
  s_mov_b32 s42, 0
L_pend_121:
  s_cmp_eq_u32 s17, 0
  s_cbranch_scc0 L_wf_rel_119
  v_cmp_gt_u32 vcc, v15, v16
  s_cbranch_vccz L_wf_ok_118
L_wf_117:
  s_sleep 8
  buffer_load_dword v16, v1, s[4:7], s29 offen sc1
  s_waitcnt vmcnt(0)
  v_cmp_gt_u32 vcc, v15, v16
  s_cbranch_vccz L_wf_ok_118
  s_sub_u32 s40, s40, 1
  s_cmp_lg_u32 s40, 0
  s_cbranch_scc1 L_wf_117
  s_branch L_fail
L_wf_ok_118:
L_wf_rel_119:
  s_barrier
  s_mul_i32 s30, s18, 36864
  s_add_u32 s24, s30, 0xe200000
  s_lshl_b32 s33, s17, 10
  s_add_u32 m0, s33, 0
  s_nop 0
  buffer_load_dwordx4 v6, s[4:7], s24 offen sc1 lds
  s_add_u32 m0, s33, 4096
  s_nop 0
  buffer_load_dwordx4 v7, s[4:7], s24 offen sc1 lds
  s_add_u32 m0, s33, 8192
  s_nop 0
  buffer_load_dwordx4 v8, s[4:7], s24 offen sc1 lds
  s_add_u32 m0, s33, 12288
  s_nop 0
  buffer_load_dwordx4 v9, s[4:7], s24 offen sc1 lds
  s_add_u32 m0, s33, 16384
  s_nop 0
  buffer_load_dwordx4 v10, s[4:7], s24 offen sc1 lds
  s_add_u32 m0, s33, 20480
  s_nop 0
  buffer_load_dwordx4 v11, s[4:7], s24 offen sc1 lds
  s_add_u32 m0, s33, 24576
  s_nop 0
  buffer_load_dwordx4 v12, s[4:7], s24 offen sc1 lds
  s_add_u32 m0, s33, 28672
  s_nop 0
  buffer_load_dwordx4 v13, s[4:7], s24 offen sc1 lds
  s_add_u32 m0, s33, 32768
  s_nop 0
  buffer_load_dwordx4 v14, s[4:7], s24 offen sc1 lds
  s_add_u32 s30, s30, s46
  s_add_u32 s24, s30, 0xdc00000
  buffer_load_dwordx2 v[64:65], v5, s[4:7], s24 offen sc1
  s_add_u32 s24, s30, 0xdc04800
  buffer_load_dwordx2 v[66:67], v5, s[4:7], s24 offen sc1
  s_waitcnt vmcnt(0)
  s_barrier
  ds_read_b128 v[40:43], v2 offset:0
  ds_read_b128 v[44:47], v2 offset:18432
  ds_read_b128 v[48:51], v3 offset:0
  ds_read_b128 v[52:55], v3 offset:18432
  s_waitcnt lgkmcnt(2)
  v_mfma_f32_16x16x32_bf16 v[56:59], a[0:3], v[40:43], 0
  v_mfma_f32_16x16x32_bf16 v[60:63], a[0:3], v[44:47], 0
  ds_read_b128 v[40:43], v2 offset:128
  ds_read_b128 v[44:47], v2 offset:18560
  s_waitcnt lgkmcnt(2)
  v_mfma_f32_16x16x32_bf16 v[56:59], a[4:7], v[48:51], v[56:59]
  v_mfma_f32_16x16x32_bf16 v[60:63], a[4:7], v[52:55], v[60:63]
  ds_read_b128 v[48:51], v3 offset:128
  ds_read_b128 v[52:55], v3 offset:18560
  s_waitcnt lgkmcnt(2)
  v_mfma_f32_16x16x32_bf16 v[56:59], a[8:11], v[40:43], v[56:59]
  v_mfma_f32_16x16x32_bf16 v[60:63], a[8:11], v[44:47], v[60:63]
  ds_read_b128 v[40:43], v2 offset:256
  ds_read_b128 v[44:47], v2 offset:18688
  s_waitcnt lgkmcnt(2)
  v_mfma_f32_16x16x32_bf16 v[56:59], a[12:15], v[48:51], v[56:59]
  v_mfma_f32_16x16x32_bf16 v[60:63], a[12:15], v[52:55], v[60:63]
  ds_read_b128 v[48:51], v3 offset:256
  ds_read_b128 v[52:55], v3 offset:18688
  s_waitcnt lgkmcnt(2)
  v_mfma_f32_16x16x32_bf16 v[56:59], a[16:19], v[40:43], v[56:59]
  v_mfma_f32_16x16x32_bf16 v[60:63], a[16:19], v[44:47], v[60:63]
  ds_read_b128 v[40:43], v2 offset:384
  ds_read_b128 v[44:47], v2 offset:18816
  s_waitcnt lgkmcnt(2)
  v_mfma_f32_16x16x32_bf16 v[56:59], a[20:23], v[48:51], v[56:59]
  v_mfma_f32_16x16x32_bf16 v[60:63], a[20:23], v[52:55], v[60:63]
  ds_read_b128 v[48:51], v3 offset:384
  ds_read_b128 v[52:55], v3 offset:18816
  s_waitcnt lgkmcnt(2)
  v_mfma_f32_16x16x32_bf16 v[56:59], a[24:27], v[40:43], v[56:59]
  v_mfma_f32_16x16x32_bf16 v[60:63], a[24:27], v[44:47], v[60:63]
  ds_read_b128 v[40:43], v2 offset:512
  ds_read_b128 v[44:47], v2 offset:18944
  s_waitcnt lgkmcnt(2)
  v_mfma_f32_16x16x32_bf16 v[56:59], a[28:31], v[48:51], v[56:59]
  v_mfma_f32_16x16x32_bf16 v[60:63], a[28:31], v[52:55], v[60:63]
  ds_read_b128 v[48:51], v3 offset:512
  ds_read_b128 v[52:55], v3 offset:18944
  s_waitcnt lgkmcnt(2)
  v_mfma_f32_16x16x32_bf16 v[56:59], a[32:35], v[40:43], v[56:59]
  v_mfma_f32_16x16x32_bf16 v[60:63], a[32:35], v[44:47], v[60:63]
  ds_read_b128 v[40:43], v2 offset:640
  ds_read_b128 v[44:47], v2 offset:19072
  s_waitcnt lgkmcnt(2)
  v_mfma_f32_16x16x32_bf16 v[56:59], a[36:39], v[48:51], v[56:59]
  v_mfma_f32_16x16x32_bf16 v[60:63], a[36:39], v[52:55], v[60:63]
  ds_read_b128 v[48:51], v3 offset:640
  ds_read_b128 v[52:55], v3 offset:19072
  s_waitcnt lgkmcnt(2)
  v_mfma_f32_16x16x32_bf16 v[56:59], a[40:43], v[40:43], v[56:59]
  v_mfma_f32_16x16x32_bf16 v[60:63], a[40:43], v[44:47], v[60:63]
  ds_read_b128 v[40:43], v2 offset:768
  ds_read_b128 v[44:47], v2 offset:19200
  s_waitcnt lgkmcnt(2)
  v_mfma_f32_16x16x32_bf16 v[56:59], a[44:47], v[48:51], v[56:59]
  v_mfma_f32_16x16x32_bf16 v[60:63], a[44:47], v[52:55], v[60:63]
  ds_read_b128 v[48:51], v3 offset:768
  ds_read_b128 v[52:55], v3 offset:19200
  s_waitcnt lgkmcnt(2)
  v_mfma_f32_16x16x32_bf16 v[56:59], a[48:51], v[40:43], v[56:59]
  v_mfma_f32_16x16x32_bf16 v[60:63], a[48:51], v[44:47], v[60:63]
  ds_read_b128 v[40:43], v2 offset:896
  ds_read_b128 v[44:47], v2 offset:19328
  s_waitcnt lgkmcnt(2)
  v_mfma_f32_16x16x32_bf16 v[56:59], a[52:55], v[48:51], v[56:59]
  v_mfma_f32_16x16x32_bf16 v[60:63], a[52:55], v[52:55], v[60:63]
  ds_read_b128 v[48:51], v3 offset:896
  ds_read_b128 v[52:55], v3 offset:19328
  s_waitcnt lgkmcnt(2)
  v_mfma_f32_16x16x32_bf16 v[56:59], a[56:59], v[40:43], v[56:59]
  v_mfma_f32_16x16x32_bf16 v[60:63], a[56:59], v[44:47], v[60:63]
  ds_read_b128 v[40:43], v2 offset:1024
  ds_read_b128 v[44:47], v2 offset:19456
  s_waitcnt lgkmcnt(2)
  v_mfma_f32_16x16x32_bf16 v[56:59], a[60:63], v[48:51], v[56:59]
  v_mfma_f32_16x16x32_bf16 v[60:63], a[60:63], v[52:55], v[60:63]
  ds_read_b128 v[48:51], v3 offset:1024
  ds_read_b128 v[52:55], v3 offset:19456
  s_waitcnt lgkmcnt(2)
  v_mfma_f32_16x16x32_bf16 v[56:59], a[64:67], v[40:43], v[56:59]
  v_mfma_f32_16x16x32_bf16 v[60:63], a[64:67], v[44:47], v[60:63]
  s_waitcnt lgkmcnt(0)
  v_mfma_f32_16x16x32_bf16 v[56:59], a[68:71], v[48:51], v[56:59]
  v_mfma_f32_16x16x32_bf16 v[60:63], a[68:71], v[52:55], v[60:63]
  s_nop 7
  v_cvt_pk_bf16_f32 v56, v56, v56
  v_lshlrev_b32 v56, 16, v56
  v_cvt_pk_bf16_f32 v57, v57, v57
  v_lshlrev_b32 v57, 16, v57
  v_cvt_pk_bf16_f32 v58, v58, v58
  v_lshlrev_b32 v58, 16, v58
  v_cvt_pk_bf16_f32 v59, v59, v59
  v_lshlrev_b32 v59, 16, v59
  v_cvt_pk_bf16_f32 v60, v60, v60
  v_lshlrev_b32 v60, 16, v60
  v_cvt_pk_bf16_f32 v61, v61, v61
  v_lshlrev_b32 v61, 16, v61
  v_cvt_pk_bf16_f32 v62, v62, v62
  v_lshlrev_b32 v62, 16, v62
  v_cvt_pk_bf16_f32 v63, v63, v63
  v_lshlrev_b32 v63, 16, v63
  v_lshlrev_b32 v16, 16, v64
  v_and_b32 v17, 0xffff0000, v64
  v_lshlrev_b32 v18, 16, v65
  v_and_b32 v19, 0xffff0000, v65
  v_lshlrev_b32 v20, 16, v66
  v_and_b32 v21, 0xffff0000, v66
  v_lshlrev_b32 v22, 16, v67
  v_and_b32 v23, 0xffff0000, v67
  v_add_f32 v56, v56, v16
  v_add_f32 v57, v57, v17
  v_add_f32 v58, v58, v18
  v_add_f32 v59, v59, v19
  v_add_f32 v60, v60, v20
  v_add_f32 v61, v61, v21
  v_add_f32 v62, v62, v22
  v_add_f32 v63, v63, v23
  v_cvt_pk_bf16_f32 v56, v56, v56
  v_lshlrev_b32 v56, 16, v56
  v_cvt_pk_bf16_f32 v57, v57, v57
  v_lshlrev_b32 v57, 16, v57
  v_cvt_pk_bf16_f32 v58, v58, v58
  v_lshlrev_b32 v58, 16, v58
  v_cvt_pk_bf16_f32 v59, v59, v59
  v_lshlrev_b32 v59, 16, v59
  v_cvt_pk_bf16_f32 v60, v60, v60
  v_lshlrev_b32 v60, 16, v60
  v_cvt_pk_bf16_f32 v61, v61, v61
  v_lshlrev_b32 v61, 16, v61
  v_cvt_pk_bf16_f32 v62, v62, v62
  v_lshlrev_b32 v62, 16, v62
  v_cvt_pk_bf16_f32 v63, v63, v63
  v_lshlrev_b32 v63, 16, v63
  v_cvt_pk_bf16_f32 v16, v56, v57
  v_cvt_pk_bf16_f32 v17, v58, v59
  s_add_u32 s24, s30, 0xe500000
  buffer_store_dwordx2 v[16:17], v5, s[4:7], s24 offen sc1
  v_cvt_pk_bf16_f32 v18, v60, v61
  v_cvt_pk_bf16_f32 v19, v62, v63
  s_add_u32 s24, s30, 0xe504800
  buffer_store_dwordx2 v[18:19], v5, s[4:7], s24 offen sc1
  v_add_f32 v24, v56, v57
  v_mul_f32 v25, v56, v56
  v_add_f32 v24, v24, v58
  v_fma_f32 v25, v57, v57, v25
  v_add_f32 v24, v24, v59
  v_fma_f32 v25, v58, v58, v25
  v_fma_f32 v25, v59, v59, v25
  v_add_f32 v26, v60, v61
  v_mul_f32 v27, v60, v60
  v_add_f32 v26, v26, v62
  v_fma_f32 v27, v61, v61, v27
  v_add_f32 v26, v26, v63
  v_fma_f32 v27, v62, v62, v27
  v_fma_f32 v27, v63, v63, v27
  v_mov_b32 v28, v24
  v_mov_b32 v29, v25
  v_mov_b32 v30, v26
  v_mov_b32 v31, v27
  s_nop 0
  v_permlane16_swap_b32 v24, v28
  v_permlane16_swap_b32 v25, v29
  v_permlane16_swap_b32 v26, v30
  v_permlane16_swap_b32 v27, v31
  v_add_f32 v24, v24, v28
  v_add_f32 v25, v25, v29
  v_add_f32 v26, v26, v30
  v_add_f32 v27, v27, v31
  v_mov_b32 v28, v24
  v_mov_b32 v29, v25
  v_mov_b32 v30, v26
  v_mov_b32 v31, v27
  s_nop 0
  v_permlane32_swap_b32 v24, v28
  v_permlane32_swap_b32 v25, v29
  v_permlane32_swap_b32 v26, v30
  v_permlane32_swap_b32 v27, v31
  v_add_f32 v24, v24, v28
  v_add_f32 v25, v25, v29
  v_add_f32 v26, v26, v30
  v_add_f32 v27, v27, v31
  s_lshl_b32 s24, s17, 8
  v_lshl_add_u32 v16, v4, 3, s24
  s_mov_b64 exec, 0xffff
  ds_write_b64 v16, v[24:25] offset:36864
  ds_write_b64 v16, v[26:27] offset:36992
  s_mov_b64 exec, -1
  s_waitcnt lgkmcnt(0)
  s_barrier
  s_cmp_eq_u32 s17, 0
  s_cbranch_scc0 L_r5_st_123
  v_and_b32 v16, 31, v0
  v_lshlrev_b32 v16, 3, v16
  ds_read_b64 v[18:19], v16 offset:36864
  ds_read_b64 v[20:21], v16 offset:37120
  ds_read_b64 v[22:23], v16 offset:37376
  ds_read_b64 v[24:25], v16 offset:37632
  s_waitcnt lgkmcnt(0)
  v_add_f32 v18, v18, v20
  v_add_f32 v19, v19, v21
  v_add_f32 v22, v22, v24
  v_add_f32 v23, v23, v25
  v_add_f32 v18, v18, v22
  v_add_f32 v19, v19, v23
  s_mul_i32 s24, s18, 9
  s_add_u32 s24, s24, s16
  s_lshl_b32 s24, s24, 8
  s_add_u32 s24, s24, 0xe800000
  s_mov_b32 exec_hi, 0
  buffer_store_dwordx2 v[18:19], v16, s[4:7], s24 offen sc1
  s_mov_b64 exec, -1
L_r5_st_123:
  s_add_u32 s42, s18, 1
  s_add_u32 s18, s18, 2
  s_cmp_lt_u32 s18, 64
  s_cbranch_scc1 L_r5_top_116
  s_waitcnt vmcnt(0)
  s_barrier
  s_cmp_eq_u32 s17, 0
  s_cbranch_scc0 L_sf_124
  v_mov_b32 v28, s42
  v_mov_b32 v29, 0
  s_mov_b64 exec, 1
  buffer_store_dword v28, v29, s[4:7], s41 offen sc1
  s_mov_b64 exec, -1
L_sf_124:
  s_endpgm
L_role_r67:
  s_sub_u32 s16, s23, 126
  s_cmp_ge_u32 s16, 36
  s_cselect_b32 s45, 1, 0
  s_mul_i32 s24, s45, 36
  s_sub_u32 s44, s16, s24
  v_and_b32 v20, 63, v0
  v_lshlrev_b32 v16, 4, v20
  s_load_dwordx2 s[8:9], s[0:1], 80
  s_mov_b32 s10, 0x510000
  s_mov_b32 s11, 0x00020000
  s_waitcnt lgkmcnt(0)
  s_and_b32 s9, s9, 0xffff
  s_lshl_b32 s24, s44, 8
  s_lshl_b32 s25, s17, 6
  v_and_b32 v20, 63, v0
  v_lshrrev_b32 v21, 4, v20
  v_and_b32 v22, 15, v20
  s_mov_b32 s32, 9216
  v_mul_lo_u32 v21, v21, s32
  v_lshl_add_u32 v21, v22, 4, v21
  s_mul_i32 s34, s17, 36864
  s_add_u32 s34, s34, s24
  s_lshl_b32 s33, s17, 10
  s_add_u32 m0, s33, 0
  s_add_u32 s32, s34, 0
  buffer_load_dwordx4 v21, s[8:11], s32 offen lds
  s_add_u32 m0, s33, 4096
  s_add_u32 s32, s34, 147456
  buffer_load_dwordx4 v21, s[8:11], s32 offen lds
  s_add_u32 m0, s33, 8192
  s_add_u32 s32, s34, 294912
  buffer_load_dwordx4 v21, s[8:11], s32 offen lds
  s_add_u32 m0, s33, 12288
  s_add_u32 s32, s34, 442368
  buffer_load_dwordx4 v21, s[8:11], s32 offen lds
  s_add_u32 m0, s33, 16384
  s_add_u32 s32, s34, 589824
  buffer_load_dwordx4 v21, s[8:11], s32 offen lds
  s_add_u32 m0, s33, 20480
  s_add_u32 s32, s34, 737280
  buffer_load_dwordx4 v21, s[8:11], s32 offen lds
  s_add_u32 m0, s33, 24576
  s_add_u32 s32, s34, 884736
  buffer_load_dwordx4 v21, s[8:11], s32 offen lds
  s_add_u32 m0, s33, 28672
  s_add_u32 s32, s34, 1032192
  buffer_load_dwordx4 v21, s[8:11], s32 offen lds
  s_add_u32 m0, s33, 32768
  s_add_u32 s32, s34, 1179648
  buffer_load_dwordx4 v21, s[8:11], s32 offen lds
  s_add_u32 m0, s33, 36864
  s_add_u32 s32, s34, 1327104
  buffer_load_dwordx4 v21, s[8:11], s32 offen lds
  s_add_u32 m0, s33, 40960
  s_add_u32 s32, s34, 1474560
  buffer_load_dwordx4 v21, s[8:11], s32 offen lds
  s_add_u32 m0, s33, 45056
  s_add_u32 s32, s34, 1622016
  buffer_load_dwordx4 v21, s[8:11], s32 offen lds
  s_add_u32 m0, s33, 49152
  s_add_u32 s32, s34, 1769472
  buffer_load_dwordx4 v21, s[8:11], s32 offen lds
  s_add_u32 m0, s33, 53248
  s_add_u32 s32, s34, 1916928
  buffer_load_dwordx4 v21, s[8:11], s32 offen lds
  s_add_u32 m0, s33, 57344
  s_add_u32 s32, s34, 2064384
  buffer_load_dwordx4 v21, s[8:11], s32 offen lds
  s_add_u32 m0, s33, 61440
  s_add_u32 s32, s34, 2211840
  buffer_load_dwordx4 v21, s[8:11], s32 offen lds
  s_add_u32 m0, s33, 65536
  s_add_u32 s32, s34, 2359296
  buffer_load_dwordx4 v21, s[8:11], s32 offen lds
  s_add_u32 m0, s33, 69632
  s_add_u32 s32, s34, 2506752
  buffer_load_dwordx4 v21, s[8:11], s32 offen lds
  s_add_u32 m0, s33, 73728
  s_add_u32 s32, s34, 2654208
  buffer_load_dwordx4 v21, s[8:11], s32 offen lds
  s_add_u32 m0, s33, 77824
  s_add_u32 s32, s34, 2801664
  buffer_load_dwordx4 v21, s[8:11], s32 offen lds
  s_add_u32 m0, s33, 81920
  s_add_u32 s32, s34, 2949120
  buffer_load_dwordx4 v21, s[8:11], s32 offen lds
  s_add_u32 m0, s33, 86016
  s_add_u32 s32, s34, 3096576
  buffer_load_dwordx4 v21, s[8:11], s32 offen lds
  s_add_u32 m0, s33, 90112
  s_add_u32 s32, s34, 3244032
  buffer_load_dwordx4 v21, s[8:11], s32 offen lds
  s_add_u32 m0, s33, 94208
  s_add_u32 s32, s34, 3391488
  buffer_load_dwordx4 v21, s[8:11], s32 offen lds
  s_add_u32 m0, s33, 98304
  s_add_u32 s32, s34, 3538944
  buffer_load_dwordx4 v21, s[8:11], s32 offen lds
  s_add_u32 m0, s33, 102400
  s_add_u32 s32, s34, 3686400
  buffer_load_dwordx4 v21, s[8:11], s32 offen lds
  s_add_u32 m0, s33, 106496
  s_add_u32 s32, s34, 3833856
  buffer_load_dwordx4 v21, s[8:11], s32 offen lds
  s_add_u32 m0, s33, 110592
  s_add_u32 s32, s34, 3981312
  buffer_load_dwordx4 v21, s[8:11], s32 offen lds
  s_add_u32 m0, s33, 114688
  s_add_u32 s32, s34, 4128768
  buffer_load_dwordx4 v21, s[8:11], s32 offen lds
  s_add_u32 m0, s33, 118784
  s_add_u32 s32, s34, 4276224
  buffer_load_dwordx4 v21, s[8:11], s32 offen lds
  s_add_u32 m0, s33, 122880
  s_add_u32 s32, s34, 4423680
  buffer_load_dwordx4 v21, s[8:11], s32 offen lds
  s_add_u32 m0, s33, 126976
  s_add_u32 s32, s34, 4571136
  buffer_load_dwordx4 v21, s[8:11], s32 offen lds
  s_add_u32 m0, s33, 131072
  s_add_u32 s32, s34, 4718592
  buffer_load_dwordx4 v21, s[8:11], s32 offen lds
  s_add_u32 m0, s33, 135168
  s_add_u32 s32, s34, 4866048
  buffer_load_dwordx4 v21, s[8:11], s32 offen lds
  s_add_u32 m0, s33, 139264
  s_add_u32 s32, s34, 5013504
  buffer_load_dwordx4 v21, s[8:11], s32 offen lds
  s_add_u32 m0, s33, 143360
  s_add_u32 s32, s34, 5160960
  buffer_load_dwordx4 v21, s[8:11], s32 offen lds
  s_waitcnt vmcnt(0)
  s_barrier
  v_lshrrev_b32 v21, 4, v20
  v_bfe_u32 v22, v20, 2, 2
  v_lshl_add_u32 v21, v21, 2, v22
  v_mul_u32_u24 v21, 256, v21
  v_and_b32 v22, 3, v20
  v_lshl_add_u32 v21, v22, 3, v21
  v_add_u32 v21, s25, v21
  v_add_u32 v23, 0, v21
  ds_read_b64_tr_b16 a[0:1], v23 offset:0
  ds_read_b64_tr_b16 a[72:73], v23 offset:32
  v_add_u32 v23, 4096, v21
  ds_read_b64_tr_b16 a[2:3], v23 offset:0
  ds_read_b64_tr_b16 a[74:75], v23 offset:32
  v_add_u32 v23, 8192, v21
  ds_read_b64_tr_b16 a[4:5], v23 offset:0
  ds_read_b64_tr_b16 a[76:77], v23 offset:32
  v_add_u32 v23, 12288, v21
  ds_read_b64_tr_b16 a[6:7], v23 offset:0
  ds_read_b64_tr_b16 a[78:79], v23 offset:32
  v_add_u32 v23, 16384, v21
  ds_read_b64_tr_b16 a[8:9], v23 offset:0
  ds_read_b64_tr_b16 a[80:81], v23 offset:32
  v_add_u32 v23, 20480, v21
  ds_read_b64_tr_b16 a[10:11], v23 offset:0
  ds_read_b64_tr_b16 a[82:83], v23 offset:32
  s_waitcnt lgkmcnt(0)
  v_add_u32 v23, 24576, v21
  ds_read_b64_tr_b16 a[12:13], v23 offset:0
  ds_read_b64_tr_b16 a[84:85], v23 offset:32
  v_add_u32 v23, 28672, v21
  ds_read_b64_tr_b16 a[14:15], v23 offset:0
  ds_read_b64_tr_b16 a[86:87], v23 offset:32
  v_add_u32 v23, 32768, v21
  ds_read_b64_tr_b16 a[16:17], v23 offset:0
  ds_read_b64_tr_b16 a[88:89], v23 offset:32
  v_add_u32 v23, 36864, v21
  ds_read_b64_tr_b16 a[18:19], v23 offset:0
  ds_read_b64_tr_b16 a[90:91], v23 offset:32
  v_add_u32 v23, 40960, v21
  ds_read_b64_tr_b16 a[20:21], v23 offset:0
  ds_read_b64_tr_b16 a[92:93], v23 offset:32
  v_add_u32 v23, 45056, v21
  ds_read_b64_tr_b16 a[22:23], v23 offset:0
  ds_read_b64_tr_b16 a[94:95], v23 offset:32
  s_waitcnt lgkmcnt(0)
  v_add_u32 v23, 49152, v21
  ds_read_b64_tr_b16 a[24:25], v23 offset:0
  ds_read_b64_tr_b16 a[96:97], v23 offset:32
  v_add_u32 v23, 53248, v21
  ds_read_b64_tr_b16 a[26:27], v23 offset:0
  ds_read_b64_tr_b16 a[98:99], v23 offset:32
  v_add_u32 v23, 57344, v21
  ds_read_b64_tr_b16 a[28:29], v23 offset:0
  ds_read_b64_tr_b16 a[100:101], v23 offset:32
  v_add_u32 v23, 61440, v21
  ds_read_b64_tr_b16 a[30:31], v23 offset:0
  ds_read_b64_tr_b16 a[102:103], v23 offset:32
  v_add_u32 v23, 65536, v21
  ds_read_b64_tr_b16 a[32:33], v23 offset:0
  ds_read_b64_tr_b16 a[104:105], v23 offset:32
  v_add_u32 v23, 69632, v21
  ds_read_b64_tr_b16 a[34:35], v23 offset:0
  ds_read_b64_tr_b16 a[106:107], v23 offset:32
  s_waitcnt lgkmcnt(0)
  v_add_u32 v23, 73728, v21
  ds_read_b64_tr_b16 a[36:37], v23 offset:0
  ds_read_b64_tr_b16 a[108:109], v23 offset:32
  v_add_u32 v23, 77824, v21
  ds_read_b64_tr_b16 a[38:39], v23 offset:0
  ds_read_b64_tr_b16 a[110:111], v23 offset:32
  v_add_u32 v23, 81920, v21
  ds_read_b64_tr_b16 a[40:41], v23 offset:0
  ds_read_b64_tr_b16 a[112:113], v23 offset:32
  v_add_u32 v23, 86016, v21
  ds_read_b64_tr_b16 a[42:43], v23 offset:0
  ds_read_b64_tr_b16 a[114:115], v23 offset:32
  v_add_u32 v23, 90112, v21
  ds_read_b64_tr_b16 a[44:45], v23 offset:0
  ds_read_b64_tr_b16 a[116:117], v23 offset:32
  v_add_u32 v23, 94208, v21
  ds_read_b64_tr_b16 a[46:47], v23 offset:0
  ds_read_b64_tr_b16 a[118:119], v23 offset:32
  s_waitcnt lgkmcnt(0)
  v_add_u32 v23, 98304, v21
  ds_read_b64_tr_b16 a[48:49], v23 offset:0
  ds_read_b64_tr_b16 a[120:121], v23 offset:32
  v_add_u32 v23, 102400, v21
  ds_read_b64_tr_b16 a[50:51], v23 offset:0
  ds_read_b64_tr_b16 a[122:123], v23 offset:32
  v_add_u32 v23, 106496, v21
  ds_read_b64_tr_b16 a[52:53], v23 offset:0
  ds_read_b64_tr_b16 a[124:125], v23 offset:32
  v_add_u32 v23, 110592, v21
  ds_read_b64_tr_b16 a[54:55], v23 offset:0
  ds_read_b64_tr_b16 a[126:127], v23 offset:32
  v_add_u32 v23, 114688, v21
  ds_read_b64_tr_b16 a[56:57], v23 offset:0
  ds_read_b64_tr_b16 a[128:129], v23 offset:32
  v_add_u32 v23, 118784, v21
  ds_read_b64_tr_b16 a[58:59], v23 offset:0
  ds_read_b64_tr_b16 a[130:131], v23 offset:32
  s_waitcnt lgkmcnt(0)
  v_add_u32 v23, 122880, v21
  ds_read_b64_tr_b16 a[60:61], v23 offset:0
  ds_read_b64_tr_b16 a[132:133], v23 offset:32
  v_add_u32 v23, 126976, v21
  ds_read_b64_tr_b16 a[62:63], v23 offset:0
  ds_read_b64_tr_b16 a[134:135], v23 offset:32
  v_add_u32 v23, 131072, v21
  ds_read_b64_tr_b16 a[64:65], v23 offset:0
  ds_read_b64_tr_b16 a[136:137], v23 offset:32
  v_add_u32 v23, 135168, v21
  ds_read_b64_tr_b16 a[66:67], v23 offset:0
  ds_read_b64_tr_b16 a[138:139], v23 offset:32
  v_add_u32 v23, 139264, v21
  ds_read_b64_tr_b16 a[68:69], v23 offset:0
  ds_read_b64_tr_b16 a[140:141], v23 offset:32
  v_add_u32 v23, 143360, v21
  ds_read_b64_tr_b16 a[70:71], v23 offset:0
  ds_read_b64_tr_b16 a[142:143], v23 offset:32
  s_waitcnt lgkmcnt(0)
  s_waitcnt lgkmcnt(0)
  s_barrier
  v_mov_b32 v28, 0x3f803f80
  v_mov_b32 v29, 0x3f803f80
  v_mov_b32 v30, 0x3f803f80
  v_mov_b32 v31, 0x3f803f80
  s_nop 1
  v_mfma_f32_16x16x32_bf16 v[48:51], a[0:3], v[28:31], 0
  v_mfma_f32_16x16x32_bf16 v[48:51], a[4:7], v[28:31], v[48:51]
  v_mfma_f32_16x16x32_bf16 v[48:51], a[8:11], v[28:31], v[48:51]
  v_mfma_f32_16x16x32_bf16 v[48:51], a[12:15], v[28:31], v[48:51]
  v_mfma_f32_16x16x32_bf16 v[48:51], a[16:19], v[28:31], v[48:51]
  v_mfma_f32_16x16x32_bf16 v[48:51], a[20:23], v[28:31], v[48:51]
  v_mfma_f32_16x16x32_bf16 v[48:51], a[24:27], v[28:31], v[48:51]
  v_mfma_f32_16x16x32_bf16 v[48:51], a[28:31], v[28:31], v[48:51]
  v_mfma_f32_16x16x32_bf16 v[48:51], a[32:35], v[28:31], v[48:51]
  v_mfma_f32_16x16x32_bf16 v[48:51], a[36:39], v[28:31], v[48:51]
  v_mfma_f32_16x16x32_bf16 v[48:51], a[40:43], v[28:31], v[48:51]
  v_mfma_f32_16x16x32_bf16 v[48:51], a[44:47], v[28:31], v[48:51]
  v_mfma_f32_16x16x32_bf16 v[48:51], a[48:51], v[28:31], v[48:51]
  v_mfma_f32_16x16x32_bf16 v[48:51], a[52:55], v[28:31], v[48:51]
  v_mfma_f32_16x16x32_bf16 v[48:51], a[56:59], v[28:31], v[48:51]
  v_mfma_f32_16x16x32_bf16 v[48:51], a[60:63], v[28:31], v[48:51]
  v_mfma_f32_16x16x32_bf16 v[48:51], a[64:67], v[28:31], v[48:51]
  v_mfma_f32_16x16x32_bf16 v[48:51], a[68:71], v[28:31], v[48:51]
  v_mfma_f32_16x16x32_bf16 v[52:55], a[72:75], v[28:31], 0
  v_mfma_f32_16x16x32_bf16 v[52:55], a[76:79], v[28:31], v[52:55]
  v_mfma_f32_16x16x32_bf16 v[52:55], a[80:83], v[28:31], v[52:55]
  v_mfma_f32_16x16x32_bf16 v[52:55], a[84:87], v[28:31], v[52:55]
  v_mfma_f32_16x16x32_bf16 v[52:55], a[88:91], v[28:31], v[52:55]
  v_mfma_f32_16x16x32_bf16 v[52:55], a[92:95], v[28:31], v[52:55]
  v_mfma_f32_16x16x32_bf16 v[52:55], a[96:99], v[28:31], v[52:55]
  v_mfma_f32_16x16x32_bf16 v[52:55], a[100:103], v[28:31], v[52:55]
  v_mfma_f32_16x16x32_bf16 v[52:55], a[104:107], v[28:31], v[52:55]
  v_mfma_f32_16x16x32_bf16 v[52:55], a[108:111], v[28:31], v[52:55]
  v_mfma_f32_16x16x32_bf16 v[52:55], a[112:115], v[28:31], v[52:55]
  v_mfma_f32_16x16x32_bf16 v[52:55], a[116:119], v[28:31], v[52:55]
  v_mfma_f32_16x16x32_bf16 v[52:55], a[120:123], v[28:31], v[52:55]
  v_mfma_f32_16x16x32_bf16 v[52:55], a[124:127], v[28:31], v[52:55]
  v_mfma_f32_16x16x32_bf16 v[52:55], a[128:131], v[28:31], v[52:55]
  v_mfma_f32_16x16x32_bf16 v[52:55], a[132:135], v[28:31], v[52:55]
  v_mfma_f32_16x16x32_bf16 v[52:55], a[136:139], v[28:31], v[52:55]
  v_mfma_f32_16x16x32_bf16 v[52:55], a[140:143], v[28:31], v[52:55]
  s_load_dwordx2 s[8:9], s[0:1], 88
  s_mov_b32 s10, 0x510000
  s_mov_b32 s11, 0x00020000
  s_waitcnt lgkmcnt(0)
  s_and_b32 s9, s9, 0xffff
  s_mul_i32 s24, s44, 147456
  s_lshl_b32 s33, s17, 10
  s_add_u32 m0, s33, 0
  s_add_u32 s32, s24, s33
  s_nop 0
  buffer_load_dwordx4 v16, s[8:11], s32 offen lds
  s_add_u32 m0, s33, 4096
  s_add_u32 s32, s24, s33
  s_add_u32 s32, s32, 4096
  buffer_load_dwordx4 v16, s[8:11], s32 offen lds
  s_add_u32 m0, s33, 8192
  s_add_u32 s32, s24, s33
  s_add_u32 s32, s32, 8192
  buffer_load_dwordx4 v16, s[8:11], s32 offen lds
  s_add_u32 m0, s33, 12288
  s_add_u32 s32, s24, s33
  s_add_u32 s32, s32, 12288
  buffer_load_dwordx4 v16, s[8:11], s32 offen lds
  s_add_u32 m0, s33, 16384
  s_add_u32 s32, s24, s33
  s_add_u32 s32, s32, 16384
  buffer_load_dwordx4 v16, s[8:11], s32 offen lds
  s_add_u32 m0, s33, 20480
  s_add_u32 s32, s24, s33
  s_add_u32 s32, s32, 20480
  buffer_load_dwordx4 v16, s[8:11], s32 offen lds
  s_add_u32 m0, s33, 24576
  s_add_u32 s32, s24, s33
  s_add_u32 s32, s32, 24576
  buffer_load_dwordx4 v16, s[8:11], s32 offen lds
  s_add_u32 m0, s33, 28672
  s_add_u32 s32, s24, s33
  s_add_u32 s32, s32, 28672
  buffer_load_dwordx4 v16, s[8:11], s32 offen lds
  s_add_u32 m0, s33, 32768
  s_add_u32 s32, s24, s33
  s_add_u32 s32, s32, 32768
  buffer_load_dwordx4 v16, s[8:11], s32 offen lds
  s_add_u32 m0, s33, 36864
  s_add_u32 s32, s24, s33
  s_add_u32 s32, s32, 36864
  buffer_load_dwordx4 v16, s[8:11], s32 offen lds
  s_add_u32 m0, s33, 40960
  s_add_u32 s32, s24, s33
  s_add_u32 s32, s32, 40960
  buffer_load_dwordx4 v16, s[8:11], s32 offen lds
  s_add_u32 m0, s33, 45056
  s_add_u32 s32, s24, s33
  s_add_u32 s32, s32, 45056
  buffer_load_dwordx4 v16, s[8:11], s32 offen lds
  s_add_u32 m0, s33, 49152
  s_add_u32 s32, s24, s33
  s_add_u32 s32, s32, 49152
  buffer_load_dwordx4 v16, s[8:11], s32 offen lds
  s_add_u32 m0, s33, 53248
  s_add_u32 s32, s24, s33
  s_add_u32 s32, s32, 53248
  buffer_load_dwordx4 v16, s[8:11], s32 offen lds
  s_add_u32 m0, s33, 57344
  s_add_u32 s32, s24, s33
  s_add_u32 s32, s32, 57344
  buffer_load_dwordx4 v16, s[8:11], s32 offen lds
  s_add_u32 m0, s33, 61440
  s_add_u32 s32, s24, s33
  s_add_u32 s32, s32, 61440
  buffer_load_dwordx4 v16, s[8:11], s32 offen lds
  s_add_u32 m0, s33, 65536
  s_add_u32 s32, s24, s33
  s_add_u32 s32, s32, 65536
  buffer_load_dwordx4 v16, s[8:11], s32 offen lds
  s_add_u32 m0, s33, 69632
  s_add_u32 s32, s24, s33
  s_add_u32 s32, s32, 69632
  buffer_load_dwordx4 v16, s[8:11], s32 offen lds
  s_add_u32 m0, s33, 73728
  s_add_u32 s32, s24, s33
  s_add_u32 s32, s32, 73728
  buffer_load_dwordx4 v16, s[8:11], s32 offen lds
  s_add_u32 m0, s33, 77824
  s_add_u32 s32, s24, s33
  s_add_u32 s32, s32, 77824
  buffer_load_dwordx4 v16, s[8:11], s32 offen lds
  s_add_u32 m0, s33, 81920
  s_add_u32 s32, s24, s33
  s_add_u32 s32, s32, 81920
  buffer_load_dwordx4 v16, s[8:11], s32 offen lds
  s_add_u32 m0, s33, 86016
  s_add_u32 s32, s24, s33
  s_add_u32 s32, s32, 86016
  buffer_load_dwordx4 v16, s[8:11], s32 offen lds
  s_add_u32 m0, s33, 90112
  s_add_u32 s32, s24, s33
  s_add_u32 s32, s32, 90112
  buffer_load_dwordx4 v16, s[8:11], s32 offen lds
  s_add_u32 m0, s33, 94208
  s_add_u32 s32, s24, s33
  s_add_u32 s32, s32, 94208
  buffer_load_dwordx4 v16, s[8:11], s32 offen lds
  s_add_u32 m0, s33, 98304
  s_add_u32 s32, s24, s33
  s_add_u32 s32, s32, 98304
  buffer_load_dwordx4 v16, s[8:11], s32 offen lds
  s_add_u32 m0, s33, 102400
  s_add_u32 s32, s24, s33
  s_add_u32 s32, s32, 102400
  buffer_load_dwordx4 v16, s[8:11], s32 offen lds
  s_add_u32 m0, s33, 106496
  s_add_u32 s32, s24, s33
  s_add_u32 s32, s32, 106496
  buffer_load_dwordx4 v16, s[8:11], s32 offen lds
  s_add_u32 m0, s33, 110592
  s_add_u32 s32, s24, s33
  s_add_u32 s32, s32, 110592
  buffer_load_dwordx4 v16, s[8:11], s32 offen lds
  s_add_u32 m0, s33, 114688
  s_add_u32 s32, s24, s33
  s_add_u32 s32, s32, 114688
  buffer_load_dwordx4 v16, s[8:11], s32 offen lds
  s_add_u32 m0, s33, 118784
  s_add_u32 s32, s24, s33
  s_add_u32 s32, s32, 118784
  buffer_load_dwordx4 v16, s[8:11], s32 offen lds
  s_add_u32 m0, s33, 122880
  s_add_u32 s32, s24, s33
  s_add_u32 s32, s32, 122880
  buffer_load_dwordx4 v16, s[8:11], s32 offen lds
  s_add_u32 m0, s33, 126976
  s_add_u32 s32, s24, s33
  s_add_u32 s32, s32, 126976
  buffer_load_dwordx4 v16, s[8:11], s32 offen lds
  s_add_u32 m0, s33, 131072
  s_add_u32 s32, s24, s33
  s_add_u32 s32, s32, 131072
  buffer_load_dwordx4 v16, s[8:11], s32 offen lds
  s_add_u32 m0, s33, 135168
  s_add_u32 s32, s24, s33
  s_add_u32 s32, s32, 135168
  buffer_load_dwordx4 v16, s[8:11], s32 offen lds
  s_add_u32 m0, s33, 139264
  s_add_u32 s32, s24, s33
  s_add_u32 s32, s32, 139264
  buffer_load_dwordx4 v16, s[8:11], s32 offen lds
  s_add_u32 m0, s33, 143360
  s_add_u32 s32, s24, s33
  s_add_u32 s32, s32, 143360
  buffer_load_dwordx4 v16, s[8:11], s32 offen lds
  s_waitcnt vmcnt(0)
  s_barrier
  s_mul_i32 s25, s17, 288
  v_and_b32 v20, 63, v0
  v_lshrrev_b32 v21, 4, v20
  v_bfe_u32 v22, v20, 2, 2
  v_lshl_add_u32 v21, v21, 2, v22
  v_mul_u32_u24 v21, 1152, v21
  v_and_b32 v22, 3, v20
  v_lshl_add_u32 v21, v22, 3, v21
  v_add_u32 v21, s25, v21
  v_add_u32 v23, 0, v21
  ds_read_b64_tr_b16 a[144:145], v23 offset:0
  ds_read_b64_tr_b16 a[160:161], v23 offset:32
  ds_read_b64_tr_b16 a[176:177], v23 offset:64
  ds_read_b64_tr_b16 a[192:193], v23 offset:96
  ds_read_b64_tr_b16 a[208:209], v23 offset:128
  ds_read_b64_tr_b16 a[224:225], v23 offset:160
  ds_read_b64_tr_b16 a[240:241], v23 offset:192
  ds_read_b64_tr_b16 v[224:225], v23 offset:224
  ds_read_b64_tr_b16 v[240:241], v23 offset:256
  v_add_u32 v23, 18432, v21
  ds_read_b64_tr_b16 a[146:147], v23 offset:0
  ds_read_b64_tr_b16 a[162:163], v23 offset:32
  ds_read_b64_tr_b16 a[178:179], v23 offset:64
  s_waitcnt lgkmcnt(0)
  ds_read_b64_tr_b16 a[194:195], v23 offset:96
  ds_read_b64_tr_b16 a[210:211], v23 offset:128
  ds_read_b64_tr_b16 a[226:227], v23 offset:160
  ds_read_b64_tr_b16 a[242:243], v23 offset:192
  ds_read_b64_tr_b16 v[226:227], v23 offset:224
  ds_read_b64_tr_b16 v[242:243], v23 offset:256
  v_add_u32 v23, 36864, v21
  ds_read_b64_tr_b16 a[148:149], v23 offset:0
  ds_read_b64_tr_b16 a[164:165], v23 offset:32
  ds_read_b64_tr_b16 a[180:181], v23 offset:64
  ds_read_b64_tr_b16 a[196:197], v23 offset:96
  ds_read_b64_tr_b16 a[212:213], v23 offset:128
  ds_read_b64_tr_b16 a[228:229], v23 offset:160
  s_waitcnt lgkmcnt(0)
  ds_read_b64_tr_b16 a[244:245], v23 offset:192
  ds_read_b64_tr_b16 v[228:229], v23 offset:224
  ds_read_b64_tr_b16 v[244:245], v23 offset:256
  v_add_u32 v23, 55296, v21
  ds_read_b64_tr_b16 a[150:151], v23 offset:0
  ds_read_b64_tr_b16 a[166:167], v23 offset:32
  ds_read_b64_tr_b16 a[182:183], v23 offset:64
  ds_read_b64_tr_b16 a[198:199], v23 offset:96
  ds_read_b64_tr_b16 a[214:215], v23 offset:128
  ds_read_b64_tr_b16 a[230:231], v23 offset:160
  ds_read_b64_tr_b16 a[246:247], v23 offset:192
  ds_read_b64_tr_b16 v[230:231], v23 offset:224
  ds_read_b64_tr_b16 v[246:247], v23 offset:256
  s_waitcnt lgkmcnt(0)
  v_add_u32 v23, 73728, v21
  ds_read_b64_tr_b16 a[152:153], v23 offset:0
  ds_read_b64_tr_b16 a[168:169], v23 offset:32
  ds_read_b64_tr_b16 a[184:185], v23 offset:64
  ds_read_b64_tr_b16 a[200:201], v23 offset:96
  ds_read_b64_tr_b16 a[216:217], v23 offset:128
  ds_read_b64_tr_b16 a[232:233], v23 offset:160
  ds_read_b64_tr_b16 a[248:249], v23 offset:192
  ds_read_b64_tr_b16 v[232:233], v23 offset:224
  ds_read_b64_tr_b16 v[248:249], v23 offset:256
  v_add_u32 v23, 92160, v21
  ds_read_b64_tr_b16 a[154:155], v23 offset:0
  ds_read_b64_tr_b16 a[170:171], v23 offset:32
  ds_read_b64_tr_b16 a[186:187], v23 offset:64
  s_waitcnt lgkmcnt(0)
  ds_read_b64_tr_b16 a[202:203], v23 offset:96
  ds_read_b64_tr_b16 a[218:219], v23 offset:128
  ds_read_b64_tr_b16 a[234:235], v23 offset:160
  ds_read_b64_tr_b16 a[250:251], v23 offset:192
  ds_read_b64_tr_b16 v[234:235], v23 offset:224
  ds_read_b64_tr_b16 v[250:251], v23 offset:256
  v_add_u32 v23, 110592, v21
  ds_read_b64_tr_b16 a[156:157], v23 offset:0
  ds_read_b64_tr_b16 a[172:173], v23 offset:32
  ds_read_b64_tr_b16 a[188:189], v23 offset:64
  ds_read_b64_tr_b16 a[204:205], v23 offset:96
  ds_read_b64_tr_b16 a[220:221], v23 offset:128
  ds_read_b64_tr_b16 a[236:237], v23 offset:160
  s_waitcnt lgkmcnt(0)
  ds_read_b64_tr_b16 a[252:253], v23 offset:192
  ds_read_b64_tr_b16 v[236:237], v23 offset:224
  ds_read_b64_tr_b16 v[252:253], v23 offset:256
  v_add_u32 v23, 129024, v21
  ds_read_b64_tr_b16 a[158:159], v23 offset:0
  ds_read_b64_tr_b16 a[174:175], v23 offset:32
  ds_read_b64_tr_b16 a[190:191], v23 offset:64
  ds_read_b64_tr_b16 a[206:207], v23 offset:96
  ds_read_b64_tr_b16 a[222:223], v23 offset:128
  ds_read_b64_tr_b16 a[238:239], v23 offset:160
  ds_read_b64_tr_b16 a[254:255], v23 offset:192
  ds_read_b64_tr_b16 v[238:239], v23 offset:224
  ds_read_b64_tr_b16 v[254:255], v23 offset:256
  s_waitcnt lgkmcnt(0)
  s_waitcnt lgkmcnt(0)
  s_barrier
  v_and_b32 v20, 63, v0
  s_lshl_b32 s32, s17, 6
  s_add_u32 s32, s32, 0
  v_add_u32 v21, s32, v20
  v_mul_u32_u24 v22, 58255, v21
  v_lshrrev_b32 v22, 22, v22
  v_mul_u32_u24 v23, 72, v22
  v_sub_u32 v23, v21, v23
  v_bfe_u32 v24, v22, 1, 3
  v_xor_b32 v23, v23, v24
  v_lshlrev_b32 v23, 4, v23
  v_mul_u32_u24 v22, 1152, v22
  v_add_u32 v6, v22, v23
  s_lshl_b32 s32, s17, 6
  s_add_u32 s32, s32, 256
  v_add_u32 v21, s32, v20
  v_mul_u32_u24 v22, 58255, v21
  v_lshrrev_b32 v22, 22, v22
  v_mul_u32_u24 v23, 72, v22
  v_sub_u32 v23, v21, v23
  v_bfe_u32 v24, v22, 1, 3
  v_xor_b32 v23, v23, v24
  v_lshlrev_b32 v23, 4, v23
  v_mul_u32_u24 v22, 1152, v22
  v_add_u32 v7, v22, v23
  s_lshl_b32 s32, s17, 6
  s_add_u32 s32, s32, 512
  v_add_u32 v21, s32, v20
  v_mul_u32_u24 v22, 58255, v21
  v_lshrrev_b32 v22, 22, v22
  v_mul_u32_u24 v23, 72, v22
  v_sub_u32 v23, v21, v23
  v_bfe_u32 v24, v22, 1, 3
  v_xor_b32 v23, v23, v24
  v_lshlrev_b32 v23, 4, v23
  v_mul_u32_u24 v22, 1152, v22
  v_add_u32 v8, v22, v23
  s_lshl_b32 s32, s17, 6
  s_add_u32 s32, s32, 768
  v_add_u32 v21, s32, v20
  v_mul_u32_u24 v22, 58255, v21
  v_lshrrev_b32 v22, 22, v22
  v_mul_u32_u24 v23, 72, v22
  v_sub_u32 v23, v21, v23
  v_bfe_u32 v24, v22, 1, 3
  v_xor_b32 v23, v23, v24
  v_lshlrev_b32 v23, 4, v23
  v_mul_u32_u24 v22, 1152, v22
  v_add_u32 v9, v22, v23
  s_lshl_b32 s32, s17, 6
  s_add_u32 s32, s32, 1024
  v_add_u32 v21, s32, v20
  v_mul_u32_u24 v22, 58255, v21
  v_lshrrev_b32 v22, 22, v22
  v_mul_u32_u24 v23, 72, v22
  v_sub_u32 v23, v21, v23
  v_bfe_u32 v24, v22, 1, 3
  v_xor_b32 v23, v23, v24
  v_lshlrev_b32 v23, 4, v23
  v_mul_u32_u24 v22, 1152, v22
  v_add_u32 v10, v22, v23
  s_lshl_b32 s32, s17, 6
  s_add_u32 s32, s32, 1280
  v_add_u32 v21, s32, v20
  v_mul_u32_u24 v22, 58255, v21
  v_lshrrev_b32 v22, 22, v22
  v_mul_u32_u24 v23, 72, v22
  v_sub_u32 v23, v21, v23
  v_bfe_u32 v24, v22, 1, 3
  v_xor_b32 v23, v23, v24
  v_lshlrev_b32 v23, 4, v23
  v_mul_u32_u24 v22, 1152, v22
  v_add_u32 v11, v22, v23
  s_lshl_b32 s32, s17, 6
  s_add_u32 s32, s32, 1536
  v_add_u32 v21, s32, v20
  v_mul_u32_u24 v22, 58255, v21
  v_lshrrev_b32 v22, 22, v22
  v_mul_u32_u24 v23, 72, v22
  v_sub_u32 v23, v21, v23
  v_bfe_u32 v24, v22, 1, 3
  v_xor_b32 v23, v23, v24
  v_lshlrev_b32 v23, 4, v23
  v_mul_u32_u24 v22, 1152, v22
  v_add_u32 v12, v22, v23
  s_lshl_b32 s32, s17, 6
  s_add_u32 s32, s32, 1792
  v_add_u32 v21, s32, v20
  v_mul_u32_u24 v22, 58255, v21
  v_lshrrev_b32 v22, 22, v22
  v_mul_u32_u24 v23, 72, v22
  v_sub_u32 v23, v21, v23
  v_bfe_u32 v24, v22, 1, 3
  v_xor_b32 v23, v23, v24
  v_lshlrev_b32 v23, 4, v23
  v_mul_u32_u24 v22, 1152, v22
  v_add_u32 v13, v22, v23
  s_lshl_b32 s32, s17, 6
  s_add_u32 s32, s32, 2048
  v_add_u32 v21, s32, v20
  v_mul_u32_u24 v22, 58255, v21
  v_lshrrev_b32 v22, 22, v22
  v_mul_u32_u24 v23, 72, v22
  v_sub_u32 v23, v21, v23
  v_bfe_u32 v24, v22, 1, 3
  v_xor_b32 v23, v23, v24
  v_lshlrev_b32 v23, 4, v23
  v_mul_u32_u24 v22, 1152, v22
  v_add_u32 v14, v22, v23
  v_and_b32 v21, 15, v20
  v_lshrrev_b32 v22, 4, v20
  v_bfe_u32 v23, v21, 1, 3
  v_xor_b32 v23, v23, v22
  v_lshlrev_b32 v23, 4, v23
  v_mul_u32_u24 v21, 1152, v21
  v_add_u32 v2, v21, v23
  v_xor_b32 v3, 64, v2
  v_and_b32 v20, 63, v0
  v_min_u32 v21, 40, v20
  v_subrev_u32 v22, 9, v21
  v_lshlrev_b32 v22, 2, v22
  v_add_u32 v22, 0xe901000, v22
  s_mul_i32 s24, s45, 36
  s_add_u32 s24, s24, 0xe900a00
  v_lshl_add_u32 v1, v21, 2, s24
  v_cmp_gt_u32 s[60:61], 9, v21
  s_nop 1
  v_cndmask_b32 v1, v22, v1, s[60:61]
  v_and_b32 v21, 15, v20
  v_lshrrev_b32 v22, 4, v20
  v_and_b32 v204, 63, v0
  v_lshrrev_b32 v205, 3, v204
  v_and_b32 v206, 7, v204
  v_and_b32 v207, 3, v206
  v_lshlrev_b32 v207, 4, v207
  v_lshrrev_b32 v208, 2, v206
  v_lshl_add_u32 v207, v208, 3, v207
  v_add_u32 v207, v207, v205
  v_lshlrev_b32 v201, 2, v207
  s_mov_b32 s32, 59904
  v_mul_lo_u32 v4, v205, s32
  v_lshl_add_u32 v4, v206, 4, v4
  v_lshrrev_b32 v205, 2, v204
  v_and_b32 v206, 3, v204
  v_lshl_add_u32 v207, v206, 4, v205
  v_lshlrev_b32 v202, 2, v207
  v_mul_lo_u32 v200, v205, s32
  v_lshl_add_u32 v200, v206, 3, v200
  v_add_u32 v200, 256, v200
  s_mov_b32 s62, 0x00ff00ff
  s_mov_b32 s63, 0x00ff00ff
  v_lshlrev_b32 v5, 8, v22
  v_lshl_add_u32 v5, v21, 3, v5
  v_lshlrev_b32 v15, 3, v21
  v_add_u32 v15, 2048, v15
  v_mov_b32 v23, 0x40000000
  v_cmp_eq_u32 vcc, 0, v22
  s_nop 1
  v_cndmask_b32 v15, v23, v15, vcc
  s_mul_i32 s24, s17, 384
  s_mul_i32 s46, s44, 1664
  s_add_u32 s46, s46, s24
  s_add_u32 s46, s46, 0x8800000
  s_lshl_b32 s41, s16, 2
  s_add_u32 s41, s41, 0xe900c00
  v_mov_b32 v212, 128
  s_mov_b32 s24, 262144
L_wc_125:
  buffer_load_dword v213, v212, s[12:15], 0 offen sc1
  s_waitcnt vmcnt(0)
  v_cmp_gt_u32 vcc, 33, v213
  s_cbranch_vccz L_wc_ok_126
  s_sleep 8
  s_sub_u32 s24, s24, 1
  s_cmp_lg_u32 s24, 0
  s_cbranch_scc1 L_wc_125
  s_branch L_fail
L_wc_ok_126:
  s_mov_b32 s18, s45
  s_mov_b32 s47, 16384
  s_mov_b32 s52, 0
L_r67_top_127:
  s_cmp_eq_u32 s52, 1
  s_cbranch_scc1 L_r67_pre_128
  s_add_u32 s28, s18, 1
  s_max_u32 s29, s18, 15
  s_sub_u32 s29, s29, 15
  v_mov_b32 v17, s29
  v_mov_b32 v207, s28
  v_cndmask_b32 v17, v17, v207, s[60:61]
  s_and_b32 s29, s18, 15
  s_lshl_b32 s29, s29, 7
  v_mov_b32 v207, s29
  v_cndmask_b32 v207, v207, 0, s[60:61]
  v_add_u32 v206, v1, v207
  s_mov_b32 s40, 262144
  s_cmp_eq_u32 s17, 0
  s_cbranch_scc0 L_wf_first_133
  buffer_load_dword v20, v206, s[4:7], 0 offen sc1
L_wf_first_133:
  s_waitcnt vmcnt(0)
  s_cmp_eq_u32 s42, 0
  s_cbranch_scc1 L_pend_134
  s_barrier
  s_cmp_eq_u32 s17, 0
  s_cbranch_scc0 L_pend2_135
  v_mov_b32 v21, s42
  buffer_store_dword v21, off, s[4:7], s41 sc1
L_pend2_135:
  s_mov_b32 s42, 0
L_pend_134:
  s_cmp_eq_u32 s17, 0
  s_cbranch_scc0 L_wf_rel_132
  v_cmp_gt_u32 vcc, v17, v20
  s_cbranch_vccz L_wf_ok_131
L_wf_130:
  s_sleep 8
  buffer_load_dword v20, v206, s[4:7], 0 offen sc1
  s_waitcnt vmcnt(0)
  v_cmp_gt_u32 vcc, v17, v20
  s_cbranch_vccz L_wf_ok_131
  s_sub_u32 s40, s40, 1
  s_cmp_lg_u32 s40, 0
  s_cbranch_scc1 L_wf_130
  s_branch L_fail
L_wf_ok_131:
L_wf_rel_132:
  s_barrier
  s_mul_i32 s24, s18, 36864
  s_add_u32 s24, s24, 0xe500000
  s_lshl_b32 s33, s17, 10
  s_add_u32 s33, s33, s47
  s_add_u32 m0, s33, 0
  s_nop 0
  buffer_load_dwordx4 v6, s[4:7], s24 offen sc1 lds
  s_add_u32 m0, s33, 4096
  s_nop 0
  buffer_load_dwordx4 v7, s[4:7], s24 offen sc1 lds
  s_add_u32 m0, s33, 8192
  s_nop 0
  buffer_load_dwordx4 v8, s[4:7], s24 offen sc1 lds
  s_add_u32 m0, s33, 12288
  s_nop 0
  buffer_load_dwordx4 v9, s[4:7], s24 offen sc1 lds
  s_add_u32 m0, s33, 16384
  s_nop 0
  buffer_load_dwordx4 v10, s[4:7], s24 offen sc1 lds
  s_add_u32 m0, s33, 20480
  s_nop 0
  buffer_load_dwordx4 v11, s[4:7], s24 offen sc1 lds
  s_add_u32 m0, s33, 24576
  s_nop 0
  buffer_load_dwordx4 v12, s[4:7], s24 offen sc1 lds
  s_add_u32 m0, s33, 28672
  s_nop 0
  buffer_load_dwordx4 v13, s[4:7], s24 offen sc1 lds
  s_add_u32 m0, s33, 32768
  s_nop 0
  buffer_load_dwordx4 v14, s[4:7], s24 offen sc1 lds
  s_mul_i32 s24, s18, 2304
  s_add_u32 s24, s24, 0xe800000
  buffer_load_dwordx2 v[212:213], v5, s[4:7], s24 offen offset:0 sc1
  buffer_load_dwordx2 v[214:215], v5, s[4:7], s24 offen offset:1024 sc1
  buffer_load_dwordx2 v[216:217], v15, s[4:7], s24 offen offset:0 sc1
  buffer_load_dwordx2 v[218:219], v5, s[4:7], s24 offen offset:128 sc1
  buffer_load_dwordx2 v[220:221], v5, s[4:7], s24 offen offset:1152 sc1
  buffer_load_dwordx2 v[222:223], v15, s[4:7], s24 offen offset:128 sc1
  s_waitcnt vmcnt(0)
  s_branch L_r67_go_129
L_r67_pre_128:
  s_waitcnt vmcnt(10)
L_r67_go_129:
  s_barrier
  s_add_u32 s53, s18, 2
  v_add_u32 v204, s47, v2
  v_add_u32 v205, s47, v3
  ds_read_b128 v[60:63], v204 offset:0
  ds_read_b128 v[64:67], v204 offset:18432
  ds_read_b128 v[68:71], v205 offset:0
  ds_read_b128 v[72:75], v205 offset:18432
  s_waitcnt lgkmcnt(2)
  v_mfma_f32_16x16x32_bf16 v[76:79], a[0:3], v[60:63], 0
  v_add_f32 v20, v212, v214
  v_mfma_f32_16x16x32_bf16 v[80:83], a[0:3], v[64:67], 0
  v_add_f32 v20, v20, v216
  v_mfma_f32_16x16x32_bf16 v[84:87], a[72:75], v[60:63], 0
  v_add_f32 v21, v213, v215
  v_mfma_f32_16x16x32_bf16 v[88:91], a[72:75], v[64:67], 0
  v_add_f32 v21, v21, v217
  ds_read_b128 v[60:63], v204 offset:128
  ds_read_b128 v[64:67], v204 offset:18560
  s_waitcnt lgkmcnt(2)
  v_mfma_f32_16x16x32_bf16 v[76:79], a[4:7], v[68:71], v[76:79]
  v_add_f32 v26, v218, v220
  v_mfma_f32_16x16x32_bf16 v[80:83], a[4:7], v[72:75], v[80:83]
  v_add_f32 v26, v26, v222
  v_mfma_f32_16x16x32_bf16 v[84:87], a[76:79], v[68:71], v[84:87]
  v_add_f32 v27, v219, v221
  v_mfma_f32_16x16x32_bf16 v[88:91], a[76:79], v[72:75], v[88:91]
  v_add_f32 v27, v27, v223
  ds_read_b128 v[68:71], v205 offset:128
  ds_read_b128 v[72:75], v205 offset:18560
  s_waitcnt lgkmcnt(2)
  v_mfma_f32_16x16x32_bf16 v[76:79], a[8:11], v[60:63], v[76:79]
  v_mov_b32 v32, v20
  v_mfma_f32_16x16x32_bf16 v[80:83], a[8:11], v[64:67], v[80:83]
  v_mov_b32 v33, v21
  v_mfma_f32_16x16x32_bf16 v[84:87], a[80:83], v[60:63], v[84:87]
  v_mov_b32 v34, v26
  v_mfma_f32_16x16x32_bf16 v[88:91], a[80:83], v[64:67], v[88:91]
  v_mov_b32 v35, v27
  ds_read_b128 v[60:63], v204 offset:256
  ds_read_b128 v[64:67], v204 offset:18688
  s_waitcnt lgkmcnt(2)
  v_mfma_f32_16x16x32_bf16 v[76:79], a[12:15], v[68:71], v[76:79]
  s_nop 0
  v_mfma_f32_16x16x32_bf16 v[80:83], a[12:15], v[72:75], v[80:83]
  v_permlane16_swap_b32 v20, v32
  v_mfma_f32_16x16x32_bf16 v[84:87], a[84:87], v[68:71], v[84:87]
  v_permlane16_swap_b32 v21, v33
  v_mfma_f32_16x16x32_bf16 v[88:91], a[84:87], v[72:75], v[88:91]
  v_permlane16_swap_b32 v26, v34
  ds_read_b128 v[68:71], v205 offset:256
  ds_read_b128 v[72:75], v205 offset:18688
  s_waitcnt lgkmcnt(2)
  v_mfma_f32_16x16x32_bf16 v[76:79], a[16:19], v[60:63], v[76:79]
  v_permlane16_swap_b32 v27, v35
  v_mfma_f32_16x16x32_bf16 v[80:83], a[16:19], v[64:67], v[80:83]
  v_add_f32 v20, v20, v32
  v_mfma_f32_16x16x32_bf16 v[84:87], a[88:91], v[60:63], v[84:87]
  v_add_f32 v21, v21, v33
  v_mfma_f32_16x16x32_bf16 v[88:91], a[88:91], v[64:67], v[88:91]
  v_add_f32 v26, v26, v34
  ds_read_b128 v[60:63], v204 offset:384
  ds_read_b128 v[64:67], v204 offset:18816
  s_waitcnt lgkmcnt(2)
  v_mfma_f32_16x16x32_bf16 v[76:79], a[20:23], v[68:71], v[76:79]
  v_add_f32 v27, v27, v35
  v_mfma_f32_16x16x32_bf16 v[80:83], a[20:23], v[72:75], v[80:83]
  v_mov_b32 v32, v20
  v_mfma_f32_16x16x32_bf16 v[84:87], a[92:95], v[68:71], v[84:87]
  v_mov_b32 v33, v21
  v_mfma_f32_16x16x32_bf16 v[88:91], a[92:95], v[72:75], v[88:91]
  v_mov_b32 v34, v26
  ds_read_b128 v[68:71], v205 offset:384
  ds_read_b128 v[72:75], v205 offset:18816
  s_waitcnt lgkmcnt(2)
  v_mfma_f32_16x16x32_bf16 v[76:79], a[24:27], v[60:63], v[76:79]
  v_mov_b32 v35, v27
  v_mfma_f32_16x16x32_bf16 v[80:83], a[24:27], v[64:67], v[80:83]
  s_nop 0
  v_mfma_f32_16x16x32_bf16 v[84:87], a[96:99], v[60:63], v[84:87]
  v_permlane32_swap_b32 v20, v32
  v_mfma_f32_16x16x32_bf16 v[88:91], a[96:99], v[64:67], v[88:91]
  v_permlane32_swap_b32 v21, v33
  ds_read_b128 v[60:63], v204 offset:512
  ds_read_b128 v[64:67], v204 offset:18944
  s_waitcnt lgkmcnt(2)
  v_mfma_f32_16x16x32_bf16 v[76:79], a[28:31], v[68:71], v[76:79]
  v_permlane32_swap_b32 v26, v34
  v_mfma_f32_16x16x32_bf16 v[80:83], a[28:31], v[72:75], v[80:83]
  v_permlane32_swap_b32 v27, v35
  v_mfma_f32_16x16x32_bf16 v[84:87], a[100:103], v[68:71], v[84:87]
  v_add_f32 v20, v20, v32
  v_mfma_f32_16x16x32_bf16 v[88:91], a[100:103], v[72:75], v[88:91]
  v_add_f32 v21, v21, v33
  ds_read_b128 v[68:71], v205 offset:512
  ds_read_b128 v[72:75], v205 offset:18944
  s_waitcnt lgkmcnt(2)
  v_mfma_f32_16x16x32_bf16 v[76:79], a[32:35], v[60:63], v[76:79]
  v_add_f32 v26, v26, v34
  v_mfma_f32_16x16x32_bf16 v[80:83], a[32:35], v[64:67], v[80:83]
  v_add_f32 v27, v27, v35
  v_mfma_f32_16x16x32_bf16 v[84:87], a[104:107], v[60:63], v[84:87]
  v_mul_f32 v20, 0x3ae38e39, v20
  v_mfma_f32_16x16x32_bf16 v[88:91], a[104:107], v[64:67], v[88:91]
  v_mul_f32 v21, 0x3ae38e39, v21
  ds_read_b128 v[60:63], v204 offset:640
  ds_read_b128 v[64:67], v204 offset:19072
  s_waitcnt lgkmcnt(2)
  v_mfma_f32_16x16x32_bf16 v[76:79], a[36:39], v[68:71], v[76:79]
  v_fma_f32 v21, -v20, v20, v21
  v_mfma_f32_16x16x32_bf16 v[80:83], a[36:39], v[72:75], v[80:83]
  v_max_f32 v21, 0, v21
  v_mfma_f32_16x16x32_bf16 v[84:87], a[108:111], v[68:71], v[84:87]
  v_cvt_pk_bf16_f32 v20, v20, v20
  v_mfma_f32_16x16x32_bf16 v[88:91], a[108:111], v[72:75], v[88:91]
  v_lshlrev_b32 v20, 16, v20
  ds_read_b128 v[68:71], v205 offset:640
  ds_read_b128 v[72:75], v205 offset:19072
  s_waitcnt lgkmcnt(2)
  v_mfma_f32_16x16x32_bf16 v[76:79], a[40:43], v[60:63], v[76:79]
  v_cvt_pk_bf16_f32 v21, v21, v21
  v_mfma_f32_16x16x32_bf16 v[80:83], a[40:43], v[64:67], v[80:83]
  v_lshlrev_b32 v21, 16, v21
  v_mfma_f32_16x16x32_bf16 v[84:87], a[112:115], v[60:63], v[84:87]
  v_add_f32 v21, 0x3727c5ac, v21
  v_mfma_f32_16x16x32_bf16 v[88:91], a[112:115], v[64:67], v[88:91]
  v_cvt_pk_bf16_f32 v21, v21, v21
  ds_read_b128 v[60:63], v204 offset:768
  ds_read_b128 v[64:67], v204 offset:19200
  s_waitcnt lgkmcnt(2)
  v_mfma_f32_16x16x32_bf16 v[76:79], a[44:47], v[68:71], v[76:79]
  v_lshlrev_b32 v21, 16, v21
  v_mfma_f32_16x16x32_bf16 v[80:83], a[44:47], v[72:75], v[80:83]
  v_sqrt_f32 v21, v21
  v_mfma_f32_16x16x32_bf16 v[84:87], a[116:119], v[68:71], v[84:87]
  s_nop 0
  v_mfma_f32_16x16x32_bf16 v[88:91], a[116:119], v[72:75], v[88:91]
  v_cvt_pk_bf16_f32 v21, v21, v21
  ds_read_b128 v[68:71], v205 offset:768
  ds_read_b128 v[72:75], v205 offset:19200
  s_waitcnt lgkmcnt(2)
  v_mfma_f32_16x16x32_bf16 v[76:79], a[48:51], v[60:63], v[76:79]
  v_lshlrev_b32 v21, 16, v21
  v_mfma_f32_16x16x32_bf16 v[80:83], a[48:51], v[64:67], v[80:83]
  v_rcp_f32 v56, v21
  v_mfma_f32_16x16x32_bf16 v[84:87], a[120:123], v[60:63], v[84:87]
  v_mov_b32 v57, v20
  v_mfma_f32_16x16x32_bf16 v[88:91], a[120:123], v[64:67], v[88:91]
  v_mul_f32 v26, 0x3ae38e39, v26
  ds_read_b128 v[60:63], v204 offset:896
  ds_read_b128 v[64:67], v204 offset:19328
  s_waitcnt lgkmcnt(2)
  v_mfma_f32_16x16x32_bf16 v[76:79], a[52:55], v[68:71], v[76:79]
  v_mul_f32 v27, 0x3ae38e39, v27
  v_mfma_f32_16x16x32_bf16 v[80:83], a[52:55], v[72:75], v[80:83]
  v_fma_f32 v27, -v26, v26, v27
  v_mfma_f32_16x16x32_bf16 v[84:87], a[124:127], v[68:71], v[84:87]
  v_max_f32 v27, 0, v27
  v_mfma_f32_16x16x32_bf16 v[88:91], a[124:127], v[72:75], v[88:91]
  v_cvt_pk_bf16_f32 v26, v26, v26
  ds_read_b128 v[68:71], v205 offset:896
  ds_read_b128 v[72:75], v205 offset:19328
  s_waitcnt lgkmcnt(2)
  v_mfma_f32_16x16x32_bf16 v[76:79], a[56:59], v[60:63], v[76:79]
  v_lshlrev_b32 v26, 16, v26
  v_mfma_f32_16x16x32_bf16 v[80:83], a[56:59], v[64:67], v[80:83]
  v_cvt_pk_bf16_f32 v27, v27, v27
  v_mfma_f32_16x16x32_bf16 v[84:87], a[128:131], v[60:63], v[84:87]
  v_lshlrev_b32 v27, 16, v27
  v_mfma_f32_16x16x32_bf16 v[88:91], a[128:131], v[64:67], v[88:91]
  v_add_f32 v27, 0x3727c5ac, v27
  ds_read_b128 v[60:63], v204 offset:1024
  ds_read_b128 v[64:67], v204 offset:19456
  s_waitcnt lgkmcnt(2)
  v_mfma_f32_16x16x32_bf16 v[76:79], a[60:63], v[68:71], v[76:79]
  v_cvt_pk_bf16_f32 v27, v27, v27
  v_mfma_f32_16x16x32_bf16 v[80:83], a[60:63], v[72:75], v[80:83]
  v_lshlrev_b32 v27, 16, v27
  v_mfma_f32_16x16x32_bf16 v[84:87], a[132:135], v[68:71], v[84:87]
  v_sqrt_f32 v27, v27
  v_mfma_f32_16x16x32_bf16 v[88:91], a[132:135], v[72:75], v[88:91]
  s_nop 0
  ds_read_b128 v[68:71], v205 offset:1024
  ds_read_b128 v[72:75], v205 offset:19456
  s_waitcnt lgkmcnt(2)
  v_mfma_f32_16x16x32_bf16 v[76:79], a[64:67], v[60:63], v[76:79]
  v_cvt_pk_bf16_f32 v27, v27, v27
  v_mfma_f32_16x16x32_bf16 v[80:83], a[64:67], v[64:67], v[80:83]
  v_lshlrev_b32 v27, 16, v27
  v_mfma_f32_16x16x32_bf16 v[84:87], a[136:139], v[60:63], v[84:87]
  v_rcp_f32 v58, v27
  v_mfma_f32_16x16x32_bf16 v[88:91], a[136:139], v[64:67], v[88:91]
  v_mov_b32 v59, v26
  s_waitcnt lgkmcnt(0)
  v_mfma_f32_16x16x32_bf16 v[76:79], a[68:71], v[68:71], v[76:79]
  v_mfma_f32_16x16x32_bf16 v[80:83], a[68:71], v[72:75], v[80:83]
  v_mfma_f32_16x16x32_bf16 v[84:87], a[140:143], v[68:71], v[84:87]
  v_mfma_f32_16x16x32_bf16 v[88:91], a[140:143], v[72:75], v[88:91]
  s_nop 7
  v_fma_f32 v76, -v57, v48, v76
  v_fma_f32 v77, -v57, v49, v77
  v_fma_f32 v78, -v57, v50, v78
  v_fma_f32 v79, -v57, v51, v79
  v_fma_f32 v84, -v57, v52, v84
  v_fma_f32 v85, -v57, v53, v85
  v_fma_f32 v86, -v57, v54, v86
  v_fma_f32 v87, -v57, v55, v87
  v_mul_f32 v76, v76, v56
  v_mul_f32 v77, v77, v56
  v_mul_f32 v78, v78, v56
  v_mul_f32 v79, v79, v56
  v_mul_f32 v84, v84, v56
  v_mul_f32 v85, v85, v56
  v_mul_f32 v86, v86, v56
  v_mul_f32 v87, v87, v56
  v_cvt_pk_bf16_f32 v76, v76, v76
  v_lshlrev_b32 v76, 16, v76
  v_cvt_pk_bf16_f32 v77, v77, v77
  v_lshlrev_b32 v77, 16, v77
  v_cvt_pk_bf16_f32 v78, v78, v78
  v_lshlrev_b32 v78, 16, v78
  v_cvt_pk_bf16_f32 v79, v79, v79
  v_lshlrev_b32 v79, 16, v79
  v_cvt_pk_bf16_f32 v84, v84, v84
  v_lshlrev_b32 v84, 16, v84
  v_cvt_pk_bf16_f32 v85, v85, v85
  v_lshlrev_b32 v85, 16, v85
  v_cvt_pk_bf16_f32 v86, v86, v86
  v_lshlrev_b32 v86, 16, v86
  v_cvt_pk_bf16_f32 v87, v87, v87
  v_lshlrev_b32 v87, 16, v87
  s_mov_b32 s36, 0xbdd2d3e8
  s_mov_b32 s37, 0xc0135761
  v_mul_f32 v20, v76, v76
  v_mul_f32 v21, v77, v77
  v_mul_f32 v22, v78, v78
  v_mul_f32 v23, v79, v79
  v_mul_f32 v24, v84, v84
  v_mul_f32 v25, v85, v85
  v_mul_f32 v26, v86, v86
  v_mul_f32 v27, v87, v87
  v_mov_b32 v28, s37
  v_fma_f32 v20, v20, s36, v28
  v_fma_f32 v21, v21, s36, v28
  v_fma_f32 v22, v22, s36, v28
  v_fma_f32 v23, v23, s36, v28
  v_fma_f32 v24, v24, s36, v28
  v_fma_f32 v25, v25, s36, v28
  v_fma_f32 v26, v26, s36, v28
  v_fma_f32 v27, v27, s36, v28
  v_mul_f32 v20, v20, v76
  v_mul_f32 v21, v21, v77
  v_mul_f32 v22, v22, v78
  v_mul_f32 v23, v23, v79
  v_mul_f32 v24, v24, v84
  v_mul_f32 v25, v25, v85
  v_mul_f32 v26, v26, v86
  v_mul_f32 v27, v27, v87
  v_exp_f32 v20, v20
  v_exp_f32 v21, v21
  v_exp_f32 v22, v22
  v_exp_f32 v23, v23
  v_exp_f32 v24, v24
  v_exp_f32 v25, v25
  v_exp_f32 v26, v26
  v_exp_f32 v27, v27
  v_add_f32 v20, 1.0, v20
  v_add_f32 v21, 1.0, v21
  v_add_f32 v22, 1.0, v22
  v_add_f32 v23, 1.0, v23
  v_add_f32 v24, 1.0, v24
  v_add_f32 v25, 1.0, v25
  v_add_f32 v26, 1.0, v26
  v_add_f32 v27, 1.0, v27
  v_rcp_f32 v20, v20
  v_rcp_f32 v21, v21
  v_rcp_f32 v22, v22
  v_rcp_f32 v23, v23
  v_rcp_f32 v24, v24
  v_rcp_f32 v25, v25
  v_rcp_f32 v26, v26
  v_rcp_f32 v27, v27
  s_nop 0
  v_mul_f32 v76, v76, v20
  v_mul_f32 v77, v77, v21
  v_mul_f32 v78, v78, v22
  v_mul_f32 v79, v79, v23
  v_mul_f32 v84, v84, v24
  v_mul_f32 v85, v85, v25
  v_mul_f32 v86, v86, v26
  v_mul_f32 v87, v87, v27
  v_cvt_pk_bf16_f32 v92, v76, v77
  v_cvt_pk_bf16_f32 v93, v78, v79
  v_cvt_pk_bf16_f32 v94, v84, v85
  v_cvt_pk_bf16_f32 v95, v86, v87
  s_lshl_b32 s24, s17, 10
  v_add_u32 v30, s24, v16
  ds_write_b128 v30, v[92:95] offset:0
  s_nop 1
  v_fma_f32 v80, -v59, v48, v80
  v_fma_f32 v81, -v59, v49, v81
  v_fma_f32 v82, -v59, v50, v82
  v_fma_f32 v83, -v59, v51, v83
  v_fma_f32 v88, -v59, v52, v88
  v_fma_f32 v89, -v59, v53, v89
  v_fma_f32 v90, -v59, v54, v90
  v_fma_f32 v91, -v59, v55, v91
  v_mul_f32 v80, v80, v58
  v_mul_f32 v81, v81, v58
  v_mul_f32 v82, v82, v58
  v_mul_f32 v83, v83, v58
  v_mul_f32 v88, v88, v58
  v_mul_f32 v89, v89, v58
  v_mul_f32 v90, v90, v58
  v_mul_f32 v91, v91, v58
  v_cvt_pk_bf16_f32 v80, v80, v80
  v_lshlrev_b32 v80, 16, v80
  v_cvt_pk_bf16_f32 v81, v81, v81
  v_lshlrev_b32 v81, 16, v81
  v_cvt_pk_bf16_f32 v82, v82, v82
  v_lshlrev_b32 v82, 16, v82
  v_cvt_pk_bf16_f32 v83, v83, v83
  v_lshlrev_b32 v83, 16, v83
  v_cvt_pk_bf16_f32 v88, v88, v88
  v_lshlrev_b32 v88, 16, v88
  v_cvt_pk_bf16_f32 v89, v89, v89
  v_lshlrev_b32 v89, 16, v89
  v_cvt_pk_bf16_f32 v90, v90, v90
  v_lshlrev_b32 v90, 16, v90
  v_cvt_pk_bf16_f32 v91, v91, v91
  v_lshlrev_b32 v91, 16, v91
  s_mov_b32 s36, 0xbdd2d3e8
  s_mov_b32 s37, 0xc0135761
  v_mul_f32 v20, v80, v80
  v_mul_f32 v21, v81, v81
  v_mul_f32 v22, v82, v82
  v_mul_f32 v23, v83, v83
  v_mul_f32 v24, v88, v88
  v_mul_f32 v25, v89, v89
  v_mul_f32 v26, v90, v90
  v_mul_f32 v27, v91, v91
  v_mov_b32 v28, s37
  v_fma_f32 v20, v20, s36, v28
  v_fma_f32 v21, v21, s36, v28
  v_fma_f32 v22, v22, s36, v28
  v_fma_f32 v23, v23, s36, v28
  v_fma_f32 v24, v24, s36, v28
  v_fma_f32 v25, v25, s36, v28
  v_fma_f32 v26, v26, s36, v28
  v_fma_f32 v27, v27, s36, v28
  v_mul_f32 v20, v20, v80
  v_mul_f32 v21, v21, v81
  v_mul_f32 v22, v22, v82
  v_mul_f32 v23, v23, v83
  v_mul_f32 v24, v24, v88
  v_mul_f32 v25, v25, v89
  v_mul_f32 v26, v26, v90
  v_mul_f32 v27, v27, v91
  v_exp_f32 v20, v20
  v_exp_f32 v21, v21
  v_exp_f32 v22, v22
  v_exp_f32 v23, v23
  v_exp_f32 v24, v24
  v_exp_f32 v25, v25
  v_exp_f32 v26, v26
  v_exp_f32 v27, v27
  v_add_f32 v20, 1.0, v20
  v_add_f32 v21, 1.0, v21
  v_add_f32 v22, 1.0, v22
  v_add_f32 v23, 1.0, v23
  v_add_f32 v24, 1.0, v24
  v_add_f32 v25, 1.0, v25
  v_add_f32 v26, 1.0, v26
  v_add_f32 v27, 1.0, v27
  v_rcp_f32 v20, v20
  v_rcp_f32 v21, v21
  v_rcp_f32 v22, v22
  v_rcp_f32 v23, v23
  v_rcp_f32 v24, v24
  v_rcp_f32 v25, v25
  v_rcp_f32 v26, v26
  v_rcp_f32 v27, v27
  s_nop 0
  v_mul_f32 v80, v80, v20
  v_mul_f32 v81, v81, v21
  v_mul_f32 v82, v82, v22
  v_mul_f32 v83, v83, v23
  v_mul_f32 v88, v88, v24
  v_mul_f32 v89, v89, v25
  v_mul_f32 v90, v90, v26
  v_mul_f32 v91, v91, v27
  v_cvt_pk_bf16_f32 v92, v80, v81
  v_cvt_pk_bf16_f32 v93, v82, v83
  v_cvt_pk_bf16_f32 v94, v88, v89
  v_cvt_pk_bf16_f32 v95, v90, v91
  s_lshl_b32 s24, s17, 10
  v_add_u32 v30, s24, v16
  ds_write_b128 v30, v[92:95] offset:4096
  s_nop 1
  s_waitcnt vmcnt(0) lgkmcnt(0)
  s_barrier
  ds_read_b128 v[96:99], v16 offset:0
  ds_read_b128 v[112:115], v16 offset:4096
  ds_read_b128 v[100:103], v16 offset:1024
  ds_read_b128 v[116:119], v16 offset:5120
  ds_read_b128 v[104:107], v16 offset:2048
  ds_read_b128 v[120:123], v16 offset:6144
  ds_read_b128 v[108:111], v16 offset:3072
  ds_read_b128 v[124:127], v16 offset:7168
  s_add_u32 s28, s53, 1
  s_max_u32 s29, s53, 15
  s_sub_u32 s29, s29, 15
  v_mov_b32 v17, s29
  v_mov_b32 v207, s28
  v_cndmask_b32 v17, v17, v207, s[60:61]
  s_and_b32 s29, s53, 15
  s_lshl_b32 s29, s29, 7
  v_mov_b32 v207, s29
  v_cndmask_b32 v207, v207, 0, s[60:61]
  v_add_u32 v206, v1, v207
  s_cmp_eq_u32 s17, 0
  s_cbranch_scc0 L_r67_pb_136
  s_cmp_eq_u32 s42, 0
  s_cbranch_scc1 L_r67_pb2_137
  v_mov_b32 v20, s42
  buffer_store_dword v20, off, s[4:7], s41 sc1
L_r67_pb2_137:
  buffer_load_dword v207, v206, s[4:7], 0 offen sc1
L_r67_pb_136:
  s_mov_b32 s42, 0
  s_waitcnt lgkmcnt(6)
  v_mfma_f32_16x16x32_bf16 v[128:131], a[144:147], v[96:99], 0
  v_mfma_f32_16x16x32_bf16 v[132:135], a[144:147], v[112:115], 0
  v_mfma_f32_16x16x32_bf16 v[136:139], a[160:163], v[96:99], 0
  v_mfma_f32_16x16x32_bf16 v[140:143], a[160:163], v[112:115], 0
  v_mfma_f32_16x16x32_bf16 v[144:147], a[176:179], v[96:99], 0
  v_mfma_f32_16x16x32_bf16 v[148:151], a[176:179], v[112:115], 0
  v_mfma_f32_16x16x32_bf16 v[152:155], a[192:195], v[96:99], 0
  v_mfma_f32_16x16x32_bf16 v[156:159], a[192:195], v[112:115], 0
  v_mfma_f32_16x16x32_bf16 v[160:163], a[208:211], v[96:99], 0
  v_mfma_f32_16x16x32_bf16 v[164:167], a[208:211], v[112:115], 0
  v_mfma_f32_16x16x32_bf16 v[168:171], a[224:227], v[96:99], 0
  v_mfma_f32_16x16x32_bf16 v[172:175], a[224:227], v[112:115], 0
  v_mfma_f32_16x16x32_bf16 v[176:179], a[240:243], v[96:99], 0
  v_mfma_f32_16x16x32_bf16 v[180:183], a[240:243], v[112:115], 0
  v_mfma_f32_16x16x32_bf16 v[184:187], v[224:227], v[96:99], 0
  v_mfma_f32_16x16x32_bf16 v[188:191], v[224:227], v[112:115], 0
  v_mfma_f32_16x16x32_bf16 v[192:195], v[240:243], v[96:99], 0
  v_mfma_f32_16x16x32_bf16 v[196:199], v[240:243], v[112:115], 0
  s_waitcnt lgkmcnt(4)
  v_mfma_f32_16x16x32_bf16 v[128:131], a[148:151], v[100:103], v[128:131]
  v_mfma_f32_16x16x32_bf16 v[132:135], a[148:151], v[116:119], v[132:135]
  v_mfma_f32_16x16x32_bf16 v[136:139], a[164:167], v[100:103], v[136:139]
  v_mfma_f32_16x16x32_bf16 v[140:143], a[164:167], v[116:119], v[140:143]
  v_mfma_f32_16x16x32_bf16 v[144:147], a[180:183], v[100:103], v[144:147]
  v_mfma_f32_16x16x32_bf16 v[148:151], a[180:183], v[116:119], v[148:151]
  v_mfma_f32_16x16x32_bf16 v[152:155], a[196:199], v[100:103], v[152:155]
  v_mfma_f32_16x16x32_bf16 v[156:159], a[196:199], v[116:119], v[156:159]
  v_mfma_f32_16x16x32_bf16 v[160:163], a[212:215], v[100:103], v[160:163]
  v_mfma_f32_16x16x32_bf16 v[164:167], a[212:215], v[116:119], v[164:167]
  v_mfma_f32_16x16x32_bf16 v[168:171], a[228:231], v[100:103], v[168:171]
  v_mfma_f32_16x16x32_bf16 v[172:175], a[228:231], v[116:119], v[172:175]
  v_mfma_f32_16x16x32_bf16 v[176:179], a[244:247], v[100:103], v[176:179]
  v_mfma_f32_16x16x32_bf16 v[180:183], a[244:247], v[116:119], v[180:183]
  v_mfma_f32_16x16x32_bf16 v[184:187], v[228:231], v[100:103], v[184:187]
  v_mfma_f32_16x16x32_bf16 v[188:191], v[228:231], v[116:119], v[188:191]
  v_mfma_f32_16x16x32_bf16 v[192:195], v[244:247], v[100:103], v[192:195]
  v_mfma_f32_16x16x32_bf16 v[196:199], v[244:247], v[116:119], v[196:199]
  s_waitcnt lgkmcnt(2)
  v_mfma_f32_16x16x32_bf16 v[128:131], a[152:155], v[104:107], v[128:131]
  v_mfma_f32_16x16x32_bf16 v[132:135], a[152:155], v[120:123], v[132:135]
  v_mfma_f32_16x16x32_bf16 v[136:139], a[168:171], v[104:107], v[136:139]
  v_mfma_f32_16x16x32_bf16 v[140:143], a[168:171], v[120:123], v[140:143]
  v_mfma_f32_16x16x32_bf16 v[144:147], a[184:187], v[104:107], v[144:147]
  v_mfma_f32_16x16x32_bf16 v[148:151], a[184:187], v[120:123], v[148:151]
  v_mfma_f32_16x16x32_bf16 v[152:155], a[200:203], v[104:107], v[152:155]
  v_mfma_f32_16x16x32_bf16 v[156:159], a[200:203], v[120:123], v[156:159]
  v_mfma_f32_16x16x32_bf16 v[160:163], a[216:219], v[104:107], v[160:163]
  v_mfma_f32_16x16x32_bf16 v[164:167], a[216:219], v[120:123], v[164:167]
  v_mfma_f32_16x16x32_bf16 v[168:171], a[232:235], v[104:107], v[168:171]
  v_mfma_f32_16x16x32_bf16 v[172:175], a[232:235], v[120:123], v[172:175]
  v_mfma_f32_16x16x32_bf16 v[176:179], a[248:251], v[104:107], v[176:179]
  v_mfma_f32_16x16x32_bf16 v[180:183], a[248:251], v[120:123], v[180:183]
  v_mfma_f32_16x16x32_bf16 v[184:187], v[232:235], v[104:107], v[184:187]
  v_mfma_f32_16x16x32_bf16 v[188:191], v[232:235], v[120:123], v[188:191]
  v_mfma_f32_16x16x32_bf16 v[192:195], v[248:251], v[104:107], v[192:195]
  v_mfma_f32_16x16x32_bf16 v[196:199], v[248:251], v[120:123], v[196:199]
  s_waitcnt lgkmcnt(0)
  v_mfma_f32_16x16x32_bf16 v[128:131], a[156:159], v[108:111], v[128:131]
  v_mfma_f32_16x16x32_bf16 v[132:135], a[156:159], v[124:127], v[132:135]
  v_mfma_f32_16x16x32_bf16 v[136:139], a[172:175], v[108:111], v[136:139]
  v_mfma_f32_16x16x32_bf16 v[140:143], a[172:175], v[124:127], v[140:143]
  v_mfma_f32_16x16x32_bf16 v[144:147], a[188:191], v[108:111], v[144:147]
  v_mfma_f32_16x16x32_bf16 v[148:151], a[188:191], v[124:127], v[148:151]
  v_mfma_f32_16x16x32_bf16 v[152:155], a[204:207], v[108:111], v[152:155]
  v_mfma_f32_16x16x32_bf16 v[156:159], a[204:207], v[124:127], v[156:159]
  v_mfma_f32_16x16x32_bf16 v[160:163], a[220:223], v[108:111], v[160:163]
  v_mfma_f32_16x16x32_bf16 v[164:167], a[220:223], v[124:127], v[164:167]
  v_mfma_f32_16x16x32_bf16 v[168:171], a[236:239], v[108:111], v[168:171]
  v_mfma_f32_16x16x32_bf16 v[172:175], a[236:239], v[124:127], v[172:175]
  v_mfma_f32_16x16x32_bf16 v[176:179], a[252:255], v[108:111], v[176:179]
  v_mfma_f32_16x16x32_bf16 v[180:183], a[252:255], v[124:127], v[180:183]
  v_mfma_f32_16x16x32_bf16 v[184:187], v[236:239], v[108:111], v[184:187]
  v_mfma_f32_16x16x32_bf16 v[188:191], v[236:239], v[124:127], v[188:191]
  v_mfma_f32_16x16x32_bf16 v[192:195], v[252:255], v[108:111], v[192:195]
  v_mfma_f32_16x16x32_bf16 v[196:199], v[252:255], v[124:127], v[196:199]
  s_cmp_eq_u32 s17, 0
  s_cbranch_scc0 L_r67_vw_138
  s_waitcnt vmcnt(0)
  v_cmp_gt_u32 vcc, v17, v207
  s_cmp_lt_u32 s53, 64
  s_cselect_b32 s30, 1, 0
  s_cmp_eq_u64 vcc, 0
  s_cselect_b32 s30, s30, 0
  v_mov_b32 v207, s30
  v_mov_b32 v206, 8192
  ds_write_b32 v206, v207
  s_waitcnt lgkmcnt(0)
L_r67_vw_138:
  s_barrier
  v_mov_b32 v206, 8192
  ds_read_b32 v207, v206
  s_sub_u32 s47, 69632, s47
  s_waitcnt lgkmcnt(0)
  v_readfirstlane_b32 s52, v207
  s_nop 0
  s_cmp_eq_u32 s52, 1
  s_cbranch_scc0 L_r67_nf_139
  s_mul_i32 s24, s53, 36864
  s_add_u32 s24, s24, 0xe500000
  s_lshl_b32 s33, s17, 10
  s_add_u32 s33, s33, s47
  s_add_u32 m0, s33, 0
  s_nop 0
  buffer_load_dwordx4 v6, s[4:7], s24 offen sc1 lds
  s_add_u32 m0, s33, 4096
  s_nop 0
  buffer_load_dwordx4 v7, s[4:7], s24 offen sc1 lds
  s_add_u32 m0, s33, 8192
  s_nop 0
  buffer_load_dwordx4 v8, s[4:7], s24 offen sc1 lds
  s_add_u32 m0, s33, 12288
  s_nop 0
  buffer_load_dwordx4 v9, s[4:7], s24 offen sc1 lds
  s_add_u32 m0, s33, 16384
  s_nop 0
  buffer_load_dwordx4 v10, s[4:7], s24 offen sc1 lds
  s_add_u32 m0, s33, 20480
  s_nop 0
  buffer_load_dwordx4 v11, s[4:7], s24 offen sc1 lds
  s_add_u32 m0, s33, 24576
  s_nop 0
  buffer_load_dwordx4 v12, s[4:7], s24 offen sc1 lds
  s_add_u32 m0, s33, 28672
  s_nop 0
  buffer_load_dwordx4 v13, s[4:7], s24 offen sc1 lds
  s_add_u32 m0, s33, 32768
  s_nop 0
  buffer_load_dwordx4 v14, s[4:7], s24 offen sc1 lds
  s_mul_i32 s24, s53, 2304
  s_add_u32 s24, s24, 0xe800000
  buffer_load_dwordx2 v[212:213], v5, s[4:7], s24 offen offset:0 sc1
  buffer_load_dwordx2 v[214:215], v5, s[4:7], s24 offen offset:1024 sc1
  buffer_load_dwordx2 v[216:217], v15, s[4:7], s24 offen offset:0 sc1
  buffer_load_dwordx2 v[218:219], v5, s[4:7], s24 offen offset:128 sc1
  buffer_load_dwordx2 v[220:221], v5, s[4:7], s24 offen offset:1152 sc1
  buffer_load_dwordx2 v[222:223], v15, s[4:7], s24 offen offset:128 sc1
L_r67_nf_139:
  s_nop 7
  s_and_b32 s24, s18, 15
  s_mul_i32 s24, s24, 1916928
  s_add_u32 s24, s24, s46
  v_cvt_pk_bf16_f32 v20, v128, v129
  v_cvt_pk_bf16_f32 v21, v130, v131
  v_cvt_pk_bf16_f32 v22, v136, v137
  v_cvt_pk_bf16_f32 v23, v138, v139
  v_cvt_pk_bf16_f32 v24, v144, v145
  v_cvt_pk_bf16_f32 v25, v146, v147
  v_cvt_pk_bf16_f32 v26, v152, v153
  v_cvt_pk_bf16_f32 v27, v154, v155
  s_mov_b64 vcc, s[62:63]
  s_nop 0
  v_cndmask_b32_dpp v28, v24, v20, vcc row_shr:8 row_mask:0xf bank_mask:0xf bound_ctrl:1
  v_cndmask_b32_dpp v29, v25, v21, vcc row_shr:8 row_mask:0xf bank_mask:0xf bound_ctrl:1
  v_cndmask_b32_dpp v30, v26, v22, vcc row_shr:8 row_mask:0xf bank_mask:0xf bound_ctrl:1
  v_cndmask_b32_dpp v31, v27, v23, vcc row_shr:8 row_mask:0xf bank_mask:0xf bound_ctrl:1
  s_not_b64 vcc, vcc
  v_cndmask_b32_dpp v32, v20, v24, vcc row_shl:8 row_mask:0xf bank_mask:0xf bound_ctrl:1
  v_cndmask_b32_dpp v33, v21, v25, vcc row_shl:8 row_mask:0xf bank_mask:0xf bound_ctrl:1
  v_cndmask_b32_dpp v34, v22, v26, vcc row_shl:8 row_mask:0xf bank_mask:0xf bound_ctrl:1
  v_cndmask_b32_dpp v35, v23, v27, vcc row_shl:8 row_mask:0xf bank_mask:0xf bound_ctrl:1
  ds_bpermute_b32 v36, v201, v28
  ds_bpermute_b32 v37, v201, v29
  ds_bpermute_b32 v38, v201, v30
  ds_bpermute_b32 v39, v201, v31
  ds_bpermute_b32 v40, v201, v32
  ds_bpermute_b32 v41, v201, v33
  ds_bpermute_b32 v42, v201, v34
  ds_bpermute_b32 v43, v201, v35
  s_add_u32 s33, s24, 0
  s_add_u32 s34, s33, 479232
  s_waitcnt lgkmcnt(4)
  buffer_store_dwordx4 v[36:39], v4, s[4:7], s33 offen sc1
  s_waitcnt lgkmcnt(0)
  buffer_store_dwordx4 v[40:43], v4, s[4:7], s34 offen sc1
  v_cvt_pk_bf16_f32 v20, v160, v161
  v_cvt_pk_bf16_f32 v21, v162, v163
  v_cvt_pk_bf16_f32 v22, v168, v169
  v_cvt_pk_bf16_f32 v23, v170, v171
  v_cvt_pk_bf16_f32 v24, v176, v177
  v_cvt_pk_bf16_f32 v25, v178, v179
  v_cvt_pk_bf16_f32 v26, v184, v185
  v_cvt_pk_bf16_f32 v27, v186, v187
  s_mov_b64 vcc, s[62:63]
  s_nop 0
  v_cndmask_b32_dpp v28, v24, v20, vcc row_shr:8 row_mask:0xf bank_mask:0xf bound_ctrl:1
  v_cndmask_b32_dpp v29, v25, v21, vcc row_shr:8 row_mask:0xf bank_mask:0xf bound_ctrl:1
  v_cndmask_b32_dpp v30, v26, v22, vcc row_shr:8 row_mask:0xf bank_mask:0xf bound_ctrl:1
  v_cndmask_b32_dpp v31, v27, v23, vcc row_shr:8 row_mask:0xf bank_mask:0xf bound_ctrl:1
  s_not_b64 vcc, vcc
  v_cndmask_b32_dpp v32, v20, v24, vcc row_shl:8 row_mask:0xf bank_mask:0xf bound_ctrl:1
  v_cndmask_b32_dpp v33, v21, v25, vcc row_shl:8 row_mask:0xf bank_mask:0xf bound_ctrl:1
  v_cndmask_b32_dpp v34, v22, v26, vcc row_shl:8 row_mask:0xf bank_mask:0xf bound_ctrl:1
  v_cndmask_b32_dpp v35, v23, v27, vcc row_shl:8 row_mask:0xf bank_mask:0xf bound_ctrl:1
  ds_bpermute_b32 v36, v201, v28
  ds_bpermute_b32 v37, v201, v29
  ds_bpermute_b32 v38, v201, v30
  ds_bpermute_b32 v39, v201, v31
  ds_bpermute_b32 v40, v201, v32
  ds_bpermute_b32 v41, v201, v33
  ds_bpermute_b32 v42, v201, v34
  ds_bpermute_b32 v43, v201, v35
  s_add_u32 s33, s24, 128
  s_add_u32 s34, s33, 479232
  s_waitcnt lgkmcnt(4)
  buffer_store_dwordx4 v[36:39], v4, s[4:7], s33 offen sc1
  s_waitcnt lgkmcnt(0)
  buffer_store_dwordx4 v[40:43], v4, s[4:7], s34 offen sc1
  v_cvt_pk_bf16_f32 v20, v192, v193
  v_cvt_pk_bf16_f32 v21, v194, v195
  ds_bpermute_b32 v24, v202, v20
  ds_bpermute_b32 v25, v202, v21
  s_add_u32 s33, s24, 0
  s_waitcnt lgkmcnt(0)
  buffer_store_dwordx2 v[24:25], v200, s[4:7], s33 offen sc1
  v_cvt_pk_bf16_f32 v20, v132, v133
  v_cvt_pk_bf16_f32 v21, v134, v135
  v_cvt_pk_bf16_f32 v22, v140, v141
  v_cvt_pk_bf16_f32 v23, v142, v143
  v_cvt_pk_bf16_f32 v24, v148, v149
  v_cvt_pk_bf16_f32 v25, v150, v151
  v_cvt_pk_bf16_f32 v26, v156, v157
  v_cvt_pk_bf16_f32 v27, v158, v159
  s_mov_b64 vcc, s[62:63]
  s_nop 0
  v_cndmask_b32_dpp v28, v24, v20, vcc row_shr:8 row_mask:0xf bank_mask:0xf bound_ctrl:1
  v_cndmask_b32_dpp v29, v25, v21, vcc row_shr:8 row_mask:0xf bank_mask:0xf bound_ctrl:1
  v_cndmask_b32_dpp v30, v26, v22, vcc row_shr:8 row_mask:0xf bank_mask:0xf bound_ctrl:1
  v_cndmask_b32_dpp v31, v27, v23, vcc row_shr:8 row_mask:0xf bank_mask:0xf bound_ctrl:1
  s_not_b64 vcc, vcc
  v_cndmask_b32_dpp v32, v20, v24, vcc row_shl:8 row_mask:0xf bank_mask:0xf bound_ctrl:1
  v_cndmask_b32_dpp v33, v21, v25, vcc row_shl:8 row_mask:0xf bank_mask:0xf bound_ctrl:1
  v_cndmask_b32_dpp v34, v22, v26, vcc row_shl:8 row_mask:0xf bank_mask:0xf bound_ctrl:1
  v_cndmask_b32_dpp v35, v23, v27, vcc row_shl:8 row_mask:0xf bank_mask:0xf bound_ctrl:1
  ds_bpermute_b32 v36, v201, v28
  ds_bpermute_b32 v37, v201, v29
  ds_bpermute_b32 v38, v201, v30
  ds_bpermute_b32 v39, v201, v31
  ds_bpermute_b32 v40, v201, v32
  ds_bpermute_b32 v41, v201, v33
  ds_bpermute_b32 v42, v201, v34
  ds_bpermute_b32 v43, v201, v35
  s_add_u32 s33, s24, 958464
  s_add_u32 s34, s33, 479232
  s_waitcnt lgkmcnt(4)
  buffer_store_dwordx4 v[36:39], v4, s[4:7], s33 offen sc1
  s_waitcnt lgkmcnt(0)
  buffer_store_dwordx4 v[40:43], v4, s[4:7], s34 offen sc1
  v_cvt_pk_bf16_f32 v20, v164, v165
  v_cvt_pk_bf16_f32 v21, v166, v167
  v_cvt_pk_bf16_f32 v22, v172, v173
  v_cvt_pk_bf16_f32 v23, v174, v175
  v_cvt_pk_bf16_f32 v24, v180, v181
  v_cvt_pk_bf16_f32 v25, v182, v183
  v_cvt_pk_bf16_f32 v26, v188, v189
  v_cvt_pk_bf16_f32 v27, v190, v191
  s_mov_b64 vcc, s[62:63]
  s_nop 0
  v_cndmask_b32_dpp v28, v24, v20, vcc row_shr:8 row_mask:0xf bank_mask:0xf bound_ctrl:1
  v_cndmask_b32_dpp v29, v25, v21, vcc row_shr:8 row_mask:0xf bank_mask:0xf bound_ctrl:1
  v_cndmask_b32_dpp v30, v26, v22, vcc row_shr:8 row_mask:0xf bank_mask:0xf bound_ctrl:1
  v_cndmask_b32_dpp v31, v27, v23, vcc row_shr:8 row_mask:0xf bank_mask:0xf bound_ctrl:1
  s_not_b64 vcc, vcc
  v_cndmask_b32_dpp v32, v20, v24, vcc row_shl:8 row_mask:0xf bank_mask:0xf bound_ctrl:1
  v_cndmask_b32_dpp v33, v21, v25, vcc row_shl:8 row_mask:0xf bank_mask:0xf bound_ctrl:1
  v_cndmask_b32_dpp v34, v22, v26, vcc row_shl:8 row_mask:0xf bank_mask:0xf bound_ctrl:1
  v_cndmask_b32_dpp v35, v23, v27, vcc row_shl:8 row_mask:0xf bank_mask:0xf bound_ctrl:1
  ds_bpermute_b32 v36, v201, v28
  ds_bpermute_b32 v37, v201, v29
  ds_bpermute_b32 v38, v201, v30
  ds_bpermute_b32 v39, v201, v31
  ds_bpermute_b32 v40, v201, v32
  ds_bpermute_b32 v41, v201, v33
  ds_bpermute_b32 v42, v201, v34
  ds_bpermute_b32 v43, v201, v35
  s_add_u32 s33, s24, 958592
  s_add_u32 s34, s33, 479232
  s_waitcnt lgkmcnt(4)
  buffer_store_dwordx4 v[36:39], v4, s[4:7], s33 offen sc1
  s_waitcnt lgkmcnt(0)
  buffer_store_dwordx4 v[40:43], v4, s[4:7], s34 offen sc1
  v_cvt_pk_bf16_f32 v20, v196, v197
  v_cvt_pk_bf16_f32 v21, v198, v199
  ds_bpermute_b32 v24, v202, v20
  ds_bpermute_b32 v25, v202, v21
  s_add_u32 s33, s24, 958464
  s_waitcnt lgkmcnt(0)
  buffer_store_dwordx2 v[24:25], v200, s[4:7], s33 offen sc1
  s_add_u32 s42, s18, 1
  s_mov_b32 s18, s53
  s_cmp_lt_u32 s18, 64
  s_cbranch_scc1 L_r67_top_127
  s_waitcnt vmcnt(0)
  s_barrier
  s_cmp_eq_u32 s17, 0
  s_cbranch_scc0 L_sf_140
  v_mov_b32 v20, s42
  v_mov_b32 v21, 0
  s_mov_b64 exec, 1
  buffer_store_dword v20, v21, s[4:7], s41 offen sc1
  s_mov_b64 exec, -1
L_sf_140:
  s_endpgm
L_role_r8:
  s_sub_u32 s16, s23, 198
  s_load_dwordx2 s[48:49], s[0:1], 96
  s_mov_b32 s50, 0x240000
  s_mov_b32 s51, 0x00020000
  s_waitcnt lgkmcnt(0)
  s_and_b32 s49, s49, 0xffff
  v_and_b32 v20, 15, v0
  v_mov_b32 v21, 0x3f80
  v_mov_b32 v22, 0x3f800000
  v_and_b32 v12, 1, v20
  v_cmp_eq_u32 vcc, 0, v12
  s_nop 1
  v_cndmask_b32 v21, v22, v21, vcc
  v_lshrrev_b32 v20, 1, v20
  v_cmp_eq_u32 vcc, 0, v20
  s_nop 1
  v_cndmask_b32 v12, 0, v21, vcc
  v_cmp_eq_u32 vcc, 1, v20
  s_nop 1
  v_cndmask_b32 v13, 0, v21, vcc
  v_cmp_eq_u32 vcc, 2, v20
  s_nop 1
  v_cndmask_b32 v14, 0, v21, vcc
  v_cmp_eq_u32 vcc, 3, v20
  s_nop 1
  v_cndmask_b32 v15, 0, v21, vcc
  s_nop 1
  v_mov_b32_dpp v16, v12 row_shr:8 row_mask:0xf bank_mask:0xf bound_ctrl:1
  v_mov_b32_dpp v17, v13 row_shr:8 row_mask:0xf bank_mask:0xf bound_ctrl:1
  v_mov_b32_dpp v18, v14 row_shr:8 row_mask:0xf bank_mask:0xf bound_ctrl:1
  v_mov_b32_dpp v19, v15 row_shr:8 row_mask:0xf bank_mask:0xf bound_ctrl:1
  v_and_b32 v20, 63, v0
  v_lshrrev_b32 v21, 4, v20
  v_and_b32 v22, 15, v20
  v_mul_u32_u24 v1, 1664, v21
  v_lshl_add_u32 v1, v22, 4, v1
  v_lshrrev_b32 v23, 3, v22
  v_lshl_add_u32 v2, v23, 2, v21
  v_mul_u32_u24 v2, 1664, v2
  v_bfe_u32 v24, v22, 1, 2
  v_mul_u32_u24 v24, 384, v24
  v_add_u32 v2, v2, v24
  v_and_b32 v24, 1, v22
  v_lshl_add_u32 v2, v24, 4, v2
  v_add_u32 v2, 256, v2
  v_and_b32 v24, 1, v21
  v_lshrrev_b32 v23, 1, v21
  v_add_u32 v23, 0, v23
  v_mul_u32_u24 v23, 9, v23
  v_lshrrev_b32 v25, 2, v22
  v_lshl_add_u32 v23, v25, 1, v23
  v_add_u32 v23, v23, v24
  v_and_b32 v25, 3, v22
  v_lshrrev_b32 v4, 1, v23
  v_lshlrev_b32 v4, 6, v4
  v_lshl_add_u32 v4, v25, 4, v4
  v_and_b32 v26, 1, v23
  v_lshl_add_u32 v4, v26, 3, v4
  v_lshlrev_b32 v7, 5, v23
  v_lshl_add_u32 v7, v25, 3, v7
  v_and_b32 v24, 1, v21
  v_lshrrev_b32 v23, 1, v21
  v_add_u32 v23, 2, v23
  v_mul_u32_u24 v23, 9, v23
  v_lshrrev_b32 v25, 2, v22
  v_lshl_add_u32 v23, v25, 1, v23
  v_add_u32 v23, v23, v24
  v_and_b32 v25, 3, v22
  v_lshrrev_b32 v5, 1, v23
  v_lshlrev_b32 v5, 6, v5
  v_lshl_add_u32 v5, v25, 4, v5
  v_and_b32 v26, 1, v23
  v_lshl_add_u32 v5, v26, 3, v5
  v_lshlrev_b32 v8, 5, v23
  v_lshl_add_u32 v8, v25, 3, v8
  v_and_b32 v24, 1, v21
  v_bfe_u32 v23, v22, 1, 2
  v_mul_u32_u24 v23, 9, v23
  v_add_u32 v23, 8, v23
  v_and_b32 v25, 1, v22
  v_lshl_add_u32 v25, v25, 1, v24
  v_lshrrev_b32 v6, 1, v23
  v_lshlrev_b32 v6, 6, v6
  v_lshl_add_u32 v6, v25, 4, v6
  v_and_b32 v26, 1, v23
  v_lshl_add_u32 v6, v26, 3, v6
  v_lshlrev_b32 v9, 5, v23
  v_lshl_add_u32 v9, v25, 3, v9
  v_cmp_gt_u32 vcc, 8, v22
  v_cmp_gt_u32 s[34:35], 2, v21
  s_nop 1
  s_and_b64 vcc, vcc, s[34:35]
  v_mov_b32 v26, 0x40000000
  s_nop 0
  v_cndmask_b32 v6, v26, v6, vcc
  v_cndmask_b32 v9, v26, v9, vcc
  v_and_b32 v20, 8, v0
  v_mov_b32 v21, 0x40000000
  v_cmp_eq_u32 vcc, 0, v20
  s_nop 1
  v_cndmask_b32 v10, v21, v2, vcc
  v_and_b32 v20, 63, v0
  v_min_u32 v3, 35, v20
  v_lshlrev_b32 v3, 2, v3
  v_mov_b32 v232, 128
  s_mov_b32 s24, 262144
L_wc_141:
  buffer_load_dword v233, v232, s[12:15], 0 offen sc1
  s_waitcnt vmcnt(0)
  v_cmp_gt_u32 vcc, 33, v233
  s_cbranch_vccz L_wc_ok_142
  s_sleep 8
  s_sub_u32 s24, s24, 1
  s_cmp_lg_u32 s24, 0
  s_cbranch_scc1 L_wc_141
  s_branch L_fail
L_wc_ok_142:
  s_lshl_b32 s47, s16, 2
  s_add_u32 s47, s47, s17
L_r8_top_143:
  s_lshr_b32 s18, s47, 5
  s_and_b32 s52, s47, 31
  s_mul_i32 s45, s47, 1152
  s_and_b32 s46, s18, 1
  s_mul_i32 s46, s46, 144
  s_add_u32 s46, s46, 0xe900c00
  s_add_u32 s28, s18, 1
  s_mov_b32 s40, 262144
  buffer_load_dword v20, v3, s[4:7], s46 offen sc1
L_wf_first_147:
  s_waitcnt vmcnt(0)
  v_cmp_gt_u32 vcc, s28, v20
  s_cbranch_vccz L_wf_ok_145
L_wf_144:
  s_sleep 8
  buffer_load_dword v20, v3, s[4:7], s46 offen sc1
  s_waitcnt vmcnt(0)
  v_cmp_gt_u32 vcc, s28, v20
  s_cbranch_vccz L_wf_ok_145
  s_sub_u32 s40, s40, 1
  s_cmp_lg_u32 s40, 0
  s_cbranch_scc1 L_wf_144
  s_branch L_fail
L_wf_ok_145:
  s_add_u32 s24, s45, 0xdf00000
  s_add_u32 s25, s45, 0xe500000
  buffer_load_dwordx2 v[54:55], v4, s[4:7], s24 offen sc1
  buffer_load_dwordx2 v[48:49], v4, s[4:7], s25 offen sc1
  buffer_load_dwordx2 v[56:57], v5, s[4:7], s24 offen sc1
  buffer_load_dwordx2 v[50:51], v5, s[4:7], s25 offen sc1
  buffer_load_dwordx2 v[58:59], v6, s[4:7], s24 offen sc1
  buffer_load_dwordx2 v[52:53], v6, s[4:7], s25 offen sc1
  s_and_b32 s44, s18, 15
  s_mul_i32 s44, s44, 1916928
  s_mul_i32 s24, s52, 59904
  s_add_u32 s44, s44, s24
  s_add_u32 s44, s44, 0x8800000
  s_and_b32 s41, s18, 15
  s_lshl_b32 s41, s41, 5
  s_add_u32 s41, s41, s52
  s_lshl_b32 s41, s41, 2
  s_add_u32 s41, s41, 0xe901000
  s_add_u32 s32, s44, 0
  buffer_load_dwordx4 a[0:3], v1, s[4:7], s32 offen sc1
  s_add_u32 s32, s44, 6656
  buffer_load_dwordx4 a[4:7], v1, s[4:7], s32 offen sc1
  s_add_u32 s32, s44, 13312
  buffer_load_dwordx4 a[8:11], v1, s[4:7], s32 offen sc1
  s_add_u32 s32, s44, 19968
  buffer_load_dwordx4 a[12:15], v1, s[4:7], s32 offen sc1
  s_add_u32 s32, s44, 26624
  buffer_load_dwordx4 a[16:19], v1, s[4:7], s32 offen sc1
  s_add_u32 s32, s44, 33280
  buffer_load_dwordx4 a[20:23], v1, s[4:7], s32 offen sc1
  s_add_u32 s32, s44, 39936
  buffer_load_dwordx4 a[24:27], v1, s[4:7], s32 offen sc1
  s_add_u32 s32, s44, 46592
  buffer_load_dwordx4 a[28:31], v1, s[4:7], s32 offen sc1
  s_add_u32 s32, s44, 53248
  buffer_load_dwordx4 a[32:35], v1, s[4:7], s32 offen sc1
  s_add_u32 s32, s44, 384
  buffer_load_dwordx4 a[36:39], v1, s[4:7], s32 offen sc1
  s_add_u32 s32, s44, 7040
  buffer_load_dwordx4 a[40:43], v1, s[4:7], s32 offen sc1
  s_add_u32 s32, s44, 13696
  buffer_load_dwordx4 a[44:47], v1, s[4:7], s32 offen sc1
  s_add_u32 s32, s44, 20352
  buffer_load_dwordx4 a[48:51], v1, s[4:7], s32 offen sc1
  s_add_u32 s32, s44, 27008
  buffer_load_dwordx4 a[52:55], v1, s[4:7], s32 offen sc1
  s_add_u32 s32, s44, 33664
  buffer_load_dwordx4 a[56:59], v1, s[4:7], s32 offen sc1
  s_add_u32 s32, s44, 40320
  buffer_load_dwordx4 a[60:63], v1, s[4:7], s32 offen sc1
  s_add_u32 s32, s44, 46976
  buffer_load_dwordx4 a[64:67], v1, s[4:7], s32 offen sc1
  s_add_u32 s32, s44, 53632
  buffer_load_dwordx4 a[68:71], v1, s[4:7], s32 offen sc1
  s_add_u32 s32, s44, 768
  buffer_load_dwordx4 a[72:75], v1, s[4:7], s32 offen sc1
  s_add_u32 s32, s44, 7424
  buffer_load_dwordx4 a[76:79], v1, s[4:7], s32 offen sc1
  s_add_u32 s32, s44, 14080
  buffer_load_dwordx4 a[80:83], v1, s[4:7], s32 offen sc1
  s_add_u32 s32, s44, 20736
  buffer_load_dwordx4 a[84:87], v1, s[4:7], s32 offen sc1
  s_add_u32 s32, s44, 27392
  buffer_load_dwordx4 a[88:91], v1, s[4:7], s32 offen sc1
  s_add_u32 s32, s44, 34048
  buffer_load_dwordx4 a[92:95], v1, s[4:7], s32 offen sc1
  s_add_u32 s32, s44, 40704
  buffer_load_dwordx4 a[96:99], v1, s[4:7], s32 offen sc1
  s_add_u32 s32, s44, 47360
  buffer_load_dwordx4 a[100:103], v1, s[4:7], s32 offen sc1
  s_add_u32 s32, s44, 54016
  buffer_load_dwordx4 a[104:107], v1, s[4:7], s32 offen sc1
  s_add_u32 s32, s44, 1152
  buffer_load_dwordx4 a[108:111], v1, s[4:7], s32 offen sc1
  s_add_u32 s32, s44, 7808
  buffer_load_dwordx4 a[112:115], v1, s[4:7], s32 offen sc1
  s_add_u32 s32, s44, 14464
  buffer_load_dwordx4 a[116:119], v1, s[4:7], s32 offen sc1
  s_add_u32 s32, s44, 21120
  buffer_load_dwordx4 a[120:123], v1, s[4:7], s32 offen sc1
  s_add_u32 s32, s44, 27776
  buffer_load_dwordx4 a[124:127], v1, s[4:7], s32 offen sc1
  s_add_u32 s32, s44, 34432
  buffer_load_dwordx4 a[128:131], v1, s[4:7], s32 offen sc1
  s_add_u32 s32, s44, 41088
  buffer_load_dwordx4 a[132:135], v1, s[4:7], s32 offen sc1
  s_add_u32 s32, s44, 47744
  buffer_load_dwordx4 a[136:139], v1, s[4:7], s32 offen sc1
  s_add_u32 s32, s44, 54400
  buffer_load_dwordx4 a[140:143], v1, s[4:7], s32 offen sc1
  s_add_u32 s32, s44, 0
  buffer_load_dwordx4 a[144:147], v2, s[4:7], s32 offen sc1
  s_add_u32 s32, s44, 13312
  buffer_load_dwordx4 a[148:151], v2, s[4:7], s32 offen sc1
  s_add_u32 s32, s44, 26624
  buffer_load_dwordx4 a[152:155], v2, s[4:7], s32 offen sc1
  s_add_u32 s32, s44, 39936
  buffer_load_dwordx4 a[156:159], v2, s[4:7], s32 offen sc1
  s_add_u32 s32, s44, 53248
  buffer_load_dwordx4 a[160:163], v10, s[4:7], s32 offen sc1
  s_waitcnt vmcnt(40)
  v_mfma_f32_16x16x32_bf16 v[36:39], v[12:15], a[0:3], 0
  s_waitcnt vmcnt(39)
  v_mfma_f32_16x16x32_bf16 v[36:39], v[12:15], a[4:7], v[36:39]
  s_waitcnt vmcnt(38)
  v_mfma_f32_16x16x32_bf16 v[36:39], v[12:15], a[8:11], v[36:39]
  s_waitcnt vmcnt(37)
  v_mfma_f32_16x16x32_bf16 v[36:39], v[12:15], a[12:15], v[36:39]
  s_waitcnt vmcnt(36)
  v_mfma_f32_16x16x32_bf16 v[36:39], v[12:15], a[16:19], v[36:39]
  s_waitcnt vmcnt(35)
  v_mfma_f32_16x16x32_bf16 v[36:39], v[12:15], a[20:23], v[36:39]
  s_waitcnt vmcnt(34)
  v_mfma_f32_16x16x32_bf16 v[36:39], v[12:15], a[24:27], v[36:39]
  s_waitcnt vmcnt(33)
  v_mfma_f32_16x16x32_bf16 v[36:39], v[12:15], a[28:31], v[36:39]
  s_waitcnt vmcnt(32)
  v_mfma_f32_16x16x32_bf16 v[36:39], v[12:15], a[32:35], v[36:39]
  s_waitcnt vmcnt(31)
  v_mfma_f32_16x16x32_bf16 v[36:39], v[16:19], a[36:39], v[36:39]
  s_waitcnt vmcnt(30)
  v_mfma_f32_16x16x32_bf16 v[36:39], v[16:19], a[40:43], v[36:39]
  s_waitcnt vmcnt(29)
  v_mfma_f32_16x16x32_bf16 v[36:39], v[16:19], a[44:47], v[36:39]
  s_waitcnt vmcnt(28)
  v_mfma_f32_16x16x32_bf16 v[36:39], v[16:19], a[48:51], v[36:39]
  s_waitcnt vmcnt(27)
  v_mfma_f32_16x16x32_bf16 v[36:39], v[16:19], a[52:55], v[36:39]
  s_waitcnt vmcnt(26)
  v_mfma_f32_16x16x32_bf16 v[36:39], v[16:19], a[56:59], v[36:39]
  s_waitcnt vmcnt(25)
  v_mfma_f32_16x16x32_bf16 v[36:39], v[16:19], a[60:63], v[36:39]
  s_waitcnt vmcnt(24)
  v_mfma_f32_16x16x32_bf16 v[36:39], v[16:19], a[64:67], v[36:39]
  s_waitcnt vmcnt(23)
  v_mfma_f32_16x16x32_bf16 v[36:39], v[16:19], a[68:71], v[36:39]
  s_waitcnt vmcnt(22)
  v_mfma_f32_16x16x32_bf16 v[40:43], v[12:15], a[72:75], 0
  s_waitcnt vmcnt(21)
  v_mfma_f32_16x16x32_bf16 v[40:43], v[12:15], a[76:79], v[40:43]
  s_waitcnt vmcnt(20)
  v_mfma_f32_16x16x32_bf16 v[40:43], v[12:15], a[80:83], v[40:43]
  s_waitcnt vmcnt(19)
  v_mfma_f32_16x16x32_bf16 v[40:43], v[12:15], a[84:87], v[40:43]
  s_waitcnt vmcnt(18)
  v_mfma_f32_16x16x32_bf16 v[40:43], v[12:15], a[88:91], v[40:43]
  s_waitcnt vmcnt(17)
  v_mfma_f32_16x16x32_bf16 v[40:43], v[12:15], a[92:95], v[40:43]
  s_waitcnt vmcnt(16)
  v_mfma_f32_16x16x32_bf16 v[40:43], v[12:15], a[96:99], v[40:43]
  s_waitcnt vmcnt(15)
  v_mfma_f32_16x16x32_bf16 v[40:43], v[12:15], a[100:103], v[40:43]
  s_waitcnt vmcnt(14)
  v_mfma_f32_16x16x32_bf16 v[40:43], v[12:15], a[104:107], v[40:43]
  s_waitcnt vmcnt(13)
  v_mfma_f32_16x16x32_bf16 v[40:43], v[16:19], a[108:111], v[40:43]
  s_waitcnt vmcnt(12)
  v_mfma_f32_16x16x32_bf16 v[40:43], v[16:19], a[112:115], v[40:43]
  s_waitcnt vmcnt(11)
  v_mfma_f32_16x16x32_bf16 v[40:43], v[16:19], a[116:119], v[40:43]
  s_waitcnt vmcnt(10)
  v_mfma_f32_16x16x32_bf16 v[40:43], v[16:19], a[120:123], v[40:43]
  s_waitcnt vmcnt(9)
  v_mfma_f32_16x16x32_bf16 v[40:43], v[16:19], a[124:127], v[40:43]
  s_waitcnt vmcnt(8)
  v_mfma_f32_16x16x32_bf16 v[40:43], v[16:19], a[128:131], v[40:43]
  s_waitcnt vmcnt(7)
  v_mfma_f32_16x16x32_bf16 v[40:43], v[16:19], a[132:135], v[40:43]
  s_waitcnt vmcnt(6)
  v_mfma_f32_16x16x32_bf16 v[40:43], v[16:19], a[136:139], v[40:43]
  s_waitcnt vmcnt(5)
  v_mfma_f32_16x16x32_bf16 v[40:43], v[16:19], a[140:143], v[40:43]
  s_waitcnt vmcnt(4)
  v_mfma_f32_16x16x32_bf16 v[44:47], v[12:15], a[144:147], 0
  s_waitcnt vmcnt(3)
  v_mfma_f32_16x16x32_bf16 v[44:47], v[12:15], a[148:151], v[44:47]
  s_waitcnt vmcnt(2)
  v_mfma_f32_16x16x32_bf16 v[44:47], v[12:15], a[152:155], v[44:47]
  s_waitcnt vmcnt(1)
  v_mfma_f32_16x16x32_bf16 v[44:47], v[12:15], a[156:159], v[44:47]
  s_waitcnt vmcnt(0)
  v_mfma_f32_16x16x32_bf16 v[44:47], v[12:15], a[160:163], v[44:47]
  s_nop 7
  v_add_f32_dpp v44, v44, v44 row_shl:8 row_mask:0xf bank_mask:0xf bound_ctrl:1
  v_add_f32_dpp v45, v45, v45 row_shl:8 row_mask:0xf bank_mask:0xf bound_ctrl:1
  v_add_f32_dpp v46, v46, v46 row_shl:8 row_mask:0xf bank_mask:0xf bound_ctrl:1
  v_add_f32_dpp v47, v47, v47 row_shl:8 row_mask:0xf bank_mask:0xf bound_ctrl:1
  s_add_u32 s28, s18, 1
  v_mov_b32 v34, s28
  buffer_store_dword v34, off, s[4:7], s41 sc1
  v_cvt_pk_bf16_f32 v36, v36, v36
  v_lshlrev_b32 v36, 16, v36
  v_cvt_pk_bf16_f32 v37, v37, v37
  v_lshlrev_b32 v37, 16, v37
  v_cvt_pk_bf16_f32 v38, v38, v38
  v_lshlrev_b32 v38, 16, v38
  v_cvt_pk_bf16_f32 v39, v39, v39
  v_lshlrev_b32 v39, 16, v39
  v_cvt_pk_bf16_f32 v40, v40, v40
  v_lshlrev_b32 v40, 16, v40
  v_cvt_pk_bf16_f32 v41, v41, v41
  v_lshlrev_b32 v41, 16, v41
  v_cvt_pk_bf16_f32 v42, v42, v42
  v_lshlrev_b32 v42, 16, v42
  v_cvt_pk_bf16_f32 v43, v43, v43
  v_lshlrev_b32 v43, 16, v43
  v_cvt_pk_bf16_f32 v44, v44, v44
  v_lshlrev_b32 v44, 16, v44
  v_cvt_pk_bf16_f32 v45, v45, v45
  v_lshlrev_b32 v45, 16, v45
  v_cvt_pk_bf16_f32 v46, v46, v46
  v_lshlrev_b32 v46, 16, v46
  v_cvt_pk_bf16_f32 v47, v47, v47
  v_lshlrev_b32 v47, 16, v47
  v_lshlrev_b32 v20, 16, v48
  v_and_b32 v21, 0xffff0000, v48
  v_lshlrev_b32 v22, 16, v49
  v_and_b32 v23, 0xffff0000, v49
  v_lshlrev_b32 v24, 16, v50
  v_and_b32 v25, 0xffff0000, v50
  v_lshlrev_b32 v26, 16, v51
  v_and_b32 v27, 0xffff0000, v51
  v_lshlrev_b32 v28, 16, v52
  v_and_b32 v29, 0xffff0000, v52
  v_lshlrev_b32 v30, 16, v53
  v_and_b32 v31, 0xffff0000, v53
  v_add_f32 v36, v36, v20
  v_add_f32 v37, v37, v21
  v_add_f32 v38, v38, v22
  v_add_f32 v39, v39, v23
  v_add_f32 v40, v40, v24
  v_add_f32 v41, v41, v25
  v_add_f32 v42, v42, v26
  v_add_f32 v43, v43, v27
  v_add_f32 v44, v44, v28
  v_add_f32 v45, v45, v29
  v_add_f32 v46, v46, v30
  v_add_f32 v47, v47, v31
  v_cvt_pk_bf16_f32 v36, v36, v36
  v_lshlrev_b32 v36, 16, v36
  v_cvt_pk_bf16_f32 v37, v37, v37
  v_lshlrev_b32 v37, 16, v37
  v_cvt_pk_bf16_f32 v38, v38, v38
  v_lshlrev_b32 v38, 16, v38
  v_cvt_pk_bf16_f32 v39, v39, v39
  v_lshlrev_b32 v39, 16, v39
  v_cvt_pk_bf16_f32 v40, v40, v40
  v_lshlrev_b32 v40, 16, v40
  v_cvt_pk_bf16_f32 v41, v41, v41
  v_lshlrev_b32 v41, 16, v41
  v_cvt_pk_bf16_f32 v42, v42, v42
  v_lshlrev_b32 v42, 16, v42
  v_cvt_pk_bf16_f32 v43, v43, v43
  v_lshlrev_b32 v43, 16, v43
  v_cvt_pk_bf16_f32 v44, v44, v44
  v_lshlrev_b32 v44, 16, v44
  v_cvt_pk_bf16_f32 v45, v45, v45
  v_lshlrev_b32 v45, 16, v45
  v_cvt_pk_bf16_f32 v46, v46, v46
  v_lshlrev_b32 v46, 16, v46
  v_cvt_pk_bf16_f32 v47, v47, v47
  v_lshlrev_b32 v47, 16, v47
  v_lshlrev_b32 v20, 16, v54
  v_and_b32 v21, 0xffff0000, v54
  v_lshlrev_b32 v22, 16, v55
  v_and_b32 v23, 0xffff0000, v55
  v_lshlrev_b32 v24, 16, v56
  v_and_b32 v25, 0xffff0000, v56
  v_lshlrev_b32 v26, 16, v57
  v_and_b32 v27, 0xffff0000, v57
  v_lshlrev_b32 v28, 16, v58
  v_and_b32 v29, 0xffff0000, v58
  v_lshlrev_b32 v30, 16, v59
  v_and_b32 v31, 0xffff0000, v59
  v_add_f32 v36, v36, v20
  v_add_f32 v37, v37, v21
  v_add_f32 v38, v38, v22
  v_add_f32 v39, v39, v23
  v_add_f32 v40, v40, v24
  v_add_f32 v41, v41, v25
  v_add_f32 v42, v42, v26
  v_add_f32 v43, v43, v27
  v_add_f32 v44, v44, v28
  v_add_f32 v45, v45, v29
  v_add_f32 v46, v46, v30
  v_add_f32 v47, v47, v31
  v_cvt_pk_bf16_f32 v20, v36, v37
  v_cvt_pk_bf16_f32 v21, v38, v39
  buffer_store_dwordx2 v[20:21], v7, s[48:51], s45 offen
  v_cvt_pk_bf16_f32 v22, v40, v41
  v_cvt_pk_bf16_f32 v23, v42, v43
  buffer_store_dwordx2 v[22:23], v8, s[48:51], s45 offen
  v_cvt_pk_bf16_f32 v24, v44, v45
  v_cvt_pk_bf16_f32 v25, v46, v47
  buffer_store_dwordx2 v[24:25], v9, s[48:51], s45 offen
  s_add_u32 s47, s47, 104
  s_cmp_lt_u32 s47, 2048
  s_cbranch_scc1 L_r8_top_143
  s_waitcnt vmcnt(0)
  s_endpgm
L_fail:
  s_mov_b64 exec, 1
  v_mov_b32 v1, 0
  v_mov_b32 v2, 0xdead
  s_mov_b32 s24, 0xe90fff0
  buffer_store_dword v2, v1, s[4:7], s24 offen sc1
L_end:
  s_endpgm
.section .rodata,"a"
.p2align 6
.amdhsa_kernel sequential_preLN__memory_aug_recurrent_mem_tr__mixer_s_mlp__prompt_kernel
  .amdhsa_next_free_vgpr 512
  .amdhsa_next_free_sgpr 102
  .amdhsa_accum_offset 256
  .amdhsa_group_segment_fixed_size 0
  .amdhsa_kernarg_size 120
  .amdhsa_user_sgpr_count 2
  .amdhsa_user_sgpr_kernarg_segment_ptr 1
  .amdhsa_system_sgpr_workgroup_id_x 1
.end_amdhsa_kernel
```
